```python
import torch

def _softmax(x, axis=-1):
    return torch.softmax(x, dim=axis)
def _gelu(x):
    return torch.nn.functional.gelu(x, approximate="tanh")
def _silu(x):
    return torch.nn.functional.silu(x)
def _sigmoid(x):
    return torch.sigmoid(x)
def _layernorm(x, axis=-1, eps=1e-5):
    m = x.mean(dim=axis, keepdim=True)
    v = x.var(dim=axis, keepdim=True, unbiased=False)
    return (x - m) / torch.sqrt(v + eps)
def _scatter_add(tgt, idx, src, axis=0):
    return tgt.clone().index_add_(axis, idx, src)
def _segment_sum(src, seg, n):
    out = torch.zeros((n,) + src.shape[1:], dtype=src.dtype)
    return out.index_add_(0, seg, src)
def _pad(x, pw):
    flat = tuple(v for pair in reversed(pw) for v in pair)
    return torch.nn.functional.pad(x, flat)

kernel_name = 'sequential_preLN__compressed_kv_cla__glu_gated_bilinear__prompt'

def setup_inputs():

    _w = (lambda a: (lambda t: t.to(torch.bfloat16) if t.is_floating_point() else t)(torch.as_tensor(a)))
    def _A_setup():
        B, H, Sq, Sk, D, M = 1, 16, 2048, 2048, 256, 448
        Dc = 4 * D
        return {
            "x": _w((lambda *s: torch.randn(*s, dtype=torch.bfloat16) * 0.05)(B, Sq, M)),
            "c_kv": _w((lambda *s: torch.randn(*s, dtype=torch.bfloat16) * 0.4)(B, Sk, Dc)),
            "w_q": _w((lambda *s: torch.randn(*s, dtype=torch.bfloat16) * 1.6)(M, H, D) * (M ** -0.5)),
            "w_uk": _w((lambda *s: torch.randn(*s, dtype=torch.bfloat16) * 1.6)(Dc, H, D) * (Dc ** -0.5)),
            "w_uv": _w((lambda *s: torch.randn(*s, dtype=torch.bfloat16) * 0.4)(Dc, H, D) * (Dc ** -0.5)),
            "w_o": _w((lambda *s: torch.randn(*s, dtype=torch.bfloat16) * 0.4)(H, D, M) * ((H * D) ** -0.5)),
        }
    _A_in = _A_setup()

    def _B_setup():
        B, S, D, F = 1, 2048, 448, 1792
        return {
            "x": _w((lambda *s: torch.randn(*s, dtype=torch.bfloat16) * 0.05)(B, S, D)),
            "w_gate": _w((lambda *s: torch.randn(*s, dtype=torch.bfloat16) * 0.4)(D, F) * (D ** -0.5)),
            "w_up": _w((lambda *s: torch.randn(*s, dtype=torch.bfloat16) * 0.4)(D, F) * (D ** -0.5)),
            "w_down": _w((lambda *s: torch.randn(*s, dtype=torch.bfloat16) * 0.4)(F, D) * (F ** -0.5)),
        }
    _B_in = _B_setup()

    return {
        "A_x": _A_in["x"],
        "A_c_kv": _A_in["c_kv"],
        "A_w_q": _A_in["w_q"],
        "A_w_uk": _A_in["w_uk"],
        "A_w_uv": _A_in["w_uv"],
        "A_w_o": _A_in["w_o"],
        "B_x": _B_in["x"],
        "B_w_gate": _B_in["w_gate"],
        "B_w_up": _B_in["w_up"],
        "B_w_down": _B_in["w_down"],
    }

def reference(A_x, A_c_kv, A_w_q, A_w_uk, A_w_uv, A_w_o, B_x, B_w_gate, B_w_up, B_w_down):
    def _A_ref(x, c_kv, w_q, w_uk, w_uv, w_o):
        B, Sq, M = x.shape[0], x.shape[1], x.shape[2]
        Sk = c_kv.shape[1]
        H, D = w_q.shape[1], w_q.shape[2]
        q = torch.einsum("bqm,mhd->bhqd", x, w_q)
        k = torch.einsum("bkc,chd->bhkd", c_kv, w_uk)
        v = torch.einsum("bkc,chd->bhkd", c_kv, w_uv)
        scores = torch.einsum("bhqd,bhkd->bhqk", q, k) * (D ** -0.5)
        off = Sk - Sq
        qi = torch.arange(Sq)[:, None]
        kj = torch.arange(Sk)[None, :]
        cmask = kj <= (qi + off)
        scores = torch.where(cmask[None, None], scores, -1e9)
        p = _softmax(scores, axis=-1)
        ctx = torch.einsum("bhqk,bhkd->bhqd", p, v)
        return torch.einsum("bhqd,hdm->bqm", ctx, w_o)

    def _B_ref(x, w_gate, w_up, w_down):
        g = torch.einsum("bsd,df->bsf", x, w_gate)
        u = torch.einsum("bsd,df->bsf", x, w_up)
        h = g * u
        return torch.einsum("bsf,fd->bsd", h, w_down)

    x = A_x
    h = x + _A_ref(_layernorm(x, axis=-1), A_c_kv, A_w_q, A_w_uk, A_w_uv, A_w_o)
    h2 = h + _B_ref(_layernorm(h, axis=-1), B_w_gate, B_w_up, B_w_down)
    return h2
```

```asm
; @launch grid=(256,1,1) block=(256,1,1) lds=163840
.amdgcn_target "amdgcn-amd-amdhsa--gfx950"
.text
.globl sequential_preLN__compressed_kv_cla__glu_gated_bilinear__prompt_kernel
.type sequential_preLN__compressed_kv_cla__glu_gated_bilinear__prompt_kernel,@function
.p2align 8
sequential_preLN__compressed_kv_cla__glu_gated_bilinear__prompt_kernel:
    s_cmp_ge_u32 s2, 256
    s_cbranch_scc1 L_done
    s_load_dwordx8 s[4:11], s[0:1], 0
    s_load_dwordx2 s[12:13], s[0:1], 32
    s_load_dwordx2 s[14:15], s[0:1], 96
    s_getpc_b64 s[64:65]
    s_add_u32 s64, s64, sequential_preLN__compressed_kv_cla__glu_gated_bilinear__prompt_kernel@rel32@lo+4
    s_addc_u32 s65, s65, sequential_preLN__compressed_kv_cla__glu_gated_bilinear__prompt_kernel@rel32@hi+12
    s_mov_b32 s66, L1_epi-sequential_preLN__compressed_kv_cla__glu_gated_bilinear__prompt_kernel
    s_mov_b32 s67, 0x20000
    v_lshlrev_b32 v30, 6, v0
    buffer_load_dword v224, v30, s[64:67], 0 offen
    v_add_u32 v30, 0x4000, v30
    buffer_load_dword v224, v30, s[64:67], 0 offen
    s_getpc_b64 s[64:65]
    s_add_u32 s64, s64, L_done@rel32@lo+4
    s_addc_u32 s65, s65, L_done@rel32@hi+12
    s_mov_b32 s66, L_hot_end-L_done
    s_mov_b32 s67, 0x20000
    v_lshlrev_b32 v30, 6, v0
    buffer_load_dword v224, v30, s[64:67], 0 offen
    s_getpc_b64 s[64:65]
    s_add_u32 s64, s64, L1_epi@rel32@lo+4
    s_addc_u32 s65, s65, L1_epi@rel32@hi+12
    s_mul_i32 s3, s2, (((L_hot_end-L1_epi)/256+63)&~63)
    s_add_u32 s64, s64, s3
    s_addc_u32 s65, s65, 0
    s_sub_u32 s66, L_hot_end-L1_epi, s3
    s_cselect_b32 s66, 0, s66
    s_min_u32 s66, s66, (((L_hot_end-L1_epi)/256+63)&~63)
    s_mov_b32 s67, 0x20000
    v_lshlrev_b32 v30, 6, v0
    buffer_load_dword v224, v30, s[64:67], 0 offen
    v_and_b32 v22, 63, v0
    v_lshrrev_b32 v23, 6, v0
    v_lshlrev_b32 v1, 4, v22
    v_readfirstlane_b32 s32, v23
    v_and_b32 v24, 15, v22
    v_lshrrev_b32 v25, 4, v22
    s_and_b32 s3, s2, 7
    s_lshr_b32 s33, s2, 3
    s_and_b32 s36, s33, 7
    s_lshr_b32 s34, s33, 3
    s_and_b32 s35, s34, 1
    s_lshl_b32 s3, s3, 1
    s_add_u32 s35, s35, s3
    s_lshr_b32 s37, s34, 1
    s_and_b32 s38, s33, 1
    s_add_u32 s38, s38, s3
    s_lshr_b32 s39, s33, 2
    s_sub_u32 s40, 15, s39
    s_bitcmp1_b32 s33, 1
    s_cselect_b32 s39, s39, s40
    s_and_b32 s33, s32, 1
    s_lshr_b32 s34, s32, 1
    v_lshrrev_b32 v26, 3, v22
    s_lshl_b32 s40, s32, 6
    v_add_u32 v26, s40, v26
    v_lshlrev_b32 v26, 11, v26
    v_and_b32 v27, 7, v22
    v_xor_b32 v27, v27, v25
    v_xor_b32 v28, 4, v27
    v_lshl_add_u32 v27, v27, 4, v26
    v_lshl_add_u32 v28, v28, 4, v26
    v_add_u32 v12, 0, v27
    v_add_u32 v13, 15360, v28
    v_add_u32 v14, 30720, v27
    v_add_u32 v15, 46080, v28
    v_lshrrev_b32 v26, 5, v22
    v_and_b32 v27, 31, v22
    s_lshl_b32 s40, s33, 3
    v_lshlrev_b32 v28, 1, v26
    v_xor_b32 v27, v27, v28
    v_xor_b32 v27, s40, v27
    s_lshl_b32 s40, s32, 3
    v_add_u32 v26, s40, v26
    v_lshlrev_b32 v26, 13, v26
    v_xor_b32 v28, 4, v27
    v_lshl_add_u32 v27, v27, 4, v26
    v_lshl_add_u32 v28, v28, 4, v26
    v_add_u32 v16, 0, v27
    v_add_u32 v17, 15360, v28
    v_add_u32 v18, 30720, v27
    v_add_u32 v19, 46080, v28
    s_lshl_b32 s24, s32, 12
    s_add_u32 s25, s24, 16384
    s_add_u32 s26, s24, 32768
    s_add_u32 s27, s24, 49152
    s_lshl_b32 s53, s32, 13
    s_add_u32 s53, s53, 65536
    s_lshl_b32 s40, s36, 19
    s_lshl_b32 s42, s35, 9
    s_cmp_eq_u32 s37, 1
    s_waitcnt lgkmcnt(0)
    s_cselect_b32 s48, s12, s10
    s_cselect_b32 s49, s13, s11
    s_add_u32 s16, s6, s40
    s_addc_u32 s17, s7, 0
    s_mov_b32 s18, 0x80000
    s_mov_b32 s19, 0x20000
    s_add_u32 s20, s48, s42
    s_addc_u32 s21, s49, 0
    s_sub_u32 s22, 8388608, s42
    s_mov_b32 s23, 0x20000
    s_mov_b32 s40, 0
    s_mov_b32 s41, 65536
    s_mov_b32 s42, 0
    s_add_u32 s28, s14, 0x7800000
    s_addc_u32 s29, s15, 0
    s_mov_b32 s30, 0x40080
    s_mov_b32 s31, 0x20000
    v_mov_b32 v29, 0x40000
    buffer_load_dword v240, v29, s[28:31], 0 offen
    s_lshl_b32 s3, s2, 3
    s_lshl_b32 s43, s32, 1
    s_add_u32 s3, s3, s43
    s_mul_i32 s3, s3, 896
    s_add_u32 s44, s4, s3
    s_addc_u32 s45, s5, 0
    s_movk_i32 s46, 896
    s_mov_b32 s47, 0x20000
    buffer_load_dwordx4 v[232:235], v1, s[44:47], 0 offen
    s_add_u32 s44, s44, 896
    s_addc_u32 s45, s45, 0
    buffer_load_dwordx4 v[236:239], v1, s[44:47], 0 offen
    s_mov_b32 m0, s53
    s_nop 0
    buffer_load_dwordx4 v12, s[16:19], s40 offen offset:0 lds
    buffer_load_dwordx4 v13, s[16:19], s40 offen offset:1024 lds
    buffer_load_dwordx4 v14, s[16:19], s40 offen offset:2048 lds
    buffer_load_dwordx4 v15, s[16:19], s40 offen offset:3072 lds
    s_lshl_b32 s3, s38, 9
    s_add_u32 s56, s8, s3
    s_addc_u32 s57, s9, 0
    s_sub_u32 s58, 3670016, s3
    v_lshrrev_b32 v26, 2, v24
    v_lshl_add_u32 v27, v25, 3, v26
    v_lshlrev_b32 v27, 9, v27
    v_and_b32 v28, 3, v24
    s_mov_b32 m0, s24
    s_nop 0
    buffer_load_dwordx4 v16, s[20:23], s42 offen offset:0 lds
    v_lshl_add_u32 v27, v28, 3, v27
    s_lshl_b32 s3, s34, 8
    v_add_u32 v27, s3, v27
    v_and_b32 v28, 1, v25
    v_lshl_add_u32 v28, v28, 2, v26
    v_xor_b32 v29, 0, v28
    v_lshl_add_u32 v2, v29, 5, v27
    buffer_load_dwordx4 v17, s[20:23], s42 offen offset:1024 lds
    v_xor_b32 v29, 1, v28
    v_lshl_add_u32 v3, v29, 5, v27
    v_xor_b32 v29, 2, v28
    v_lshl_add_u32 v4, v29, 5, v27
    v_xor_b32 v29, 3, v28
    v_lshl_add_u32 v5, v29, 5, v27
    v_xor_b32 v29, 4, v28
    buffer_load_dwordx4 v18, s[20:23], s42 offen offset:2048 lds
    v_lshl_add_u32 v6, v29, 5, v27
    v_xor_b32 v29, 5, v28
    v_lshl_add_u32 v7, v29, 5, v27
    v_xor_b32 v29, 6, v28
    v_lshl_add_u32 v8, v29, 5, v27
    v_xor_b32 v29, 7, v28
    v_lshl_add_u32 v9, v29, 5, v27
    buffer_load_dwordx4 v19, s[20:23], s42 offen offset:3072 lds
    s_add_u32 s42, s42, 262144
    s_lshl_b32 s3, s33, 7
    v_add_u32 v26, s3, v24
    v_lshlrev_b32 v26, 7, v26
    v_add_u32 v26, 65536, v26
    v_lshrrev_b32 v27, 1, v24
    v_xor_b32 v27, v27, v25
    v_xor_b32 v28, 4, v27
    v_lshl_add_u32 v10, v27, 4, v26
    s_add_u32 m0, s53, 4096
    s_nop 0
    buffer_load_dwordx4 v12, s[16:19], s41 offen offset:0 lds
    v_lshl_add_u32 v11, v28, 4, v26
    s_mov_b32 s68, s8
    s_mov_b32 s69, s9
    s_mov_b32 s70, 3670016
    s_mov_b32 s71, 0x20000
    s_mov_b32 s59, 0
    s_sub_u32 s59, s2, s59
    buffer_load_dwordx4 v13, s[16:19], s41 offen offset:1024 lds
    s_mul_i32 s59, s59, 16384
    s_add_u32 s68, s68, s59
    s_addc_u32 s69, s69, 0
    s_sub_u32 s70, s70, s59
    s_cselect_b32 s70, 0, s70
    s_min_u32 s70, s70, 16384
    v_lshlrev_b32 v23, 4, v0
    buffer_load_dwordx4 v14, s[16:19], s41 offen offset:2048 lds
    s_mov_b32 s59, 0
    s_mov_b32 s72, s14
    s_mov_b32 s73, s15
    s_mov_b32 s74, 0x3000000
    s_mov_b32 s75, 0x20000
    s_lshr_b32 s3, s2, 1
    s_mul_i32 s3, s3, 14336
    buffer_load_dwordx4 v15, s[16:19], s41 offen offset:3072 lds
    s_add_u32 s40, s40, 128
    s_add_u32 s41, s41, 128
    s_add_u32 s53, s53, 32768
    s_add_u32 s3, s3, 0x7000000
    s_add_u32 s44, s14, s3
    s_addc_u32 s45, s15, 0
    s_movk_i32 s46, 14336
    s_lshl_b32 s3, s32, 5
    s_add_u32 s3, s3, 131072
    v_lshlrev_b32 v20, 7, v22
    v_add_u32 v20, s3, v20
    s_mov_b32 m0, s25
    s_nop 0
    buffer_load_dwordx4 v16, s[20:23], s42 offen offset:0 lds
    v_lshlrev_b32 v241, 4, v0
    v_add_u32 v241, 131072, v241
    v_lshrrev_b32 v242, 3, v0
    v_and_b32 v243, 7, v0
    v_lshlrev_b32 v243, 4, v243
    v_lshl_add_u32 v242, v242, 8, v243
    s_and_b32 s48, s2, 1
    buffer_load_dwordx4 v17, s[20:23], s42 offen offset:1024 lds
    s_lshl_b32 s48, s48, 7
    v_add_u32 v243, 0x2000, v242
    v_mov_b64 v[96:97], 0
    v_mov_b64 v[98:99], 0
    s_nop 1
    v_mfma_f32_32x32x16_bf16 a[0:15], v[96:99], v[96:99], 0
    v_mfma_f32_32x32x16_bf16 a[16:31], v[96:99], v[96:99], 0
    buffer_load_dwordx4 v18, s[20:23], s42 offen offset:2048 lds
    v_mfma_f32_32x32x16_bf16 a[32:47], v[96:99], v[96:99], 0
    v_mfma_f32_32x32x16_bf16 a[48:63], v[96:99], v[96:99], 0
    v_mfma_f32_32x32x16_bf16 a[64:79], v[96:99], v[96:99], 0
    v_mfma_f32_32x32x16_bf16 a[80:95], v[96:99], v[96:99], 0
    v_mfma_f32_32x32x16_bf16 a[96:111], v[96:99], v[96:99], 0
    v_mfma_f32_32x32x16_bf16 a[112:127], v[96:99], v[96:99], 0
    v_mfma_f32_32x32x16_bf16 a[128:143], v[96:99], v[96:99], 0
    buffer_load_dwordx4 v19, s[20:23], s42 offen offset:3072 lds
    s_add_u32 s42, s42, 262144
    v_mfma_f32_32x32x16_bf16 a[144:159], v[96:99], v[96:99], 0
    v_mfma_f32_32x32x16_bf16 a[160:175], v[96:99], v[96:99], 0
    v_mfma_f32_32x32x16_bf16 a[176:191], v[96:99], v[96:99], 0
    v_mfma_f32_32x32x16_bf16 a[192:207], v[96:99], v[96:99], 0
    v_mfma_f32_32x32x16_bf16 a[208:223], v[96:99], v[96:99], 0
    v_mfma_f32_32x32x16_bf16 a[224:239], v[96:99], v[96:99], 0
    v_mfma_f32_32x32x16_bf16 a[240:255], v[96:99], v[96:99], 0
    s_waitcnt vmcnt(16)
    s_mov_b32 m0, s53
    s_nop 0
    buffer_load_dwordx4 v12, s[16:19], s40 offen offset:0 lds
    buffer_load_dwordx4 v13, s[16:19], s40 offen offset:1024 lds
    v_add_u32 v240, 1, v240
    v_or_b32 v31, 0x80000000, v240
    v_mov_b32 v21, 0x3f803f80
    v_readfirstlane_b32 s7, v31
    v_mov_b32 v24, 0
    v_mov_b32 v25, 0
    v_mov_b32 v26, 0
    v_mov_b32 v27, 0
    v_dot2c_f32_bf16 v24, v232, v21
    v_dot2c_f32_bf16 v26, v232, v232
    buffer_load_dwordx4 v14, s[16:19], s40 offen offset:2048 lds
    v_dot2c_f32_bf16 v25, v236, v21
    v_dot2c_f32_bf16 v27, v236, v236
    v_dot2c_f32_bf16 v24, v233, v21
    v_dot2c_f32_bf16 v26, v233, v233
    v_dot2c_f32_bf16 v25, v237, v21
    v_dot2c_f32_bf16 v27, v237, v237
    v_dot2c_f32_bf16 v24, v234, v21
    v_dot2c_f32_bf16 v26, v234, v234
    v_dot2c_f32_bf16 v25, v238, v21
    buffer_load_dwordx4 v15, s[16:19], s40 offen offset:3072 lds
    v_dot2c_f32_bf16 v27, v238, v238
    v_dot2c_f32_bf16 v24, v235, v21
    v_dot2c_f32_bf16 v26, v235, v235
    v_dot2c_f32_bf16 v25, v239, v21
    v_dot2c_f32_bf16 v27, v239, v239
    s_nop 2
    v_add_f32_dpp v24, v24, v24 row_ror:8 row_mask:0xf bank_mask:0xf
    v_add_f32_dpp v25, v25, v25 row_ror:8 row_mask:0xf bank_mask:0xf
    v_add_f32_dpp v26, v26, v26 row_ror:8 row_mask:0xf bank_mask:0xf
    v_add_f32_dpp v27, v27, v27 row_ror:8 row_mask:0xf bank_mask:0xf
    s_mov_b32 m0, s26
    s_nop 0
    buffer_load_dwordx4 v16, s[20:23], s42 offen offset:0 lds
    v_add_f32_dpp v24, v24, v24 row_ror:4 row_mask:0xf bank_mask:0xf
    v_add_f32_dpp v25, v25, v25 row_ror:4 row_mask:0xf bank_mask:0xf
    v_add_f32_dpp v26, v26, v26 row_ror:4 row_mask:0xf bank_mask:0xf
    v_add_f32_dpp v27, v27, v27 row_ror:4 row_mask:0xf bank_mask:0xf
    v_add_f32_dpp v24, v24, v24 row_ror:2 row_mask:0xf bank_mask:0xf
    v_add_f32_dpp v25, v25, v25 row_ror:2 row_mask:0xf bank_mask:0xf
    v_add_f32_dpp v26, v26, v26 row_ror:2 row_mask:0xf bank_mask:0xf
    v_add_f32_dpp v27, v27, v27 row_ror:2 row_mask:0xf bank_mask:0xf
    v_add_f32_dpp v24, v24, v24 row_ror:1 row_mask:0xf bank_mask:0xf
    buffer_load_dwordx4 v17, s[20:23], s42 offen offset:1024 lds
    v_add_f32_dpp v25, v25, v25 row_ror:1 row_mask:0xf bank_mask:0xf
    v_add_f32_dpp v26, v26, v26 row_ror:1 row_mask:0xf bank_mask:0xf
    v_add_f32_dpp v27, v27, v27 row_ror:1 row_mask:0xf bank_mask:0xf
    v_mov_b32 v244, v24
    v_mov_b32 v245, v25
    v_mov_b32 v246, v26
    v_mov_b32 v247, v27
    v_permlane32_swap_b32 v24, v244
    v_permlane32_swap_b32 v25, v245
    buffer_load_dwordx4 v18, s[20:23], s42 offen offset:2048 lds
    v_permlane32_swap_b32 v26, v246
    v_permlane32_swap_b32 v27, v247
    v_add_f32 v24, v24, v244
    v_add_f32 v25, v25, v245
    v_add_f32 v26, v26, v246
    v_add_f32 v27, v27, v247
    v_mov_b32 v244, v24
    v_mov_b32 v245, v25
    v_mov_b32 v246, v26
    v_mov_b32 v247, v27
    buffer_load_dwordx4 v19, s[20:23], s42 offen offset:3072 lds
    s_add_u32 s42, s42, 262144
    v_permlane16_swap_b32 v24, v244
    v_permlane16_swap_b32 v25, v245
    v_permlane16_swap_b32 v26, v246
    v_permlane16_swap_b32 v27, v247
    v_add_f32 v24, v24, v244
    v_add_f32 v25, v25, v245
    v_add_f32 v26, v26, v246
    v_add_f32 v27, v27, v247
    s_mov_b32 s3, 0x3b124925
    s_add_u32 m0, s53, 4096
    s_nop 0
    buffer_load_dwordx4 v12, s[16:19], s41 offen offset:0 lds
    s_mov_b32 s62, 0x3727c5ac
    s_mov_b32 s63, 0x3db8aa3b
    v_mul_f32 v24, s3, v24
    v_mul_f32 v26, s3, v26
    v_fma_f32 v26, -v24, v24, v26
    v_max_f32 v26, 0, v26
    v_add_f32 v26, s62, v26
    v_rsq_f32 v26, v26
    s_nop 0
    v_mul_f32 v26, s63, v26
    buffer_load_dwordx4 v13, s[16:19], s41 offen offset:1024 lds
    v_mul_f32 v24, -v24, v26
    v_mul_f32 v25, s3, v25
    v_mul_f32 v27, s3, v27
    v_fma_f32 v27, -v25, v25, v27
    v_max_f32 v27, 0, v27
    v_add_f32 v27, s62, v27
    v_rsq_f32 v27, v27
    s_nop 0
    v_mul_f32 v27, s63, v27
    buffer_load_dwordx4 v14, s[16:19], s41 offen offset:2048 lds
    v_mul_f32 v25, -v25, v27
    s_mov_b32 s3, 0xffff0000
    v_lshlrev_b32 v244, 16, v232
    v_and_b32 v245, s3, v232
    v_fma_f32 v244, v244, v26, v24
    v_fma_f32 v245, v245, v26, v24
    v_cvt_pk_bf16_f32 v232, v244, v245
    v_lshlrev_b32 v246, 16, v233
    v_and_b32 v247, s3, v233
    buffer_load_dwordx4 v15, s[16:19], s41 offen offset:3072 lds
    s_add_u32 s40, s40, 128
    s_add_u32 s41, s41, 128
    s_add_u32 s53, s53, 32768
    v_fma_f32 v246, v246, v26, v24
    v_fma_f32 v247, v247, v26, v24
    v_cvt_pk_bf16_f32 v233, v246, v247
    v_lshlrev_b32 v244, 16, v234
    v_and_b32 v245, s3, v234
    v_fma_f32 v244, v244, v26, v24
    v_fma_f32 v245, v245, v26, v24
    v_cvt_pk_bf16_f32 v234, v244, v245
    v_lshlrev_b32 v246, 16, v235
    v_and_b32 v247, s3, v235
    s_mov_b32 m0, s27
    s_nop 0
    buffer_load_dwordx4 v16, s[20:23], s42 offen offset:0 lds
    v_fma_f32 v246, v246, v26, v24
    v_fma_f32 v247, v247, v26, v24
    v_cvt_pk_bf16_f32 v235, v246, v247
    ds_write_b128 v20, v[232:235] offset:0
    v_lshlrev_b32 v244, 16, v236
    v_and_b32 v245, s3, v236
    v_fma_f32 v244, v244, v27, v25
    v_fma_f32 v245, v245, v27, v25
    v_cvt_pk_bf16_f32 v236, v244, v245
    buffer_load_dwordx4 v17, s[20:23], s42 offen offset:1024 lds
    v_lshlrev_b32 v246, 16, v237
    v_and_b32 v247, s3, v237
    v_fma_f32 v246, v246, v27, v25
    v_fma_f32 v247, v247, v27, v25
    v_cvt_pk_bf16_f32 v237, v246, v247
    v_lshlrev_b32 v244, 16, v238
    v_and_b32 v245, s3, v238
    v_fma_f32 v244, v244, v27, v25
    v_fma_f32 v245, v245, v27, v25
    v_cvt_pk_bf16_f32 v238, v244, v245
    buffer_load_dwordx4 v18, s[20:23], s42 offen offset:2048 lds
    v_lshlrev_b32 v246, 16, v239
    v_and_b32 v247, s3, v239
    v_fma_f32 v246, v246, v27, v25
    v_fma_f32 v247, v247, v27, v25
    v_cvt_pk_bf16_f32 v239, v246, v247
    ds_write_b128 v20, v[236:239] offset:16
    s_lshl_b32 s3, s36, 4
    s_lshl_b32 s49, s32, 2
    s_add_u32 s3, s3, s49
    buffer_load_dwordx4 v19, s[20:23], s42 offen offset:3072 lds
    s_add_u32 s42, s42, 262144
    v_lshrrev_b32 v248, 2, v22
    v_add_u32 v248, s3, v248
    v_lshlrev_b32 v248, 13, v248
    v_and_b32 v249, 3, v22
    v_lshl_add_u32 v248, v249, 7, v248
    v_cmp_gt_u32 vcc, 16, v22
    v_mov_b32 v249, 0x7f000000
    s_mov_b32 s49, 0x100000
    v_cndmask_b32 v248, v249, v248, vcc
    buffer_load_dword v224, v23, s[68:71], s59 offen
    s_add_u32 s59, s59, 4096
    s_mov_b32 s55, s53
    s_sub_u32 s54, s53, 65536
    s_mov_b32 s60, 32768
    s_mov_b32 s61, -65536
    s_waitcnt vmcnt(21) lgkmcnt(0)
    s_barrier
    ds_read_b128 v[232:235], v241
    ds_read_b128 v[236:239], v241 offset:4096
    ds_read_b64_tr_b16 v[32:33], v2 offset:0
    ds_read_b64_tr_b16 v[34:35], v2 offset:2048
    ds_read_b64_tr_b16 v[36:37], v3 offset:0
    ds_read_b64_tr_b16 v[38:39], v3 offset:2048
    ds_read_b64_tr_b16 v[40:41], v4 offset:0
    ds_read_b64_tr_b16 v[42:43], v4 offset:2048
    ds_read_b64_tr_b16 v[44:45], v5 offset:0
    ds_read_b64_tr_b16 v[46:47], v5 offset:2048
    ds_read_b64_tr_b16 v[48:49], v6 offset:0
    ds_read_b64_tr_b16 v[50:51], v6 offset:2048
    ds_read_b64_tr_b16 v[52:53], v7 offset:0
    ds_read_b64_tr_b16 v[54:55], v7 offset:2048
    ds_read_b64_tr_b16 v[56:57], v8 offset:0
    ds_read_b64_tr_b16 v[58:59], v8 offset:2048
    ds_read_b64_tr_b16 v[60:61], v9 offset:0
    ds_read_b64_tr_b16 v[62:63], v9 offset:2048
    ds_read_b128 v[96:99], v10 offset:0
    ds_read_b128 v[100:103], v10 offset:2048
    s_add_u32 s3, s2, 1280
    s_lshl_b32 s3, s3, 7
    s_lshl_b32 s43, s32, 2
    s_add_u32 s3, s3, s43
    v_mov_b32 v30, s3
    v_lshrrev_b32 v29, 2, v22
    v_and_b32 v28, 3, v22
    v_lshlrev_b32 v28, 2, v28
    v_lshl_add_u32 v29, v29, 7, v28
    s_lshl_b32 s3, s39, 11
    s_add_u32 s3, s3, 163840
    v_add_u32 v29, s3, v29
    s_waitcnt lgkmcnt(15)
    buffer_store_dwordx4 v[232:235], v242, s[44:47], s48 offen sc1
    buffer_store_dwordx4 v[236:239], v243, s[44:47], s48 offen sc1
    s_lshl_b32 s3, s39, 3
    s_lshl_b32 s43, s32, 1
    s_add_u32 s3, s3, s43
    s_mul_i32 s3, s3, 14336
    s_add_u32 s3, s3, 0x7000000
    s_add_u32 s44, s14, s3
    s_addc_u32 s45, s15, 0
    s_movk_i32 s46, 28672
    s_mov_b32 s50, 7
    s_movk_i32 s51, 0x44
    s_cmp_eq_u32 s37, 1
    s_cbranch_scc1 L1_loopV
L1_loopK:
    s_waitcnt lgkmcnt(1)
    v_mfma_f32_16x16x32_bf16 a[0:3], v[32:35], v[96:99], a[0:3]
    s_waitcnt vmcnt(17)
    s_barrier
    v_mfma_f32_16x16x32_bf16 a[32:35], v[36:39], v[96:99], a[32:35]
    ds_read_b128 v[104:107], v10 offset:4096
    v_mfma_f32_16x16x32_bf16 a[4:7], v[40:43], v[96:99], a[4:7]
    ds_read_b64_tr_b16 v[64:65], v2 offset:16384
    v_mfma_f32_16x16x32_bf16 a[36:39], v[44:47], v[96:99], a[36:39]
    ds_read_b64_tr_b16 v[66:67], v2 offset:18432
    v_mfma_f32_16x16x32_bf16 a[8:11], v[48:51], v[96:99], a[8:11]
    ds_read_b64_tr_b16 v[68:69], v3 offset:16384
    s_mov_b32 m0, s53
    v_mfma_f32_16x16x32_bf16 a[40:43], v[52:55], v[96:99], a[40:43]
    buffer_load_dwordx4 v12, s[16:19], s40 offen offset:0 lds
    v_mfma_f32_16x16x32_bf16 a[12:15], v[56:59], v[96:99], a[12:15]
    v_mfma_f32_16x16x32_bf16 a[44:47], v[60:63], v[96:99], a[44:47]
    s_waitcnt lgkmcnt(4)
    v_mfma_f32_16x16x32_bf16 a[60:63], v[60:63], v[100:103], a[60:63]
    ds_read_b128 v[108:111], v10 offset:6144
    v_mfma_f32_16x16x32_bf16 a[28:31], v[56:59], v[100:103], a[28:31]
    ds_read_b64_tr_b16 v[70:71], v3 offset:18432
    v_mfma_f32_16x16x32_bf16 a[56:59], v[52:55], v[100:103], a[56:59]
    ds_read_b64_tr_b16 v[72:73], v4 offset:16384
    v_mfma_f32_16x16x32_bf16 a[24:27], v[48:51], v[100:103], a[24:27]
    ds_read_b64_tr_b16 v[74:75], v4 offset:18432
    v_mfma_f32_16x16x32_bf16 a[52:55], v[44:47], v[100:103], a[52:55]
    v_mfma_f32_16x16x32_bf16 a[20:23], v[40:43], v[100:103], a[20:23]
    buffer_load_dwordx4 v13, s[16:19], s40 offen offset:1024 lds
    v_mfma_f32_16x16x32_bf16 a[48:51], v[36:39], v[100:103], a[48:51]
    v_mfma_f32_16x16x32_bf16 a[16:19], v[32:35], v[100:103], a[16:19]
    s_waitcnt lgkmcnt(7)
    v_mfma_f32_16x16x32_bf16 a[64:67], v[32:35], v[104:107], a[64:67]
    ds_read_b128 v[96:99], v10 offset:8192
    v_mfma_f32_16x16x32_bf16 a[96:99], v[36:39], v[104:107], a[96:99]
    ds_read_b64_tr_b16 v[76:77], v5 offset:16384
    v_mfma_f32_16x16x32_bf16 a[68:71], v[40:43], v[104:107], a[68:71]
    ds_read_b64_tr_b16 v[78:79], v5 offset:18432
    v_mfma_f32_16x16x32_bf16 a[100:103], v[44:47], v[104:107], a[100:103]
    ds_read_b64_tr_b16 v[80:81], v6 offset:16384
    v_mfma_f32_16x16x32_bf16 a[72:75], v[48:51], v[104:107], a[72:75]
    v_mfma_f32_16x16x32_bf16 a[104:107], v[52:55], v[104:107], a[104:107]
    buffer_load_dwordx4 v14, s[16:19], s40 offen offset:2048 lds
    v_mfma_f32_16x16x32_bf16 a[76:79], v[56:59], v[104:107], a[76:79]
    v_mfma_f32_16x16x32_bf16 a[108:111], v[60:63], v[104:107], a[108:111]
    s_waitcnt lgkmcnt(7)
    v_mfma_f32_16x16x32_bf16 a[124:127], v[60:63], v[108:111], a[124:127]
    ds_read_b128 v[100:103], v10 offset:10240
    v_mfma_f32_16x16x32_bf16 a[92:95], v[56:59], v[108:111], a[92:95]
    ds_read_b64_tr_b16 v[82:83], v6 offset:18432
    v_mfma_f32_16x16x32_bf16 a[120:123], v[52:55], v[108:111], a[120:123]
    ds_read_b64_tr_b16 v[84:85], v7 offset:16384
    v_mfma_f32_16x16x32_bf16 a[88:91], v[48:51], v[108:111], a[88:91]
    ds_read_b64_tr_b16 v[86:87], v7 offset:18432
    v_mfma_f32_16x16x32_bf16 a[116:119], v[44:47], v[108:111], a[116:119]
    v_mfma_f32_16x16x32_bf16 a[84:87], v[40:43], v[108:111], a[84:87]
    buffer_load_dwordx4 v15, s[16:19], s40 offen offset:3072 lds
    v_mfma_f32_16x16x32_bf16 a[112:115], v[36:39], v[108:111], a[112:115]
    v_mfma_f32_16x16x32_bf16 a[80:83], v[32:35], v[108:111], a[80:83]
    s_waitcnt lgkmcnt(7)
    v_mfma_f32_16x16x32_bf16 a[128:131], v[32:35], v[96:99], a[128:131]
    ds_read_b128 v[104:107], v10 offset:12288
    v_mfma_f32_16x16x32_bf16 a[160:163], v[36:39], v[96:99], a[160:163]
    ds_read_b64_tr_b16 v[88:89], v8 offset:16384
    v_mfma_f32_16x16x32_bf16 a[132:135], v[40:43], v[96:99], a[132:135]
    ds_read_b64_tr_b16 v[90:91], v8 offset:18432
    s_mov_b32 m0, s24
    v_mfma_f32_16x16x32_bf16 a[164:167], v[44:47], v[96:99], a[164:167]
    v_mfma_f32_16x16x32_bf16 a[136:139], v[48:51], v[96:99], a[136:139]
    buffer_load_dwordx4 v16, s[20:23], s42 offen offset:0 lds
    v_mfma_f32_16x16x32_bf16 a[168:171], v[52:55], v[96:99], a[168:171]
    v_mfma_f32_16x16x32_bf16 a[140:143], v[56:59], v[96:99], a[140:143]
    v_mfma_f32_16x16x32_bf16 a[172:175], v[60:63], v[96:99], a[172:175]
    s_waitcnt lgkmcnt(6)
    v_mfma_f32_16x16x32_bf16 a[188:191], v[60:63], v[100:103], a[188:191]
    ds_read_b128 v[108:111], v10 offset:14336
    v_mfma_f32_16x16x32_bf16 a[156:159], v[56:59], v[100:103], a[156:159]
    ds_read_b64_tr_b16 v[92:93], v9 offset:16384
    v_mfma_f32_16x16x32_bf16 a[184:187], v[52:55], v[100:103], a[184:187]
    ds_read_b64_tr_b16 v[94:95], v9 offset:18432
    v_mfma_f32_16x16x32_bf16 a[152:155], v[48:51], v[100:103], a[152:155]
    v_mfma_f32_16x16x32_bf16 a[180:183], v[44:47], v[100:103], a[180:183]
    buffer_load_dwordx4 v17, s[20:23], s42 offen offset:1024 lds
    v_mfma_f32_16x16x32_bf16 a[148:151], v[40:43], v[100:103], a[148:151]
    v_mfma_f32_16x16x32_bf16 a[176:179], v[36:39], v[100:103], a[176:179]
    v_mfma_f32_16x16x32_bf16 a[144:147], v[32:35], v[100:103], a[144:147]
    s_cmp_eq_u32 s54, s55
    s_cselect_b32 s52, s61, s60
    s_waitcnt lgkmcnt(5)
    v_mfma_f32_16x16x32_bf16 a[192:195], v[32:35], v[104:107], a[192:195]
    ds_read_b128 v[96:99], v11 offset:0
    v_mfma_f32_16x16x32_bf16 a[224:227], v[36:39], v[104:107], a[224:227]
    v_mfma_f32_16x16x32_bf16 a[196:199], v[40:43], v[104:107], a[196:199]
    buffer_load_dwordx4 v18, s[20:23], s42 offen offset:2048 lds
    v_mfma_f32_16x16x32_bf16 a[228:231], v[44:47], v[104:107], a[228:231]
    v_mfma_f32_16x16x32_bf16 a[200:203], v[48:51], v[104:107], a[200:203]
    v_add_u32 v10, s52, v10
    v_mfma_f32_16x16x32_bf16 a[232:235], v[52:55], v[104:107], a[232:235]
    v_mfma_f32_16x16x32_bf16 a[204:207], v[56:59], v[104:107], a[204:207]
    v_mfma_f32_16x16x32_bf16 a[236:239], v[60:63], v[104:107], a[236:239]
    s_waitcnt lgkmcnt(3)
    v_mfma_f32_16x16x32_bf16 a[252:255], v[60:63], v[108:111], a[252:255]
    ds_read_b128 v[100:103], v11 offset:2048
    v_mfma_f32_16x16x32_bf16 a[220:223], v[56:59], v[108:111], a[220:223]
    v_mfma_f32_16x16x32_bf16 a[248:251], v[52:55], v[108:111], a[248:251]
    buffer_load_dwordx4 v19, s[20:23], s42 offen offset:3072 lds
    v_mfma_f32_16x16x32_bf16 a[216:219], v[48:51], v[108:111], a[216:219]
    v_mfma_f32_16x16x32_bf16 a[244:247], v[44:47], v[108:111], a[244:247]
    v_mfma_f32_16x16x32_bf16 a[212:215], v[40:43], v[108:111], a[212:215]
    s_add_u32 s42, s42, 262144
    v_mfma_f32_16x16x32_bf16 a[240:243], v[36:39], v[108:111], a[240:243]
    v_mfma_f32_16x16x32_bf16 a[208:211], v[32:35], v[108:111], a[208:211]
    s_waitcnt lgkmcnt(1)
    v_mfma_f32_16x16x32_bf16 a[0:3], v[64:67], v[96:99], a[0:3]
    s_waitcnt vmcnt(13)
    s_barrier
    v_mfma_f32_16x16x32_bf16 a[32:35], v[68:71], v[96:99], a[32:35]
    ds_read_b128 v[104:107], v11 offset:4096
    v_mfma_f32_16x16x32_bf16 a[4:7], v[72:75], v[96:99], a[4:7]
    ds_read_b64_tr_b16 v[32:33], v2 offset:32768
    v_mfma_f32_16x16x32_bf16 a[36:39], v[76:79], v[96:99], a[36:39]
    ds_read_b64_tr_b16 v[34:35], v2 offset:34816
    v_mfma_f32_16x16x32_bf16 a[8:11], v[80:83], v[96:99], a[8:11]
    ds_read_b64_tr_b16 v[36:37], v3 offset:32768
    s_add_u32 m0, s53, 4096
    v_mfma_f32_16x16x32_bf16 a[40:43], v[84:87], v[96:99], a[40:43]
    buffer_load_dwordx4 v12, s[16:19], s41 offen offset:0 lds
    v_mfma_f32_16x16x32_bf16 a[12:15], v[88:91], v[96:99], a[12:15]
    v_mfma_f32_16x16x32_bf16 a[44:47], v[92:95], v[96:99], a[44:47]
    s_waitcnt lgkmcnt(4)
    v_mfma_f32_16x16x32_bf16 a[60:63], v[92:95], v[100:103], a[60:63]
    ds_read_b128 v[108:111], v11 offset:6144
    v_mfma_f32_16x16x32_bf16 a[28:31], v[88:91], v[100:103], a[28:31]
    ds_read_b64_tr_b16 v[38:39], v3 offset:34816
    v_mfma_f32_16x16x32_bf16 a[56:59], v[84:87], v[100:103], a[56:59]
    ds_read_b64_tr_b16 v[40:41], v4 offset:32768
    v_mfma_f32_16x16x32_bf16 a[24:27], v[80:83], v[100:103], a[24:27]
    ds_read_b64_tr_b16 v[42:43], v4 offset:34816
    v_mfma_f32_16x16x32_bf16 a[52:55], v[76:79], v[100:103], a[52:55]
    v_mfma_f32_16x16x32_bf16 a[20:23], v[72:75], v[100:103], a[20:23]
    buffer_load_dwordx4 v13, s[16:19], s41 offen offset:1024 lds
    v_mfma_f32_16x16x32_bf16 a[48:51], v[68:71], v[100:103], a[48:51]
    v_mfma_f32_16x16x32_bf16 a[16:19], v[64:67], v[100:103], a[16:19]
    s_waitcnt lgkmcnt(7)
    v_mfma_f32_16x16x32_bf16 a[64:67], v[64:67], v[104:107], a[64:67]
    ds_read_b128 v[96:99], v11 offset:8192
    v_mfma_f32_16x16x32_bf16 a[96:99], v[68:71], v[104:107], a[96:99]
    ds_read_b64_tr_b16 v[44:45], v5 offset:32768
    v_mfma_f32_16x16x32_bf16 a[68:71], v[72:75], v[104:107], a[68:71]
    ds_read_b64_tr_b16 v[46:47], v5 offset:34816
    v_mfma_f32_16x16x32_bf16 a[100:103], v[76:79], v[104:107], a[100:103]
    ds_read_b64_tr_b16 v[48:49], v6 offset:32768
    v_mfma_f32_16x16x32_bf16 a[72:75], v[80:83], v[104:107], a[72:75]
    v_mfma_f32_16x16x32_bf16 a[104:107], v[84:87], v[104:107], a[104:107]
    buffer_load_dwordx4 v14, s[16:19], s41 offen offset:2048 lds
    v_mfma_f32_16x16x32_bf16 a[76:79], v[88:91], v[104:107], a[76:79]
    v_mfma_f32_16x16x32_bf16 a[108:111], v[92:95], v[104:107], a[108:111]
    s_waitcnt lgkmcnt(7)
    v_mfma_f32_16x16x32_bf16 a[124:127], v[92:95], v[108:111], a[124:127]
    ds_read_b128 v[100:103], v11 offset:10240
    v_mfma_f32_16x16x32_bf16 a[92:95], v[88:91], v[108:111], a[92:95]
    ds_read_b64_tr_b16 v[50:51], v6 offset:34816
    v_mfma_f32_16x16x32_bf16 a[120:123], v[84:87], v[108:111], a[120:123]
    ds_read_b64_tr_b16 v[52:53], v7 offset:32768
    v_mfma_f32_16x16x32_bf16 a[88:91], v[80:83], v[108:111], a[88:91]
    ds_read_b64_tr_b16 v[54:55], v7 offset:34816
    v_mfma_f32_16x16x32_bf16 a[116:119], v[76:79], v[108:111], a[116:119]
    v_mfma_f32_16x16x32_bf16 a[84:87], v[72:75], v[108:111], a[84:87]
    buffer_load_dwordx4 v15, s[16:19], s41 offen offset:3072 lds
    v_mfma_f32_16x16x32_bf16 a[112:115], v[68:71], v[108:111], a[112:115]
    v_mfma_f32_16x16x32_bf16 a[80:83], v[64:67], v[108:111], a[80:83]
    s_waitcnt lgkmcnt(7)
    v_mfma_f32_16x16x32_bf16 a[128:131], v[64:67], v[96:99], a[128:131]
    ds_read_b128 v[104:107], v11 offset:12288
    v_mfma_f32_16x16x32_bf16 a[160:163], v[68:71], v[96:99], a[160:163]
    ds_read_b64_tr_b16 v[56:57], v8 offset:32768
    v_mfma_f32_16x16x32_bf16 a[132:135], v[72:75], v[96:99], a[132:135]
    ds_read_b64_tr_b16 v[58:59], v8 offset:34816
    s_mov_b32 m0, s25
    v_mfma_f32_16x16x32_bf16 a[164:167], v[76:79], v[96:99], a[164:167]
    v_mfma_f32_16x16x32_bf16 a[136:139], v[80:83], v[96:99], a[136:139]
    buffer_load_dwordx4 v16, s[20:23], s42 offen offset:0 lds
    v_mfma_f32_16x16x32_bf16 a[168:171], v[84:87], v[96:99], a[168:171]
    v_mfma_f32_16x16x32_bf16 a[140:143], v[88:91], v[96:99], a[140:143]
    v_mfma_f32_16x16x32_bf16 a[172:175], v[92:95], v[96:99], a[172:175]
    s_waitcnt lgkmcnt(6)
    v_mfma_f32_16x16x32_bf16 a[188:191], v[92:95], v[100:103], a[188:191]
    ds_read_b128 v[108:111], v11 offset:14336
    v_mfma_f32_16x16x32_bf16 a[156:159], v[88:91], v[100:103], a[156:159]
    ds_read_b64_tr_b16 v[60:61], v9 offset:32768
    v_mfma_f32_16x16x32_bf16 a[184:187], v[84:87], v[100:103], a[184:187]
    ds_read_b64_tr_b16 v[62:63], v9 offset:34816
    v_mfma_f32_16x16x32_bf16 a[152:155], v[80:83], v[100:103], a[152:155]
    v_mfma_f32_16x16x32_bf16 a[180:183], v[76:79], v[100:103], a[180:183]
    buffer_load_dwordx4 v17, s[20:23], s42 offen offset:1024 lds
    v_mfma_f32_16x16x32_bf16 a[148:151], v[72:75], v[100:103], a[148:151]
    v_mfma_f32_16x16x32_bf16 a[176:179], v[68:71], v[100:103], a[176:179]
    v_mfma_f32_16x16x32_bf16 a[144:147], v[64:67], v[100:103], a[144:147]
    s_waitcnt lgkmcnt(5)
    v_mfma_f32_16x16x32_bf16 a[192:195], v[64:67], v[104:107], a[192:195]
    ds_read_b128 v[96:99], v10 offset:0
    v_mfma_f32_16x16x32_bf16 a[224:227], v[68:71], v[104:107], a[224:227]
    v_mfma_f32_16x16x32_bf16 a[196:199], v[72:75], v[104:107], a[196:199]
    buffer_load_dwordx4 v18, s[20:23], s42 offen offset:2048 lds
    v_mfma_f32_16x16x32_bf16 a[228:231], v[76:79], v[104:107], a[228:231]
    v_mfma_f32_16x16x32_bf16 a[200:203], v[80:83], v[104:107], a[200:203]
    v_add_u32 v11, s52, v11
    v_mfma_f32_16x16x32_bf16 a[232:235], v[84:87], v[104:107], a[232:235]
    s_mov_b32 s53, s54
    s_add_u32 s54, s54, s52
    v_mfma_f32_16x16x32_bf16 a[204:207], v[88:91], v[104:107], a[204:207]
    s_add_u32 s40, s40, 128
    s_add_u32 s41, s41, 128
    v_mfma_f32_16x16x32_bf16 a[236:239], v[92:95], v[104:107], a[236:239]
    s_waitcnt lgkmcnt(3)
    v_mfma_f32_16x16x32_bf16 a[252:255], v[92:95], v[108:111], a[252:255]
    ds_read_b128 v[100:103], v10 offset:2048
    v_mfma_f32_16x16x32_bf16 a[220:223], v[88:91], v[108:111], a[220:223]
    v_mfma_f32_16x16x32_bf16 a[248:251], v[84:87], v[108:111], a[248:251]
    buffer_load_dwordx4 v19, s[20:23], s42 offen offset:3072 lds
    v_mfma_f32_16x16x32_bf16 a[216:219], v[80:83], v[108:111], a[216:219]
    v_mfma_f32_16x16x32_bf16 a[244:247], v[76:79], v[108:111], a[244:247]
    v_mfma_f32_16x16x32_bf16 a[212:215], v[72:75], v[108:111], a[212:215]
    s_add_u32 s42, s42, 262144
    v_mfma_f32_16x16x32_bf16 a[240:243], v[68:71], v[108:111], a[240:243]
    v_mfma_f32_16x16x32_bf16 a[208:211], v[64:67], v[108:111], a[208:211]
    s_waitcnt lgkmcnt(1)
    v_mfma_f32_16x16x32_bf16 a[0:3], v[32:35], v[96:99], a[0:3]
    s_waitcnt vmcnt(17)
    s_barrier
    v_mfma_f32_16x16x32_bf16 a[32:35], v[36:39], v[96:99], a[32:35]
    ds_read_b128 v[104:107], v10 offset:4096
    v_mfma_f32_16x16x32_bf16 a[4:7], v[40:43], v[96:99], a[4:7]
    ds_read_b64_tr_b16 v[64:65], v2 offset:49152
    v_mfma_f32_16x16x32_bf16 a[36:39], v[44:47], v[96:99], a[36:39]
    ds_read_b64_tr_b16 v[66:67], v2 offset:51200
    v_mfma_f32_16x16x32_bf16 a[8:11], v[48:51], v[96:99], a[8:11]
    ds_read_b64_tr_b16 v[68:69], v3 offset:49152
    s_mov_b32 m0, s53
    v_mfma_f32_16x16x32_bf16 a[40:43], v[52:55], v[96:99], a[40:43]
    buffer_load_dwordx4 v12, s[16:19], s40 offen offset:0 lds
    v_mfma_f32_16x16x32_bf16 a[12:15], v[56:59], v[96:99], a[12:15]
    v_mfma_f32_16x16x32_bf16 a[44:47], v[60:63], v[96:99], a[44:47]
    s_waitcnt lgkmcnt(4)
    v_mfma_f32_16x16x32_bf16 a[60:63], v[60:63], v[100:103], a[60:63]
    ds_read_b128 v[108:111], v10 offset:6144
    v_mfma_f32_16x16x32_bf16 a[28:31], v[56:59], v[100:103], a[28:31]
    ds_read_b64_tr_b16 v[70:71], v3 offset:51200
    v_mfma_f32_16x16x32_bf16 a[56:59], v[52:55], v[100:103], a[56:59]
    ds_read_b64_tr_b16 v[72:73], v4 offset:49152
    v_mfma_f32_16x16x32_bf16 a[24:27], v[48:51], v[100:103], a[24:27]
    ds_read_b64_tr_b16 v[74:75], v4 offset:51200
    v_mfma_f32_16x16x32_bf16 a[52:55], v[44:47], v[100:103], a[52:55]
    v_mfma_f32_16x16x32_bf16 a[20:23], v[40:43], v[100:103], a[20:23]
    buffer_load_dwordx4 v13, s[16:19], s40 offen offset:1024 lds
    v_mfma_f32_16x16x32_bf16 a[48:51], v[36:39], v[100:103], a[48:51]
    v_mfma_f32_16x16x32_bf16 a[16:19], v[32:35], v[100:103], a[16:19]
    s_waitcnt lgkmcnt(7)
    v_mfma_f32_16x16x32_bf16 a[64:67], v[32:35], v[104:107], a[64:67]
    ds_read_b128 v[96:99], v10 offset:8192
    v_mfma_f32_16x16x32_bf16 a[96:99], v[36:39], v[104:107], a[96:99]
    ds_read_b64_tr_b16 v[76:77], v5 offset:49152
    v_mfma_f32_16x16x32_bf16 a[68:71], v[40:43], v[104:107], a[68:71]
    ds_read_b64_tr_b16 v[78:79], v5 offset:51200
    v_mfma_f32_16x16x32_bf16 a[100:103], v[44:47], v[104:107], a[100:103]
    ds_read_b64_tr_b16 v[80:81], v6 offset:49152
    v_mfma_f32_16x16x32_bf16 a[72:75], v[48:51], v[104:107], a[72:75]
    v_mfma_f32_16x16x32_bf16 a[104:107], v[52:55], v[104:107], a[104:107]
    buffer_load_dwordx4 v14, s[16:19], s40 offen offset:2048 lds
    v_mfma_f32_16x16x32_bf16 a[76:79], v[56:59], v[104:107], a[76:79]
    v_mfma_f32_16x16x32_bf16 a[108:111], v[60:63], v[104:107], a[108:111]
    s_waitcnt lgkmcnt(7)
    v_mfma_f32_16x16x32_bf16 a[124:127], v[60:63], v[108:111], a[124:127]
    ds_read_b128 v[100:103], v10 offset:10240
    v_mfma_f32_16x16x32_bf16 a[92:95], v[56:59], v[108:111], a[92:95]
    ds_read_b64_tr_b16 v[82:83], v6 offset:51200
    v_mfma_f32_16x16x32_bf16 a[120:123], v[52:55], v[108:111], a[120:123]
    ds_read_b64_tr_b16 v[84:85], v7 offset:49152
    v_mfma_f32_16x16x32_bf16 a[88:91], v[48:51], v[108:111], a[88:91]
    ds_read_b64_tr_b16 v[86:87], v7 offset:51200
    v_mfma_f32_16x16x32_bf16 a[116:119], v[44:47], v[108:111], a[116:119]
    v_mfma_f32_16x16x32_bf16 a[84:87], v[40:43], v[108:111], a[84:87]
    buffer_load_dwordx4 v15, s[16:19], s40 offen offset:3072 lds
    v_mfma_f32_16x16x32_bf16 a[112:115], v[36:39], v[108:111], a[112:115]
    v_mfma_f32_16x16x32_bf16 a[80:83], v[32:35], v[108:111], a[80:83]
    s_waitcnt lgkmcnt(7)
    v_mfma_f32_16x16x32_bf16 a[128:131], v[32:35], v[96:99], a[128:131]
    ds_read_b128 v[104:107], v10 offset:12288
    v_mfma_f32_16x16x32_bf16 a[160:163], v[36:39], v[96:99], a[160:163]
    ds_read_b64_tr_b16 v[88:89], v8 offset:49152
    v_mfma_f32_16x16x32_bf16 a[132:135], v[40:43], v[96:99], a[132:135]
    ds_read_b64_tr_b16 v[90:91], v8 offset:51200
    s_mov_b32 m0, s26
    v_mfma_f32_16x16x32_bf16 a[164:167], v[44:47], v[96:99], a[164:167]
    v_mfma_f32_16x16x32_bf16 a[136:139], v[48:51], v[96:99], a[136:139]
    buffer_load_dwordx4 v16, s[20:23], s42 offen offset:0 lds
    v_mfma_f32_16x16x32_bf16 a[168:171], v[52:55], v[96:99], a[168:171]
    v_mfma_f32_16x16x32_bf16 a[140:143], v[56:59], v[96:99], a[140:143]
    v_mfma_f32_16x16x32_bf16 a[172:175], v[60:63], v[96:99], a[172:175]
    s_waitcnt lgkmcnt(6)
    v_mfma_f32_16x16x32_bf16 a[188:191], v[60:63], v[100:103], a[188:191]
    ds_read_b128 v[108:111], v10 offset:14336
    v_mfma_f32_16x16x32_bf16 a[156:159], v[56:59], v[100:103], a[156:159]
    ds_read_b64_tr_b16 v[92:93], v9 offset:49152
    v_mfma_f32_16x16x32_bf16 a[184:187], v[52:55], v[100:103], a[184:187]
    ds_read_b64_tr_b16 v[94:95], v9 offset:51200
    v_mfma_f32_16x16x32_bf16 a[152:155], v[48:51], v[100:103], a[152:155]
    v_mfma_f32_16x16x32_bf16 a[180:183], v[44:47], v[100:103], a[180:183]
    buffer_load_dwordx4 v17, s[20:23], s42 offen offset:1024 lds
    v_mfma_f32_16x16x32_bf16 a[148:151], v[40:43], v[100:103], a[148:151]
    v_mfma_f32_16x16x32_bf16 a[176:179], v[36:39], v[100:103], a[176:179]
    v_mfma_f32_16x16x32_bf16 a[144:147], v[32:35], v[100:103], a[144:147]
    s_cmp_eq_u32 s54, s55
    s_cselect_b32 s52, s61, s60
    s_waitcnt lgkmcnt(5)
    v_mfma_f32_16x16x32_bf16 a[192:195], v[32:35], v[104:107], a[192:195]
    ds_read_b128 v[96:99], v11 offset:0
    v_mfma_f32_16x16x32_bf16 a[224:227], v[36:39], v[104:107], a[224:227]
    v_mfma_f32_16x16x32_bf16 a[196:199], v[40:43], v[104:107], a[196:199]
    buffer_load_dwordx4 v18, s[20:23], s42 offen offset:2048 lds
    v_mfma_f32_16x16x32_bf16 a[228:231], v[44:47], v[104:107], a[228:231]
    v_mfma_f32_16x16x32_bf16 a[200:203], v[48:51], v[104:107], a[200:203]
    v_add_u32 v10, s52, v10
    v_mfma_f32_16x16x32_bf16 a[232:235], v[52:55], v[104:107], a[232:235]
    v_mfma_f32_16x16x32_bf16 a[204:207], v[56:59], v[104:107], a[204:207]
    v_mfma_f32_16x16x32_bf16 a[236:239], v[60:63], v[104:107], a[236:239]
    s_waitcnt lgkmcnt(3)
    v_mfma_f32_16x16x32_bf16 a[252:255], v[60:63], v[108:111], a[252:255]
    ds_read_b128 v[100:103], v11 offset:2048
    v_mfma_f32_16x16x32_bf16 a[220:223], v[56:59], v[108:111], a[220:223]
    v_mfma_f32_16x16x32_bf16 a[248:251], v[52:55], v[108:111], a[248:251]
    buffer_load_dwordx4 v19, s[20:23], s42 offen offset:3072 lds
    v_mfma_f32_16x16x32_bf16 a[216:219], v[48:51], v[108:111], a[216:219]
    v_mfma_f32_16x16x32_bf16 a[244:247], v[44:47], v[108:111], a[244:247]
    v_mfma_f32_16x16x32_bf16 a[212:215], v[40:43], v[108:111], a[212:215]
    s_add_u32 s42, s42, 262144
    v_mfma_f32_16x16x32_bf16 a[240:243], v[36:39], v[108:111], a[240:243]
    v_mfma_f32_16x16x32_bf16 a[208:211], v[32:35], v[108:111], a[208:211]
    s_waitcnt lgkmcnt(1)
    v_mfma_f32_16x16x32_bf16 a[0:3], v[64:67], v[96:99], a[0:3]
    s_waitcnt vmcnt(12)
    s_barrier
    v_mfma_f32_16x16x32_bf16 a[32:35], v[68:71], v[96:99], a[32:35]
    ds_read_b128 v[104:107], v11 offset:4096
    v_mfma_f32_16x16x32_bf16 a[4:7], v[72:75], v[96:99], a[4:7]
    ds_read_b64_tr_b16 v[32:33], v2 offset:0
    v_mfma_f32_16x16x32_bf16 a[36:39], v[76:79], v[96:99], a[36:39]
    ds_read_b64_tr_b16 v[34:35], v2 offset:2048
    v_mfma_f32_16x16x32_bf16 a[8:11], v[80:83], v[96:99], a[8:11]
    ds_read_b64_tr_b16 v[36:37], v3 offset:0
    s_add_u32 m0, s53, 4096
    v_mfma_f32_16x16x32_bf16 a[40:43], v[84:87], v[96:99], a[40:43]
    buffer_load_dwordx4 v12, s[16:19], s41 offen offset:0 lds
    v_mfma_f32_16x16x32_bf16 a[12:15], v[88:91], v[96:99], a[12:15]
    v_mfma_f32_16x16x32_bf16 a[44:47], v[92:95], v[96:99], a[44:47]
    s_waitcnt lgkmcnt(4)
    v_mfma_f32_16x16x32_bf16 a[60:63], v[92:95], v[100:103], a[60:63]
    ds_read_b128 v[108:111], v11 offset:6144
    v_mfma_f32_16x16x32_bf16 a[28:31], v[88:91], v[100:103], a[28:31]
    ds_read_b64_tr_b16 v[38:39], v3 offset:2048
    v_mfma_f32_16x16x32_bf16 a[56:59], v[84:87], v[100:103], a[56:59]
    ds_read_b64_tr_b16 v[40:41], v4 offset:0
    v_mfma_f32_16x16x32_bf16 a[24:27], v[80:83], v[100:103], a[24:27]
    ds_read_b64_tr_b16 v[42:43], v4 offset:2048
    v_mfma_f32_16x16x32_bf16 a[52:55], v[76:79], v[100:103], a[52:55]
    v_mfma_f32_16x16x32_bf16 a[20:23], v[72:75], v[100:103], a[20:23]
    buffer_load_dwordx4 v13, s[16:19], s41 offen offset:1024 lds
    v_mfma_f32_16x16x32_bf16 a[48:51], v[68:71], v[100:103], a[48:51]
    v_mfma_f32_16x16x32_bf16 a[16:19], v[64:67], v[100:103], a[16:19]
    s_waitcnt lgkmcnt(7)
    v_mfma_f32_16x16x32_bf16 a[64:67], v[64:67], v[104:107], a[64:67]
    ds_read_b128 v[96:99], v11 offset:8192
    v_mfma_f32_16x16x32_bf16 a[96:99], v[68:71], v[104:107], a[96:99]
    ds_read_b64_tr_b16 v[44:45], v5 offset:0
    v_mfma_f32_16x16x32_bf16 a[68:71], v[72:75], v[104:107], a[68:71]
    ds_read_b64_tr_b16 v[46:47], v5 offset:2048
    v_mfma_f32_16x16x32_bf16 a[100:103], v[76:79], v[104:107], a[100:103]
    ds_read_b64_tr_b16 v[48:49], v6 offset:0
    v_mfma_f32_16x16x32_bf16 a[72:75], v[80:83], v[104:107], a[72:75]
    v_mfma_f32_16x16x32_bf16 a[104:107], v[84:87], v[104:107], a[104:107]
    buffer_load_dwordx4 v14, s[16:19], s41 offen offset:2048 lds
    v_mfma_f32_16x16x32_bf16 a[76:79], v[88:91], v[104:107], a[76:79]
    v_mfma_f32_16x16x32_bf16 a[108:111], v[92:95], v[104:107], a[108:111]
    s_waitcnt lgkmcnt(7)
    v_mfma_f32_16x16x32_bf16 a[124:127], v[92:95], v[108:111], a[124:127]
    ds_read_b128 v[100:103], v11 offset:10240
    v_mfma_f32_16x16x32_bf16 a[92:95], v[88:91], v[108:111], a[92:95]
    ds_read_b64_tr_b16 v[50:51], v6 offset:2048
    v_mfma_f32_16x16x32_bf16 a[120:123], v[84:87], v[108:111], a[120:123]
    ds_read_b64_tr_b16 v[52:53], v7 offset:0
    v_mfma_f32_16x16x32_bf16 a[88:91], v[80:83], v[108:111], a[88:91]
    ds_read_b64_tr_b16 v[54:55], v7 offset:2048
    v_mfma_f32_16x16x32_bf16 a[116:119], v[76:79], v[108:111], a[116:119]
    v_mfma_f32_16x16x32_bf16 a[84:87], v[72:75], v[108:111], a[84:87]
    buffer_load_dwordx4 v15, s[16:19], s41 offen offset:3072 lds
    v_mfma_f32_16x16x32_bf16 a[112:115], v[68:71], v[108:111], a[112:115]
    v_mfma_f32_16x16x32_bf16 a[80:83], v[64:67], v[108:111], a[80:83]
    s_waitcnt lgkmcnt(7)
    v_mfma_f32_16x16x32_bf16 a[128:131], v[64:67], v[96:99], a[128:131]
    ds_read_b128 v[104:107], v11 offset:12288
    v_mfma_f32_16x16x32_bf16 a[160:163], v[68:71], v[96:99], a[160:163]
    ds_read_b64_tr_b16 v[56:57], v8 offset:0
    v_mfma_f32_16x16x32_bf16 a[132:135], v[72:75], v[96:99], a[132:135]
    ds_read_b64_tr_b16 v[58:59], v8 offset:2048
    s_mov_b32 m0, s27
    v_mfma_f32_16x16x32_bf16 a[164:167], v[76:79], v[96:99], a[164:167]
    v_mfma_f32_16x16x32_bf16 a[136:139], v[80:83], v[96:99], a[136:139]
    buffer_load_dwordx4 v16, s[20:23], s42 offen offset:0 lds
    v_mfma_f32_16x16x32_bf16 a[168:171], v[84:87], v[96:99], a[168:171]
    v_mfma_f32_16x16x32_bf16 a[140:143], v[88:91], v[96:99], a[140:143]
    v_mfma_f32_16x16x32_bf16 a[172:175], v[92:95], v[96:99], a[172:175]
    s_waitcnt lgkmcnt(6)
    v_mfma_f32_16x16x32_bf16 a[188:191], v[92:95], v[100:103], a[188:191]
    ds_read_b128 v[108:111], v11 offset:14336
    v_mfma_f32_16x16x32_bf16 a[156:159], v[88:91], v[100:103], a[156:159]
    ds_read_b64_tr_b16 v[60:61], v9 offset:0
    v_mfma_f32_16x16x32_bf16 a[184:187], v[84:87], v[100:103], a[184:187]
    ds_read_b64_tr_b16 v[62:63], v9 offset:2048
    v_mfma_f32_16x16x32_bf16 a[152:155], v[80:83], v[100:103], a[152:155]
    v_mfma_f32_16x16x32_bf16 a[180:183], v[76:79], v[100:103], a[180:183]
    buffer_load_dwordx4 v17, s[20:23], s42 offen offset:1024 lds
    v_mfma_f32_16x16x32_bf16 a[148:151], v[72:75], v[100:103], a[148:151]
    v_mfma_f32_16x16x32_bf16 a[176:179], v[68:71], v[100:103], a[176:179]
    v_mfma_f32_16x16x32_bf16 a[144:147], v[64:67], v[100:103], a[144:147]
    s_waitcnt lgkmcnt(5)
    v_mfma_f32_16x16x32_bf16 a[192:195], v[64:67], v[104:107], a[192:195]
    ds_read_b128 v[96:99], v10 offset:0
    v_mfma_f32_16x16x32_bf16 a[224:227], v[68:71], v[104:107], a[224:227]
    v_mfma_f32_16x16x32_bf16 a[196:199], v[72:75], v[104:107], a[196:199]
    buffer_load_dwordx4 v18, s[20:23], s42 offen offset:2048 lds
    v_mfma_f32_16x16x32_bf16 a[228:231], v[76:79], v[104:107], a[228:231]
    v_mfma_f32_16x16x32_bf16 a[200:203], v[80:83], v[104:107], a[200:203]
    v_add_u32 v11, s52, v11
    v_mfma_f32_16x16x32_bf16 a[232:235], v[84:87], v[104:107], a[232:235]
    s_mov_b32 s53, s54
    s_add_u32 s54, s54, s52
    v_mfma_f32_16x16x32_bf16 a[204:207], v[88:91], v[104:107], a[204:207]
    s_add_u32 s40, s40, 128
    s_add_u32 s41, s41, 128
    v_mfma_f32_16x16x32_bf16 a[236:239], v[92:95], v[104:107], a[236:239]
    s_waitcnt lgkmcnt(3)
    v_mfma_f32_16x16x32_bf16 a[252:255], v[92:95], v[108:111], a[252:255]
    ds_read_b128 v[100:103], v10 offset:2048
    v_mfma_f32_16x16x32_bf16 a[220:223], v[88:91], v[108:111], a[220:223]
    v_mfma_f32_16x16x32_bf16 a[248:251], v[84:87], v[108:111], a[248:251]
    buffer_load_dwordx4 v19, s[20:23], s42 offen offset:3072 lds
    s_bitcmp1_b32 s51, s50
    s_cbranch_scc1 L1_loopK_hk
L1_loopK_hr:
    v_mfma_f32_16x16x32_bf16 a[216:219], v[80:83], v[108:111], a[216:219]
    v_mfma_f32_16x16x32_bf16 a[244:247], v[76:79], v[108:111], a[244:247]
    buffer_load_dword v224, v23, s[68:71], s59 offen
    v_mfma_f32_16x16x32_bf16 a[212:215], v[72:75], v[108:111], a[212:215]
    s_add_u32 s42, s42, 262144
    s_add_u32 s59, s59, 4096
    v_mfma_f32_16x16x32_bf16 a[240:243], v[68:71], v[108:111], a[240:243]
    s_sub_u32 s50, s50, 1
    s_cmp_lg_u32 s50, 0
    v_mfma_f32_16x16x32_bf16 a[208:211], v[64:67], v[108:111], a[208:211]
    s_cbranch_scc1 L1_loopK
    v_cmp_ne_u32 vcc, s7, v28
    s_cbranch_vccnz L1_loopK_xw
L1_loopK_xr:
    v_mov_b32 v20, v1
    v_add_u32 v21, 0x1000, v1
    s_mov_b32 s43, 0
    s_movk_i32 s48, 8192
    s_lshr_b32 s62, s2, 3
    s_getpc_b64 s[64:65]
    s_add_u32 s64, s64, L1_epi@rel32@lo+4
    s_addc_u32 s65, s65, L1_epi@rel32@hi+12
    s_mul_i32 s3, s62, (((L2_end-L1_epi)/32+63)&~63)
    s_add_u32 s64, s64, s3
    s_addc_u32 s65, s65, 0
    s_sub_u32 s66, L2_end-L1_epi, s3
    s_cselect_b32 s66, 0, s66
    s_min_u32 s66, s66, (((L2_end-L1_epi)/32+63)&~63)
    s_mov_b32 s67, 0x20000
    v_lshlrev_b32 v30, 6, v0
    buffer_load_dword v31, v30, s[64:67], 0 offen
    s_getpc_b64 s[64:65]
    s_add_u32 s64, s64, L_done@rel32@lo+4
    s_addc_u32 s65, s65, L_done@rel32@hi+12
    s_mul_i32 s3, s62, (((L_hot_end-L_done)/32+63)&~63)
    s_add_u32 s64, s64, s3
    s_addc_u32 s65, s65, 0
    s_sub_u32 s66, L_hot_end-L_done, s3
    s_cselect_b32 s66, 0, s66
    s_min_u32 s66, s66, (((L_hot_end-L_done)/32+63)&~63)
    s_mov_b32 s67, 0x20000
    v_lshlrev_b32 v30, 6, v0
    buffer_load_dword v31, v30, s[64:67], 0 offen
    s_mov_b32 s20, s56
    s_mov_b32 s21, s57
    s_mov_b32 s22, s58
    s_mov_b32 s42, 0
    s_mov_b32 s49, 1572864
    s_waitcnt lgkmcnt(1)
    v_mfma_f32_16x16x32_bf16 a[0:3], v[32:35], v[96:99], a[0:3]
    s_waitcnt vmcnt(19)
    s_barrier
    v_mfma_f32_16x16x32_bf16 a[32:35], v[36:39], v[96:99], a[32:35]
    ds_read_b128 v[104:107], v10 offset:4096
    v_mfma_f32_16x16x32_bf16 a[4:7], v[40:43], v[96:99], a[4:7]
    ds_read_b64_tr_b16 v[64:65], v2 offset:16384
    v_mfma_f32_16x16x32_bf16 a[36:39], v[44:47], v[96:99], a[36:39]
    ds_read_b64_tr_b16 v[66:67], v2 offset:18432
    buffer_load_dwordx4 v[112:115], v20, s[44:47], s43 offen offset:0 sc1
    v_mfma_f32_16x16x32_bf16 a[8:11], v[48:51], v[96:99], a[8:11]
    ds_read_b64_tr_b16 v[68:69], v3 offset:16384
    v_mfma_f32_16x16x32_bf16 a[40:43], v[52:55], v[96:99], a[40:43]
    v_mfma_f32_16x16x32_bf16 a[12:15], v[56:59], v[96:99], a[12:15]
    s_add_u32 m0, s24, 98304
    v_mfma_f32_16x16x32_bf16 a[44:47], v[60:63], v[96:99], a[44:47]
    buffer_load_dwordx4 v16, s[20:23], s49 offen offset:0 lds
    s_waitcnt lgkmcnt(4)
    v_mfma_f32_16x16x32_bf16 a[60:63], v[60:63], v[100:103], a[60:63]
    ds_read_b128 v[108:111], v10 offset:6144
    v_mfma_f32_16x16x32_bf16 a[28:31], v[56:59], v[100:103], a[28:31]
    ds_read_b64_tr_b16 v[70:71], v3 offset:18432
    v_mfma_f32_16x16x32_bf16 a[56:59], v[52:55], v[100:103], a[56:59]
    ds_read_b64_tr_b16 v[72:73], v4 offset:16384
    v_mfma_f32_16x16x32_bf16 a[24:27], v[48:51], v[100:103], a[24:27]
    ds_read_b64_tr_b16 v[74:75], v4 offset:18432
    buffer_load_dwordx4 v[120:123], v20, s[44:47], s43 offen offset:1024 sc1
    v_mfma_f32_16x16x32_bf16 a[52:55], v[44:47], v[100:103], a[52:55]
    v_mfma_f32_16x16x32_bf16 a[20:23], v[40:43], v[100:103], a[20:23]
    v_mfma_f32_16x16x32_bf16 a[48:51], v[36:39], v[100:103], a[48:51]
    v_mfma_f32_16x16x32_bf16 a[16:19], v[32:35], v[100:103], a[16:19]
    buffer_load_dwordx4 v17, s[20:23], s49 offen offset:1024 lds
    s_waitcnt lgkmcnt(7)
    v_mfma_f32_16x16x32_bf16 a[64:67], v[32:35], v[104:107], a[64:67]
    ds_read_b128 v[96:99], v10 offset:8192
    v_mfma_f32_16x16x32_bf16 a[96:99], v[36:39], v[104:107], a[96:99]
    ds_read_b64_tr_b16 v[76:77], v5 offset:16384
    v_mfma_f32_16x16x32_bf16 a[68:71], v[40:43], v[104:107], a[68:71]
    ds_read_b64_tr_b16 v[78:79], v5 offset:18432
    v_mfma_f32_16x16x32_bf16 a[100:103], v[44:47], v[104:107], a[100:103]
    ds_read_b64_tr_b16 v[80:81], v6 offset:16384
    buffer_load_dwordx4 v[128:131], v20, s[44:47], s43 offen offset:2048 sc1
    v_mfma_f32_16x16x32_bf16 a[72:75], v[48:51], v[104:107], a[72:75]
    v_mfma_f32_16x16x32_bf16 a[104:107], v[52:55], v[104:107], a[104:107]
    v_mfma_f32_16x16x32_bf16 a[76:79], v[56:59], v[104:107], a[76:79]
    v_mfma_f32_16x16x32_bf16 a[108:111], v[60:63], v[104:107], a[108:111]
    buffer_load_dwordx4 v18, s[20:23], s49 offen offset:2048 lds
    s_waitcnt lgkmcnt(7)
    v_mfma_f32_16x16x32_bf16 a[124:127], v[60:63], v[108:111], a[124:127]
    ds_read_b128 v[100:103], v10 offset:10240
    v_mfma_f32_16x16x32_bf16 a[92:95], v[56:59], v[108:111], a[92:95]
    ds_read_b64_tr_b16 v[82:83], v6 offset:18432
    v_mfma_f32_16x16x32_bf16 a[120:123], v[52:55], v[108:111], a[120:123]
    ds_read_b64_tr_b16 v[84:85], v7 offset:16384
    v_mfma_f32_16x16x32_bf16 a[88:91], v[48:51], v[108:111], a[88:91]
    ds_read_b64_tr_b16 v[86:87], v7 offset:18432
    buffer_load_dwordx4 v[136:139], v20, s[44:47], s43 offen offset:3072 sc1
    v_mfma_f32_16x16x32_bf16 a[116:119], v[44:47], v[108:111], a[116:119]
    v_mfma_f32_16x16x32_bf16 a[84:87], v[40:43], v[108:111], a[84:87]
    v_mfma_f32_16x16x32_bf16 a[112:115], v[36:39], v[108:111], a[112:115]
    v_mfma_f32_16x16x32_bf16 a[80:83], v[32:35], v[108:111], a[80:83]
    buffer_load_dwordx4 v19, s[20:23], s49 offen offset:3072 lds
    s_waitcnt lgkmcnt(7)
    v_mfma_f32_16x16x32_bf16 a[128:131], v[32:35], v[96:99], a[128:131]
    ds_read_b128 v[104:107], v10 offset:12288
    s_add_u32 s49, s49, 262144
    v_mfma_f32_16x16x32_bf16 a[160:163], v[36:39], v[96:99], a[160:163]
    ds_read_b64_tr_b16 v[88:89], v8 offset:16384
    v_mfma_f32_16x16x32_bf16 a[132:135], v[40:43], v[96:99], a[132:135]
    ds_read_b64_tr_b16 v[90:91], v8 offset:18432
    v_mfma_f32_16x16x32_bf16 a[164:167], v[44:47], v[96:99], a[164:167]
    buffer_load_dwordx4 v[144:147], v21, s[44:47], s43 offen offset:0 sc1
    v_mfma_f32_16x16x32_bf16 a[136:139], v[48:51], v[96:99], a[136:139]
    v_mfma_f32_16x16x32_bf16 a[168:171], v[52:55], v[96:99], a[168:171]
    v_mfma_f32_16x16x32_bf16 a[140:143], v[56:59], v[96:99], a[140:143]
    s_mov_b32 m0, s24
    v_mfma_f32_16x16x32_bf16 a[172:175], v[60:63], v[96:99], a[172:175]
    buffer_load_dwordx4 v16, s[20:23], s42 offen offset:0 lds
    s_waitcnt lgkmcnt(6)
    v_mfma_f32_16x16x32_bf16 a[188:191], v[60:63], v[100:103], a[188:191]
    ds_read_b128 v[108:111], v10 offset:14336
    v_mfma_f32_16x16x32_bf16 a[156:159], v[56:59], v[100:103], a[156:159]
    ds_read_b64_tr_b16 v[92:93], v9 offset:16384
    v_mfma_f32_16x16x32_bf16 a[184:187], v[52:55], v[100:103], a[184:187]
    ds_read_b64_tr_b16 v[94:95], v9 offset:18432
    v_mfma_f32_16x16x32_bf16 a[152:155], v[48:51], v[100:103], a[152:155]
    buffer_load_dwordx4 v[152:155], v21, s[44:47], s43 offen offset:1024 sc1
    v_mfma_f32_16x16x32_bf16 a[180:183], v[44:47], v[100:103], a[180:183]
    v_mfma_f32_16x16x32_bf16 a[148:151], v[40:43], v[100:103], a[148:151]
    v_mfma_f32_16x16x32_bf16 a[176:179], v[36:39], v[100:103], a[176:179]
    v_mfma_f32_16x16x32_bf16 a[144:147], v[32:35], v[100:103], a[144:147]
    buffer_load_dwordx4 v17, s[20:23], s42 offen offset:1024 lds
    s_cmp_eq_u32 s54, s55
    s_cselect_b32 s52, s61, s60
    s_waitcnt lgkmcnt(5)
    v_mfma_f32_16x16x32_bf16 a[192:195], v[32:35], v[104:107], a[192:195]
    ds_read_b128 v[96:99], v11 offset:0
    v_mfma_f32_16x16x32_bf16 a[224:227], v[36:39], v[104:107], a[224:227]
    v_mfma_f32_16x16x32_bf16 a[196:199], v[40:43], v[104:107], a[196:199]
    v_mfma_f32_16x16x32_bf16 a[228:231], v[44:47], v[104:107], a[228:231]
    buffer_load_dwordx4 v[160:163], v21, s[44:47], s43 offen offset:2048 sc1
    v_mfma_f32_16x16x32_bf16 a[200:203], v[48:51], v[104:107], a[200:203]
    v_add_u32 v10, s52, v10
    v_mfma_f32_16x16x32_bf16 a[232:235], v[52:55], v[104:107], a[232:235]
    v_mfma_f32_16x16x32_bf16 a[204:207], v[56:59], v[104:107], a[204:207]
    v_mfma_f32_16x16x32_bf16 a[236:239], v[60:63], v[104:107], a[236:239]
    buffer_load_dwordx4 v18, s[20:23], s42 offen offset:2048 lds
    s_waitcnt lgkmcnt(3)
    v_mfma_f32_16x16x32_bf16 a[252:255], v[60:63], v[108:111], a[252:255]
    ds_read_b128 v[100:103], v11 offset:2048
    v_mfma_f32_16x16x32_bf16 a[220:223], v[56:59], v[108:111], a[220:223]
    v_mfma_f32_16x16x32_bf16 a[248:251], v[52:55], v[108:111], a[248:251]
    v_mfma_f32_16x16x32_bf16 a[216:219], v[48:51], v[108:111], a[216:219]
    v_mfma_f32_16x16x32_bf16 a[244:247], v[44:47], v[108:111], a[244:247]
    v_mfma_f32_16x16x32_bf16 a[212:215], v[40:43], v[108:111], a[212:215]
    v_mfma_f32_16x16x32_bf16 a[240:243], v[36:39], v[108:111], a[240:243]
    v_mfma_f32_16x16x32_bf16 a[208:211], v[32:35], v[108:111], a[208:211]
    buffer_load_dwordx4 v19, s[20:23], s42 offen offset:3072 lds
    s_add_u32 s42, s42, 262144
    s_waitcnt lgkmcnt(1)
    v_mfma_f32_16x16x32_bf16 a[0:3], v[64:67], v[96:99], a[0:3]
    s_waitcnt vmcnt(22)
    s_barrier
    v_mfma_f32_16x16x32_bf16 a[32:35], v[68:71], v[96:99], a[32:35]
    ds_read_b128 v[104:107], v11 offset:4096
    v_mfma_f32_16x16x32_bf16 a[4:7], v[72:75], v[96:99], a[4:7]
    ds_read_b64_tr_b16 v[32:33], v2 offset:32768
    v_mfma_f32_16x16x32_bf16 a[36:39], v[76:79], v[96:99], a[36:39]
    ds_read_b64_tr_b16 v[34:35], v2 offset:34816
    buffer_load_dwordx4 v[168:171], v21, s[44:47], s43 offen offset:3072 sc1
    v_mfma_f32_16x16x32_bf16 a[8:11], v[80:83], v[96:99], a[8:11]
    ds_read_b64_tr_b16 v[36:37], v3 offset:32768
    v_mfma_f32_16x16x32_bf16 a[40:43], v[84:87], v[96:99], a[40:43]
    v_mfma_f32_16x16x32_bf16 a[12:15], v[88:91], v[96:99], a[12:15]
    s_add_u32 m0, s24, 114688
    v_mfma_f32_16x16x32_bf16 a[44:47], v[92:95], v[96:99], a[44:47]
    buffer_load_dwordx4 v16, s[20:23], s49 offen offset:0 lds
    s_waitcnt lgkmcnt(4)
    v_mfma_f32_16x16x32_bf16 a[60:63], v[92:95], v[100:103], a[60:63]
    ds_read_b128 v[108:111], v11 offset:6144
    v_mfma_f32_16x16x32_bf16 a[28:31], v[88:91], v[100:103], a[28:31]
    ds_read_b64_tr_b16 v[38:39], v3 offset:34816
    v_mfma_f32_16x16x32_bf16 a[56:59], v[84:87], v[100:103], a[56:59]
    ds_read_b64_tr_b16 v[40:41], v4 offset:32768
    v_mfma_f32_16x16x32_bf16 a[24:27], v[80:83], v[100:103], a[24:27]
    ds_read_b64_tr_b16 v[42:43], v4 offset:34816
    buffer_load_dwordx4 v[176:179], v20, s[44:47], s48 offen offset:0 sc1
    v_mfma_f32_16x16x32_bf16 a[52:55], v[76:79], v[100:103], a[52:55]
    v_mfma_f32_16x16x32_bf16 a[20:23], v[72:75], v[100:103], a[20:23]
    v_mfma_f32_16x16x32_bf16 a[48:51], v[68:71], v[100:103], a[48:51]
    v_mfma_f32_16x16x32_bf16 a[16:19], v[64:67], v[100:103], a[16:19]
    buffer_load_dwordx4 v17, s[20:23], s49 offen offset:1024 lds
    s_waitcnt lgkmcnt(7)
    v_mfma_f32_16x16x32_bf16 a[64:67], v[64:67], v[104:107], a[64:67]
    ds_read_b128 v[96:99], v11 offset:8192
    v_mfma_f32_16x16x32_bf16 a[96:99], v[68:71], v[104:107], a[96:99]
    ds_read_b64_tr_b16 v[44:45], v5 offset:32768
    v_mfma_f32_16x16x32_bf16 a[68:71], v[72:75], v[104:107], a[68:71]
    ds_read_b64_tr_b16 v[46:47], v5 offset:34816
    v_mfma_f32_16x16x32_bf16 a[100:103], v[76:79], v[104:107], a[100:103]
    ds_read_b64_tr_b16 v[48:49], v6 offset:32768
    buffer_load_dwordx4 v[184:187], v20, s[44:47], s48 offen offset:1024 sc1
    v_mfma_f32_16x16x32_bf16 a[72:75], v[80:83], v[104:107], a[72:75]
    v_mfma_f32_16x16x32_bf16 a[104:107], v[84:87], v[104:107], a[104:107]
    v_mfma_f32_16x16x32_bf16 a[76:79], v[88:91], v[104:107], a[76:79]
    v_mfma_f32_16x16x32_bf16 a[108:111], v[92:95], v[104:107], a[108:111]
    buffer_load_dwordx4 v18, s[20:23], s49 offen offset:2048 lds
    s_waitcnt lgkmcnt(7)
    v_mfma_f32_16x16x32_bf16 a[124:127], v[92:95], v[108:111], a[124:127]
    ds_read_b128 v[100:103], v11 offset:10240
    v_mfma_f32_16x16x32_bf16 a[92:95], v[88:91], v[108:111], a[92:95]
    ds_read_b64_tr_b16 v[50:51], v6 offset:34816
    v_mfma_f32_16x16x32_bf16 a[120:123], v[84:87], v[108:111], a[120:123]
    ds_read_b64_tr_b16 v[52:53], v7 offset:32768
    v_mfma_f32_16x16x32_bf16 a[88:91], v[80:83], v[108:111], a[88:91]
    ds_read_b64_tr_b16 v[54:55], v7 offset:34816
    buffer_load_dwordx4 v[192:195], v20, s[44:47], s48 offen offset:2048 sc1
    v_mfma_f32_16x16x32_bf16 a[116:119], v[76:79], v[108:111], a[116:119]
    v_mfma_f32_16x16x32_bf16 a[84:87], v[72:75], v[108:111], a[84:87]
    v_mfma_f32_16x16x32_bf16 a[112:115], v[68:71], v[108:111], a[112:115]
    v_mfma_f32_16x16x32_bf16 a[80:83], v[64:67], v[108:111], a[80:83]
    buffer_load_dwordx4 v19, s[20:23], s49 offen offset:3072 lds
    s_waitcnt lgkmcnt(7)
    v_mfma_f32_16x16x32_bf16 a[128:131], v[64:67], v[96:99], a[128:131]
    ds_read_b128 v[104:107], v11 offset:12288
    s_add_u32 s49, s49, 262144
    v_mfma_f32_16x16x32_bf16 a[160:163], v[68:71], v[96:99], a[160:163]
    ds_read_b64_tr_b16 v[56:57], v8 offset:32768
    v_mfma_f32_16x16x32_bf16 a[132:135], v[72:75], v[96:99], a[132:135]
    ds_read_b64_tr_b16 v[58:59], v8 offset:34816
    v_mfma_f32_16x16x32_bf16 a[164:167], v[76:79], v[96:99], a[164:167]
    buffer_load_dwordx4 v[200:203], v20, s[44:47], s48 offen offset:3072 sc1
    v_mfma_f32_16x16x32_bf16 a[136:139], v[80:83], v[96:99], a[136:139]
    v_mfma_f32_16x16x32_bf16 a[168:171], v[84:87], v[96:99], a[168:171]
    v_mfma_f32_16x16x32_bf16 a[140:143], v[88:91], v[96:99], a[140:143]
    s_mov_b32 m0, s25
    v_mfma_f32_16x16x32_bf16 a[172:175], v[92:95], v[96:99], a[172:175]
    buffer_load_dwordx4 v16, s[20:23], s42 offen offset:0 lds
    s_waitcnt lgkmcnt(6)
    v_mfma_f32_16x16x32_bf16 a[188:191], v[92:95], v[100:103], a[188:191]
    ds_read_b128 v[108:111], v11 offset:14336
    v_mfma_f32_16x16x32_bf16 a[156:159], v[88:91], v[100:103], a[156:159]
    ds_read_b64_tr_b16 v[60:61], v9 offset:32768
    v_mfma_f32_16x16x32_bf16 a[184:187], v[84:87], v[100:103], a[184:187]
    ds_read_b64_tr_b16 v[62:63], v9 offset:34816
    v_mfma_f32_16x16x32_bf16 a[152:155], v[80:83], v[100:103], a[152:155]
    buffer_load_dwordx4 v[208:211], v21, s[44:47], s48 offen offset:0 sc1
    v_mfma_f32_16x16x32_bf16 a[180:183], v[76:79], v[100:103], a[180:183]
    v_mfma_f32_16x16x32_bf16 a[148:151], v[72:75], v[100:103], a[148:151]
    v_mfma_f32_16x16x32_bf16 a[176:179], v[68:71], v[100:103], a[176:179]
    v_mfma_f32_16x16x32_bf16 a[144:147], v[64:67], v[100:103], a[144:147]
    buffer_load_dwordx4 v17, s[20:23], s42 offen offset:1024 lds
    s_waitcnt lgkmcnt(5)
    v_mfma_f32_16x16x32_bf16 a[192:195], v[64:67], v[104:107], a[192:195]
    ds_read_b128 v[96:99], v10 offset:0
    v_mfma_f32_16x16x32_bf16 a[224:227], v[68:71], v[104:107], a[224:227]
    v_mfma_f32_16x16x32_bf16 a[196:199], v[72:75], v[104:107], a[196:199]
    v_mfma_f32_16x16x32_bf16 a[228:231], v[76:79], v[104:107], a[228:231]
    buffer_load_dwordx4 v[216:219], v21, s[44:47], s48 offen offset:1024 sc1
    v_mfma_f32_16x16x32_bf16 a[200:203], v[80:83], v[104:107], a[200:203]
    v_add_u32 v11, s52, v11
    v_mfma_f32_16x16x32_bf16 a[232:235], v[84:87], v[104:107], a[232:235]
    s_add_u32 s54, s54, s52
    v_mfma_f32_16x16x32_bf16 a[204:207], v[88:91], v[104:107], a[204:207]
    v_mfma_f32_16x16x32_bf16 a[236:239], v[92:95], v[104:107], a[236:239]
    buffer_load_dwordx4 v18, s[20:23], s42 offen offset:2048 lds
    s_waitcnt lgkmcnt(3)
    v_mfma_f32_16x16x32_bf16 a[252:255], v[92:95], v[108:111], a[252:255]
    ds_read_b128 v[100:103], v10 offset:2048
    v_mfma_f32_16x16x32_bf16 a[220:223], v[88:91], v[108:111], a[220:223]
    v_mfma_f32_16x16x32_bf16 a[248:251], v[84:87], v[108:111], a[248:251]
    v_mfma_f32_16x16x32_bf16 a[216:219], v[80:83], v[108:111], a[216:219]
    v_mfma_f32_16x16x32_bf16 a[244:247], v[76:79], v[108:111], a[244:247]
    v_mfma_f32_16x16x32_bf16 a[212:215], v[72:75], v[108:111], a[212:215]
    v_mfma_f32_16x16x32_bf16 a[240:243], v[68:71], v[108:111], a[240:243]
    v_mfma_f32_16x16x32_bf16 a[208:211], v[64:67], v[108:111], a[208:211]
    buffer_load_dwordx4 v19, s[20:23], s42 offen offset:3072 lds
    s_add_u32 s42, s42, 262144
    s_waitcnt lgkmcnt(1)
    v_mfma_f32_16x16x32_bf16 a[0:3], v[32:35], v[96:99], a[0:3]
    s_waitcnt vmcnt(33)
    s_barrier
    v_mfma_f32_16x16x32_bf16 a[32:35], v[36:39], v[96:99], a[32:35]
    ds_read_b128 v[104:107], v10 offset:4096
    v_mfma_f32_16x16x32_bf16 a[4:7], v[40:43], v[96:99], a[4:7]
    ds_read_b64_tr_b16 v[64:65], v2 offset:49152
    v_mfma_f32_16x16x32_bf16 a[36:39], v[44:47], v[96:99], a[36:39]
    ds_read_b64_tr_b16 v[66:67], v2 offset:51200
    buffer_load_dwordx4 v[116:119], v21, s[44:47], s48 offen offset:2048 sc1
    v_mfma_f32_16x16x32_bf16 a[8:11], v[48:51], v[96:99], a[8:11]
    ds_read_b64_tr_b16 v[68:69], v3 offset:49152
    v_mfma_f32_16x16x32_bf16 a[40:43], v[52:55], v[96:99], a[40:43]
    v_mfma_f32_16x16x32_bf16 a[12:15], v[56:59], v[96:99], a[12:15]
    s_add_u32 m0, s24, 131072
    v_mfma_f32_16x16x32_bf16 a[44:47], v[60:63], v[96:99], a[44:47]
    buffer_load_dwordx4 v16, s[20:23], s49 offen offset:0 lds
    s_waitcnt lgkmcnt(4)
    v_mfma_f32_16x16x32_bf16 a[60:63], v[60:63], v[100:103], a[60:63]
    ds_read_b128 v[108:111], v10 offset:6144
    v_mfma_f32_16x16x32_bf16 a[28:31], v[56:59], v[100:103], a[28:31]
    ds_read_b64_tr_b16 v[70:71], v3 offset:51200
    v_mfma_f32_16x16x32_bf16 a[56:59], v[52:55], v[100:103], a[56:59]
    ds_read_b64_tr_b16 v[72:73], v4 offset:49152
    v_mfma_f32_16x16x32_bf16 a[24:27], v[48:51], v[100:103], a[24:27]
    ds_read_b64_tr_b16 v[74:75], v4 offset:51200
    buffer_load_dwordx4 v[124:127], v21, s[44:47], s48 offen offset:3072 sc1
    v_mfma_f32_16x16x32_bf16 a[52:55], v[44:47], v[100:103], a[52:55]
    s_movk_i32 s43, 16384
    s_movk_i32 s48, 24576
    v_mfma_f32_16x16x32_bf16 a[20:23], v[40:43], v[100:103], a[20:23]
    v_mfma_f32_16x16x32_bf16 a[48:51], v[36:39], v[100:103], a[48:51]
    v_mfma_f32_16x16x32_bf16 a[16:19], v[32:35], v[100:103], a[16:19]
    buffer_load_dwordx4 v17, s[20:23], s49 offen offset:1024 lds
    s_waitcnt lgkmcnt(7)
    v_mfma_f32_16x16x32_bf16 a[64:67], v[32:35], v[104:107], a[64:67]
    ds_read_b128 v[96:99], v10 offset:8192
    v_mfma_f32_16x16x32_bf16 a[96:99], v[36:39], v[104:107], a[96:99]
    ds_read_b64_tr_b16 v[76:77], v5 offset:49152
    v_mfma_f32_16x16x32_bf16 a[68:71], v[40:43], v[104:107], a[68:71]
    ds_read_b64_tr_b16 v[78:79], v5 offset:51200
    v_mfma_f32_16x16x32_bf16 a[100:103], v[44:47], v[104:107], a[100:103]
    ds_read_b64_tr_b16 v[80:81], v6 offset:49152
    buffer_load_dwordx4 v[132:135], v20, s[44:47], s43 offen offset:0 sc1
    v_mfma_f32_16x16x32_bf16 a[72:75], v[48:51], v[104:107], a[72:75]
    v_mfma_f32_16x16x32_bf16 a[104:107], v[52:55], v[104:107], a[104:107]
    v_mfma_f32_16x16x32_bf16 a[76:79], v[56:59], v[104:107], a[76:79]
    v_mfma_f32_16x16x32_bf16 a[108:111], v[60:63], v[104:107], a[108:111]
    buffer_load_dwordx4 v18, s[20:23], s49 offen offset:2048 lds
    s_waitcnt lgkmcnt(7)
    v_mfma_f32_16x16x32_bf16 a[124:127], v[60:63], v[108:111], a[124:127]
    ds_read_b128 v[100:103], v10 offset:10240
    v_mfma_f32_16x16x32_bf16 a[92:95], v[56:59], v[108:111], a[92:95]
    ds_read_b64_tr_b16 v[82:83], v6 offset:51200
    v_mfma_f32_16x16x32_bf16 a[120:123], v[52:55], v[108:111], a[120:123]
    ds_read_b64_tr_b16 v[84:85], v7 offset:49152
    v_mfma_f32_16x16x32_bf16 a[88:91], v[48:51], v[108:111], a[88:91]
    ds_read_b64_tr_b16 v[86:87], v7 offset:51200
    buffer_load_dwordx4 v[140:143], v20, s[44:47], s43 offen offset:1024 sc1
    v_mfma_f32_16x16x32_bf16 a[116:119], v[44:47], v[108:111], a[116:119]
    v_mfma_f32_16x16x32_bf16 a[84:87], v[40:43], v[108:111], a[84:87]
    v_mfma_f32_16x16x32_bf16 a[112:115], v[36:39], v[108:111], a[112:115]
    v_mfma_f32_16x16x32_bf16 a[80:83], v[32:35], v[108:111], a[80:83]
    buffer_load_dwordx4 v19, s[20:23], s49 offen offset:3072 lds
    s_waitcnt lgkmcnt(7)
    v_mfma_f32_16x16x32_bf16 a[128:131], v[32:35], v[96:99], a[128:131]
    ds_read_b128 v[104:107], v10 offset:12288
    s_add_u32 s49, s49, 262144
    v_mfma_f32_16x16x32_bf16 a[160:163], v[36:39], v[96:99], a[160:163]
    ds_read_b64_tr_b16 v[88:89], v8 offset:49152
    v_mfma_f32_16x16x32_bf16 a[132:135], v[40:43], v[96:99], a[132:135]
    ds_read_b64_tr_b16 v[90:91], v8 offset:51200
    v_mfma_f32_16x16x32_bf16 a[164:167], v[44:47], v[96:99], a[164:167]
    buffer_load_dwordx4 v[148:151], v20, s[44:47], s43 offen offset:2048 sc1
    v_mfma_f32_16x16x32_bf16 a[136:139], v[48:51], v[96:99], a[136:139]
    v_mfma_f32_16x16x32_bf16 a[168:171], v[52:55], v[96:99], a[168:171]
    v_mfma_f32_16x16x32_bf16 a[140:143], v[56:59], v[96:99], a[140:143]
    s_mov_b32 m0, s26
    v_mfma_f32_16x16x32_bf16 a[172:175], v[60:63], v[96:99], a[172:175]
    buffer_load_dwordx4 v16, s[20:23], s42 offen offset:0 lds
    s_waitcnt lgkmcnt(6)
    v_mfma_f32_16x16x32_bf16 a[188:191], v[60:63], v[100:103], a[188:191]
    ds_read_b128 v[108:111], v10 offset:14336
    v_mfma_f32_16x16x32_bf16 a[156:159], v[56:59], v[100:103], a[156:159]
    ds_read_b64_tr_b16 v[92:93], v9 offset:49152
    v_mfma_f32_16x16x32_bf16 a[184:187], v[52:55], v[100:103], a[184:187]
    ds_read_b64_tr_b16 v[94:95], v9 offset:51200
    v_mfma_f32_16x16x32_bf16 a[152:155], v[48:51], v[100:103], a[152:155]
    buffer_load_dwordx4 v[156:159], v20, s[44:47], s43 offen offset:3072 sc1
    v_mfma_f32_16x16x32_bf16 a[180:183], v[44:47], v[100:103], a[180:183]
    v_mfma_f32_16x16x32_bf16 a[148:151], v[40:43], v[100:103], a[148:151]
    v_mfma_f32_16x16x32_bf16 a[176:179], v[36:39], v[100:103], a[176:179]
    v_mfma_f32_16x16x32_bf16 a[144:147], v[32:35], v[100:103], a[144:147]
    buffer_load_dwordx4 v17, s[20:23], s42 offen offset:1024 lds
    s_cmp_eq_u32 s54, s55
    s_cselect_b32 s52, s61, s60
    s_waitcnt lgkmcnt(5)
    v_mfma_f32_16x16x32_bf16 a[192:195], v[32:35], v[104:107], a[192:195]
    ds_read_b128 v[96:99], v11 offset:0
    v_mfma_f32_16x16x32_bf16 a[224:227], v[36:39], v[104:107], a[224:227]
    v_mfma_f32_16x16x32_bf16 a[196:199], v[40:43], v[104:107], a[196:199]
    v_mfma_f32_16x16x32_bf16 a[228:231], v[44:47], v[104:107], a[228:231]
    buffer_load_dwordx4 v[164:167], v21, s[44:47], s43 offen offset:0 sc1
    v_mfma_f32_16x16x32_bf16 a[200:203], v[48:51], v[104:107], a[200:203]
    v_add_u32 v10, s52, v10
    v_mfma_f32_16x16x32_bf16 a[232:235], v[52:55], v[104:107], a[232:235]
    v_mfma_f32_16x16x32_bf16 a[204:207], v[56:59], v[104:107], a[204:207]
    v_mfma_f32_16x16x32_bf16 a[236:239], v[60:63], v[104:107], a[236:239]
    buffer_load_dwordx4 v18, s[20:23], s42 offen offset:2048 lds
    s_waitcnt lgkmcnt(3)
    v_mfma_f32_16x16x32_bf16 a[252:255], v[60:63], v[108:111], a[252:255]
    ds_read_b128 v[100:103], v11 offset:2048
    v_mfma_f32_16x16x32_bf16 a[220:223], v[56:59], v[108:111], a[220:223]
    v_mfma_f32_16x16x32_bf16 a[248:251], v[52:55], v[108:111], a[248:251]
    v_mfma_f32_16x16x32_bf16 a[216:219], v[48:51], v[108:111], a[216:219]
    v_mfma_f32_16x16x32_bf16 a[244:247], v[44:47], v[108:111], a[244:247]
    v_mfma_f32_16x16x32_bf16 a[212:215], v[40:43], v[108:111], a[212:215]
    v_mfma_f32_16x16x32_bf16 a[240:243], v[36:39], v[108:111], a[240:243]
    v_mfma_f32_16x16x32_bf16 a[208:211], v[32:35], v[108:111], a[208:211]
    buffer_load_dwordx4 v19, s[20:23], s42 offen offset:3072 lds
    s_add_u32 s42, s42, 262144
    s_waitcnt lgkmcnt(1)
    v_mfma_f32_16x16x32_bf16 a[0:3], v[64:67], v[96:99], a[0:3]
    s_barrier
    v_mfma_f32_16x16x32_bf16 a[32:35], v[68:71], v[96:99], a[32:35]
    ds_read_b128 v[104:107], v11 offset:4096
    v_mfma_f32_16x16x32_bf16 a[4:7], v[72:75], v[96:99], a[4:7]
    v_mfma_f32_16x16x32_bf16 a[36:39], v[76:79], v[96:99], a[36:39]
    buffer_load_dwordx4 v[172:175], v21, s[44:47], s43 offen offset:1024 sc1
    v_mfma_f32_16x16x32_bf16 a[8:11], v[80:83], v[96:99], a[8:11]
    v_mfma_f32_16x16x32_bf16 a[40:43], v[84:87], v[96:99], a[40:43]
    v_mfma_f32_16x16x32_bf16 a[12:15], v[88:91], v[96:99], a[12:15]
    s_add_u32 m0, s24, 147456
    v_mfma_f32_16x16x32_bf16 a[44:47], v[92:95], v[96:99], a[44:47]
    buffer_load_dwordx4 v16, s[20:23], s49 offen offset:0 lds
    s_waitcnt lgkmcnt(1)
    v_mfma_f32_16x16x32_bf16 a[60:63], v[92:95], v[100:103], a[60:63]
    ds_read_b128 v[108:111], v11 offset:6144
    v_mfma_f32_16x16x32_bf16 a[28:31], v[88:91], v[100:103], a[28:31]
    v_mfma_f32_16x16x32_bf16 a[56:59], v[84:87], v[100:103], a[56:59]
    v_mfma_f32_16x16x32_bf16 a[24:27], v[80:83], v[100:103], a[24:27]
    buffer_load_dwordx4 v[180:183], v21, s[44:47], s43 offen offset:2048 sc1
    v_mfma_f32_16x16x32_bf16 a[52:55], v[76:79], v[100:103], a[52:55]
    v_mfma_f32_16x16x32_bf16 a[20:23], v[72:75], v[100:103], a[20:23]
    v_mfma_f32_16x16x32_bf16 a[48:51], v[68:71], v[100:103], a[48:51]
    v_mfma_f32_16x16x32_bf16 a[16:19], v[64:67], v[100:103], a[16:19]
    buffer_load_dwordx4 v17, s[20:23], s49 offen offset:1024 lds
    s_waitcnt lgkmcnt(1)
    v_mfma_f32_16x16x32_bf16 a[64:67], v[64:67], v[104:107], a[64:67]
    ds_read_b128 v[96:99], v11 offset:8192
    v_mfma_f32_16x16x32_bf16 a[96:99], v[68:71], v[104:107], a[96:99]
    v_mfma_f32_16x16x32_bf16 a[68:71], v[72:75], v[104:107], a[68:71]
    v_mfma_f32_16x16x32_bf16 a[100:103], v[76:79], v[104:107], a[100:103]
    buffer_load_dwordx4 v[188:191], v21, s[44:47], s43 offen offset:3072 sc1
    v_mfma_f32_16x16x32_bf16 a[72:75], v[80:83], v[104:107], a[72:75]
    v_mfma_f32_16x16x32_bf16 a[104:107], v[84:87], v[104:107], a[104:107]
    v_mfma_f32_16x16x32_bf16 a[76:79], v[88:91], v[104:107], a[76:79]
    v_mfma_f32_16x16x32_bf16 a[108:111], v[92:95], v[104:107], a[108:111]
    buffer_load_dwordx4 v18, s[20:23], s49 offen offset:2048 lds
    s_waitcnt lgkmcnt(1)
    v_mfma_f32_16x16x32_bf16 a[124:127], v[92:95], v[108:111], a[124:127]
    ds_read_b128 v[100:103], v11 offset:10240
    v_mfma_f32_16x16x32_bf16 a[92:95], v[88:91], v[108:111], a[92:95]
    v_mfma_f32_16x16x32_bf16 a[120:123], v[84:87], v[108:111], a[120:123]
    v_mfma_f32_16x16x32_bf16 a[88:91], v[80:83], v[108:111], a[88:91]
    buffer_load_dwordx4 v[196:199], v20, s[44:47], s48 offen offset:0 sc1
    v_mfma_f32_16x16x32_bf16 a[116:119], v[76:79], v[108:111], a[116:119]
    v_mfma_f32_16x16x32_bf16 a[84:87], v[72:75], v[108:111], a[84:87]
    v_mfma_f32_16x16x32_bf16 a[112:115], v[68:71], v[108:111], a[112:115]
    v_mfma_f32_16x16x32_bf16 a[80:83], v[64:67], v[108:111], a[80:83]
    buffer_load_dwordx4 v19, s[20:23], s49 offen offset:3072 lds
    s_waitcnt lgkmcnt(1)
    v_mfma_f32_16x16x32_bf16 a[128:131], v[64:67], v[96:99], a[128:131]
    ds_read_b128 v[104:107], v11 offset:12288
    s_add_u32 s49, s49, 262144
    v_mfma_f32_16x16x32_bf16 a[160:163], v[68:71], v[96:99], a[160:163]
    v_mfma_f32_16x16x32_bf16 a[132:135], v[72:75], v[96:99], a[132:135]
    v_mfma_f32_16x16x32_bf16 a[164:167], v[76:79], v[96:99], a[164:167]
    buffer_load_dwordx4 v[204:207], v20, s[44:47], s48 offen offset:1024 sc1
    v_mfma_f32_16x16x32_bf16 a[136:139], v[80:83], v[96:99], a[136:139]
    v_mfma_f32_16x16x32_bf16 a[168:171], v[84:87], v[96:99], a[168:171]
    v_mfma_f32_16x16x32_bf16 a[140:143], v[88:91], v[96:99], a[140:143]
    s_mov_b32 m0, s27
    v_mfma_f32_16x16x32_bf16 a[172:175], v[92:95], v[96:99], a[172:175]
    buffer_load_dwordx4 v16, s[20:23], s42 offen offset:0 lds
    s_waitcnt lgkmcnt(1)
    v_mfma_f32_16x16x32_bf16 a[188:191], v[92:95], v[100:103], a[188:191]
    ds_read_b128 v[108:111], v11 offset:14336
    v_mfma_f32_16x16x32_bf16 a[156:159], v[88:91], v[100:103], a[156:159]
    v_mfma_f32_16x16x32_bf16 a[184:187], v[84:87], v[100:103], a[184:187]
    v_mfma_f32_16x16x32_bf16 a[152:155], v[80:83], v[100:103], a[152:155]
    buffer_load_dwordx4 v[212:215], v20, s[44:47], s48 offen offset:2048 sc1
    v_mfma_f32_16x16x32_bf16 a[180:183], v[76:79], v[100:103], a[180:183]
    v_mfma_f32_16x16x32_bf16 a[148:151], v[72:75], v[100:103], a[148:151]
    v_mfma_f32_16x16x32_bf16 a[176:179], v[68:71], v[100:103], a[176:179]
    v_mfma_f32_16x16x32_bf16 a[144:147], v[64:67], v[100:103], a[144:147]
    buffer_load_dwordx4 v17, s[20:23], s42 offen offset:1024 lds
    s_waitcnt lgkmcnt(1)
    v_mfma_f32_16x16x32_bf16 a[192:195], v[64:67], v[104:107], a[192:195]
    v_mfma_f32_16x16x32_bf16 a[224:227], v[68:71], v[104:107], a[224:227]
    v_mfma_f32_16x16x32_bf16 a[196:199], v[72:75], v[104:107], a[196:199]
    v_mfma_f32_16x16x32_bf16 a[228:231], v[76:79], v[104:107], a[228:231]
    buffer_load_dwordx4 v[220:223], v20, s[44:47], s48 offen offset:3072 sc1
    v_mfma_f32_16x16x32_bf16 a[200:203], v[80:83], v[104:107], a[200:203]
    v_add_u32 v11, s52, v11
    v_mfma_f32_16x16x32_bf16 a[232:235], v[84:87], v[104:107], a[232:235]
    v_mfma_f32_16x16x32_bf16 a[204:207], v[88:91], v[104:107], a[204:207]
    v_mfma_f32_16x16x32_bf16 a[236:239], v[92:95], v[104:107], a[236:239]
    buffer_load_dwordx4 v18, s[20:23], s42 offen offset:2048 lds
    s_waitcnt lgkmcnt(0)
    v_mfma_f32_16x16x32_bf16 a[252:255], v[92:95], v[108:111], a[252:255]
    v_mfma_f32_16x16x32_bf16 a[220:223], v[88:91], v[108:111], a[220:223]
    v_mfma_f32_16x16x32_bf16 a[248:251], v[84:87], v[108:111], a[248:251]
    v_mfma_f32_16x16x32_bf16 a[216:219], v[80:83], v[108:111], a[216:219]
    v_mfma_f32_16x16x32_bf16 a[244:247], v[76:79], v[108:111], a[244:247]
    v_mfma_f32_16x16x32_bf16 a[212:215], v[72:75], v[108:111], a[212:215]
    v_mfma_f32_16x16x32_bf16 a[240:243], v[68:71], v[108:111], a[240:243]
    v_mfma_f32_16x16x32_bf16 a[208:211], v[64:67], v[108:111], a[208:211]
    buffer_load_dwordx4 v19, s[20:23], s42 offen offset:3072 lds
    s_add_u32 s42, s42, 262144
    s_branch L1_epi
L1_loopV:
    s_waitcnt lgkmcnt(1)
    v_mfma_f32_16x16x32_bf16 a[0:3], v[96:99], v[32:35], a[0:3]
    s_waitcnt vmcnt(17)
    s_barrier
    v_mfma_f32_16x16x32_bf16 a[4:7], v[96:99], v[36:39], a[4:7]
    ds_read_b128 v[104:107], v10 offset:4096
    v_mfma_f32_16x16x32_bf16 a[8:11], v[96:99], v[40:43], a[8:11]
    ds_read_b64_tr_b16 v[64:65], v2 offset:16384
    v_mfma_f32_16x16x32_bf16 a[12:15], v[96:99], v[44:47], a[12:15]
    ds_read_b64_tr_b16 v[66:67], v2 offset:18432
    v_mfma_f32_16x16x32_bf16 a[16:19], v[96:99], v[48:51], a[16:19]
    ds_read_b64_tr_b16 v[68:69], v3 offset:16384
    s_mov_b32 m0, s53
    v_mfma_f32_16x16x32_bf16 a[20:23], v[96:99], v[52:55], a[20:23]
    buffer_load_dwordx4 v12, s[16:19], s40 offen offset:0 lds
    v_mfma_f32_16x16x32_bf16 a[24:27], v[96:99], v[56:59], a[24:27]
    v_mfma_f32_16x16x32_bf16 a[28:31], v[96:99], v[60:63], a[28:31]
    s_waitcnt lgkmcnt(4)
    v_mfma_f32_16x16x32_bf16 a[60:63], v[100:103], v[60:63], a[60:63]
    ds_read_b128 v[108:111], v10 offset:6144
    v_mfma_f32_16x16x32_bf16 a[56:59], v[100:103], v[56:59], a[56:59]
    ds_read_b64_tr_b16 v[70:71], v3 offset:18432
    v_mfma_f32_16x16x32_bf16 a[52:55], v[100:103], v[52:55], a[52:55]
    ds_read_b64_tr_b16 v[72:73], v4 offset:16384
    v_mfma_f32_16x16x32_bf16 a[48:51], v[100:103], v[48:51], a[48:51]
    ds_read_b64_tr_b16 v[74:75], v4 offset:18432
    v_mfma_f32_16x16x32_bf16 a[44:47], v[100:103], v[44:47], a[44:47]
    v_mfma_f32_16x16x32_bf16 a[40:43], v[100:103], v[40:43], a[40:43]
    buffer_load_dwordx4 v13, s[16:19], s40 offen offset:1024 lds
    v_mfma_f32_16x16x32_bf16 a[36:39], v[100:103], v[36:39], a[36:39]
    v_mfma_f32_16x16x32_bf16 a[32:35], v[100:103], v[32:35], a[32:35]
    s_waitcnt lgkmcnt(7)
    v_mfma_f32_16x16x32_bf16 a[64:67], v[104:107], v[32:35], a[64:67]
    ds_read_b128 v[96:99], v10 offset:8192
    v_mfma_f32_16x16x32_bf16 a[68:71], v[104:107], v[36:39], a[68:71]
    ds_read_b64_tr_b16 v[76:77], v5 offset:16384
    v_mfma_f32_16x16x32_bf16 a[72:75], v[104:107], v[40:43], a[72:75]
    ds_read_b64_tr_b16 v[78:79], v5 offset:18432
    v_mfma_f32_16x16x32_bf16 a[76:79], v[104:107], v[44:47], a[76:79]
    ds_read_b64_tr_b16 v[80:81], v6 offset:16384
    v_mfma_f32_16x16x32_bf16 a[80:83], v[104:107], v[48:51], a[80:83]
    v_mfma_f32_16x16x32_bf16 a[84:87], v[104:107], v[52:55], a[84:87]
    buffer_load_dwordx4 v14, s[16:19], s40 offen offset:2048 lds
    v_mfma_f32_16x16x32_bf16 a[88:91], v[104:107], v[56:59], a[88:91]
    v_mfma_f32_16x16x32_bf16 a[92:95], v[104:107], v[60:63], a[92:95]
    s_waitcnt lgkmcnt(7)
    v_mfma_f32_16x16x32_bf16 a[124:127], v[108:111], v[60:63], a[124:127]
    ds_read_b128 v[100:103], v10 offset:10240
    v_mfma_f32_16x16x32_bf16 a[120:123], v[108:111], v[56:59], a[120:123]
    ds_read_b64_tr_b16 v[82:83], v6 offset:18432
    v_mfma_f32_16x16x32_bf16 a[116:119], v[108:111], v[52:55], a[116:119]
    ds_read_b64_tr_b16 v[84:85], v7 offset:16384
    v_mfma_f32_16x16x32_bf16 a[112:115], v[108:111], v[48:51], a[112:115]
    ds_read_b64_tr_b16 v[86:87], v7 offset:18432
    v_mfma_f32_16x16x32_bf16 a[108:111], v[108:111], v[44:47], a[108:111]
    v_mfma_f32_16x16x32_bf16 a[104:107], v[108:111], v[40:43], a[104:107]
    buffer_load_dwordx4 v15, s[16:19], s40 offen offset:3072 lds
    v_mfma_f32_16x16x32_bf16 a[100:103], v[108:111], v[36:39], a[100:103]
    v_mfma_f32_16x16x32_bf16 a[96:99], v[108:111], v[32:35], a[96:99]
    s_waitcnt lgkmcnt(7)
    v_mfma_f32_16x16x32_bf16 a[128:131], v[96:99], v[32:35], a[128:131]
    ds_read_b128 v[104:107], v10 offset:12288
    v_mfma_f32_16x16x32_bf16 a[132:135], v[96:99], v[36:39], a[132:135]
    ds_read_b64_tr_b16 v[88:89], v8 offset:16384
    v_mfma_f32_16x16x32_bf16 a[136:139], v[96:99], v[40:43], a[136:139]
    ds_read_b64_tr_b16 v[90:91], v8 offset:18432
    s_mov_b32 m0, s24
    v_mfma_f32_16x16x32_bf16 a[140:143], v[96:99], v[44:47], a[140:143]
    v_mfma_f32_16x16x32_bf16 a[144:147], v[96:99], v[48:51], a[144:147]
    buffer_load_dwordx4 v16, s[20:23], s42 offen offset:0 lds
    v_mfma_f32_16x16x32_bf16 a[148:151], v[96:99], v[52:55], a[148:151]
    v_mfma_f32_16x16x32_bf16 a[152:155], v[96:99], v[56:59], a[152:155]
    v_mfma_f32_16x16x32_bf16 a[156:159], v[96:99], v[60:63], a[156:159]
    s_waitcnt lgkmcnt(6)
    v_mfma_f32_16x16x32_bf16 a[188:191], v[100:103], v[60:63], a[188:191]
    ds_read_b128 v[108:111], v10 offset:14336
    v_mfma_f32_16x16x32_bf16 a[184:187], v[100:103], v[56:59], a[184:187]
    ds_read_b64_tr_b16 v[92:93], v9 offset:16384
    v_mfma_f32_16x16x32_bf16 a[180:183], v[100:103], v[52:55], a[180:183]
    ds_read_b64_tr_b16 v[94:95], v9 offset:18432
    v_mfma_f32_16x16x32_bf16 a[176:179], v[100:103], v[48:51], a[176:179]
    v_mfma_f32_16x16x32_bf16 a[172:175], v[100:103], v[44:47], a[172:175]
    buffer_load_dwordx4 v17, s[20:23], s42 offen offset:1024 lds
    v_mfma_f32_16x16x32_bf16 a[168:171], v[100:103], v[40:43], a[168:171]
    v_mfma_f32_16x16x32_bf16 a[164:167], v[100:103], v[36:39], a[164:167]
    v_mfma_f32_16x16x32_bf16 a[160:163], v[100:103], v[32:35], a[160:163]
    s_cmp_eq_u32 s54, s55
    s_cselect_b32 s52, s61, s60
    s_waitcnt lgkmcnt(5)
    v_mfma_f32_16x16x32_bf16 a[192:195], v[104:107], v[32:35], a[192:195]
    ds_read_b128 v[96:99], v11 offset:0
    v_mfma_f32_16x16x32_bf16 a[196:199], v[104:107], v[36:39], a[196:199]
    v_mfma_f32_16x16x32_bf16 a[200:203], v[104:107], v[40:43], a[200:203]
    buffer_load_dwordx4 v18, s[20:23], s42 offen offset:2048 lds
    v_mfma_f32_16x16x32_bf16 a[204:207], v[104:107], v[44:47], a[204:207]
    v_mfma_f32_16x16x32_bf16 a[208:211], v[104:107], v[48:51], a[208:211]
    v_add_u32 v10, s52, v10
    v_mfma_f32_16x16x32_bf16 a[212:215], v[104:107], v[52:55], a[212:215]
    v_mfma_f32_16x16x32_bf16 a[216:219], v[104:107], v[56:59], a[216:219]
    v_mfma_f32_16x16x32_bf16 a[220:223], v[104:107], v[60:63], a[220:223]
    s_waitcnt lgkmcnt(3)
    v_mfma_f32_16x16x32_bf16 a[252:255], v[108:111], v[60:63], a[252:255]
    ds_read_b128 v[100:103], v11 offset:2048
    v_mfma_f32_16x16x32_bf16 a[248:251], v[108:111], v[56:59], a[248:251]
    v_mfma_f32_16x16x32_bf16 a[244:247], v[108:111], v[52:55], a[244:247]
    buffer_load_dwordx4 v19, s[20:23], s42 offen offset:3072 lds
    v_mfma_f32_16x16x32_bf16 a[240:243], v[108:111], v[48:51], a[240:243]
    v_mfma_f32_16x16x32_bf16 a[236:239], v[108:111], v[44:47], a[236:239]
    v_mfma_f32_16x16x32_bf16 a[232:235], v[108:111], v[40:43], a[232:235]
    s_add_u32 s42, s42, 262144
    v_mfma_f32_16x16x32_bf16 a[228:231], v[108:111], v[36:39], a[228:231]
    v_mfma_f32_16x16x32_bf16 a[224:227], v[108:111], v[32:35], a[224:227]
    s_waitcnt lgkmcnt(1)
    v_mfma_f32_16x16x32_bf16 a[0:3], v[96:99], v[64:67], a[0:3]
    s_waitcnt vmcnt(13)
    s_barrier
    v_mfma_f32_16x16x32_bf16 a[4:7], v[96:99], v[68:71], a[4:7]
    ds_read_b128 v[104:107], v11 offset:4096
    v_mfma_f32_16x16x32_bf16 a[8:11], v[96:99], v[72:75], a[8:11]
    ds_read_b64_tr_b16 v[32:33], v2 offset:32768
    v_mfma_f32_16x16x32_bf16 a[12:15], v[96:99], v[76:79], a[12:15]
    ds_read_b64_tr_b16 v[34:35], v2 offset:34816
    v_mfma_f32_16x16x32_bf16 a[16:19], v[96:99], v[80:83], a[16:19]
    ds_read_b64_tr_b16 v[36:37], v3 offset:32768
    s_add_u32 m0, s53, 4096
    v_mfma_f32_16x16x32_bf16 a[20:23], v[96:99], v[84:87], a[20:23]
    buffer_load_dwordx4 v12, s[16:19], s41 offen offset:0 lds
    v_mfma_f32_16x16x32_bf16 a[24:27], v[96:99], v[88:91], a[24:27]
    v_mfma_f32_16x16x32_bf16 a[28:31], v[96:99], v[92:95], a[28:31]
    s_waitcnt lgkmcnt(4)
    v_mfma_f32_16x16x32_bf16 a[60:63], v[100:103], v[92:95], a[60:63]
    ds_read_b128 v[108:111], v11 offset:6144
    v_mfma_f32_16x16x32_bf16 a[56:59], v[100:103], v[88:91], a[56:59]
    ds_read_b64_tr_b16 v[38:39], v3 offset:34816
    v_mfma_f32_16x16x32_bf16 a[52:55], v[100:103], v[84:87], a[52:55]
    ds_read_b64_tr_b16 v[40:41], v4 offset:32768
    v_mfma_f32_16x16x32_bf16 a[48:51], v[100:103], v[80:83], a[48:51]
    ds_read_b64_tr_b16 v[42:43], v4 offset:34816
    v_mfma_f32_16x16x32_bf16 a[44:47], v[100:103], v[76:79], a[44:47]
    v_mfma_f32_16x16x32_bf16 a[40:43], v[100:103], v[72:75], a[40:43]
    buffer_load_dwordx4 v13, s[16:19], s41 offen offset:1024 lds
    v_mfma_f32_16x16x32_bf16 a[36:39], v[100:103], v[68:71], a[36:39]
    v_mfma_f32_16x16x32_bf16 a[32:35], v[100:103], v[64:67], a[32:35]
    s_waitcnt lgkmcnt(7)
    v_mfma_f32_16x16x32_bf16 a[64:67], v[104:107], v[64:67], a[64:67]
    ds_read_b128 v[96:99], v11 offset:8192
    v_mfma_f32_16x16x32_bf16 a[68:71], v[104:107], v[68:71], a[68:71]
    ds_read_b64_tr_b16 v[44:45], v5 offset:32768
    v_mfma_f32_16x16x32_bf16 a[72:75], v[104:107], v[72:75], a[72:75]
    ds_read_b64_tr_b16 v[46:47], v5 offset:34816
    v_mfma_f32_16x16x32_bf16 a[76:79], v[104:107], v[76:79], a[76:79]
    ds_read_b64_tr_b16 v[48:49], v6 offset:32768
    v_mfma_f32_16x16x32_bf16 a[80:83], v[104:107], v[80:83], a[80:83]
    v_mfma_f32_16x16x32_bf16 a[84:87], v[104:107], v[84:87], a[84:87]
    buffer_load_dwordx4 v14, s[16:19], s41 offen offset:2048 lds
    v_mfma_f32_16x16x32_bf16 a[88:91], v[104:107], v[88:91], a[88:91]
    v_mfma_f32_16x16x32_bf16 a[92:95], v[104:107], v[92:95], a[92:95]
    s_waitcnt lgkmcnt(7)
    v_mfma_f32_16x16x32_bf16 a[124:127], v[108:111], v[92:95], a[124:127]
    ds_read_b128 v[100:103], v11 offset:10240
    v_mfma_f32_16x16x32_bf16 a[120:123], v[108:111], v[88:91], a[120:123]
    ds_read_b64_tr_b16 v[50:51], v6 offset:34816
    v_mfma_f32_16x16x32_bf16 a[116:119], v[108:111], v[84:87], a[116:119]
    ds_read_b64_tr_b16 v[52:53], v7 offset:32768
    v_mfma_f32_16x16x32_bf16 a[112:115], v[108:111], v[80:83], a[112:115]
    ds_read_b64_tr_b16 v[54:55], v7 offset:34816
    v_mfma_f32_16x16x32_bf16 a[108:111], v[108:111], v[76:79], a[108:111]
    v_mfma_f32_16x16x32_bf16 a[104:107], v[108:111], v[72:75], a[104:107]
    buffer_load_dwordx4 v15, s[16:19], s41 offen offset:3072 lds
    v_mfma_f32_16x16x32_bf16 a[100:103], v[108:111], v[68:71], a[100:103]
    v_mfma_f32_16x16x32_bf16 a[96:99], v[108:111], v[64:67], a[96:99]
    s_waitcnt lgkmcnt(7)
    v_mfma_f32_16x16x32_bf16 a[128:131], v[96:99], v[64:67], a[128:131]
    ds_read_b128 v[104:107], v11 offset:12288
    v_mfma_f32_16x16x32_bf16 a[132:135], v[96:99], v[68:71], a[132:135]
    ds_read_b64_tr_b16 v[56:57], v8 offset:32768
    v_mfma_f32_16x16x32_bf16 a[136:139], v[96:99], v[72:75], a[136:139]
    ds_read_b64_tr_b16 v[58:59], v8 offset:34816
    s_mov_b32 m0, s25
    v_mfma_f32_16x16x32_bf16 a[140:143], v[96:99], v[76:79], a[140:143]
    v_mfma_f32_16x16x32_bf16 a[144:147], v[96:99], v[80:83], a[144:147]
    buffer_load_dwordx4 v16, s[20:23], s42 offen offset:0 lds
    v_mfma_f32_16x16x32_bf16 a[148:151], v[96:99], v[84:87], a[148:151]
    v_mfma_f32_16x16x32_bf16 a[152:155], v[96:99], v[88:91], a[152:155]
    v_mfma_f32_16x16x32_bf16 a[156:159], v[96:99], v[92:95], a[156:159]
    s_waitcnt lgkmcnt(6)
    v_mfma_f32_16x16x32_bf16 a[188:191], v[100:103], v[92:95], a[188:191]
    ds_read_b128 v[108:111], v11 offset:14336
    v_mfma_f32_16x16x32_bf16 a[184:187], v[100:103], v[88:91], a[184:187]
    ds_read_b64_tr_b16 v[60:61], v9 offset:32768
    v_mfma_f32_16x16x32_bf16 a[180:183], v[100:103], v[84:87], a[180:183]
    ds_read_b64_tr_b16 v[62:63], v9 offset:34816
    v_mfma_f32_16x16x32_bf16 a[176:179], v[100:103], v[80:83], a[176:179]
    v_mfma_f32_16x16x32_bf16 a[172:175], v[100:103], v[76:79], a[172:175]
    buffer_load_dwordx4 v17, s[20:23], s42 offen offset:1024 lds
    v_mfma_f32_16x16x32_bf16 a[168:171], v[100:103], v[72:75], a[168:171]
    v_mfma_f32_16x16x32_bf16 a[164:167], v[100:103], v[68:71], a[164:167]
    v_mfma_f32_16x16x32_bf16 a[160:163], v[100:103], v[64:67], a[160:163]
    s_waitcnt lgkmcnt(5)
    v_mfma_f32_16x16x32_bf16 a[192:195], v[104:107], v[64:67], a[192:195]
    ds_read_b128 v[96:99], v10 offset:0
    v_mfma_f32_16x16x32_bf16 a[196:199], v[104:107], v[68:71], a[196:199]
    v_mfma_f32_16x16x32_bf16 a[200:203], v[104:107], v[72:75], a[200:203]
    buffer_load_dwordx4 v18, s[20:23], s42 offen offset:2048 lds
    v_mfma_f32_16x16x32_bf16 a[204:207], v[104:107], v[76:79], a[204:207]
    v_mfma_f32_16x16x32_bf16 a[208:211], v[104:107], v[80:83], a[208:211]
    v_add_u32 v11, s52, v11
    v_mfma_f32_16x16x32_bf16 a[212:215], v[104:107], v[84:87], a[212:215]
    s_mov_b32 s53, s54
    s_add_u32 s54, s54, s52
    v_mfma_f32_16x16x32_bf16 a[216:219], v[104:107], v[88:91], a[216:219]
    s_add_u32 s40, s40, 128
    s_add_u32 s41, s41, 128
    v_mfma_f32_16x16x32_bf16 a[220:223], v[104:107], v[92:95], a[220:223]
    s_waitcnt lgkmcnt(3)
    v_mfma_f32_16x16x32_bf16 a[252:255], v[108:111], v[92:95], a[252:255]
    ds_read_b128 v[100:103], v10 offset:2048
    v_mfma_f32_16x16x32_bf16 a[248:251], v[108:111], v[88:91], a[248:251]
    v_mfma_f32_16x16x32_bf16 a[244:247], v[108:111], v[84:87], a[244:247]
    buffer_load_dwordx4 v19, s[20:23], s42 offen offset:3072 lds
    v_mfma_f32_16x16x32_bf16 a[240:243], v[108:111], v[80:83], a[240:243]
    v_mfma_f32_16x16x32_bf16 a[236:239], v[108:111], v[76:79], a[236:239]
    v_mfma_f32_16x16x32_bf16 a[232:235], v[108:111], v[72:75], a[232:235]
    s_add_u32 s42, s42, 262144
    v_mfma_f32_16x16x32_bf16 a[228:231], v[108:111], v[68:71], a[228:231]
    v_mfma_f32_16x16x32_bf16 a[224:227], v[108:111], v[64:67], a[224:227]
    s_waitcnt lgkmcnt(1)
    v_mfma_f32_16x16x32_bf16 a[0:3], v[96:99], v[32:35], a[0:3]
    s_waitcnt vmcnt(17)
    s_barrier
    v_mfma_f32_16x16x32_bf16 a[4:7], v[96:99], v[36:39], a[4:7]
    ds_read_b128 v[104:107], v10 offset:4096
    v_mfma_f32_16x16x32_bf16 a[8:11], v[96:99], v[40:43], a[8:11]
    ds_read_b64_tr_b16 v[64:65], v2 offset:49152
    v_mfma_f32_16x16x32_bf16 a[12:15], v[96:99], v[44:47], a[12:15]
    ds_read_b64_tr_b16 v[66:67], v2 offset:51200
    v_mfma_f32_16x16x32_bf16 a[16:19], v[96:99], v[48:51], a[16:19]
    ds_read_b64_tr_b16 v[68:69], v3 offset:49152
    s_mov_b32 m0, s53
    v_mfma_f32_16x16x32_bf16 a[20:23], v[96:99], v[52:55], a[20:23]
    buffer_load_dwordx4 v12, s[16:19], s40 offen offset:0 lds
    v_mfma_f32_16x16x32_bf16 a[24:27], v[96:99], v[56:59], a[24:27]
    v_mfma_f32_16x16x32_bf16 a[28:31], v[96:99], v[60:63], a[28:31]
    s_waitcnt lgkmcnt(4)
    v_mfma_f32_16x16x32_bf16 a[60:63], v[100:103], v[60:63], a[60:63]
    ds_read_b128 v[108:111], v10 offset:6144
    v_mfma_f32_16x16x32_bf16 a[56:59], v[100:103], v[56:59], a[56:59]
    ds_read_b64_tr_b16 v[70:71], v3 offset:51200
    v_mfma_f32_16x16x32_bf16 a[52:55], v[100:103], v[52:55], a[52:55]
    ds_read_b64_tr_b16 v[72:73], v4 offset:49152
    v_mfma_f32_16x16x32_bf16 a[48:51], v[100:103], v[48:51], a[48:51]
    ds_read_b64_tr_b16 v[74:75], v4 offset:51200
    v_mfma_f32_16x16x32_bf16 a[44:47], v[100:103], v[44:47], a[44:47]
    v_mfma_f32_16x16x32_bf16 a[40:43], v[100:103], v[40:43], a[40:43]
    buffer_load_dwordx4 v13, s[16:19], s40 offen offset:1024 lds
    v_mfma_f32_16x16x32_bf16 a[36:39], v[100:103], v[36:39], a[36:39]
    v_mfma_f32_16x16x32_bf16 a[32:35], v[100:103], v[32:35], a[32:35]
    s_waitcnt lgkmcnt(7)
    v_mfma_f32_16x16x32_bf16 a[64:67], v[104:107], v[32:35], a[64:67]
    ds_read_b128 v[96:99], v10 offset:8192
    v_mfma_f32_16x16x32_bf16 a[68:71], v[104:107], v[36:39], a[68:71]
    ds_read_b64_tr_b16 v[76:77], v5 offset:49152
    v_mfma_f32_16x16x32_bf16 a[72:75], v[104:107], v[40:43], a[72:75]
    ds_read_b64_tr_b16 v[78:79], v5 offset:51200
    v_mfma_f32_16x16x32_bf16 a[76:79], v[104:107], v[44:47], a[76:79]
    ds_read_b64_tr_b16 v[80:81], v6 offset:49152
    v_mfma_f32_16x16x32_bf16 a[80:83], v[104:107], v[48:51], a[80:83]
    v_mfma_f32_16x16x32_bf16 a[84:87], v[104:107], v[52:55], a[84:87]
    buffer_load_dwordx4 v14, s[16:19], s40 offen offset:2048 lds
    v_mfma_f32_16x16x32_bf16 a[88:91], v[104:107], v[56:59], a[88:91]
    v_mfma_f32_16x16x32_bf16 a[92:95], v[104:107], v[60:63], a[92:95]
    s_waitcnt lgkmcnt(7)
    v_mfma_f32_16x16x32_bf16 a[124:127], v[108:111], v[60:63], a[124:127]
    ds_read_b128 v[100:103], v10 offset:10240
    v_mfma_f32_16x16x32_bf16 a[120:123], v[108:111], v[56:59], a[120:123]
    ds_read_b64_tr_b16 v[82:83], v6 offset:51200
    v_mfma_f32_16x16x32_bf16 a[116:119], v[108:111], v[52:55], a[116:119]
    ds_read_b64_tr_b16 v[84:85], v7 offset:49152
    v_mfma_f32_16x16x32_bf16 a[112:115], v[108:111], v[48:51], a[112:115]
    ds_read_b64_tr_b16 v[86:87], v7 offset:51200
    v_mfma_f32_16x16x32_bf16 a[108:111], v[108:111], v[44:47], a[108:111]
    v_mfma_f32_16x16x32_bf16 a[104:107], v[108:111], v[40:43], a[104:107]
    buffer_load_dwordx4 v15, s[16:19], s40 offen offset:3072 lds
    v_mfma_f32_16x16x32_bf16 a[100:103], v[108:111], v[36:39], a[100:103]
    v_mfma_f32_16x16x32_bf16 a[96:99], v[108:111], v[32:35], a[96:99]
    s_waitcnt lgkmcnt(7)
    v_mfma_f32_16x16x32_bf16 a[128:131], v[96:99], v[32:35], a[128:131]
    ds_read_b128 v[104:107], v10 offset:12288
    v_mfma_f32_16x16x32_bf16 a[132:135], v[96:99], v[36:39], a[132:135]
    ds_read_b64_tr_b16 v[88:89], v8 offset:49152
    v_mfma_f32_16x16x32_bf16 a[136:139], v[96:99], v[40:43], a[136:139]
    ds_read_b64_tr_b16 v[90:91], v8 offset:51200
    s_mov_b32 m0, s26
    v_mfma_f32_16x16x32_bf16 a[140:143], v[96:99], v[44:47], a[140:143]
    v_mfma_f32_16x16x32_bf16 a[144:147], v[96:99], v[48:51], a[144:147]
    buffer_load_dwordx4 v16, s[20:23], s42 offen offset:0 lds
    v_mfma_f32_16x16x32_bf16 a[148:151], v[96:99], v[52:55], a[148:151]
    v_mfma_f32_16x16x32_bf16 a[152:155], v[96:99], v[56:59], a[152:155]
    v_mfma_f32_16x16x32_bf16 a[156:159], v[96:99], v[60:63], a[156:159]
    s_waitcnt lgkmcnt(6)
    v_mfma_f32_16x16x32_bf16 a[188:191], v[100:103], v[60:63], a[188:191]
    ds_read_b128 v[108:111], v10 offset:14336
    v_mfma_f32_16x16x32_bf16 a[184:187], v[100:103], v[56:59], a[184:187]
    ds_read_b64_tr_b16 v[92:93], v9 offset:49152
    v_mfma_f32_16x16x32_bf16 a[180:183], v[100:103], v[52:55], a[180:183]
    ds_read_b64_tr_b16 v[94:95], v9 offset:51200
    v_mfma_f32_16x16x32_bf16 a[176:179], v[100:103], v[48:51], a[176:179]
    v_mfma_f32_16x16x32_bf16 a[172:175], v[100:103], v[44:47], a[172:175]
    buffer_load_dwordx4 v17, s[20:23], s42 offen offset:1024 lds
    v_mfma_f32_16x16x32_bf16 a[168:171], v[100:103], v[40:43], a[168:171]
    v_mfma_f32_16x16x32_bf16 a[164:167], v[100:103], v[36:39], a[164:167]
    v_mfma_f32_16x16x32_bf16 a[160:163], v[100:103], v[32:35], a[160:163]
    s_cmp_eq_u32 s54, s55
    s_cselect_b32 s52, s61, s60
    s_waitcnt lgkmcnt(5)
    v_mfma_f32_16x16x32_bf16 a[192:195], v[104:107], v[32:35], a[192:195]
    ds_read_b128 v[96:99], v11 offset:0
    v_mfma_f32_16x16x32_bf16 a[196:199], v[104:107], v[36:39], a[196:199]
    v_mfma_f32_16x16x32_bf16 a[200:203], v[104:107], v[40:43], a[200:203]
    buffer_load_dwordx4 v18, s[20:23], s42 offen offset:2048 lds
    v_mfma_f32_16x16x32_bf16 a[204:207], v[104:107], v[44:47], a[204:207]
    v_mfma_f32_16x16x32_bf16 a[208:211], v[104:107], v[48:51], a[208:211]
    v_add_u32 v10, s52, v10
    v_mfma_f32_16x16x32_bf16 a[212:215], v[104:107], v[52:55], a[212:215]
    v_mfma_f32_16x16x32_bf16 a[216:219], v[104:107], v[56:59], a[216:219]
    v_mfma_f32_16x16x32_bf16 a[220:223], v[104:107], v[60:63], a[220:223]
    s_waitcnt lgkmcnt(3)
    v_mfma_f32_16x16x32_bf16 a[252:255], v[108:111], v[60:63], a[252:255]
    ds_read_b128 v[100:103], v11 offset:2048
    v_mfma_f32_16x16x32_bf16 a[248:251], v[108:111], v[56:59], a[248:251]
    v_mfma_f32_16x16x32_bf16 a[244:247], v[108:111], v[52:55], a[244:247]
    buffer_load_dwordx4 v19, s[20:23], s42 offen offset:3072 lds
    v_mfma_f32_16x16x32_bf16 a[240:243], v[108:111], v[48:51], a[240:243]
    v_mfma_f32_16x16x32_bf16 a[236:239], v[108:111], v[44:47], a[236:239]
    v_mfma_f32_16x16x32_bf16 a[232:235], v[108:111], v[40:43], a[232:235]
    s_add_u32 s42, s42, 262144
    v_mfma_f32_16x16x32_bf16 a[228:231], v[108:111], v[36:39], a[228:231]
    v_mfma_f32_16x16x32_bf16 a[224:227], v[108:111], v[32:35], a[224:227]
    s_waitcnt lgkmcnt(1)
    v_mfma_f32_16x16x32_bf16 a[0:3], v[96:99], v[64:67], a[0:3]
    s_waitcnt vmcnt(12)
    s_barrier
    v_mfma_f32_16x16x32_bf16 a[4:7], v[96:99], v[68:71], a[4:7]
    ds_read_b128 v[104:107], v11 offset:4096
    v_mfma_f32_16x16x32_bf16 a[8:11], v[96:99], v[72:75], a[8:11]
    ds_read_b64_tr_b16 v[32:33], v2 offset:0
    v_mfma_f32_16x16x32_bf16 a[12:15], v[96:99], v[76:79], a[12:15]
    ds_read_b64_tr_b16 v[34:35], v2 offset:2048
    v_mfma_f32_16x16x32_bf16 a[16:19], v[96:99], v[80:83], a[16:19]
    ds_read_b64_tr_b16 v[36:37], v3 offset:0
    s_add_u32 m0, s53, 4096
    v_mfma_f32_16x16x32_bf16 a[20:23], v[96:99], v[84:87], a[20:23]
    buffer_load_dwordx4 v12, s[16:19], s41 offen offset:0 lds
    v_mfma_f32_16x16x32_bf16 a[24:27], v[96:99], v[88:91], a[24:27]
    v_mfma_f32_16x16x32_bf16 a[28:31], v[96:99], v[92:95], a[28:31]
    s_waitcnt lgkmcnt(4)
    v_mfma_f32_16x16x32_bf16 a[60:63], v[100:103], v[92:95], a[60:63]
    ds_read_b128 v[108:111], v11 offset:6144
    v_mfma_f32_16x16x32_bf16 a[56:59], v[100:103], v[88:91], a[56:59]
    ds_read_b64_tr_b16 v[38:39], v3 offset:2048
    v_mfma_f32_16x16x32_bf16 a[52:55], v[100:103], v[84:87], a[52:55]
    ds_read_b64_tr_b16 v[40:41], v4 offset:0
    v_mfma_f32_16x16x32_bf16 a[48:51], v[100:103], v[80:83], a[48:51]
    ds_read_b64_tr_b16 v[42:43], v4 offset:2048
    v_mfma_f32_16x16x32_bf16 a[44:47], v[100:103], v[76:79], a[44:47]
    v_mfma_f32_16x16x32_bf16 a[40:43], v[100:103], v[72:75], a[40:43]
    buffer_load_dwordx4 v13, s[16:19], s41 offen offset:1024 lds
    v_mfma_f32_16x16x32_bf16 a[36:39], v[100:103], v[68:71], a[36:39]
    v_mfma_f32_16x16x32_bf16 a[32:35], v[100:103], v[64:67], a[32:35]
    s_waitcnt lgkmcnt(7)
    v_mfma_f32_16x16x32_bf16 a[64:67], v[104:107], v[64:67], a[64:67]
    ds_read_b128 v[96:99], v11 offset:8192
    v_mfma_f32_16x16x32_bf16 a[68:71], v[104:107], v[68:71], a[68:71]
    ds_read_b64_tr_b16 v[44:45], v5 offset:0
    v_mfma_f32_16x16x32_bf16 a[72:75], v[104:107], v[72:75], a[72:75]
    ds_read_b64_tr_b16 v[46:47], v5 offset:2048
    v_mfma_f32_16x16x32_bf16 a[76:79], v[104:107], v[76:79], a[76:79]
    ds_read_b64_tr_b16 v[48:49], v6 offset:0
    v_mfma_f32_16x16x32_bf16 a[80:83], v[104:107], v[80:83], a[80:83]
    v_mfma_f32_16x16x32_bf16 a[84:87], v[104:107], v[84:87], a[84:87]
    buffer_load_dwordx4 v14, s[16:19], s41 offen offset:2048 lds
    v_mfma_f32_16x16x32_bf16 a[88:91], v[104:107], v[88:91], a[88:91]
    v_mfma_f32_16x16x32_bf16 a[92:95], v[104:107], v[92:95], a[92:95]
    s_waitcnt lgkmcnt(7)
    v_mfma_f32_16x16x32_bf16 a[124:127], v[108:111], v[92:95], a[124:127]
    ds_read_b128 v[100:103], v11 offset:10240
    v_mfma_f32_16x16x32_bf16 a[120:123], v[108:111], v[88:91], a[120:123]
    ds_read_b64_tr_b16 v[50:51], v6 offset:2048
    v_mfma_f32_16x16x32_bf16 a[116:119], v[108:111], v[84:87], a[116:119]
    ds_read_b64_tr_b16 v[52:53], v7 offset:0
    v_mfma_f32_16x16x32_bf16 a[112:115], v[108:111], v[80:83], a[112:115]
    ds_read_b64_tr_b16 v[54:55], v7 offset:2048
    v_mfma_f32_16x16x32_bf16 a[108:111], v[108:111], v[76:79], a[108:111]
    v_mfma_f32_16x16x32_bf16 a[104:107], v[108:111], v[72:75], a[104:107]
    buffer_load_dwordx4 v15, s[16:19], s41 offen offset:3072 lds
    v_mfma_f32_16x16x32_bf16 a[100:103], v[108:111], v[68:71], a[100:103]
    v_mfma_f32_16x16x32_bf16 a[96:99], v[108:111], v[64:67], a[96:99]
    s_waitcnt lgkmcnt(7)
    v_mfma_f32_16x16x32_bf16 a[128:131], v[96:99], v[64:67], a[128:131]
    ds_read_b128 v[104:107], v11 offset:12288
    v_mfma_f32_16x16x32_bf16 a[132:135], v[96:99], v[68:71], a[132:135]
    ds_read_b64_tr_b16 v[56:57], v8 offset:0
    v_mfma_f32_16x16x32_bf16 a[136:139], v[96:99], v[72:75], a[136:139]
    ds_read_b64_tr_b16 v[58:59], v8 offset:2048
    s_mov_b32 m0, s27
    v_mfma_f32_16x16x32_bf16 a[140:143], v[96:99], v[76:79], a[140:143]
    v_mfma_f32_16x16x32_bf16 a[144:147], v[96:99], v[80:83], a[144:147]
    buffer_load_dwordx4 v16, s[20:23], s42 offen offset:0 lds
    v_mfma_f32_16x16x32_bf16 a[148:151], v[96:99], v[84:87], a[148:151]
    v_mfma_f32_16x16x32_bf16 a[152:155], v[96:99], v[88:91], a[152:155]
    v_mfma_f32_16x16x32_bf16 a[156:159], v[96:99], v[92:95], a[156:159]
    s_waitcnt lgkmcnt(6)
    v_mfma_f32_16x16x32_bf16 a[188:191], v[100:103], v[92:95], a[188:191]
    ds_read_b128 v[108:111], v11 offset:14336
    v_mfma_f32_16x16x32_bf16 a[184:187], v[100:103], v[88:91], a[184:187]
    ds_read_b64_tr_b16 v[60:61], v9 offset:0
    v_mfma_f32_16x16x32_bf16 a[180:183], v[100:103], v[84:87], a[180:183]
    ds_read_b64_tr_b16 v[62:63], v9 offset:2048
    v_mfma_f32_16x16x32_bf16 a[176:179], v[100:103], v[80:83], a[176:179]
    v_mfma_f32_16x16x32_bf16 a[172:175], v[100:103], v[76:79], a[172:175]
    buffer_load_dwordx4 v17, s[20:23], s42 offen offset:1024 lds
    v_mfma_f32_16x16x32_bf16 a[168:171], v[100:103], v[72:75], a[168:171]
    v_mfma_f32_16x16x32_bf16 a[164:167], v[100:103], v[68:71], a[164:167]
    v_mfma_f32_16x16x32_bf16 a[160:163], v[100:103], v[64:67], a[160:163]
    s_waitcnt lgkmcnt(5)
    v_mfma_f32_16x16x32_bf16 a[192:195], v[104:107], v[64:67], a[192:195]
    ds_read_b128 v[96:99], v10 offset:0
    v_mfma_f32_16x16x32_bf16 a[196:199], v[104:107], v[68:71], a[196:199]
    v_mfma_f32_16x16x32_bf16 a[200:203], v[104:107], v[72:75], a[200:203]
    buffer_load_dwordx4 v18, s[20:23], s42 offen offset:2048 lds
    v_mfma_f32_16x16x32_bf16 a[204:207], v[104:107], v[76:79], a[204:207]
    v_mfma_f32_16x16x32_bf16 a[208:211], v[104:107], v[80:83], a[208:211]
    v_add_u32 v11, s52, v11
    v_mfma_f32_16x16x32_bf16 a[212:215], v[104:107], v[84:87], a[212:215]
    s_mov_b32 s53, s54
    s_add_u32 s54, s54, s52
    v_mfma_f32_16x16x32_bf16 a[216:219], v[104:107], v[88:91], a[216:219]
    s_add_u32 s40, s40, 128
    s_add_u32 s41, s41, 128
    v_mfma_f32_16x16x32_bf16 a[220:223], v[104:107], v[92:95], a[220:223]
    s_waitcnt lgkmcnt(3)
    v_mfma_f32_16x16x32_bf16 a[252:255], v[108:111], v[92:95], a[252:255]
    ds_read_b128 v[100:103], v10 offset:2048
    v_mfma_f32_16x16x32_bf16 a[248:251], v[108:111], v[88:91], a[248:251]
    v_mfma_f32_16x16x32_bf16 a[244:247], v[108:111], v[84:87], a[244:247]
    buffer_load_dwordx4 v19, s[20:23], s42 offen offset:3072 lds
    s_bitcmp1_b32 s51, s50
    s_cbranch_scc1 L1_loopV_hk
L1_loopV_hr:
    v_mfma_f32_16x16x32_bf16 a[240:243], v[108:111], v[80:83], a[240:243]
    v_mfma_f32_16x16x32_bf16 a[236:239], v[108:111], v[76:79], a[236:239]
    buffer_load_dword v224, v23, s[68:71], s59 offen
    v_mfma_f32_16x16x32_bf16 a[232:235], v[108:111], v[72:75], a[232:235]
    s_add_u32 s42, s42, 262144
    s_add_u32 s59, s59, 4096
    v_mfma_f32_16x16x32_bf16 a[228:231], v[108:111], v[68:71], a[228:231]
    s_sub_u32 s50, s50, 1
    s_cmp_lg_u32 s50, 0
    v_mfma_f32_16x16x32_bf16 a[224:227], v[108:111], v[64:67], a[224:227]
    s_cbranch_scc1 L1_loopV
    v_cmp_ne_u32 vcc, s7, v28
    s_cbranch_vccnz L1_loopV_xw
L1_loopV_xr:
    v_mov_b32 v20, v1
    v_add_u32 v21, 0x1000, v1
    s_mov_b32 s43, 0
    s_movk_i32 s48, 8192
    s_lshr_b32 s62, s2, 3
    s_getpc_b64 s[64:65]
    s_add_u32 s64, s64, L1_epi@rel32@lo+4
    s_addc_u32 s65, s65, L1_epi@rel32@hi+12
    s_mul_i32 s3, s62, (((L2_end-L1_epi)/32+63)&~63)
    s_add_u32 s64, s64, s3
    s_addc_u32 s65, s65, 0
    s_sub_u32 s66, L2_end-L1_epi, s3
    s_cselect_b32 s66, 0, s66
    s_min_u32 s66, s66, (((L2_end-L1_epi)/32+63)&~63)
    s_mov_b32 s67, 0x20000
    v_lshlrev_b32 v30, 6, v0
    buffer_load_dword v31, v30, s[64:67], 0 offen
    s_getpc_b64 s[64:65]
    s_add_u32 s64, s64, L_done@rel32@lo+4
    s_addc_u32 s65, s65, L_done@rel32@hi+12
    s_mul_i32 s3, s62, (((L_hot_end-L_done)/32+63)&~63)
    s_add_u32 s64, s64, s3
    s_addc_u32 s65, s65, 0
    s_sub_u32 s66, L_hot_end-L_done, s3
    s_cselect_b32 s66, 0, s66
    s_min_u32 s66, s66, (((L_hot_end-L_done)/32+63)&~63)
    s_mov_b32 s67, 0x20000
    v_lshlrev_b32 v30, 6, v0
    buffer_load_dword v31, v30, s[64:67], 0 offen
    s_mov_b32 s20, s56
    s_mov_b32 s21, s57
    s_mov_b32 s22, s58
    s_mov_b32 s42, 0
    s_mov_b32 s49, 1572864
    s_waitcnt lgkmcnt(1)
    v_mfma_f32_16x16x32_bf16 a[0:3], v[96:99], v[32:35], a[0:3]
    s_waitcnt vmcnt(19)
    s_barrier
    v_mfma_f32_16x16x32_bf16 a[4:7], v[96:99], v[36:39], a[4:7]
    ds_read_b128 v[104:107], v10 offset:4096
    v_mfma_f32_16x16x32_bf16 a[8:11], v[96:99], v[40:43], a[8:11]
    ds_read_b64_tr_b16 v[64:65], v2 offset:16384
    v_mfma_f32_16x16x32_bf16 a[12:15], v[96:99], v[44:47], a[12:15]
    ds_read_b64_tr_b16 v[66:67], v2 offset:18432
    buffer_load_dwordx4 v[112:115], v20, s[44:47], s43 offen offset:0 sc1
    v_mfma_f32_16x16x32_bf16 a[16:19], v[96:99], v[48:51], a[16:19]
    ds_read_b64_tr_b16 v[68:69], v3 offset:16384
    v_mfma_f32_16x16x32_bf16 a[20:23], v[96:99], v[52:55], a[20:23]
    v_mfma_f32_16x16x32_bf16 a[24:27], v[96:99], v[56:59], a[24:27]
    s_add_u32 m0, s24, 98304
    v_mfma_f32_16x16x32_bf16 a[28:31], v[96:99], v[60:63], a[28:31]
    buffer_load_dwordx4 v16, s[20:23], s49 offen offset:0 lds
    s_waitcnt lgkmcnt(4)
    v_mfma_f32_16x16x32_bf16 a[60:63], v[100:103], v[60:63], a[60:63]
    ds_read_b128 v[108:111], v10 offset:6144
    v_mfma_f32_16x16x32_bf16 a[56:59], v[100:103], v[56:59], a[56:59]
    ds_read_b64_tr_b16 v[70:71], v3 offset:18432
    v_mfma_f32_16x16x32_bf16 a[52:55], v[100:103], v[52:55], a[52:55]
    ds_read_b64_tr_b16 v[72:73], v4 offset:16384
    v_mfma_f32_16x16x32_bf16 a[48:51], v[100:103], v[48:51], a[48:51]
    ds_read_b64_tr_b16 v[74:75], v4 offset:18432
    buffer_load_dwordx4 v[120:123], v20, s[44:47], s43 offen offset:1024 sc1
    v_mfma_f32_16x16x32_bf16 a[44:47], v[100:103], v[44:47], a[44:47]
    v_mfma_f32_16x16x32_bf16 a[40:43], v[100:103], v[40:43], a[40:43]
    v_mfma_f32_16x16x32_bf16 a[36:39], v[100:103], v[36:39], a[36:39]
    v_mfma_f32_16x16x32_bf16 a[32:35], v[100:103], v[32:35], a[32:35]
    buffer_load_dwordx4 v17, s[20:23], s49 offen offset:1024 lds
    s_waitcnt lgkmcnt(7)
    v_mfma_f32_16x16x32_bf16 a[64:67], v[104:107], v[32:35], a[64:67]
    ds_read_b128 v[96:99], v10 offset:8192
    v_mfma_f32_16x16x32_bf16 a[68:71], v[104:107], v[36:39], a[68:71]
    ds_read_b64_tr_b16 v[76:77], v5 offset:16384
    v_mfma_f32_16x16x32_bf16 a[72:75], v[104:107], v[40:43], a[72:75]
    ds_read_b64_tr_b16 v[78:79], v5 offset:18432
    v_mfma_f32_16x16x32_bf16 a[76:79], v[104:107], v[44:47], a[76:79]
    ds_read_b64_tr_b16 v[80:81], v6 offset:16384
    buffer_load_dwordx4 v[128:131], v20, s[44:47], s43 offen offset:2048 sc1
    v_mfma_f32_16x16x32_bf16 a[80:83], v[104:107], v[48:51], a[80:83]
    v_mfma_f32_16x16x32_bf16 a[84:87], v[104:107], v[52:55], a[84:87]
    v_mfma_f32_16x16x32_bf16 a[88:91], v[104:107], v[56:59], a[88:91]
    v_mfma_f32_16x16x32_bf16 a[92:95], v[104:107], v[60:63], a[92:95]
    buffer_load_dwordx4 v18, s[20:23], s49 offen offset:2048 lds
    s_waitcnt lgkmcnt(7)
    v_mfma_f32_16x16x32_bf16 a[124:127], v[108:111], v[60:63], a[124:127]
    ds_read_b128 v[100:103], v10 offset:10240
    v_mfma_f32_16x16x32_bf16 a[120:123], v[108:111], v[56:59], a[120:123]
    ds_read_b64_tr_b16 v[82:83], v6 offset:18432
    v_mfma_f32_16x16x32_bf16 a[116:119], v[108:111], v[52:55], a[116:119]
    ds_read_b64_tr_b16 v[84:85], v7 offset:16384
    v_mfma_f32_16x16x32_bf16 a[112:115], v[108:111], v[48:51], a[112:115]
    ds_read_b64_tr_b16 v[86:87], v7 offset:18432
    buffer_load_dwordx4 v[136:139], v20, s[44:47], s43 offen offset:3072 sc1
    v_mfma_f32_16x16x32_bf16 a[108:111], v[108:111], v[44:47], a[108:111]
    v_mfma_f32_16x16x32_bf16 a[104:107], v[108:111], v[40:43], a[104:107]
    v_mfma_f32_16x16x32_bf16 a[100:103], v[108:111], v[36:39], a[100:103]
    v_mfma_f32_16x16x32_bf16 a[96:99], v[108:111], v[32:35], a[96:99]
    buffer_load_dwordx4 v19, s[20:23], s49 offen offset:3072 lds
    s_waitcnt lgkmcnt(7)
    v_mfma_f32_16x16x32_bf16 a[128:131], v[96:99], v[32:35], a[128:131]
    ds_read_b128 v[104:107], v10 offset:12288
    s_add_u32 s49, s49, 262144
    v_mfma_f32_16x16x32_bf16 a[132:135], v[96:99], v[36:39], a[132:135]
    ds_read_b64_tr_b16 v[88:89], v8 offset:16384
    v_mfma_f32_16x16x32_bf16 a[136:139], v[96:99], v[40:43], a[136:139]
    ds_read_b64_tr_b16 v[90:91], v8 offset:18432
    v_mfma_f32_16x16x32_bf16 a[140:143], v[96:99], v[44:47], a[140:143]
    buffer_load_dwordx4 v[144:147], v21, s[44:47], s43 offen offset:0 sc1
    v_mfma_f32_16x16x32_bf16 a[144:147], v[96:99], v[48:51], a[144:147]
    v_mfma_f32_16x16x32_bf16 a[148:151], v[96:99], v[52:55], a[148:151]
    v_mfma_f32_16x16x32_bf16 a[152:155], v[96:99], v[56:59], a[152:155]
    s_mov_b32 m0, s24
    v_mfma_f32_16x16x32_bf16 a[156:159], v[96:99], v[60:63], a[156:159]
    buffer_load_dwordx4 v16, s[20:23], s42 offen offset:0 lds
    s_waitcnt lgkmcnt(6)
    v_mfma_f32_16x16x32_bf16 a[188:191], v[100:103], v[60:63], a[188:191]
    ds_read_b128 v[108:111], v10 offset:14336
    v_mfma_f32_16x16x32_bf16 a[184:187], v[100:103], v[56:59], a[184:187]
    ds_read_b64_tr_b16 v[92:93], v9 offset:16384
    v_mfma_f32_16x16x32_bf16 a[180:183], v[100:103], v[52:55], a[180:183]
    ds_read_b64_tr_b16 v[94:95], v9 offset:18432
    v_mfma_f32_16x16x32_bf16 a[176:179], v[100:103], v[48:51], a[176:179]
    buffer_load_dwordx4 v[152:155], v21, s[44:47], s43 offen offset:1024 sc1
    v_mfma_f32_16x16x32_bf16 a[172:175], v[100:103], v[44:47], a[172:175]
    v_mfma_f32_16x16x32_bf16 a[168:171], v[100:103], v[40:43], a[168:171]
    v_mfma_f32_16x16x32_bf16 a[164:167], v[100:103], v[36:39], a[164:167]
    v_mfma_f32_16x16x32_bf16 a[160:163], v[100:103], v[32:35], a[160:163]
    buffer_load_dwordx4 v17, s[20:23], s42 offen offset:1024 lds
    s_cmp_eq_u32 s54, s55
    s_cselect_b32 s52, s61, s60
    s_waitcnt lgkmcnt(5)
    v_mfma_f32_16x16x32_bf16 a[192:195], v[104:107], v[32:35], a[192:195]
    ds_read_b128 v[96:99], v11 offset:0
    v_mfma_f32_16x16x32_bf16 a[196:199], v[104:107], v[36:39], a[196:199]
    v_mfma_f32_16x16x32_bf16 a[200:203], v[104:107], v[40:43], a[200:203]
    v_mfma_f32_16x16x32_bf16 a[204:207], v[104:107], v[44:47], a[204:207]
    buffer_load_dwordx4 v[160:163], v21, s[44:47], s43 offen offset:2048 sc1
    v_mfma_f32_16x16x32_bf16 a[208:211], v[104:107], v[48:51], a[208:211]
    v_add_u32 v10, s52, v10
    v_mfma_f32_16x16x32_bf16 a[212:215], v[104:107], v[52:55], a[212:215]
    v_mfma_f32_16x16x32_bf16 a[216:219], v[104:107], v[56:59], a[216:219]
    v_mfma_f32_16x16x32_bf16 a[220:223], v[104:107], v[60:63], a[220:223]
    buffer_load_dwordx4 v18, s[20:23], s42 offen offset:2048 lds
    s_waitcnt lgkmcnt(3)
    v_mfma_f32_16x16x32_bf16 a[252:255], v[108:111], v[60:63], a[252:255]
    ds_read_b128 v[100:103], v11 offset:2048
    v_mfma_f32_16x16x32_bf16 a[248:251], v[108:111], v[56:59], a[248:251]
    v_mfma_f32_16x16x32_bf16 a[244:247], v[108:111], v[52:55], a[244:247]
    v_mfma_f32_16x16x32_bf16 a[240:243], v[108:111], v[48:51], a[240:243]
    v_mfma_f32_16x16x32_bf16 a[236:239], v[108:111], v[44:47], a[236:239]
    v_mfma_f32_16x16x32_bf16 a[232:235], v[108:111], v[40:43], a[232:235]
    v_mfma_f32_16x16x32_bf16 a[228:231], v[108:111], v[36:39], a[228:231]
    v_mfma_f32_16x16x32_bf16 a[224:227], v[108:111], v[32:35], a[224:227]
    buffer_load_dwordx4 v19, s[20:23], s42 offen offset:3072 lds
    s_add_u32 s42, s42, 262144
    s_waitcnt lgkmcnt(1)
    v_mfma_f32_16x16x32_bf16 a[0:3], v[96:99], v[64:67], a[0:3]
    s_waitcnt vmcnt(22)
    s_barrier
    v_mfma_f32_16x16x32_bf16 a[4:7], v[96:99], v[68:71], a[4:7]
    ds_read_b128 v[104:107], v11 offset:4096
    v_mfma_f32_16x16x32_bf16 a[8:11], v[96:99], v[72:75], a[8:11]
    ds_read_b64_tr_b16 v[32:33], v2 offset:32768
    v_mfma_f32_16x16x32_bf16 a[12:15], v[96:99], v[76:79], a[12:15]
    ds_read_b64_tr_b16 v[34:35], v2 offset:34816
    buffer_load_dwordx4 v[168:171], v21, s[44:47], s43 offen offset:3072 sc1
    v_mfma_f32_16x16x32_bf16 a[16:19], v[96:99], v[80:83], a[16:19]
    ds_read_b64_tr_b16 v[36:37], v3 offset:32768
    v_mfma_f32_16x16x32_bf16 a[20:23], v[96:99], v[84:87], a[20:23]
    v_mfma_f32_16x16x32_bf16 a[24:27], v[96:99], v[88:91], a[24:27]
    s_add_u32 m0, s24, 114688
    v_mfma_f32_16x16x32_bf16 a[28:31], v[96:99], v[92:95], a[28:31]
    buffer_load_dwordx4 v16, s[20:23], s49 offen offset:0 lds
    s_waitcnt lgkmcnt(4)
    v_mfma_f32_16x16x32_bf16 a[60:63], v[100:103], v[92:95], a[60:63]
    ds_read_b128 v[108:111], v11 offset:6144
    v_mfma_f32_16x16x32_bf16 a[56:59], v[100:103], v[88:91], a[56:59]
    ds_read_b64_tr_b16 v[38:39], v3 offset:34816
    v_mfma_f32_16x16x32_bf16 a[52:55], v[100:103], v[84:87], a[52:55]
    ds_read_b64_tr_b16 v[40:41], v4 offset:32768
    v_mfma_f32_16x16x32_bf16 a[48:51], v[100:103], v[80:83], a[48:51]
    ds_read_b64_tr_b16 v[42:43], v4 offset:34816
    buffer_load_dwordx4 v[176:179], v20, s[44:47], s48 offen offset:0 sc1
    v_mfma_f32_16x16x32_bf16 a[44:47], v[100:103], v[76:79], a[44:47]
    v_mfma_f32_16x16x32_bf16 a[40:43], v[100:103], v[72:75], a[40:43]
    v_mfma_f32_16x16x32_bf16 a[36:39], v[100:103], v[68:71], a[36:39]
    v_mfma_f32_16x16x32_bf16 a[32:35], v[100:103], v[64:67], a[32:35]
    buffer_load_dwordx4 v17, s[20:23], s49 offen offset:1024 lds
    s_waitcnt lgkmcnt(7)
    v_mfma_f32_16x16x32_bf16 a[64:67], v[104:107], v[64:67], a[64:67]
    ds_read_b128 v[96:99], v11 offset:8192
    v_mfma_f32_16x16x32_bf16 a[68:71], v[104:107], v[68:71], a[68:71]
    ds_read_b64_tr_b16 v[44:45], v5 offset:32768
    v_mfma_f32_16x16x32_bf16 a[72:75], v[104:107], v[72:75], a[72:75]
    ds_read_b64_tr_b16 v[46:47], v5 offset:34816
    v_mfma_f32_16x16x32_bf16 a[76:79], v[104:107], v[76:79], a[76:79]
    ds_read_b64_tr_b16 v[48:49], v6 offset:32768
    buffer_load_dwordx4 v[184:187], v20, s[44:47], s48 offen offset:1024 sc1
    v_mfma_f32_16x16x32_bf16 a[80:83], v[104:107], v[80:83], a[80:83]
    v_mfma_f32_16x16x32_bf16 a[84:87], v[104:107], v[84:87], a[84:87]
    v_mfma_f32_16x16x32_bf16 a[88:91], v[104:107], v[88:91], a[88:91]
    v_mfma_f32_16x16x32_bf16 a[92:95], v[104:107], v[92:95], a[92:95]
    buffer_load_dwordx4 v18, s[20:23], s49 offen offset:2048 lds
    s_waitcnt lgkmcnt(7)
    v_mfma_f32_16x16x32_bf16 a[124:127], v[108:111], v[92:95], a[124:127]
    ds_read_b128 v[100:103], v11 offset:10240
    v_mfma_f32_16x16x32_bf16 a[120:123], v[108:111], v[88:91], a[120:123]
    ds_read_b64_tr_b16 v[50:51], v6 offset:34816
    v_mfma_f32_16x16x32_bf16 a[116:119], v[108:111], v[84:87], a[116:119]
    ds_read_b64_tr_b16 v[52:53], v7 offset:32768
    v_mfma_f32_16x16x32_bf16 a[112:115], v[108:111], v[80:83], a[112:115]
    ds_read_b64_tr_b16 v[54:55], v7 offset:34816
    buffer_load_dwordx4 v[192:195], v20, s[44:47], s48 offen offset:2048 sc1
    v_mfma_f32_16x16x32_bf16 a[108:111], v[108:111], v[76:79], a[108:111]
    v_mfma_f32_16x16x32_bf16 a[104:107], v[108:111], v[72:75], a[104:107]
    v_mfma_f32_16x16x32_bf16 a[100:103], v[108:111], v[68:71], a[100:103]
    v_mfma_f32_16x16x32_bf16 a[96:99], v[108:111], v[64:67], a[96:99]
    buffer_load_dwordx4 v19, s[20:23], s49 offen offset:3072 lds
    s_waitcnt lgkmcnt(7)
    v_mfma_f32_16x16x32_bf16 a[128:131], v[96:99], v[64:67], a[128:131]
    ds_read_b128 v[104:107], v11 offset:12288
    s_add_u32 s49, s49, 262144
    v_mfma_f32_16x16x32_bf16 a[132:135], v[96:99], v[68:71], a[132:135]
    ds_read_b64_tr_b16 v[56:57], v8 offset:32768
    v_mfma_f32_16x16x32_bf16 a[136:139], v[96:99], v[72:75], a[136:139]
    ds_read_b64_tr_b16 v[58:59], v8 offset:34816
    v_mfma_f32_16x16x32_bf16 a[140:143], v[96:99], v[76:79], a[140:143]
    buffer_load_dwordx4 v[200:203], v20, s[44:47], s48 offen offset:3072 sc1
    v_mfma_f32_16x16x32_bf16 a[144:147], v[96:99], v[80:83], a[144:147]
    v_mfma_f32_16x16x32_bf16 a[148:151], v[96:99], v[84:87], a[148:151]
    v_mfma_f32_16x16x32_bf16 a[152:155], v[96:99], v[88:91], a[152:155]
    s_mov_b32 m0, s25
    v_mfma_f32_16x16x32_bf16 a[156:159], v[96:99], v[92:95], a[156:159]
    buffer_load_dwordx4 v16, s[20:23], s42 offen offset:0 lds
    s_waitcnt lgkmcnt(6)
    v_mfma_f32_16x16x32_bf16 a[188:191], v[100:103], v[92:95], a[188:191]
    ds_read_b128 v[108:111], v11 offset:14336
    v_mfma_f32_16x16x32_bf16 a[184:187], v[100:103], v[88:91], a[184:187]
    ds_read_b64_tr_b16 v[60:61], v9 offset:32768
    v_mfma_f32_16x16x32_bf16 a[180:183], v[100:103], v[84:87], a[180:183]
    ds_read_b64_tr_b16 v[62:63], v9 offset:34816
    v_mfma_f32_16x16x32_bf16 a[176:179], v[100:103], v[80:83], a[176:179]
    buffer_load_dwordx4 v[208:211], v21, s[44:47], s48 offen offset:0 sc1
    v_mfma_f32_16x16x32_bf16 a[172:175], v[100:103], v[76:79], a[172:175]
    v_mfma_f32_16x16x32_bf16 a[168:171], v[100:103], v[72:75], a[168:171]
    v_mfma_f32_16x16x32_bf16 a[164:167], v[100:103], v[68:71], a[164:167]
    v_mfma_f32_16x16x32_bf16 a[160:163], v[100:103], v[64:67], a[160:163]
    buffer_load_dwordx4 v17, s[20:23], s42 offen offset:1024 lds
    s_waitcnt lgkmcnt(5)
    v_mfma_f32_16x16x32_bf16 a[192:195], v[104:107], v[64:67], a[192:195]
    ds_read_b128 v[96:99], v10 offset:0
    v_mfma_f32_16x16x32_bf16 a[196:199], v[104:107], v[68:71], a[196:199]
    v_mfma_f32_16x16x32_bf16 a[200:203], v[104:107], v[72:75], a[200:203]
    v_mfma_f32_16x16x32_bf16 a[204:207], v[104:107], v[76:79], a[204:207]
    buffer_load_dwordx4 v[216:219], v21, s[44:47], s48 offen offset:1024 sc1
    v_mfma_f32_16x16x32_bf16 a[208:211], v[104:107], v[80:83], a[208:211]
    v_add_u32 v11, s52, v11
    v_mfma_f32_16x16x32_bf16 a[212:215], v[104:107], v[84:87], a[212:215]
    s_add_u32 s54, s54, s52
    v_mfma_f32_16x16x32_bf16 a[216:219], v[104:107], v[88:91], a[216:219]
    v_mfma_f32_16x16x32_bf16 a[220:223], v[104:107], v[92:95], a[220:223]
    buffer_load_dwordx4 v18, s[20:23], s42 offen offset:2048 lds
    s_waitcnt lgkmcnt(3)
    v_mfma_f32_16x16x32_bf16 a[252:255], v[108:111], v[92:95], a[252:255]
    ds_read_b128 v[100:103], v10 offset:2048
    v_mfma_f32_16x16x32_bf16 a[248:251], v[108:111], v[88:91], a[248:251]
    v_mfma_f32_16x16x32_bf16 a[244:247], v[108:111], v[84:87], a[244:247]
    v_mfma_f32_16x16x32_bf16 a[240:243], v[108:111], v[80:83], a[240:243]
    v_mfma_f32_16x16x32_bf16 a[236:239], v[108:111], v[76:79], a[236:239]
    v_mfma_f32_16x16x32_bf16 a[232:235], v[108:111], v[72:75], a[232:235]
    v_mfma_f32_16x16x32_bf16 a[228:231], v[108:111], v[68:71], a[228:231]
    v_mfma_f32_16x16x32_bf16 a[224:227], v[108:111], v[64:67], a[224:227]
    buffer_load_dwordx4 v19, s[20:23], s42 offen offset:3072 lds
    s_add_u32 s42, s42, 262144
    s_waitcnt lgkmcnt(1)
    v_mfma_f32_16x16x32_bf16 a[0:3], v[96:99], v[32:35], a[0:3]
    s_waitcnt vmcnt(33)
    s_barrier
    v_mfma_f32_16x16x32_bf16 a[4:7], v[96:99], v[36:39], a[4:7]
    ds_read_b128 v[104:107], v10 offset:4096
    v_mfma_f32_16x16x32_bf16 a[8:11], v[96:99], v[40:43], a[8:11]
    ds_read_b64_tr_b16 v[64:65], v2 offset:49152
    v_mfma_f32_16x16x32_bf16 a[12:15], v[96:99], v[44:47], a[12:15]
    ds_read_b64_tr_b16 v[66:67], v2 offset:51200
    buffer_load_dwordx4 v[116:119], v21, s[44:47], s48 offen offset:2048 sc1
    v_mfma_f32_16x16x32_bf16 a[16:19], v[96:99], v[48:51], a[16:19]
    ds_read_b64_tr_b16 v[68:69], v3 offset:49152
    v_mfma_f32_16x16x32_bf16 a[20:23], v[96:99], v[52:55], a[20:23]
    v_mfma_f32_16x16x32_bf16 a[24:27], v[96:99], v[56:59], a[24:27]
    s_add_u32 m0, s24, 131072
    v_mfma_f32_16x16x32_bf16 a[28:31], v[96:99], v[60:63], a[28:31]
    buffer_load_dwordx4 v16, s[20:23], s49 offen offset:0 lds
    s_waitcnt lgkmcnt(4)
    v_mfma_f32_16x16x32_bf16 a[60:63], v[100:103], v[60:63], a[60:63]
    ds_read_b128 v[108:111], v10 offset:6144
    v_mfma_f32_16x16x32_bf16 a[56:59], v[100:103], v[56:59], a[56:59]
    ds_read_b64_tr_b16 v[70:71], v3 offset:51200
    v_mfma_f32_16x16x32_bf16 a[52:55], v[100:103], v[52:55], a[52:55]
    ds_read_b64_tr_b16 v[72:73], v4 offset:49152
    v_mfma_f32_16x16x32_bf16 a[48:51], v[100:103], v[48:51], a[48:51]
    ds_read_b64_tr_b16 v[74:75], v4 offset:51200
    buffer_load_dwordx4 v[124:127], v21, s[44:47], s48 offen offset:3072 sc1
    v_mfma_f32_16x16x32_bf16 a[44:47], v[100:103], v[44:47], a[44:47]
    s_movk_i32 s43, 16384
    s_movk_i32 s48, 24576
    v_mfma_f32_16x16x32_bf16 a[40:43], v[100:103], v[40:43], a[40:43]
    v_mfma_f32_16x16x32_bf16 a[36:39], v[100:103], v[36:39], a[36:39]
    v_mfma_f32_16x16x32_bf16 a[32:35], v[100:103], v[32:35], a[32:35]
    buffer_load_dwordx4 v17, s[20:23], s49 offen offset:1024 lds
    s_waitcnt lgkmcnt(7)
    v_mfma_f32_16x16x32_bf16 a[64:67], v[104:107], v[32:35], a[64:67]
    ds_read_b128 v[96:99], v10 offset:8192
    v_mfma_f32_16x16x32_bf16 a[68:71], v[104:107], v[36:39], a[68:71]
    ds_read_b64_tr_b16 v[76:77], v5 offset:49152
    v_mfma_f32_16x16x32_bf16 a[72:75], v[104:107], v[40:43], a[72:75]
    ds_read_b64_tr_b16 v[78:79], v5 offset:51200
    v_mfma_f32_16x16x32_bf16 a[76:79], v[104:107], v[44:47], a[76:79]
    ds_read_b64_tr_b16 v[80:81], v6 offset:49152
    buffer_load_dwordx4 v[132:135], v20, s[44:47], s43 offen offset:0 sc1
    v_mfma_f32_16x16x32_bf16 a[80:83], v[104:107], v[48:51], a[80:83]
    v_mfma_f32_16x16x32_bf16 a[84:87], v[104:107], v[52:55], a[84:87]
    v_mfma_f32_16x16x32_bf16 a[88:91], v[104:107], v[56:59], a[88:91]
    v_mfma_f32_16x16x32_bf16 a[92:95], v[104:107], v[60:63], a[92:95]
    buffer_load_dwordx4 v18, s[20:23], s49 offen offset:2048 lds
    s_waitcnt lgkmcnt(7)
    v_mfma_f32_16x16x32_bf16 a[124:127], v[108:111], v[60:63], a[124:127]
    ds_read_b128 v[100:103], v10 offset:10240
    v_mfma_f32_16x16x32_bf16 a[120:123], v[108:111], v[56:59], a[120:123]
    ds_read_b64_tr_b16 v[82:83], v6 offset:51200
    v_mfma_f32_16x16x32_bf16 a[116:119], v[108:111], v[52:55], a[116:119]
    ds_read_b64_tr_b16 v[84:85], v7 offset:49152
    v_mfma_f32_16x16x32_bf16 a[112:115], v[108:111], v[48:51], a[112:115]
    ds_read_b64_tr_b16 v[86:87], v7 offset:51200
    buffer_load_dwordx4 v[140:143], v20, s[44:47], s43 offen offset:1024 sc1
    v_mfma_f32_16x16x32_bf16 a[108:111], v[108:111], v[44:47], a[108:111]
    v_mfma_f32_16x16x32_bf16 a[104:107], v[108:111], v[40:43], a[104:107]
    v_mfma_f32_16x16x32_bf16 a[100:103], v[108:111], v[36:39], a[100:103]
    v_mfma_f32_16x16x32_bf16 a[96:99], v[108:111], v[32:35], a[96:99]
    buffer_load_dwordx4 v19, s[20:23], s49 offen offset:3072 lds
    s_waitcnt lgkmcnt(7)
    v_mfma_f32_16x16x32_bf16 a[128:131], v[96:99], v[32:35], a[128:131]
    ds_read_b128 v[104:107], v10 offset:12288
    s_add_u32 s49, s49, 262144
    v_mfma_f32_16x16x32_bf16 a[132:135], v[96:99], v[36:39], a[132:135]
    ds_read_b64_tr_b16 v[88:89], v8 offset:49152
    v_mfma_f32_16x16x32_bf16 a[136:139], v[96:99], v[40:43], a[136:139]
    ds_read_b64_tr_b16 v[90:91], v8 offset:51200
    v_mfma_f32_16x16x32_bf16 a[140:143], v[96:99], v[44:47], a[140:143]
    buffer_load_dwordx4 v[148:151], v20, s[44:47], s43 offen offset:2048 sc1
    v_mfma_f32_16x16x32_bf16 a[144:147], v[96:99], v[48:51], a[144:147]
    v_mfma_f32_16x16x32_bf16 a[148:151], v[96:99], v[52:55], a[148:151]
    v_mfma_f32_16x16x32_bf16 a[152:155], v[96:99], v[56:59], a[152:155]
    s_mov_b32 m0, s26
    v_mfma_f32_16x16x32_bf16 a[156:159], v[96:99], v[60:63], a[156:159]
    buffer_load_dwordx4 v16, s[20:23], s42 offen offset:0 lds
    s_waitcnt lgkmcnt(6)
    v_mfma_f32_16x16x32_bf16 a[188:191], v[100:103], v[60:63], a[188:191]
    ds_read_b128 v[108:111], v10 offset:14336
    v_mfma_f32_16x16x32_bf16 a[184:187], v[100:103], v[56:59], a[184:187]
    ds_read_b64_tr_b16 v[92:93], v9 offset:49152
    v_mfma_f32_16x16x32_bf16 a[180:183], v[100:103], v[52:55], a[180:183]
    ds_read_b64_tr_b16 v[94:95], v9 offset:51200
    v_mfma_f32_16x16x32_bf16 a[176:179], v[100:103], v[48:51], a[176:179]
    buffer_load_dwordx4 v[156:159], v20, s[44:47], s43 offen offset:3072 sc1
    v_mfma_f32_16x16x32_bf16 a[172:175], v[100:103], v[44:47], a[172:175]
    v_mfma_f32_16x16x32_bf16 a[168:171], v[100:103], v[40:43], a[168:171]
    v_mfma_f32_16x16x32_bf16 a[164:167], v[100:103], v[36:39], a[164:167]
    v_mfma_f32_16x16x32_bf16 a[160:163], v[100:103], v[32:35], a[160:163]
    buffer_load_dwordx4 v17, s[20:23], s42 offen offset:1024 lds
    s_cmp_eq_u32 s54, s55
    s_cselect_b32 s52, s61, s60
    s_waitcnt lgkmcnt(5)
    v_mfma_f32_16x16x32_bf16 a[192:195], v[104:107], v[32:35], a[192:195]
    ds_read_b128 v[96:99], v11 offset:0
    v_mfma_f32_16x16x32_bf16 a[196:199], v[104:107], v[36:39], a[196:199]
    v_mfma_f32_16x16x32_bf16 a[200:203], v[104:107], v[40:43], a[200:203]
    v_mfma_f32_16x16x32_bf16 a[204:207], v[104:107], v[44:47], a[204:207]
    buffer_load_dwordx4 v[164:167], v21, s[44:47], s43 offen offset:0 sc1
    v_mfma_f32_16x16x32_bf16 a[208:211], v[104:107], v[48:51], a[208:211]
    v_add_u32 v10, s52, v10
    v_mfma_f32_16x16x32_bf16 a[212:215], v[104:107], v[52:55], a[212:215]
    v_mfma_f32_16x16x32_bf16 a[216:219], v[104:107], v[56:59], a[216:219]
    v_mfma_f32_16x16x32_bf16 a[220:223], v[104:107], v[60:63], a[220:223]
    buffer_load_dwordx4 v18, s[20:23], s42 offen offset:2048 lds
    s_waitcnt lgkmcnt(3)
    v_mfma_f32_16x16x32_bf16 a[252:255], v[108:111], v[60:63], a[252:255]
    ds_read_b128 v[100:103], v11 offset:2048
    v_mfma_f32_16x16x32_bf16 a[248:251], v[108:111], v[56:59], a[248:251]
    v_mfma_f32_16x16x32_bf16 a[244:247], v[108:111], v[52:55], a[244:247]
    v_mfma_f32_16x16x32_bf16 a[240:243], v[108:111], v[48:51], a[240:243]
    v_mfma_f32_16x16x32_bf16 a[236:239], v[108:111], v[44:47], a[236:239]
    v_mfma_f32_16x16x32_bf16 a[232:235], v[108:111], v[40:43], a[232:235]
    v_mfma_f32_16x16x32_bf16 a[228:231], v[108:111], v[36:39], a[228:231]
    v_mfma_f32_16x16x32_bf16 a[224:227], v[108:111], v[32:35], a[224:227]
    buffer_load_dwordx4 v19, s[20:23], s42 offen offset:3072 lds
    s_add_u32 s42, s42, 262144
    s_waitcnt lgkmcnt(1)
    v_mfma_f32_16x16x32_bf16 a[0:3], v[96:99], v[64:67], a[0:3]
    s_barrier
    v_mfma_f32_16x16x32_bf16 a[4:7], v[96:99], v[68:71], a[4:7]
    ds_read_b128 v[104:107], v11 offset:4096
    v_mfma_f32_16x16x32_bf16 a[8:11], v[96:99], v[72:75], a[8:11]
    v_mfma_f32_16x16x32_bf16 a[12:15], v[96:99], v[76:79], a[12:15]
    buffer_load_dwordx4 v[172:175], v21, s[44:47], s43 offen offset:1024 sc1
    v_mfma_f32_16x16x32_bf16 a[16:19], v[96:99], v[80:83], a[16:19]
    v_mfma_f32_16x16x32_bf16 a[20:23], v[96:99], v[84:87], a[20:23]
    v_mfma_f32_16x16x32_bf16 a[24:27], v[96:99], v[88:91], a[24:27]
    s_add_u32 m0, s24, 147456
    v_mfma_f32_16x16x32_bf16 a[28:31], v[96:99], v[92:95], a[28:31]
    buffer_load_dwordx4 v16, s[20:23], s49 offen offset:0 lds
    s_waitcnt lgkmcnt(1)
    v_mfma_f32_16x16x32_bf16 a[60:63], v[100:103], v[92:95], a[60:63]
    ds_read_b128 v[108:111], v11 offset:6144
    v_mfma_f32_16x16x32_bf16 a[56:59], v[100:103], v[88:91], a[56:59]
    v_mfma_f32_16x16x32_bf16 a[52:55], v[100:103], v[84:87], a[52:55]
    v_mfma_f32_16x16x32_bf16 a[48:51], v[100:103], v[80:83], a[48:51]
    buffer_load_dwordx4 v[180:183], v21, s[44:47], s43 offen offset:2048 sc1
    v_mfma_f32_16x16x32_bf16 a[44:47], v[100:103], v[76:79], a[44:47]
    v_mfma_f32_16x16x32_bf16 a[40:43], v[100:103], v[72:75], a[40:43]
    v_mfma_f32_16x16x32_bf16 a[36:39], v[100:103], v[68:71], a[36:39]
    v_mfma_f32_16x16x32_bf16 a[32:35], v[100:103], v[64:67], a[32:35]
    buffer_load_dwordx4 v17, s[20:23], s49 offen offset:1024 lds
    s_waitcnt lgkmcnt(1)
    v_mfma_f32_16x16x32_bf16 a[64:67], v[104:107], v[64:67], a[64:67]
    ds_read_b128 v[96:99], v11 offset:8192
    v_mfma_f32_16x16x32_bf16 a[68:71], v[104:107], v[68:71], a[68:71]
    v_mfma_f32_16x16x32_bf16 a[72:75], v[104:107], v[72:75], a[72:75]
    v_mfma_f32_16x16x32_bf16 a[76:79], v[104:107], v[76:79], a[76:79]
    buffer_load_dwordx4 v[188:191], v21, s[44:47], s43 offen offset:3072 sc1
    v_mfma_f32_16x16x32_bf16 a[80:83], v[104:107], v[80:83], a[80:83]
    v_mfma_f32_16x16x32_bf16 a[84:87], v[104:107], v[84:87], a[84:87]
    v_mfma_f32_16x16x32_bf16 a[88:91], v[104:107], v[88:91], a[88:91]
    v_mfma_f32_16x16x32_bf16 a[92:95], v[104:107], v[92:95], a[92:95]
    buffer_load_dwordx4 v18, s[20:23], s49 offen offset:2048 lds
    s_waitcnt lgkmcnt(1)
    v_mfma_f32_16x16x32_bf16 a[124:127], v[108:111], v[92:95], a[124:127]
    ds_read_b128 v[100:103], v11 offset:10240
    v_mfma_f32_16x16x32_bf16 a[120:123], v[108:111], v[88:91], a[120:123]
    v_mfma_f32_16x16x32_bf16 a[116:119], v[108:111], v[84:87], a[116:119]
    v_mfma_f32_16x16x32_bf16 a[112:115], v[108:111], v[80:83], a[112:115]
    buffer_load_dwordx4 v[196:199], v20, s[44:47], s48 offen offset:0 sc1
    v_mfma_f32_16x16x32_bf16 a[108:111], v[108:111], v[76:79], a[108:111]
    v_mfma_f32_16x16x32_bf16 a[104:107], v[108:111], v[72:75], a[104:107]
    v_mfma_f32_16x16x32_bf16 a[100:103], v[108:111], v[68:71], a[100:103]
    v_mfma_f32_16x16x32_bf16 a[96:99], v[108:111], v[64:67], a[96:99]
    buffer_load_dwordx4 v19, s[20:23], s49 offen offset:3072 lds
    s_waitcnt lgkmcnt(1)
    v_mfma_f32_16x16x32_bf16 a[128:131], v[96:99], v[64:67], a[128:131]
    ds_read_b128 v[104:107], v11 offset:12288
    s_add_u32 s49, s49, 262144
    v_mfma_f32_16x16x32_bf16 a[132:135], v[96:99], v[68:71], a[132:135]
    v_mfma_f32_16x16x32_bf16 a[136:139], v[96:99], v[72:75], a[136:139]
    v_mfma_f32_16x16x32_bf16 a[140:143], v[96:99], v[76:79], a[140:143]
    buffer_load_dwordx4 v[204:207], v20, s[44:47], s48 offen offset:1024 sc1
    v_mfma_f32_16x16x32_bf16 a[144:147], v[96:99], v[80:83], a[144:147]
    v_mfma_f32_16x16x32_bf16 a[148:151], v[96:99], v[84:87], a[148:151]
    v_mfma_f32_16x16x32_bf16 a[152:155], v[96:99], v[88:91], a[152:155]
    s_mov_b32 m0, s27
    v_mfma_f32_16x16x32_bf16 a[156:159], v[96:99], v[92:95], a[156:159]
    buffer_load_dwordx4 v16, s[20:23], s42 offen offset:0 lds
    s_waitcnt lgkmcnt(1)
    v_mfma_f32_16x16x32_bf16 a[188:191], v[100:103], v[92:95], a[188:191]
    ds_read_b128 v[108:111], v11 offset:14336
    v_mfma_f32_16x16x32_bf16 a[184:187], v[100:103], v[88:91], a[184:187]
    v_mfma_f32_16x16x32_bf16 a[180:183], v[100:103], v[84:87], a[180:183]
    v_mfma_f32_16x16x32_bf16 a[176:179], v[100:103], v[80:83], a[176:179]
    buffer_load_dwordx4 v[212:215], v20, s[44:47], s48 offen offset:2048 sc1
    v_mfma_f32_16x16x32_bf16 a[172:175], v[100:103], v[76:79], a[172:175]
    v_mfma_f32_16x16x32_bf16 a[168:171], v[100:103], v[72:75], a[168:171]
    v_mfma_f32_16x16x32_bf16 a[164:167], v[100:103], v[68:71], a[164:167]
    v_mfma_f32_16x16x32_bf16 a[160:163], v[100:103], v[64:67], a[160:163]
    buffer_load_dwordx4 v17, s[20:23], s42 offen offset:1024 lds
    s_waitcnt lgkmcnt(1)
    v_mfma_f32_16x16x32_bf16 a[192:195], v[104:107], v[64:67], a[192:195]
    v_mfma_f32_16x16x32_bf16 a[196:199], v[104:107], v[68:71], a[196:199]
    v_mfma_f32_16x16x32_bf16 a[200:203], v[104:107], v[72:75], a[200:203]
    v_mfma_f32_16x16x32_bf16 a[204:207], v[104:107], v[76:79], a[204:207]
    buffer_load_dwordx4 v[220:223], v20, s[44:47], s48 offen offset:3072 sc1
    v_mfma_f32_16x16x32_bf16 a[208:211], v[104:107], v[80:83], a[208:211]
    v_add_u32 v11, s52, v11
    v_mfma_f32_16x16x32_bf16 a[212:215], v[104:107], v[84:87], a[212:215]
    v_mfma_f32_16x16x32_bf16 a[216:219], v[104:107], v[88:91], a[216:219]
    v_mfma_f32_16x16x32_bf16 a[220:223], v[104:107], v[92:95], a[220:223]
    buffer_load_dwordx4 v18, s[20:23], s42 offen offset:2048 lds
    s_waitcnt lgkmcnt(0)
    v_mfma_f32_16x16x32_bf16 a[252:255], v[108:111], v[92:95], a[252:255]
    v_mfma_f32_16x16x32_bf16 a[248:251], v[108:111], v[88:91], a[248:251]
    v_mfma_f32_16x16x32_bf16 a[244:247], v[108:111], v[84:87], a[244:247]
    v_mfma_f32_16x16x32_bf16 a[240:243], v[108:111], v[80:83], a[240:243]
    v_mfma_f32_16x16x32_bf16 a[236:239], v[108:111], v[76:79], a[236:239]
    v_mfma_f32_16x16x32_bf16 a[232:235], v[108:111], v[72:75], a[232:235]
    v_mfma_f32_16x16x32_bf16 a[228:231], v[108:111], v[68:71], a[228:231]
    v_mfma_f32_16x16x32_bf16 a[224:227], v[108:111], v[64:67], a[224:227]
    buffer_load_dwordx4 v19, s[20:23], s42 offen offset:3072 lds
    s_add_u32 s42, s42, 262144
L1_epi:
    s_barrier
    s_lshl_b32 s3, s34, 8
    v_subrev_u32 v2, s3, v2
    v_subrev_u32 v3, s3, v3
    v_subrev_u32 v4, s3, v4
    v_subrev_u32 v5, s3, v5
    v_subrev_u32 v6, s3, v6
    v_subrev_u32 v7, s3, v7
    v_subrev_u32 v8, s3, v8
    v_subrev_u32 v9, s3, v9
    s_lshl_b32 s64, s35, 20
    s_lshl_b32 s3, s36, 17
    s_add_u32 s64, s64, s3
    s_lshl_b32 s3, s33, 16
    s_add_u32 s64, s64, s3
    s_add_u32 s3, s35, 513
    s_lshl_b32 s3, s3, 15
    s_mul_i32 s3, s3, s37
    s_add_u32 s64, s64, s3
    s_lshl_b32 s3, s34, 13
    s_add_u32 s64, s64, s3
    s_add_u32 s64, s64, 32768
    v_accvgpr_read_b32 v224, a128
    v_accvgpr_read_b32 v225, a129
    v_accvgpr_read_b32 v226, a130
    v_accvgpr_read_b32 v227, a131
    v_accvgpr_read_b32 v228, a160
    v_accvgpr_read_b32 v229, a161
    v_accvgpr_read_b32 v230, a162
    v_accvgpr_read_b32 v231, a163
    v_cvt_pk_bf16_f32 v64, v224, v225
    v_cvt_pk_bf16_f32 v65, v226, v227
    v_cvt_pk_bf16_f32 v66, v228, v229
    v_cvt_pk_bf16_f32 v67, v230, v231
    v_accvgpr_read_b32 v232, a132
    v_accvgpr_read_b32 v233, a133
    v_accvgpr_read_b32 v234, a134
    v_accvgpr_read_b32 v235, a135
    v_accvgpr_read_b32 v236, a164
    v_accvgpr_read_b32 v237, a165
    v_accvgpr_read_b32 v238, a166
    v_accvgpr_read_b32 v239, a167
    v_cvt_pk_bf16_f32 v68, v232, v233
    v_cvt_pk_bf16_f32 v69, v234, v235
    v_cvt_pk_bf16_f32 v70, v236, v237
    v_cvt_pk_bf16_f32 v71, v238, v239
    buffer_store_dwordx4 v[64:67], v1, s[72:75], s64 offen offset:0 sc1
    v_accvgpr_read_b32 v224, a136
    v_accvgpr_read_b32 v225, a137
    v_accvgpr_read_b32 v226, a138
    v_accvgpr_read_b32 v227, a139
    v_accvgpr_read_b32 v228, a168
    v_accvgpr_read_b32 v229, a169
    v_accvgpr_read_b32 v230, a170
    v_accvgpr_read_b32 v231, a171
    v_cvt_pk_bf16_f32 v72, v224, v225
    v_cvt_pk_bf16_f32 v73, v226, v227
    v_cvt_pk_bf16_f32 v74, v228, v229
    v_cvt_pk_bf16_f32 v75, v230, v231
    v_accvgpr_read_b32 v232, a140
    v_accvgpr_read_b32 v233, a141
    v_accvgpr_read_b32 v234, a142
    v_accvgpr_read_b32 v235, a143
    v_accvgpr_read_b32 v236, a172
    v_accvgpr_read_b32 v237, a173
    v_accvgpr_read_b32 v238, a174
    v_accvgpr_read_b32 v239, a175
    v_cvt_pk_bf16_f32 v76, v232, v233
    v_cvt_pk_bf16_f32 v77, v234, v235
    v_cvt_pk_bf16_f32 v78, v236, v237
    v_cvt_pk_bf16_f32 v79, v238, v239
    buffer_store_dwordx4 v[68:71], v1, s[72:75], s64 offen offset:1024 sc1
    v_accvgpr_read_b32 v224, a144
    v_accvgpr_read_b32 v225, a145
    v_accvgpr_read_b32 v226, a146
    v_accvgpr_read_b32 v227, a147
    v_accvgpr_read_b32 v228, a176
    v_accvgpr_read_b32 v229, a177
    v_accvgpr_read_b32 v230, a178
    v_accvgpr_read_b32 v231, a179
    v_cvt_pk_bf16_f32 v80, v224, v225
    v_cvt_pk_bf16_f32 v81, v226, v227
    v_cvt_pk_bf16_f32 v82, v228, v229
    v_cvt_pk_bf16_f32 v83, v230, v231
    v_accvgpr_read_b32 v232, a148
    v_accvgpr_read_b32 v233, a149
    v_accvgpr_read_b32 v234, a150
    v_accvgpr_read_b32 v235, a151
    v_accvgpr_read_b32 v236, a180
    v_accvgpr_read_b32 v237, a181
    v_accvgpr_read_b32 v238, a182
    v_accvgpr_read_b32 v239, a183
    v_cvt_pk_bf16_f32 v84, v232, v233
    v_cvt_pk_bf16_f32 v85, v234, v235
    v_cvt_pk_bf16_f32 v86, v236, v237
    v_cvt_pk_bf16_f32 v87, v238, v239
    buffer_store_dwordx4 v[72:75], v1, s[72:75], s64 offen offset:2048 sc1
    v_accvgpr_read_b32 v224, a152
    v_accvgpr_read_b32 v225, a153
    v_accvgpr_read_b32 v226, a154
    v_accvgpr_read_b32 v227, a155
    v_accvgpr_read_b32 v228, a184
    v_accvgpr_read_b32 v229, a185
    v_accvgpr_read_b32 v230, a186
    v_accvgpr_read_b32 v231, a187
    v_cvt_pk_bf16_f32 v88, v224, v225
    v_cvt_pk_bf16_f32 v89, v226, v227
    v_cvt_pk_bf16_f32 v90, v228, v229
    v_cvt_pk_bf16_f32 v91, v230, v231
    v_accvgpr_read_b32 v232, a156
    v_accvgpr_read_b32 v233, a157
    v_accvgpr_read_b32 v234, a158
    v_accvgpr_read_b32 v235, a159
    v_accvgpr_read_b32 v236, a188
    v_accvgpr_read_b32 v237, a189
    v_accvgpr_read_b32 v238, a190
    v_accvgpr_read_b32 v239, a191
    v_cvt_pk_bf16_f32 v92, v232, v233
    v_cvt_pk_bf16_f32 v93, v234, v235
    v_cvt_pk_bf16_f32 v94, v236, v237
    v_cvt_pk_bf16_f32 v95, v238, v239
    buffer_store_dwordx4 v[76:79], v1, s[72:75], s64 offen offset:3072 sc1
    s_add_u32 s64, s64, 4096
    v_accvgpr_read_b32 v224, a192
    v_accvgpr_read_b32 v225, a193
    v_accvgpr_read_b32 v226, a194
    v_accvgpr_read_b32 v227, a195
    v_accvgpr_read_b32 v228, a224
    v_accvgpr_read_b32 v229, a225
    v_accvgpr_read_b32 v230, a226
    v_accvgpr_read_b32 v231, a227
    v_cvt_pk_bf16_f32 v96, v224, v225
    v_cvt_pk_bf16_f32 v97, v226, v227
    v_cvt_pk_bf16_f32 v98, v228, v229
    v_cvt_pk_bf16_f32 v99, v230, v231
    v_accvgpr_read_b32 v232, a196
    v_accvgpr_read_b32 v233, a197
    v_accvgpr_read_b32 v234, a198
    v_accvgpr_read_b32 v235, a199
    v_accvgpr_read_b32 v236, a228
    v_accvgpr_read_b32 v237, a229
    v_accvgpr_read_b32 v238, a230
    v_accvgpr_read_b32 v239, a231
    v_cvt_pk_bf16_f32 v100, v232, v233
    v_cvt_pk_bf16_f32 v101, v234, v235
    v_cvt_pk_bf16_f32 v102, v236, v237
    v_cvt_pk_bf16_f32 v103, v238, v239
    buffer_store_dwordx4 v[80:83], v1, s[72:75], s64 offen offset:0 sc1
    v_accvgpr_read_b32 v224, a200
    v_accvgpr_read_b32 v225, a201
    v_accvgpr_read_b32 v226, a202
    v_accvgpr_read_b32 v227, a203
    v_accvgpr_read_b32 v228, a232
    v_accvgpr_read_b32 v229, a233
    v_accvgpr_read_b32 v230, a234
    v_accvgpr_read_b32 v231, a235
    v_cvt_pk_bf16_f32 v104, v224, v225
    v_cvt_pk_bf16_f32 v105, v226, v227
    v_cvt_pk_bf16_f32 v106, v228, v229
    v_cvt_pk_bf16_f32 v107, v230, v231
    v_accvgpr_read_b32 v232, a204
    v_accvgpr_read_b32 v233, a205
    v_accvgpr_read_b32 v234, a206
    v_accvgpr_read_b32 v235, a207
    v_accvgpr_read_b32 v236, a236
    v_accvgpr_read_b32 v237, a237
    v_accvgpr_read_b32 v238, a238
    v_accvgpr_read_b32 v239, a239
    v_cvt_pk_bf16_f32 v108, v232, v233
    v_cvt_pk_bf16_f32 v109, v234, v235
    v_cvt_pk_bf16_f32 v110, v236, v237
    v_cvt_pk_bf16_f32 v111, v238, v239
    buffer_store_dwordx4 v[84:87], v1, s[72:75], s64 offen offset:1024 sc1
    v_accvgpr_read_b32 v224, a208
    v_accvgpr_read_b32 v225, a209
    v_accvgpr_read_b32 v226, a210
    v_accvgpr_read_b32 v227, a211
    v_accvgpr_read_b32 v228, a240
    v_accvgpr_read_b32 v229, a241
    v_accvgpr_read_b32 v230, a242
    v_accvgpr_read_b32 v231, a243
    v_cvt_pk_bf16_f32 v240, v224, v225
    v_cvt_pk_bf16_f32 v241, v226, v227
    v_cvt_pk_bf16_f32 v242, v228, v229
    v_cvt_pk_bf16_f32 v243, v230, v231
    v_accvgpr_read_b32 v232, a212
    v_accvgpr_read_b32 v233, a213
    v_accvgpr_read_b32 v234, a214
    v_accvgpr_read_b32 v235, a215
    v_accvgpr_read_b32 v236, a244
    v_accvgpr_read_b32 v237, a245
    v_accvgpr_read_b32 v238, a246
    v_accvgpr_read_b32 v239, a247
    v_cvt_pk_bf16_f32 v244, v232, v233
    v_cvt_pk_bf16_f32 v245, v234, v235
    v_cvt_pk_bf16_f32 v246, v236, v237
    v_cvt_pk_bf16_f32 v247, v238, v239
    buffer_store_dwordx4 v[88:91], v1, s[72:75], s64 offen offset:2048 sc1
    v_accvgpr_read_b32 v224, a216
    v_accvgpr_read_b32 v225, a217
    v_accvgpr_read_b32 v226, a218
    v_accvgpr_read_b32 v227, a219
    v_accvgpr_read_b32 v228, a248
    v_accvgpr_read_b32 v229, a249
    v_accvgpr_read_b32 v230, a250
    v_accvgpr_read_b32 v231, a251
    v_cvt_pk_bf16_f32 v248, v224, v225
    v_cvt_pk_bf16_f32 v249, v226, v227
    v_cvt_pk_bf16_f32 v250, v228, v229
    v_cvt_pk_bf16_f32 v251, v230, v231
    v_accvgpr_read_b32 v232, a220
    v_accvgpr_read_b32 v233, a221
    v_accvgpr_read_b32 v234, a222
    v_accvgpr_read_b32 v235, a223
    v_accvgpr_read_b32 v236, a252
    v_accvgpr_read_b32 v237, a253
    v_accvgpr_read_b32 v238, a254
    v_accvgpr_read_b32 v239, a255
    v_cvt_pk_bf16_f32 v252, v232, v233
    v_cvt_pk_bf16_f32 v253, v234, v235
    v_cvt_pk_bf16_f32 v254, v236, v237
    v_cvt_pk_bf16_f32 v255, v238, v239
    buffer_store_dwordx4 v[92:95], v1, s[72:75], s64 offen offset:3072 sc1
    s_add_u32 s64, s64, 12288
    s_lshl_b32 s6, s35, 1
    s_add_u32 s6, s6, s37
    s_lshl_b32 s6, s6, 3
    s_add_u32 s6, s6, s36
    s_lshl_b32 s6, s6, 7
    s_mov_b32 s44, s32
    s_and_b32 s3, s2, 7
    s_lshr_b32 s46, s2, 3
    s_and_b32 s45, s46, 1
    s_lshl_b32 s3, s3, 1
    s_add_u32 s45, s45, s3
    s_lshr_b32 s46, s46, 1
    s_and_b32 s47, s46, 1
    s_lshr_b32 s46, s46, 1
    s_lshl_b32 s4, s45, 3
    s_add_u32 s4, s4, s46
    s_lshl_b32 s4, s4, 7
    s_add_u32 s5, s4, 49152
    s_add_u32 s4, s4, 32768
    s_lshl_b32 s3, s46, 2
    s_add_u32 s49, s3, 4
    s_mov_b32 s48, s46
    s_mov_b32 s50, 0
    s_lshl_b32 s41, s46, 7
    s_add_u32 s41, s41, 64
    s_sub_u32 s43, 24, s3
    s_sub_u32 s52, 64, s3
    s_cmp_ge_u32 s46, 6
    s_cselect_b32 s41, -1, s41
    s_cselect_b32 s52, s52, 40
    s_cselect_b32 s51, 0, s43
    s_cselect_b32 s53, 0, 2
    s_sub_u32 s3, 15, s46
    s_cmp_eq_u32 s47, 0
    s_cselect_b32 s48, s3, s48
    s_cselect_b32 s49, s52, s49
    s_cselect_b32 s50, s53, s50
    s_cselect_b32 s41, -1, s41
    s_cselect_b32 s51, s51, 0
    s_sub_u32 s39, s49, 4
    s_mov_b32 s33, 0
    s_lshl_b32 s37, s44, 12
    v_add_u32 v20, s37, v1
    s_lshl_b32 s3, s45, 20
    s_lshl_b32 s51, s51, 14
    s_add_u32 s51, s51, s3
    s_add_u32 s8, s14, s51
    s_addc_u32 s9, s15, 0
    s_lshl_b32 s10, s49, 14
    s_mov_b32 s11, 0x20000
    s_add_u32 s3, s45, 512
    s_lshl_b32 s3, s3, 15
    s_add_u32 s16, s8, s3
    s_addc_u32 s17, s9, 0
    s_add_u32 s18, s10, 32768
    s_mov_b32 s19, 0x20000
    s_mov_b32 s32, 0
    s_add_u32 s35, s37, 65536
    s_lshl_b32 s52, s45, 11
    s_mov_b32 s53, 0
    s_waitcnt vmcnt(8)
    s_barrier
    ds_read_b64_tr_b16 v[32:33], v2 offset:0
    ds_read_b64_tr_b16 v[34:35], v2 offset:2048
    ds_read_b64_tr_b16 v[36:37], v3 offset:0
    ds_read_b64_tr_b16 v[38:39], v3 offset:2048
    ds_read_b64_tr_b16 v[40:41], v4 offset:0
    ds_read_b64_tr_b16 v[42:43], v4 offset:2048
    ds_read_b64_tr_b16 v[44:45], v5 offset:0
    ds_read_b64_tr_b16 v[46:47], v5 offset:2048
    ds_read_b64_tr_b16 v[48:49], v6 offset:0
    ds_read_b64_tr_b16 v[50:51], v6 offset:2048
    ds_read_b64_tr_b16 v[52:53], v7 offset:0
    ds_read_b64_tr_b16 v[54:55], v7 offset:2048
    s_waitcnt lgkmcnt(8)
    v_mfma_f32_16x16x32_bf16 a[128:131], v[32:35], v[112:115], 0
    ds_read_b64_tr_b16 v[56:57], v8 offset:0
    v_mfma_f32_16x16x32_bf16 a[132:135], v[32:35], v[116:119], 0
    ds_read_b64_tr_b16 v[58:59], v8 offset:2048
    s_add_u32 m0, s24, 65536
    s_mov_b32 s42, 1048576
    v_mfma_f32_16x16x32_bf16 a[140:143], v[36:39], v[116:119], 0
    ds_read_b64_tr_b16 v[60:61], v9 offset:0
    buffer_load_dwordx4 v16, s[20:23], s42 offen offset:0 lds
    buffer_store_dwordx4 v[96:99], v1, s[72:75], s64 offen offset:0 sc1
    v_mfma_f32_16x16x32_bf16 a[136:139], v[36:39], v[112:115], 0
    ds_read_b64_tr_b16 v[62:63], v9 offset:2048
    s_waitcnt lgkmcnt(8)
    v_mfma_f32_16x16x32_bf16 a[144:147], v[40:43], v[112:115], 0
    ds_read_b64_tr_b16 v[32:33], v2 offset:256
    v_mfma_f32_16x16x32_bf16 a[148:151], v[40:43], v[116:119], 0
    ds_read_b64_tr_b16 v[34:35], v2 offset:2304
    v_mfma_f32_16x16x32_bf16 a[156:159], v[44:47], v[116:119], 0
    ds_read_b64_tr_b16 v[36:37], v3 offset:256
    v_mfma_f32_16x16x32_bf16 a[152:155], v[44:47], v[112:115], 0
    ds_read_b64_tr_b16 v[38:39], v3 offset:2304
    s_waitcnt lgkmcnt(8)
    v_mfma_f32_16x16x32_bf16 a[160:163], v[48:51], v[112:115], 0
    ds_read_b64_tr_b16 v[40:41], v4 offset:256
    buffer_load_dwordx4 v17, s[20:23], s42 offen offset:1024 lds
    v_mfma_f32_16x16x32_bf16 a[164:167], v[48:51], v[116:119], 0
    ds_read_b64_tr_b16 v[42:43], v4 offset:2304
    v_mfma_f32_16x16x32_bf16 a[172:175], v[52:55], v[116:119], 0
    ds_read_b64_tr_b16 v[44:45], v5 offset:256
    v_mfma_f32_16x16x32_bf16 a[168:171], v[52:55], v[112:115], 0
    ds_read_b64_tr_b16 v[46:47], v5 offset:2304
    s_waitcnt lgkmcnt(8)
    v_mfma_f32_16x16x32_bf16 a[176:179], v[56:59], v[112:115], 0
    ds_read_b64_tr_b16 v[48:49], v6 offset:256
    buffer_store_dwordx4 v[100:103], v1, s[72:75], s64 offen offset:1024 sc1
    v_mfma_f32_16x16x32_bf16 a[180:183], v[56:59], v[116:119], 0
    ds_read_b64_tr_b16 v[50:51], v6 offset:2304
    v_mfma_f32_16x16x32_bf16 a[188:191], v[60:63], v[116:119], 0
    ds_read_b64_tr_b16 v[52:53], v7 offset:256
    buffer_load_dwordx4 v18, s[20:23], s42 offen offset:2048 lds
    v_mfma_f32_16x16x32_bf16 a[184:187], v[60:63], v[112:115], 0
    ds_read_b64_tr_b16 v[54:55], v7 offset:2304
    s_waitcnt lgkmcnt(8)
    v_mfma_f32_16x16x32_bf16 a[192:195], v[32:35], v[112:115], 0
    ds_read_b64_tr_b16 v[56:57], v8 offset:256
    v_mfma_f32_16x16x32_bf16 a[196:199], v[32:35], v[116:119], 0
    ds_read_b64_tr_b16 v[58:59], v8 offset:2304
    v_mfma_f32_16x16x32_bf16 a[204:207], v[36:39], v[116:119], 0
    ds_read_b64_tr_b16 v[60:61], v9 offset:256
    v_mfma_f32_16x16x32_bf16 a[200:203], v[36:39], v[112:115], 0
    ds_read_b64_tr_b16 v[62:63], v9 offset:2304
    s_waitcnt lgkmcnt(8)
    v_mfma_f32_16x16x32_bf16 a[208:211], v[40:43], v[112:115], 0
    ds_read_b64_tr_b16 v[32:33], v2 offset:16384
    buffer_load_dwordx4 v19, s[20:23], s42 offen offset:3072 lds
    v_mfma_f32_16x16x32_bf16 a[212:215], v[40:43], v[116:119], 0
    ds_read_b64_tr_b16 v[34:35], v2 offset:18432
    v_mfma_f32_16x16x32_bf16 a[220:223], v[44:47], v[116:119], 0
    ds_read_b64_tr_b16 v[36:37], v3 offset:16384
    v_mfma_f32_16x16x32_bf16 a[216:219], v[44:47], v[112:115], 0
    ds_read_b64_tr_b16 v[38:39], v3 offset:18432
    s_waitcnt lgkmcnt(8)
    buffer_store_dwordx4 v[104:107], v1, s[72:75], s64 offen offset:2048 sc1
    v_mfma_f32_16x16x32_bf16 a[224:227], v[48:51], v[112:115], 0
    ds_read_b64_tr_b16 v[40:41], v4 offset:16384
    v_mfma_f32_16x16x32_bf16 a[228:231], v[48:51], v[116:119], 0
    ds_read_b64_tr_b16 v[42:43], v4 offset:18432
    s_add_u32 m0, s24, 81920
    s_mov_b32 s42, 1310720
    v_mfma_f32_16x16x32_bf16 a[236:239], v[52:55], v[116:119], 0
    ds_read_b64_tr_b16 v[44:45], v5 offset:16384
    buffer_load_dwordx4 v16, s[20:23], s42 offen offset:0 lds
    v_mfma_f32_16x16x32_bf16 a[232:235], v[52:55], v[112:115], 0
    ds_read_b64_tr_b16 v[46:47], v5 offset:18432
    s_waitcnt lgkmcnt(8)
    v_mfma_f32_16x16x32_bf16 a[240:243], v[56:59], v[112:115], 0
    ds_read_b64_tr_b16 v[48:49], v6 offset:16384
    v_mfma_f32_16x16x32_bf16 a[244:247], v[56:59], v[116:119], 0
    ds_read_b64_tr_b16 v[50:51], v6 offset:18432
    v_mfma_f32_16x16x32_bf16 a[252:255], v[60:63], v[116:119], 0
    ds_read_b64_tr_b16 v[52:53], v7 offset:16384
    v_mfma_f32_16x16x32_bf16 a[248:251], v[60:63], v[112:115], 0
    ds_read_b64_tr_b16 v[54:55], v7 offset:18432
    s_waitcnt lgkmcnt(8)
    v_mfma_f32_16x16x32_bf16 a[128:131], v[32:35], v[120:123], a[128:131]
    ds_read_b64_tr_b16 v[56:57], v8 offset:16384
    buffer_load_dwordx4 v17, s[20:23], s42 offen offset:1024 lds
    v_mfma_f32_16x16x32_bf16 a[132:135], v[32:35], v[124:127], a[132:135]
    ds_read_b64_tr_b16 v[58:59], v8 offset:18432
    v_mfma_f32_16x16x32_bf16 a[140:143], v[36:39], v[124:127], a[140:143]
    ds_read_b64_tr_b16 v[60:61], v9 offset:16384
    buffer_store_dwordx4 v[108:111], v1, s[72:75], s64 offen offset:3072 sc1
    s_add_u32 s64, s64, 4096
    v_mfma_f32_16x16x32_bf16 a[136:139], v[36:39], v[120:123], a[136:139]
    ds_read_b64_tr_b16 v[62:63], v9 offset:18432
    s_waitcnt lgkmcnt(8)
    v_mfma_f32_16x16x32_bf16 a[144:147], v[40:43], v[120:123], a[144:147]
    ds_read_b64_tr_b16 v[32:33], v2 offset:16640
    v_mfma_f32_16x16x32_bf16 a[148:151], v[40:43], v[124:127], a[148:151]
    ds_read_b64_tr_b16 v[34:35], v2 offset:18688
    v_mfma_f32_16x16x32_bf16 a[156:159], v[44:47], v[124:127], a[156:159]
    ds_read_b64_tr_b16 v[36:37], v3 offset:16640
    buffer_load_dwordx4 v18, s[20:23], s42 offen offset:2048 lds
    v_mfma_f32_16x16x32_bf16 a[152:155], v[44:47], v[120:123], a[152:155]
    ds_read_b64_tr_b16 v[38:39], v3 offset:18688
    s_waitcnt lgkmcnt(8)
    v_mfma_f32_16x16x32_bf16 a[160:163], v[48:51], v[120:123], a[160:163]
    ds_read_b64_tr_b16 v[40:41], v4 offset:16640
    v_mfma_f32_16x16x32_bf16 a[164:167], v[48:51], v[124:127], a[164:167]
    ds_read_b64_tr_b16 v[42:43], v4 offset:18688
    v_mfma_f32_16x16x32_bf16 a[172:175], v[52:55], v[124:127], a[172:175]
    ds_read_b64_tr_b16 v[44:45], v5 offset:16640
    v_mfma_f32_16x16x32_bf16 a[168:171], v[52:55], v[120:123], a[168:171]
    ds_read_b64_tr_b16 v[46:47], v5 offset:18688
    s_waitcnt lgkmcnt(8)
    v_mfma_f32_16x16x32_bf16 a[176:179], v[56:59], v[120:123], a[176:179]
    ds_read_b64_tr_b16 v[48:49], v6 offset:16640
    buffer_load_dwordx4 v19, s[20:23], s42 offen offset:3072 lds
    v_mfma_f32_16x16x32_bf16 a[180:183], v[56:59], v[124:127], a[180:183]
    ds_read_b64_tr_b16 v[50:51], v6 offset:18688
    buffer_store_dwordx4 v[240:243], v1, s[72:75], s64 offen offset:0 sc1
    v_mfma_f32_16x16x32_bf16 a[188:191], v[60:63], v[124:127], a[188:191]
    ds_read_b64_tr_b16 v[52:53], v7 offset:16640
    v_mfma_f32_16x16x32_bf16 a[184:187], v[60:63], v[120:123], a[184:187]
    ds_read_b64_tr_b16 v[54:55], v7 offset:18688
    s_waitcnt lgkmcnt(8)
    v_mfma_f32_16x16x32_bf16 a[192:195], v[32:35], v[120:123], a[192:195]
    ds_read_b64_tr_b16 v[56:57], v8 offset:16640
    v_mfma_f32_16x16x32_bf16 a[196:199], v[32:35], v[124:127], a[196:199]
    ds_read_b64_tr_b16 v[58:59], v8 offset:18688
    v_mfma_f32_16x16x32_bf16 a[204:207], v[36:39], v[124:127], a[204:207]
    ds_read_b64_tr_b16 v[60:61], v9 offset:16640
    s_mov_b32 s42, 2621440
    v_mfma_f32_16x16x32_bf16 a[200:203], v[36:39], v[120:123], a[200:203]
    ds_read_b64_tr_b16 v[62:63], v9 offset:18688
    s_waitcnt lgkmcnt(8)
    v_mfma_f32_16x16x32_bf16 a[208:211], v[40:43], v[120:123], a[208:211]
    ds_read_b64_tr_b16 v[32:33], v2 offset:32768
    v_mfma_f32_16x16x32_bf16 a[212:215], v[40:43], v[124:127], a[212:215]
    ds_read_b64_tr_b16 v[34:35], v2 offset:34816
    v_mfma_f32_16x16x32_bf16 a[220:223], v[44:47], v[124:127], a[220:223]
    ds_read_b64_tr_b16 v[36:37], v3 offset:32768
    v_mfma_f32_16x16x32_bf16 a[216:219], v[44:47], v[120:123], a[216:219]
    ds_read_b64_tr_b16 v[38:39], v3 offset:34816
    s_waitcnt lgkmcnt(8)
    buffer_store_dwordx4 v[244:247], v1, s[72:75], s64 offen offset:1024 sc1
    v_mfma_f32_16x16x32_bf16 a[224:227], v[48:51], v[120:123], a[224:227]
    ds_read_b64_tr_b16 v[40:41], v4 offset:32768
    v_mfma_f32_16x16x32_bf16 a[228:231], v[48:51], v[124:127], a[228:231]
    ds_read_b64_tr_b16 v[42:43], v4 offset:34816
    v_mfma_f32_16x16x32_bf16 a[236:239], v[52:55], v[124:127], a[236:239]
    ds_read_b64_tr_b16 v[44:45], v5 offset:32768
    v_accvgpr_read_b32 v224, a0
    v_mfma_f32_16x16x32_bf16 a[232:235], v[52:55], v[120:123], a[232:235]
    ds_read_b64_tr_b16 v[46:47], v5 offset:34816
    s_waitcnt lgkmcnt(8)
    v_accvgpr_read_b32 v225, a1
    v_mfma_f32_16x16x32_bf16 a[240:243], v[56:59], v[120:123], a[240:243]
    ds_read_b64_tr_b16 v[48:49], v6 offset:32768
    v_accvgpr_read_b32 v226, a2
    v_mfma_f32_16x16x32_bf16 a[244:247], v[56:59], v[124:127], a[244:247]
    ds_read_b64_tr_b16 v[50:51], v6 offset:34816
    v_accvgpr_read_b32 v227, a3
    v_mfma_f32_16x16x32_bf16 a[252:255], v[60:63], v[124:127], a[252:255]
    ds_read_b64_tr_b16 v[52:53], v7 offset:32768
    v_accvgpr_read_b32 v228, a32
    v_mfma_f32_16x16x32_bf16 a[248:251], v[60:63], v[120:123], a[248:251]
    ds_read_b64_tr_b16 v[54:55], v7 offset:34816
    s_waitcnt lgkmcnt(8)
    v_accvgpr_read_b32 v229, a33
    v_mfma_f32_16x16x32_bf16 a[128:131], v[32:35], v[128:131], a[128:131]
    ds_read_b64_tr_b16 v[56:57], v8 offset:32768
    v_accvgpr_read_b32 v230, a34
    v_mfma_f32_16x16x32_bf16 a[132:135], v[32:35], v[132:135], a[132:135]
    ds_read_b64_tr_b16 v[58:59], v8 offset:34816
    v_accvgpr_read_b32 v231, a35
    v_mfma_f32_16x16x32_bf16 a[140:143], v[36:39], v[132:135], a[140:143]
    ds_read_b64_tr_b16 v[60:61], v9 offset:32768
    buffer_store_dwordx4 v[248:251], v1, s[72:75], s64 offen offset:2048 sc1
    v_cvt_pk_bf16_f32 v64, v224, v225
    v_mfma_f32_16x16x32_bf16 a[136:139], v[36:39], v[128:131], a[136:139]
    ds_read_b64_tr_b16 v[62:63], v9 offset:34816
    s_waitcnt lgkmcnt(8)
    v_cvt_pk_bf16_f32 v65, v226, v227
    v_mfma_f32_16x16x32_bf16 a[144:147], v[40:43], v[128:131], a[144:147]
    ds_read_b64_tr_b16 v[32:33], v2 offset:33024
    v_cvt_pk_bf16_f32 v66, v228, v229
    v_mfma_f32_16x16x32_bf16 a[148:151], v[40:43], v[132:135], a[148:151]
    ds_read_b64_tr_b16 v[34:35], v2 offset:35072
    v_cvt_pk_bf16_f32 v67, v230, v231
    v_accvgpr_read_b32 v232, a4
    v_mfma_f32_16x16x32_bf16 a[156:159], v[44:47], v[132:135], a[156:159]
    ds_read_b64_tr_b16 v[36:37], v3 offset:33024
    v_accvgpr_read_b32 v233, a5
    v_mfma_f32_16x16x32_bf16 a[152:155], v[44:47], v[128:131], a[152:155]
    ds_read_b64_tr_b16 v[38:39], v3 offset:35072
    s_waitcnt lgkmcnt(8)
    v_accvgpr_read_b32 v234, a6
    v_mfma_f32_16x16x32_bf16 a[160:163], v[48:51], v[128:131], a[160:163]
    ds_read_b64_tr_b16 v[40:41], v4 offset:33024
    v_accvgpr_read_b32 v235, a7
    v_mfma_f32_16x16x32_bf16 a[164:167], v[48:51], v[132:135], a[164:167]
    ds_read_b64_tr_b16 v[42:43], v4 offset:35072
    v_accvgpr_read_b32 v236, a36
    v_mfma_f32_16x16x32_bf16 a[172:175], v[52:55], v[132:135], a[172:175]
    ds_read_b64_tr_b16 v[44:45], v5 offset:33024
    v_accvgpr_read_b32 v237, a37
    v_mfma_f32_16x16x32_bf16 a[168:171], v[52:55], v[128:131], a[168:171]
    ds_read_b64_tr_b16 v[46:47], v5 offset:35072
    s_waitcnt lgkmcnt(8)
    v_accvgpr_read_b32 v238, a38
    v_mfma_f32_16x16x32_bf16 a[176:179], v[56:59], v[128:131], a[176:179]
    ds_read_b64_tr_b16 v[48:49], v6 offset:33024
    v_accvgpr_read_b32 v239, a39
    v_mfma_f32_16x16x32_bf16 a[180:183], v[56:59], v[132:135], a[180:183]
    ds_read_b64_tr_b16 v[50:51], v6 offset:35072
    buffer_store_dwordx4 v[252:255], v1, s[72:75], s64 offen offset:3072 sc1
    s_sub_u32 s64, s64, 53248
    v_cvt_pk_bf16_f32 v68, v232, v233
    v_mfma_f32_16x16x32_bf16 a[188:191], v[60:63], v[132:135], a[188:191]
    ds_read_b64_tr_b16 v[52:53], v7 offset:33024
    v_cvt_pk_bf16_f32 v69, v234, v235
    v_mfma_f32_16x16x32_bf16 a[184:187], v[60:63], v[128:131], a[184:187]
    ds_read_b64_tr_b16 v[54:55], v7 offset:35072
    s_waitcnt lgkmcnt(8)
    v_cvt_pk_bf16_f32 v70, v236, v237
    v_accvgpr_read_b32 v224, a8
    v_mfma_f32_16x16x32_bf16 a[192:195], v[32:35], v[128:131], a[192:195]
    ds_read_b64_tr_b16 v[56:57], v8 offset:33024
    v_cvt_pk_bf16_f32 v71, v238, v239
    v_accvgpr_read_b32 v225, a9
    v_mfma_f32_16x16x32_bf16 a[196:199], v[32:35], v[132:135], a[196:199]
    ds_read_b64_tr_b16 v[58:59], v8 offset:35072
    v_accvgpr_read_b32 v226, a10
    v_mfma_f32_16x16x32_bf16 a[204:207], v[36:39], v[132:135], a[204:207]
    ds_read_b64_tr_b16 v[60:61], v9 offset:33024
    v_accvgpr_read_b32 v227, a11
    v_mfma_f32_16x16x32_bf16 a[200:203], v[36:39], v[128:131], a[200:203]
    ds_read_b64_tr_b16 v[62:63], v9 offset:35072
    s_waitcnt lgkmcnt(8)
    v_accvgpr_read_b32 v228, a40
    v_mfma_f32_16x16x32_bf16 a[208:211], v[40:43], v[128:131], a[208:211]
    ds_read_b64_tr_b16 v[32:33], v2 offset:49152
    v_accvgpr_read_b32 v229, a41
    v_mfma_f32_16x16x32_bf16 a[212:215], v[40:43], v[132:135], a[212:215]
    ds_read_b64_tr_b16 v[34:35], v2 offset:51200
    v_accvgpr_read_b32 v230, a42
    v_mfma_f32_16x16x32_bf16 a[220:223], v[44:47], v[132:135], a[220:223]
    ds_read_b64_tr_b16 v[36:37], v3 offset:49152
    v_accvgpr_read_b32 v231, a43
    v_mfma_f32_16x16x32_bf16 a[216:219], v[44:47], v[128:131], a[216:219]
    ds_read_b64_tr_b16 v[38:39], v3 offset:51200
    s_waitcnt lgkmcnt(8)
    v_cvt_pk_bf16_f32 v72, v224, v225
    v_mfma_f32_16x16x32_bf16 a[224:227], v[48:51], v[128:131], a[224:227]
    ds_read_b64_tr_b16 v[40:41], v4 offset:49152
    buffer_store_dwordx4 v[64:67], v1, s[72:75], s64 offen offset:0 sc1
    v_cvt_pk_bf16_f32 v73, v226, v227
    v_mfma_f32_16x16x32_bf16 a[228:231], v[48:51], v[132:135], a[228:231]
    ds_read_b64_tr_b16 v[42:43], v4 offset:51200
    v_cvt_pk_bf16_f32 v74, v228, v229
    v_mfma_f32_16x16x32_bf16 a[236:239], v[52:55], v[132:135], a[236:239]
    ds_read_b64_tr_b16 v[44:45], v5 offset:49152
    v_cvt_pk_bf16_f32 v75, v230, v231
    v_accvgpr_read_b32 v232, a12
    v_mfma_f32_16x16x32_bf16 a[232:235], v[52:55], v[128:131], a[232:235]
    ds_read_b64_tr_b16 v[46:47], v5 offset:51200
    s_waitcnt lgkmcnt(8)
    v_accvgpr_read_b32 v233, a13
    v_mfma_f32_16x16x32_bf16 a[240:243], v[56:59], v[128:131], a[240:243]
    ds_read_b64_tr_b16 v[48:49], v6 offset:49152
    v_accvgpr_read_b32 v234, a14
    v_mfma_f32_16x16x32_bf16 a[244:247], v[56:59], v[132:135], a[244:247]
    ds_read_b64_tr_b16 v[50:51], v6 offset:51200
    v_accvgpr_read_b32 v235, a15
    v_mfma_f32_16x16x32_bf16 a[252:255], v[60:63], v[132:135], a[252:255]
    ds_read_b64_tr_b16 v[52:53], v7 offset:49152
    v_accvgpr_read_b32 v236, a44
    v_mfma_f32_16x16x32_bf16 a[248:251], v[60:63], v[128:131], a[248:251]
    ds_read_b64_tr_b16 v[54:55], v7 offset:51200
    s_waitcnt lgkmcnt(8)
    v_accvgpr_read_b32 v237, a45
    v_mfma_f32_16x16x32_bf16 a[128:131], v[32:35], v[136:139], a[128:131]
    ds_read_b64_tr_b16 v[56:57], v8 offset:49152
    v_accvgpr_read_b32 v238, a46
    v_mfma_f32_16x16x32_bf16 a[132:135], v[32:35], v[140:143], a[132:135]
    ds_read_b64_tr_b16 v[58:59], v8 offset:51200
    v_accvgpr_read_b32 v239, a47
    v_mfma_f32_16x16x32_bf16 a[140:143], v[36:39], v[140:143], a[140:143]
    ds_read_b64_tr_b16 v[60:61], v9 offset:49152
    v_cvt_pk_bf16_f32 v76, v232, v233
    v_mfma_f32_16x16x32_bf16 a[136:139], v[36:39], v[136:139], a[136:139]
    ds_read_b64_tr_b16 v[62:63], v9 offset:51200
    s_waitcnt lgkmcnt(8)
    buffer_store_dwordx4 v[68:71], v1, s[72:75], s64 offen offset:1024 sc1
    v_cvt_pk_bf16_f32 v77, v234, v235
    v_mfma_f32_16x16x32_bf16 a[144:147], v[40:43], v[136:139], a[144:147]
    ds_read_b64_tr_b16 v[32:33], v2 offset:49408
    v_cvt_pk_bf16_f32 v78, v236, v237
    v_mfma_f32_16x16x32_bf16 a[148:151], v[40:43], v[140:143], a[148:151]
    ds_read_b64_tr_b16 v[34:35], v2 offset:51456
    v_add_u32 v2, 0x10000, v2
    v_cvt_pk_bf16_f32 v79, v238, v239
    v_accvgpr_read_b32 v224, a16
    v_mfma_f32_16x16x32_bf16 a[156:159], v[44:47], v[140:143], a[156:159]
    ds_read_b64_tr_b16 v[36:37], v3 offset:49408
    v_accvgpr_read_b32 v225, a17
    v_mfma_f32_16x16x32_bf16 a[152:155], v[44:47], v[136:139], a[152:155]
    ds_read_b64_tr_b16 v[38:39], v3 offset:51456
    v_add_u32 v3, 0x10000, v3
    s_waitcnt lgkmcnt(8)
    v_accvgpr_read_b32 v226, a18
    v_mfma_f32_16x16x32_bf16 a[160:163], v[48:51], v[136:139], a[160:163]
    ds_read_b64_tr_b16 v[40:41], v4 offset:49408
    v_accvgpr_read_b32 v227, a19
    v_mfma_f32_16x16x32_bf16 a[164:167], v[48:51], v[140:143], a[164:167]
    ds_read_b64_tr_b16 v[42:43], v4 offset:51456
    v_add_u32 v4, 0x10000, v4
    v_accvgpr_read_b32 v228, a48
    v_mfma_f32_16x16x32_bf16 a[172:175], v[52:55], v[140:143], a[172:175]
    ds_read_b64_tr_b16 v[44:45], v5 offset:49408
    v_accvgpr_read_b32 v229, a49
    v_mfma_f32_16x16x32_bf16 a[168:171], v[52:55], v[136:139], a[168:171]
    ds_read_b64_tr_b16 v[46:47], v5 offset:51456
    v_add_u32 v5, 0x10000, v5
    s_waitcnt lgkmcnt(8)
    v_accvgpr_read_b32 v230, a50
    v_mfma_f32_16x16x32_bf16 a[176:179], v[56:59], v[136:139], a[176:179]
    ds_read_b64_tr_b16 v[48:49], v6 offset:49408
    v_accvgpr_read_b32 v231, a51
    v_mfma_f32_16x16x32_bf16 a[180:183], v[56:59], v[140:143], a[180:183]
    ds_read_b64_tr_b16 v[50:51], v6 offset:51456
    v_add_u32 v6, 0x10000, v6
    buffer_store_dwordx4 v[72:75], v1, s[72:75], s64 offen offset:2048 sc1
    v_cvt_pk_bf16_f32 v80, v224, v225
    v_mfma_f32_16x16x32_bf16 a[188:191], v[60:63], v[140:143], a[188:191]
    ds_read_b64_tr_b16 v[52:53], v7 offset:49408
    v_cvt_pk_bf16_f32 v81, v226, v227
    v_mfma_f32_16x16x32_bf16 a[184:187], v[60:63], v[136:139], a[184:187]
    ds_read_b64_tr_b16 v[54:55], v7 offset:51456
    v_add_u32 v7, 0x10000, v7
    s_waitcnt lgkmcnt(8)
    v_cvt_pk_bf16_f32 v82, v228, v229
    v_mfma_f32_16x16x32_bf16 a[192:195], v[32:35], v[136:139], a[192:195]
    ds_read_b64_tr_b16 v[56:57], v8 offset:49408
    v_cvt_pk_bf16_f32 v83, v230, v231
    v_accvgpr_read_b32 v232, a20
    v_mfma_f32_16x16x32_bf16 a[196:199], v[32:35], v[140:143], a[196:199]
    ds_read_b64_tr_b16 v[58:59], v8 offset:51456
    v_add_u32 v8, 0x10000, v8
    v_accvgpr_read_b32 v233, a21
    v_mfma_f32_16x16x32_bf16 a[204:207], v[36:39], v[140:143], a[204:207]
    ds_read_b64_tr_b16 v[60:61], v9 offset:49408
    v_accvgpr_read_b32 v234, a22
    v_mfma_f32_16x16x32_bf16 a[200:203], v[36:39], v[136:139], a[200:203]
    ds_read_b64_tr_b16 v[62:63], v9 offset:51456
    v_add_u32 v9, 0x10000, v9
    s_waitcnt lgkmcnt(8)
    s_waitcnt vmcnt(7)
    s_barrier
    v_accvgpr_read_b32 v235, a23
    v_mfma_f32_16x16x32_bf16 a[208:211], v[40:43], v[136:139], a[208:211]
    ds_read_b64_tr_b16 v[32:33], v2 offset:0
    v_accvgpr_read_b32 v236, a52
    v_mfma_f32_16x16x32_bf16 a[212:215], v[40:43], v[140:143], a[212:215]
    ds_read_b64_tr_b16 v[34:35], v2 offset:2048
    v_accvgpr_read_b32 v237, a53
    v_mfma_f32_16x16x32_bf16 a[220:223], v[44:47], v[140:143], a[220:223]
    ds_read_b64_tr_b16 v[36:37], v3 offset:0
    v_accvgpr_read_b32 v238, a54
    v_mfma_f32_16x16x32_bf16 a[216:219], v[44:47], v[136:139], a[216:219]
    ds_read_b64_tr_b16 v[38:39], v3 offset:2048
    s_waitcnt lgkmcnt(8)
    v_accvgpr_read_b32 v239, a55
    v_mfma_f32_16x16x32_bf16 a[224:227], v[48:51], v[136:139], a[224:227]
    ds_read_b64_tr_b16 v[40:41], v4 offset:0
    buffer_store_dwordx4 v[76:79], v1, s[72:75], s64 offen offset:3072 sc1
    s_add_u32 s64, s64, 4096
    v_cvt_pk_bf16_f32 v84, v232, v233
    v_mfma_f32_16x16x32_bf16 a[228:231], v[48:51], v[140:143], a[228:231]
    ds_read_b64_tr_b16 v[42:43], v4 offset:2048
    v_cvt_pk_bf16_f32 v85, v234, v235
    v_mfma_f32_16x16x32_bf16 a[236:239], v[52:55], v[140:143], a[236:239]
    ds_read_b64_tr_b16 v[44:45], v5 offset:0
    v_cvt_pk_bf16_f32 v86, v236, v237
    v_accvgpr_read_b32 v224, a24
    v_mfma_f32_16x16x32_bf16 a[232:235], v[52:55], v[136:139], a[232:235]
    ds_read_b64_tr_b16 v[46:47], v5 offset:2048
    s_waitcnt lgkmcnt(8)
    v_cvt_pk_bf16_f32 v87, v238, v239
    v_accvgpr_read_b32 v225, a25
    v_mfma_f32_16x16x32_bf16 a[240:243], v[56:59], v[136:139], a[240:243]
    ds_read_b64_tr_b16 v[48:49], v6 offset:0
    v_accvgpr_read_b32 v226, a26
    v_mfma_f32_16x16x32_bf16 a[244:247], v[56:59], v[140:143], a[244:247]
    ds_read_b64_tr_b16 v[50:51], v6 offset:2048
    v_accvgpr_read_b32 v227, a27
    v_mfma_f32_16x16x32_bf16 a[252:255], v[60:63], v[140:143], a[252:255]
    ds_read_b64_tr_b16 v[52:53], v7 offset:0
    v_accvgpr_read_b32 v228, a56
    v_mfma_f32_16x16x32_bf16 a[248:251], v[60:63], v[136:139], a[248:251]
    ds_read_b64_tr_b16 v[54:55], v7 offset:2048
    s_waitcnt lgkmcnt(8)
    v_accvgpr_read_b32 v229, a57
    v_mfma_f32_16x16x32_bf16 a[128:131], v[32:35], v[144:147], a[128:131]
    ds_read_b64_tr_b16 v[56:57], v8 offset:0
    v_accvgpr_read_b32 v230, a58
    v_mfma_f32_16x16x32_bf16 a[132:135], v[32:35], v[148:151], a[132:135]
    ds_read_b64_tr_b16 v[58:59], v8 offset:2048
    v_accvgpr_read_b32 v231, a59
    v_mfma_f32_16x16x32_bf16 a[140:143], v[36:39], v[148:151], a[140:143]
    ds_read_b64_tr_b16 v[60:61], v9 offset:0
    v_cvt_pk_bf16_f32 v88, v224, v225
    v_mfma_f32_16x16x32_bf16 a[136:139], v[36:39], v[144:147], a[136:139]
    ds_read_b64_tr_b16 v[62:63], v9 offset:2048
    s_waitcnt lgkmcnt(8)
    buffer_store_dwordx4 v[80:83], v1, s[72:75], s64 offen offset:0 sc1
    v_cvt_pk_bf16_f32 v89, v226, v227
    v_mfma_f32_16x16x32_bf16 a[144:147], v[40:43], v[144:147], a[144:147]
    ds_read_b64_tr_b16 v[32:33], v2 offset:256
    s_barrier
    v_cvt_pk_bf16_f32 v90, v228, v229
    v_mfma_f32_16x16x32_bf16 a[148:151], v[40:43], v[148:151], a[148:151]
    ds_read_b64_tr_b16 v[34:35], v2 offset:2304
    v_cvt_pk_bf16_f32 v91, v230, v231
    v_accvgpr_read_b32 v232, a28
    v_mfma_f32_16x16x32_bf16 a[156:159], v[44:47], v[148:151], a[156:159]
    ds_read_b64_tr_b16 v[36:37], v3 offset:256
    s_mov_b32 m0, s24
    v_accvgpr_read_b32 v233, a29
    v_mfma_f32_16x16x32_bf16 a[152:155], v[44:47], v[144:147], a[152:155]
    ds_read_b64_tr_b16 v[38:39], v3 offset:2304
    s_waitcnt lgkmcnt(8)
    buffer_load_dwordx4 v16, s[20:23], s42 offen offset:0 lds
    v_accvgpr_read_b32 v234, a30
    v_mfma_f32_16x16x32_bf16 a[160:163], v[48:51], v[144:147], a[160:163]
    ds_read_b64_tr_b16 v[40:41], v4 offset:256
    v_accvgpr_read_b32 v235, a31
    v_mfma_f32_16x16x32_bf16 a[164:167], v[48:51], v[148:151], a[164:167]
    ds_read_b64_tr_b16 v[42:43], v4 offset:2304
    v_accvgpr_read_b32 v236, a60
    v_mfma_f32_16x16x32_bf16 a[172:175], v[52:55], v[148:151], a[172:175]
    ds_read_b64_tr_b16 v[44:45], v5 offset:256
    v_accvgpr_read_b32 v237, a61
    v_mfma_f32_16x16x32_bf16 a[168:171], v[52:55], v[144:147], a[168:171]
    ds_read_b64_tr_b16 v[46:47], v5 offset:2304
    s_waitcnt lgkmcnt(8)
    v_accvgpr_read_b32 v238, a62
    v_mfma_f32_16x16x32_bf16 a[176:179], v[56:59], v[144:147], a[176:179]
    ds_read_b64_tr_b16 v[48:49], v6 offset:256
    v_accvgpr_read_b32 v239, a63
    v_mfma_f32_16x16x32_bf16 a[180:183], v[56:59], v[148:151], a[180:183]
    ds_read_b64_tr_b16 v[50:51], v6 offset:2304
    buffer_load_dwordx4 v17, s[20:23], s42 offen offset:1024 lds
    v_cvt_pk_bf16_f32 v92, v232, v233
    v_mfma_f32_16x16x32_bf16 a[188:191], v[60:63], v[148:151], a[188:191]
    ds_read_b64_tr_b16 v[52:53], v7 offset:256
    buffer_store_dwordx4 v[84:87], v1, s[72:75], s64 offen offset:1024 sc1
    v_cvt_pk_bf16_f32 v93, v234, v235
    v_mfma_f32_16x16x32_bf16 a[184:187], v[60:63], v[144:147], a[184:187]
    ds_read_b64_tr_b16 v[54:55], v7 offset:2304
    s_waitcnt lgkmcnt(8)
    v_cvt_pk_bf16_f32 v94, v236, v237
    v_mfma_f32_16x16x32_bf16 a[192:195], v[32:35], v[144:147], a[192:195]
    ds_read_b64_tr_b16 v[56:57], v8 offset:256
    v_cvt_pk_bf16_f32 v95, v238, v239
    v_accvgpr_read_b32 v224, a64
    v_mfma_f32_16x16x32_bf16 a[196:199], v[32:35], v[148:151], a[196:199]
    ds_read_b64_tr_b16 v[58:59], v8 offset:2304
    v_accvgpr_read_b32 v225, a65
    v_mfma_f32_16x16x32_bf16 a[204:207], v[36:39], v[148:151], a[204:207]
    ds_read_b64_tr_b16 v[60:61], v9 offset:256
    v_accvgpr_read_b32 v226, a66
    v_mfma_f32_16x16x32_bf16 a[200:203], v[36:39], v[144:147], a[200:203]
    ds_read_b64_tr_b16 v[62:63], v9 offset:2304
    s_waitcnt lgkmcnt(8)
    buffer_load_dwordx4 v18, s[20:23], s42 offen offset:2048 lds
    v_accvgpr_read_b32 v227, a67
    v_mfma_f32_16x16x32_bf16 a[208:211], v[40:43], v[144:147], a[208:211]
    ds_read_b64_tr_b16 v[32:33], v2 offset:16384
    v_accvgpr_read_b32 v228, a96
    v_mfma_f32_16x16x32_bf16 a[212:215], v[40:43], v[148:151], a[212:215]
    ds_read_b64_tr_b16 v[34:35], v2 offset:18432
    v_accvgpr_read_b32 v229, a97
    v_mfma_f32_16x16x32_bf16 a[220:223], v[44:47], v[148:151], a[220:223]
    ds_read_b64_tr_b16 v[36:37], v3 offset:16384
    v_accvgpr_read_b32 v230, a98
    v_mfma_f32_16x16x32_bf16 a[216:219], v[44:47], v[144:147], a[216:219]
    ds_read_b64_tr_b16 v[38:39], v3 offset:18432
    s_waitcnt lgkmcnt(8)
    v_accvgpr_read_b32 v231, a99
    v_mfma_f32_16x16x32_bf16 a[224:227], v[48:51], v[144:147], a[224:227]
    ds_read_b64_tr_b16 v[40:41], v4 offset:16384
    buffer_store_dwordx4 v[88:91], v1, s[72:75], s64 offen offset:2048 sc1
    v_cvt_pk_bf16_f32 v96, v224, v225
    v_mfma_f32_16x16x32_bf16 a[228:231], v[48:51], v[148:151], a[228:231]
    ds_read_b64_tr_b16 v[42:43], v4 offset:18432
    buffer_load_dwordx4 v19, s[20:23], s42 offen offset:3072 lds
    s_add_u32 s42, s42, 262144
    v_cvt_pk_bf16_f32 v97, v226, v227
    v_mfma_f32_16x16x32_bf16 a[236:239], v[52:55], v[148:151], a[236:239]
    ds_read_b64_tr_b16 v[44:45], v5 offset:16384
    v_cvt_pk_bf16_f32 v98, v228, v229
    v_mfma_f32_16x16x32_bf16 a[232:235], v[52:55], v[144:147], a[232:235]
    ds_read_b64_tr_b16 v[46:47], v5 offset:18432
    s_waitcnt lgkmcnt(8)
    v_cvt_pk_bf16_f32 v99, v230, v231
    v_accvgpr_read_b32 v232, a68
    v_mfma_f32_16x16x32_bf16 a[240:243], v[56:59], v[144:147], a[240:243]
    ds_read_b64_tr_b16 v[48:49], v6 offset:16384
    v_accvgpr_read_b32 v233, a69
    v_mfma_f32_16x16x32_bf16 a[244:247], v[56:59], v[148:151], a[244:247]
    ds_read_b64_tr_b16 v[50:51], v6 offset:18432
    v_accvgpr_read_b32 v234, a70
    v_mfma_f32_16x16x32_bf16 a[252:255], v[60:63], v[148:151], a[252:255]
    ds_read_b64_tr_b16 v[52:53], v7 offset:16384
    s_mov_b32 m0, s25
    v_accvgpr_read_b32 v235, a71
    v_mfma_f32_16x16x32_bf16 a[248:251], v[60:63], v[144:147], a[248:251]
    ds_read_b64_tr_b16 v[54:55], v7 offset:18432
    s_waitcnt lgkmcnt(8)
    buffer_load_dwordx4 v16, s[20:23], s42 offen offset:0 lds
    v_accvgpr_read_b32 v236, a100
    v_mfma_f32_16x16x32_bf16 a[128:131], v[32:35], v[152:155], a[128:131]
    ds_read_b64_tr_b16 v[56:57], v8 offset:16384
    v_accvgpr_read_b32 v237, a101
    v_mfma_f32_16x16x32_bf16 a[132:135], v[32:35], v[156:159], a[132:135]
    ds_read_b64_tr_b16 v[58:59], v8 offset:18432
    v_accvgpr_read_b32 v238, a102
    v_mfma_f32_16x16x32_bf16 a[140:143], v[36:39], v[156:159], a[140:143]
    ds_read_b64_tr_b16 v[60:61], v9 offset:16384
    v_accvgpr_read_b32 v239, a103
    v_mfma_f32_16x16x32_bf16 a[136:139], v[36:39], v[152:155], a[136:139]
    ds_read_b64_tr_b16 v[62:63], v9 offset:18432
    s_waitcnt lgkmcnt(8)
    buffer_store_dwordx4 v[92:95], v1, s[72:75], s64 offen offset:3072 sc1
    s_add_u32 s64, s64, 12288
    v_cvt_pk_bf16_f32 v100, v232, v233
    v_mfma_f32_16x16x32_bf16 a[144:147], v[40:43], v[152:155], a[144:147]
    ds_read_b64_tr_b16 v[32:33], v2 offset:16640
    v_cvt_pk_bf16_f32 v101, v234, v235
    v_mfma_f32_16x16x32_bf16 a[148:151], v[40:43], v[156:159], a[148:151]
    ds_read_b64_tr_b16 v[34:35], v2 offset:18688
    buffer_load_dwordx4 v17, s[20:23], s42 offen offset:1024 lds
    v_cvt_pk_bf16_f32 v102, v236, v237
    v_mfma_f32_16x16x32_bf16 a[156:159], v[44:47], v[156:159], a[156:159]
    ds_read_b64_tr_b16 v[36:37], v3 offset:16640
    v_cvt_pk_bf16_f32 v103, v238, v239
    v_accvgpr_read_b32 v224, a72
    v_mfma_f32_16x16x32_bf16 a[152:155], v[44:47], v[152:155], a[152:155]
    ds_read_b64_tr_b16 v[38:39], v3 offset:18688
    s_waitcnt lgkmcnt(8)
    v_accvgpr_read_b32 v225, a73
    v_mfma_f32_16x16x32_bf16 a[160:163], v[48:51], v[152:155], a[160:163]
    ds_read_b64_tr_b16 v[40:41], v4 offset:16640
    v_accvgpr_read_b32 v226, a74
    v_mfma_f32_16x16x32_bf16 a[164:167], v[48:51], v[156:159], a[164:167]
    ds_read_b64_tr_b16 v[42:43], v4 offset:18688
    v_accvgpr_read_b32 v227, a75
    v_mfma_f32_16x16x32_bf16 a[172:175], v[52:55], v[156:159], a[172:175]
    ds_read_b64_tr_b16 v[44:45], v5 offset:16640
    v_accvgpr_read_b32 v228, a104
    v_mfma_f32_16x16x32_bf16 a[168:171], v[52:55], v[152:155], a[168:171]
    ds_read_b64_tr_b16 v[46:47], v5 offset:18688
    s_waitcnt lgkmcnt(8)
    buffer_load_dwordx4 v18, s[20:23], s42 offen offset:2048 lds
    v_accvgpr_read_b32 v229, a105
    v_mfma_f32_16x16x32_bf16 a[176:179], v[56:59], v[152:155], a[176:179]
    ds_read_b64_tr_b16 v[48:49], v6 offset:16640
    v_accvgpr_read_b32 v230, a106
    v_mfma_f32_16x16x32_bf16 a[180:183], v[56:59], v[156:159], a[180:183]
    ds_read_b64_tr_b16 v[50:51], v6 offset:18688
    v_accvgpr_read_b32 v231, a107
    v_mfma_f32_16x16x32_bf16 a[188:191], v[60:63], v[156:159], a[188:191]
    ds_read_b64_tr_b16 v[52:53], v7 offset:16640
    buffer_store_dwordx4 v[96:99], v1, s[72:75], s64 offen offset:0 sc1
    v_cvt_pk_bf16_f32 v104, v224, v225
    v_mfma_f32_16x16x32_bf16 a[184:187], v[60:63], v[152:155], a[184:187]
    ds_read_b64_tr_b16 v[54:55], v7 offset:18688
    s_waitcnt lgkmcnt(8)
    v_cvt_pk_bf16_f32 v105, v226, v227
    v_mfma_f32_16x16x32_bf16 a[192:195], v[32:35], v[152:155], a[192:195]
    ds_read_b64_tr_b16 v[56:57], v8 offset:16640
    v_cvt_pk_bf16_f32 v106, v228, v229
    v_accvgpr_read_b32 v232, a76
    v_mfma_f32_16x16x32_bf16 a[196:199], v[32:35], v[156:159], a[196:199]
    ds_read_b64_tr_b16 v[58:59], v8 offset:18688
    buffer_load_dwordx4 v19, s[20:23], s42 offen offset:3072 lds
    s_add_u32 s42, s42, 262144
    v_cvt_pk_bf16_f32 v107, v230, v231
    v_accvgpr_read_b32 v233, a77
    v_mfma_f32_16x16x32_bf16 a[204:207], v[36:39], v[156:159], a[204:207]
    ds_read_b64_tr_b16 v[60:61], v9 offset:16640
    v_accvgpr_read_b32 v234, a78
    v_mfma_f32_16x16x32_bf16 a[200:203], v[36:39], v[152:155], a[200:203]
    ds_read_b64_tr_b16 v[62:63], v9 offset:18688
    s_waitcnt lgkmcnt(8)
    v_accvgpr_read_b32 v235, a79
    v_mfma_f32_16x16x32_bf16 a[208:211], v[40:43], v[152:155], a[208:211]
    ds_read_b64_tr_b16 v[32:33], v2 offset:32768
    v_accvgpr_read_b32 v236, a108
    v_mfma_f32_16x16x32_bf16 a[212:215], v[40:43], v[156:159], a[212:215]
    ds_read_b64_tr_b16 v[34:35], v2 offset:34816
    v_accvgpr_read_b32 v237, a109
    v_mfma_f32_16x16x32_bf16 a[220:223], v[44:47], v[156:159], a[220:223]
    ds_read_b64_tr_b16 v[36:37], v3 offset:32768
    s_mov_b32 m0, s26
    v_accvgpr_read_b32 v238, a110
    v_mfma_f32_16x16x32_bf16 a[216:219], v[44:47], v[152:155], a[216:219]
    ds_read_b64_tr_b16 v[38:39], v3 offset:34816
    s_waitcnt lgkmcnt(8)
    buffer_load_dwordx4 v16, s[20:23], s42 offen offset:0 lds
    v_accvgpr_read_b32 v239, a111
    v_mfma_f32_16x16x32_bf16 a[224:227], v[48:51], v[152:155], a[224:227]
    ds_read_b64_tr_b16 v[40:41], v4 offset:32768
    v_cvt_pk_bf16_f32 v108, v232, v233
    v_mfma_f32_16x16x32_bf16 a[228:231], v[48:51], v[156:159], a[228:231]
    ds_read_b64_tr_b16 v[42:43], v4 offset:34816
    buffer_store_dwordx4 v[100:103], v1, s[72:75], s64 offen offset:1024 sc1
    v_cvt_pk_bf16_f32 v109, v234, v235
    v_mfma_f32_16x16x32_bf16 a[236:239], v[52:55], v[156:159], a[236:239]
    ds_read_b64_tr_b16 v[44:45], v5 offset:32768
    v_cvt_pk_bf16_f32 v110, v236, v237
    v_mfma_f32_16x16x32_bf16 a[232:235], v[52:55], v[152:155], a[232:235]
    ds_read_b64_tr_b16 v[46:47], v5 offset:34816
    s_waitcnt lgkmcnt(8)
    v_cvt_pk_bf16_f32 v111, v238, v239
    v_accvgpr_read_b32 v224, a80
    v_mfma_f32_16x16x32_bf16 a[240:243], v[56:59], v[152:155], a[240:243]
    ds_read_b64_tr_b16 v[48:49], v6 offset:32768
    v_accvgpr_read_b32 v225, a81
    v_mfma_f32_16x16x32_bf16 a[244:247], v[56:59], v[156:159], a[244:247]
    ds_read_b64_tr_b16 v[50:51], v6 offset:34816
    buffer_load_dwordx4 v17, s[20:23], s42 offen offset:1024 lds
    v_accvgpr_read_b32 v226, a82
    v_mfma_f32_16x16x32_bf16 a[252:255], v[60:63], v[156:159], a[252:255]
    ds_read_b64_tr_b16 v[52:53], v7 offset:32768
    v_accvgpr_read_b32 v227, a83
    v_mfma_f32_16x16x32_bf16 a[248:251], v[60:63], v[152:155], a[248:251]
    ds_read_b64_tr_b16 v[54:55], v7 offset:34816
    s_waitcnt lgkmcnt(8)
    v_accvgpr_read_b32 v228, a112
    v_mfma_f32_16x16x32_bf16 a[128:131], v[32:35], v[160:163], a[128:131]
    ds_read_b64_tr_b16 v[56:57], v8 offset:32768
    v_accvgpr_read_b32 v229, a113
    v_mfma_f32_16x16x32_bf16 a[132:135], v[32:35], v[164:167], a[132:135]
    ds_read_b64_tr_b16 v[58:59], v8 offset:34816
    v_accvgpr_read_b32 v230, a114
    v_mfma_f32_16x16x32_bf16 a[140:143], v[36:39], v[164:167], a[140:143]
    ds_read_b64_tr_b16 v[60:61], v9 offset:32768
    v_accvgpr_read_b32 v231, a115
    v_mfma_f32_16x16x32_bf16 a[136:139], v[36:39], v[160:163], a[136:139]
    ds_read_b64_tr_b16 v[62:63], v9 offset:34816
    s_waitcnt lgkmcnt(8)
    buffer_load_dwordx4 v18, s[20:23], s42 offen offset:2048 lds
    v_cvt_pk_bf16_f32 v240, v224, v225
    v_mfma_f32_16x16x32_bf16 a[144:147], v[40:43], v[160:163], a[144:147]
    ds_read_b64_tr_b16 v[32:33], v2 offset:33024
    buffer_store_dwordx4 v[104:107], v1, s[72:75], s64 offen offset:2048 sc1
    v_cvt_pk_bf16_f32 v241, v226, v227
    v_mfma_f32_16x16x32_bf16 a[148:151], v[40:43], v[164:167], a[148:151]
    ds_read_b64_tr_b16 v[34:35], v2 offset:35072
    v_cvt_pk_bf16_f32 v242, v228, v229
    v_mfma_f32_16x16x32_bf16 a[156:159], v[44:47], v[164:167], a[156:159]
    ds_read_b64_tr_b16 v[36:37], v3 offset:33024
    v_cvt_pk_bf16_f32 v243, v230, v231
    v_accvgpr_read_b32 v232, a84
    v_mfma_f32_16x16x32_bf16 a[152:155], v[44:47], v[160:163], a[152:155]
    ds_read_b64_tr_b16 v[38:39], v3 offset:35072
    s_waitcnt lgkmcnt(8)
    v_accvgpr_read_b32 v233, a85
    v_mfma_f32_16x16x32_bf16 a[160:163], v[48:51], v[160:163], a[160:163]
    ds_read_b64_tr_b16 v[40:41], v4 offset:33024
    v_accvgpr_read_b32 v234, a86
    v_mfma_f32_16x16x32_bf16 a[164:167], v[48:51], v[164:167], a[164:167]
    ds_read_b64_tr_b16 v[42:43], v4 offset:35072
    buffer_load_dwordx4 v19, s[20:23], s42 offen offset:3072 lds
    s_add_u32 s42, s42, 262144
    v_accvgpr_read_b32 v235, a87
    v_mfma_f32_16x16x32_bf16 a[172:175], v[52:55], v[164:167], a[172:175]
    ds_read_b64_tr_b16 v[44:45], v5 offset:33024
    v_accvgpr_read_b32 v236, a116
    v_mfma_f32_16x16x32_bf16 a[168:171], v[52:55], v[160:163], a[168:171]
    ds_read_b64_tr_b16 v[46:47], v5 offset:35072
    s_waitcnt lgkmcnt(8)
    v_accvgpr_read_b32 v237, a117
    v_mfma_f32_16x16x32_bf16 a[176:179], v[56:59], v[160:163], a[176:179]
    ds_read_b64_tr_b16 v[48:49], v6 offset:33024
    v_accvgpr_read_b32 v238, a118
    v_mfma_f32_16x16x32_bf16 a[180:183], v[56:59], v[164:167], a[180:183]
    ds_read_b64_tr_b16 v[50:51], v6 offset:35072
    v_accvgpr_read_b32 v239, a119
    v_mfma_f32_16x16x32_bf16 a[188:191], v[60:63], v[164:167], a[188:191]
    ds_read_b64_tr_b16 v[52:53], v7 offset:33024
    s_mov_b32 m0, s27
    buffer_store_dwordx4 v[108:111], v1, s[72:75], s64 offen offset:3072 sc1
    s_add_u32 s64, s64, 4096
    v_cvt_pk_bf16_f32 v244, v232, v233
    v_mfma_f32_16x16x32_bf16 a[184:187], v[60:63], v[160:163], a[184:187]
    ds_read_b64_tr_b16 v[54:55], v7 offset:35072
    s_waitcnt lgkmcnt(8)
    buffer_load_dwordx4 v16, s[20:23], s42 offen offset:0 lds
    v_cvt_pk_bf16_f32 v245, v234, v235
    v_mfma_f32_16x16x32_bf16 a[192:195], v[32:35], v[160:163], a[192:195]
    ds_read_b64_tr_b16 v[56:57], v8 offset:33024
    v_cvt_pk_bf16_f32 v246, v236, v237
    v_mfma_f32_16x16x32_bf16 a[196:199], v[32:35], v[164:167], a[196:199]
    ds_read_b64_tr_b16 v[58:59], v8 offset:35072
    v_cvt_pk_bf16_f32 v247, v238, v239
    v_accvgpr_read_b32 v224, a88
    v_mfma_f32_16x16x32_bf16 a[204:207], v[36:39], v[164:167], a[204:207]
    ds_read_b64_tr_b16 v[60:61], v9 offset:33024
    v_accvgpr_read_b32 v225, a89
    v_mfma_f32_16x16x32_bf16 a[200:203], v[36:39], v[160:163], a[200:203]
    ds_read_b64_tr_b16 v[62:63], v9 offset:35072
    s_waitcnt lgkmcnt(8)
    v_accvgpr_read_b32 v226, a90
    v_mfma_f32_16x16x32_bf16 a[208:211], v[40:43], v[160:163], a[208:211]
    ds_read_b64_tr_b16 v[32:33], v2 offset:49152
    v_accvgpr_read_b32 v227, a91
    v_mfma_f32_16x16x32_bf16 a[212:215], v[40:43], v[164:167], a[212:215]
    ds_read_b64_tr_b16 v[34:35], v2 offset:51200
    buffer_load_dwordx4 v17, s[20:23], s42 offen offset:1024 lds
    v_accvgpr_read_b32 v228, a120
    v_mfma_f32_16x16x32_bf16 a[220:223], v[44:47], v[164:167], a[220:223]
    ds_read_b64_tr_b16 v[36:37], v3 offset:49152
    v_accvgpr_read_b32 v229, a121
    v_mfma_f32_16x16x32_bf16 a[216:219], v[44:47], v[160:163], a[216:219]
    ds_read_b64_tr_b16 v[38:39], v3 offset:51200
    s_waitcnt lgkmcnt(8)
    v_accvgpr_read_b32 v230, a122
    v_mfma_f32_16x16x32_bf16 a[224:227], v[48:51], v[160:163], a[224:227]
    ds_read_b64_tr_b16 v[40:41], v4 offset:49152
    v_accvgpr_read_b32 v231, a123
    v_mfma_f32_16x16x32_bf16 a[228:231], v[48:51], v[164:167], a[228:231]
    ds_read_b64_tr_b16 v[42:43], v4 offset:51200
    buffer_store_dwordx4 v[240:243], v1, s[72:75], s64 offen offset:0 sc1
    v_cvt_pk_bf16_f32 v248, v224, v225
    v_mfma_f32_16x16x32_bf16 a[236:239], v[52:55], v[164:167], a[236:239]
    ds_read_b64_tr_b16 v[44:45], v5 offset:49152
    v_cvt_pk_bf16_f32 v249, v226, v227
    v_mfma_f32_16x16x32_bf16 a[232:235], v[52:55], v[160:163], a[232:235]
    ds_read_b64_tr_b16 v[46:47], v5 offset:51200
    s_waitcnt lgkmcnt(8)
    buffer_load_dwordx4 v18, s[20:23], s42 offen offset:2048 lds
    v_cvt_pk_bf16_f32 v250, v228, v229
    v_mfma_f32_16x16x32_bf16 a[240:243], v[56:59], v[160:163], a[240:243]
    ds_read_b64_tr_b16 v[48:49], v6 offset:49152
    v_cvt_pk_bf16_f32 v251, v230, v231
    v_accvgpr_read_b32 v232, a92
    v_mfma_f32_16x16x32_bf16 a[244:247], v[56:59], v[164:167], a[244:247]
    ds_read_b64_tr_b16 v[50:51], v6 offset:51200
    v_accvgpr_read_b32 v233, a93
    v_mfma_f32_16x16x32_bf16 a[252:255], v[60:63], v[164:167], a[252:255]
    ds_read_b64_tr_b16 v[52:53], v7 offset:49152
    v_accvgpr_read_b32 v234, a94
    v_mfma_f32_16x16x32_bf16 a[248:251], v[60:63], v[160:163], a[248:251]
    ds_read_b64_tr_b16 v[54:55], v7 offset:51200
    s_waitcnt lgkmcnt(8)
    v_accvgpr_read_b32 v235, a95
    v_mfma_f32_16x16x32_bf16 a[128:131], v[32:35], v[168:171], a[128:131]
    ds_read_b64_tr_b16 v[56:57], v8 offset:49152
    v_accvgpr_read_b32 v236, a124
    v_mfma_f32_16x16x32_bf16 a[132:135], v[32:35], v[172:175], a[132:135]
    ds_read_b64_tr_b16 v[58:59], v8 offset:51200
    buffer_load_dwordx4 v19, s[20:23], s42 offen offset:3072 lds
    s_add_u32 s42, s42, 262144
    v_accvgpr_read_b32 v237, a125
    v_mfma_f32_16x16x32_bf16 a[140:143], v[36:39], v[172:175], a[140:143]
    ds_read_b64_tr_b16 v[60:61], v9 offset:49152
    v_accvgpr_read_b32 v238, a126
    v_mfma_f32_16x16x32_bf16 a[136:139], v[36:39], v[168:171], a[136:139]
    ds_read_b64_tr_b16 v[62:63], v9 offset:51200
    s_waitcnt lgkmcnt(8)
    v_accvgpr_read_b32 v239, a127
    v_mfma_f32_16x16x32_bf16 a[144:147], v[40:43], v[168:171], a[144:147]
    ds_read_b64_tr_b16 v[32:33], v2 offset:49408
    buffer_store_dwordx4 v[244:247], v1, s[72:75], s64 offen offset:1024 sc1
    v_cvt_pk_bf16_f32 v252, v232, v233
    v_mfma_f32_16x16x32_bf16 a[148:151], v[40:43], v[172:175], a[148:151]
    ds_read_b64_tr_b16 v[34:35], v2 offset:51456
    v_add_u32 v2, 0x10000, v2
    v_cvt_pk_bf16_f32 v253, v234, v235
    v_mfma_f32_16x16x32_bf16 a[156:159], v[44:47], v[172:175], a[156:159]
    ds_read_b64_tr_b16 v[36:37], v3 offset:49408
    v_cvt_pk_bf16_f32 v254, v236, v237
    v_mfma_f32_16x16x32_bf16 a[152:155], v[44:47], v[168:171], a[152:155]
    ds_read_b64_tr_b16 v[38:39], v3 offset:51456
    v_add_u32 v3, 0x10000, v3
    s_waitcnt lgkmcnt(8)
    v_cvt_pk_bf16_f32 v255, v238, v239
    v_mfma_f32_16x16x32_bf16 a[160:163], v[48:51], v[168:171], a[160:163]
    ds_read_b64_tr_b16 v[40:41], v4 offset:49408
    v_mfma_f32_16x16x32_bf16 a[164:167], v[48:51], v[172:175], a[164:167]
    ds_read_b64_tr_b16 v[42:43], v4 offset:51456
    v_add_u32 v4, 0x10000, v4
    v_mfma_f32_16x16x32_bf16 a[172:175], v[52:55], v[172:175], a[172:175]
    ds_read_b64_tr_b16 v[44:45], v5 offset:49408
    v_mfma_f32_16x16x32_bf16 a[168:171], v[52:55], v[168:171], a[168:171]
    ds_read_b64_tr_b16 v[46:47], v5 offset:51456
    v_add_u32 v5, 0x10000, v5
    s_waitcnt lgkmcnt(8)
    v_mfma_f32_16x16x32_bf16 a[176:179], v[56:59], v[168:171], a[176:179]
    ds_read_b64_tr_b16 v[48:49], v6 offset:49408
    v_mfma_f32_16x16x32_bf16 a[180:183], v[56:59], v[172:175], a[180:183]
    ds_read_b64_tr_b16 v[50:51], v6 offset:51456
    v_add_u32 v6, 0x10000, v6
    v_mfma_f32_16x16x32_bf16 a[188:191], v[60:63], v[172:175], a[188:191]
    ds_read_b64_tr_b16 v[52:53], v7 offset:49408
    v_mfma_f32_16x16x32_bf16 a[184:187], v[60:63], v[168:171], a[184:187]
    ds_read_b64_tr_b16 v[54:55], v7 offset:51456
    v_add_u32 v7, 0x10000, v7
    s_waitcnt lgkmcnt(8)
    buffer_store_dwordx4 v[248:251], v1, s[72:75], s64 offen offset:2048 sc1
    v_mfma_f32_16x16x32_bf16 a[192:195], v[32:35], v[168:171], a[192:195]
    ds_read_b64_tr_b16 v[56:57], v8 offset:49408
    v_mfma_f32_16x16x32_bf16 a[196:199], v[32:35], v[172:175], a[196:199]
    ds_read_b64_tr_b16 v[58:59], v8 offset:51456
    v_add_u32 v8, 0x10000, v8
    v_mfma_f32_16x16x32_bf16 a[204:207], v[36:39], v[172:175], a[204:207]
    ds_read_b64_tr_b16 v[60:61], v9 offset:49408
    v_mfma_f32_16x16x32_bf16 a[200:203], v[36:39], v[168:171], a[200:203]
    ds_read_b64_tr_b16 v[62:63], v9 offset:51456
    v_add_u32 v9, 0x10000, v9
    s_waitcnt lgkmcnt(8)
    v_mfma_f32_16x16x32_bf16 a[208:211], v[40:43], v[168:171], a[208:211]
    ds_read_b64_tr_b16 v[32:33], v2 offset:0
    v_mfma_f32_16x16x32_bf16 a[212:215], v[40:43], v[172:175], a[212:215]
    ds_read_b64_tr_b16 v[34:35], v2 offset:2048
    v_mfma_f32_16x16x32_bf16 a[220:223], v[44:47], v[172:175], a[220:223]
    ds_read_b64_tr_b16 v[36:37], v3 offset:0
    v_mfma_f32_16x16x32_bf16 a[216:219], v[44:47], v[168:171], a[216:219]
    ds_read_b64_tr_b16 v[38:39], v3 offset:2048
    s_waitcnt lgkmcnt(8)
    v_mfma_f32_16x16x32_bf16 a[224:227], v[48:51], v[168:171], a[224:227]
    ds_read_b64_tr_b16 v[40:41], v4 offset:0
    v_mfma_f32_16x16x32_bf16 a[228:231], v[48:51], v[172:175], a[228:231]
    ds_read_b64_tr_b16 v[42:43], v4 offset:2048
    v_mfma_f32_16x16x32_bf16 a[236:239], v[52:55], v[172:175], a[236:239]
    ds_read_b64_tr_b16 v[44:45], v5 offset:0
    buffer_store_dwordx4 v[252:255], v1, s[72:75], s64 offen offset:3072 sc1
    s_add_u32 s64, s64, 12288
    v_mfma_f32_16x16x32_bf16 a[232:235], v[52:55], v[168:171], a[232:235]
    ds_read_b64_tr_b16 v[46:47], v5 offset:2048
    s_waitcnt lgkmcnt(8)
    v_mfma_f32_16x16x32_bf16 a[240:243], v[56:59], v[168:171], a[240:243]
    ds_read_b64_tr_b16 v[48:49], v6 offset:0
    v_mfma_f32_16x16x32_bf16 a[244:247], v[56:59], v[172:175], a[244:247]
    ds_read_b64_tr_b16 v[50:51], v6 offset:2048
    v_mfma_f32_16x16x32_bf16 a[252:255], v[60:63], v[172:175], a[252:255]
    ds_read_b64_tr_b16 v[52:53], v7 offset:0
    v_mfma_f32_16x16x32_bf16 a[248:251], v[60:63], v[168:171], a[248:251]
    ds_read_b64_tr_b16 v[54:55], v7 offset:2048
    s_waitcnt lgkmcnt(8)
    v_mfma_f32_16x16x32_bf16 a[128:131], v[32:35], v[176:179], a[128:131]
    ds_read_b64_tr_b16 v[56:57], v8 offset:0
    v_mfma_f32_16x16x32_bf16 a[132:135], v[32:35], v[180:183], a[132:135]
    ds_read_b64_tr_b16 v[58:59], v8 offset:2048
    v_mfma_f32_16x16x32_bf16 a[140:143], v[36:39], v[180:183], a[140:143]
    ds_read_b64_tr_b16 v[60:61], v9 offset:0
    v_mfma_f32_16x16x32_bf16 a[136:139], v[36:39], v[176:179], a[136:139]
    ds_read_b64_tr_b16 v[62:63], v9 offset:2048
    s_waitcnt lgkmcnt(8)
    v_mfma_f32_16x16x32_bf16 a[144:147], v[40:43], v[176:179], a[144:147]
    ds_read_b64_tr_b16 v[32:33], v2 offset:256
    v_mfma_f32_16x16x32_bf16 a[148:151], v[40:43], v[180:183], a[148:151]
    ds_read_b64_tr_b16 v[34:35], v2 offset:2304
    v_mfma_f32_16x16x32_bf16 a[156:159], v[44:47], v[180:183], a[156:159]
    ds_read_b64_tr_b16 v[36:37], v3 offset:256
    v_mfma_f32_16x16x32_bf16 a[152:155], v[44:47], v[176:179], a[152:155]
    ds_read_b64_tr_b16 v[38:39], v3 offset:2304
    s_waitcnt lgkmcnt(8)
    v_mfma_f32_16x16x32_bf16 a[160:163], v[48:51], v[176:179], a[160:163]
    ds_read_b64_tr_b16 v[40:41], v4 offset:256
    v_mfma_f32_16x16x32_bf16 a[164:167], v[48:51], v[180:183], a[164:167]
    ds_read_b64_tr_b16 v[42:43], v4 offset:2304
    v_mfma_f32_16x16x32_bf16 a[172:175], v[52:55], v[180:183], a[172:175]
    ds_read_b64_tr_b16 v[44:45], v5 offset:256
    v_mfma_f32_16x16x32_bf16 a[168:171], v[52:55], v[176:179], a[168:171]
    ds_read_b64_tr_b16 v[46:47], v5 offset:2304
    s_waitcnt lgkmcnt(8)
    v_mfma_f32_16x16x32_bf16 a[176:179], v[56:59], v[176:179], a[176:179]
    ds_read_b64_tr_b16 v[48:49], v6 offset:256
    v_mfma_f32_16x16x32_bf16 a[180:183], v[56:59], v[180:183], a[180:183]
    ds_read_b64_tr_b16 v[50:51], v6 offset:2304
    v_mfma_f32_16x16x32_bf16 a[188:191], v[60:63], v[180:183], a[188:191]
    ds_read_b64_tr_b16 v[52:53], v7 offset:256
    v_mfma_f32_16x16x32_bf16 a[184:187], v[60:63], v[176:179], a[184:187]
    ds_read_b64_tr_b16 v[54:55], v7 offset:2304
    s_waitcnt lgkmcnt(8)
    v_mfma_f32_16x16x32_bf16 a[192:195], v[32:35], v[176:179], a[192:195]
    ds_read_b64_tr_b16 v[56:57], v8 offset:256
    v_mfma_f32_16x16x32_bf16 a[196:199], v[32:35], v[180:183], a[196:199]
    ds_read_b64_tr_b16 v[58:59], v8 offset:2304
    v_mfma_f32_16x16x32_bf16 a[204:207], v[36:39], v[180:183], a[204:207]
    ds_read_b64_tr_b16 v[60:61], v9 offset:256
    v_mfma_f32_16x16x32_bf16 a[200:203], v[36:39], v[176:179], a[200:203]
    ds_read_b64_tr_b16 v[62:63], v9 offset:2304
    s_waitcnt lgkmcnt(8)
    v_mfma_f32_16x16x32_bf16 a[208:211], v[40:43], v[176:179], a[208:211]
    ds_read_b64_tr_b16 v[32:33], v2 offset:16384
    v_mfma_f32_16x16x32_bf16 a[212:215], v[40:43], v[180:183], a[212:215]
    ds_read_b64_tr_b16 v[34:35], v2 offset:18432
    v_mfma_f32_16x16x32_bf16 a[220:223], v[44:47], v[180:183], a[220:223]
    ds_read_b64_tr_b16 v[36:37], v3 offset:16384
    v_mfma_f32_16x16x32_bf16 a[216:219], v[44:47], v[176:179], a[216:219]
    ds_read_b64_tr_b16 v[38:39], v3 offset:18432
    s_waitcnt lgkmcnt(8)
    v_mfma_f32_16x16x32_bf16 a[224:227], v[48:51], v[176:179], a[224:227]
    ds_read_b64_tr_b16 v[40:41], v4 offset:16384
    s_lshr_b32 s62, s2, 3
    s_getpc_b64 s[68:69]
    s_add_u32 s68, s68, L1_qend@rel32@lo+4
    s_addc_u32 s69, s69, L1_qend@rel32@hi+12
    s_mul_i32 s3, s62, (((L2_tail-L1_qend)/32+63)&~63)
    s_add_u32 s68, s68, s3
    s_addc_u32 s69, s69, 0
    s_sub_u32 s70, L2_tail-L1_qend, s3
    s_cselect_b32 s70, 0, s70
    s_min_u32 s70, s70, (((L2_tail-L1_qend)/32+63)&~63)
    s_mov_b32 s71, 0x20000
    v_lshlrev_b32 v21, 6, v0
    buffer_load_dword v21, v21, s[68:71], 0 offen
    v_mfma_f32_16x16x32_bf16 a[228:231], v[48:51], v[180:183], a[228:231]
    ds_read_b64_tr_b16 v[42:43], v4 offset:18432
    v_mfma_f32_16x16x32_bf16 a[236:239], v[52:55], v[180:183], a[236:239]
    ds_read_b64_tr_b16 v[44:45], v5 offset:16384
    v_mfma_f32_16x16x32_bf16 a[232:235], v[52:55], v[176:179], a[232:235]
    ds_read_b64_tr_b16 v[46:47], v5 offset:18432
    s_waitcnt lgkmcnt(8)
    v_mfma_f32_16x16x32_bf16 a[240:243], v[56:59], v[176:179], a[240:243]
    ds_read_b64_tr_b16 v[48:49], v6 offset:16384
    v_mfma_f32_16x16x32_bf16 a[244:247], v[56:59], v[180:183], a[244:247]
    ds_read_b64_tr_b16 v[50:51], v6 offset:18432
    v_mfma_f32_16x16x32_bf16 a[252:255], v[60:63], v[180:183], a[252:255]
    ds_read_b64_tr_b16 v[52:53], v7 offset:16384
    v_mfma_f32_16x16x32_bf16 a[248:251], v[60:63], v[176:179], a[248:251]
    ds_read_b64_tr_b16 v[54:55], v7 offset:18432
    s_waitcnt lgkmcnt(8)
    v_mfma_f32_16x16x32_bf16 a[128:131], v[32:35], v[184:187], a[128:131]
    ds_read_b64_tr_b16 v[56:57], v8 offset:16384
    v_mfma_f32_16x16x32_bf16 a[132:135], v[32:35], v[188:191], a[132:135]
    ds_read_b64_tr_b16 v[58:59], v8 offset:18432
    v_mfma_f32_16x16x32_bf16 a[140:143], v[36:39], v[188:191], a[140:143]
    ds_read_b64_tr_b16 v[60:61], v9 offset:16384
    v_mfma_f32_16x16x32_bf16 a[136:139], v[36:39], v[184:187], a[136:139]
    ds_read_b64_tr_b16 v[62:63], v9 offset:18432
    s_waitcnt lgkmcnt(8)
    v_mfma_f32_16x16x32_bf16 a[144:147], v[40:43], v[184:187], a[144:147]
    ds_read_b64_tr_b16 v[32:33], v2 offset:16640
    v_mfma_f32_16x16x32_bf16 a[148:151], v[40:43], v[188:191], a[148:151]
    ds_read_b64_tr_b16 v[34:35], v2 offset:18688
    v_subrev_u32 v2, 0x20000, v2
    v_mfma_f32_16x16x32_bf16 a[156:159], v[44:47], v[188:191], a[156:159]
    ds_read_b64_tr_b16 v[36:37], v3 offset:16640
    v_mfma_f32_16x16x32_bf16 a[152:155], v[44:47], v[184:187], a[152:155]
    ds_read_b64_tr_b16 v[38:39], v3 offset:18688
    v_subrev_u32 v3, 0x20000, v3
    s_waitcnt lgkmcnt(8)
    v_mfma_f32_16x16x32_bf16 a[160:163], v[48:51], v[184:187], a[160:163]
    ds_read_b64_tr_b16 v[40:41], v4 offset:16640
    v_mfma_f32_16x16x32_bf16 a[164:167], v[48:51], v[188:191], a[164:167]
    ds_read_b64_tr_b16 v[42:43], v4 offset:18688
    v_subrev_u32 v4, 0x20000, v4
    v_mfma_f32_16x16x32_bf16 a[172:175], v[52:55], v[188:191], a[172:175]
    ds_read_b64_tr_b16 v[44:45], v5 offset:16640
    v_mfma_f32_16x16x32_bf16 a[168:171], v[52:55], v[184:187], a[168:171]
    ds_read_b64_tr_b16 v[46:47], v5 offset:18688
    v_subrev_u32 v5, 0x20000, v5
    s_waitcnt lgkmcnt(8)
    v_mfma_f32_16x16x32_bf16 a[176:179], v[56:59], v[184:187], a[176:179]
    ds_read_b64_tr_b16 v[48:49], v6 offset:16640
    v_mfma_f32_16x16x32_bf16 a[180:183], v[56:59], v[188:191], a[180:183]
    ds_read_b64_tr_b16 v[50:51], v6 offset:18688
    v_subrev_u32 v6, 0x20000, v6
    v_mfma_f32_16x16x32_bf16 a[188:191], v[60:63], v[188:191], a[188:191]
    ds_read_b64_tr_b16 v[52:53], v7 offset:16640
    v_mfma_f32_16x16x32_bf16 a[184:187], v[60:63], v[184:187], a[184:187]
    ds_read_b64_tr_b16 v[54:55], v7 offset:18688
    v_subrev_u32 v7, 0x20000, v7
    s_waitcnt lgkmcnt(8)
    v_mfma_f32_16x16x32_bf16 a[192:195], v[32:35], v[184:187], a[192:195]
    ds_read_b64_tr_b16 v[56:57], v8 offset:16640
    v_mfma_f32_16x16x32_bf16 a[196:199], v[32:35], v[188:191], a[196:199]
    ds_read_b64_tr_b16 v[58:59], v8 offset:18688
    v_subrev_u32 v8, 0x20000, v8
    v_mfma_f32_16x16x32_bf16 a[204:207], v[36:39], v[188:191], a[204:207]
    ds_read_b64_tr_b16 v[60:61], v9 offset:16640
    v_mfma_f32_16x16x32_bf16 a[200:203], v[36:39], v[184:187], a[200:203]
    ds_read_b64_tr_b16 v[62:63], v9 offset:18688
    v_subrev_u32 v9, 0x20000, v9
    s_waitcnt lgkmcnt(8)
    s_waitcnt vmcnt(4)
    s_barrier
    v_mfma_f32_16x16x32_bf16 a[208:211], v[40:43], v[184:187], a[208:211]
    ds_read_b64_tr_b16 v[32:33], v2 offset:0
    v_mfma_f32_16x16x32_bf16 a[212:215], v[40:43], v[188:191], a[212:215]
    ds_read_b64_tr_b16 v[34:35], v2 offset:2048
    v_mfma_f32_16x16x32_bf16 a[220:223], v[44:47], v[188:191], a[220:223]
    ds_read_b64_tr_b16 v[36:37], v3 offset:0
    v_mfma_f32_16x16x32_bf16 a[216:219], v[44:47], v[184:187], a[216:219]
    ds_read_b64_tr_b16 v[38:39], v3 offset:2048
    s_waitcnt lgkmcnt(8)
    v_mfma_f32_16x16x32_bf16 a[224:227], v[48:51], v[184:187], a[224:227]
    ds_read_b64_tr_b16 v[40:41], v4 offset:0
    v_mfma_f32_16x16x32_bf16 a[228:231], v[48:51], v[188:191], a[228:231]
    ds_read_b64_tr_b16 v[42:43], v4 offset:2048
    v_mfma_f32_16x16x32_bf16 a[236:239], v[52:55], v[188:191], a[236:239]
    ds_read_b64_tr_b16 v[44:45], v5 offset:0
    v_mfma_f32_16x16x32_bf16 a[232:235], v[52:55], v[184:187], a[232:235]
    ds_read_b64_tr_b16 v[46:47], v5 offset:2048
    s_waitcnt lgkmcnt(8)
    v_mfma_f32_16x16x32_bf16 a[240:243], v[56:59], v[184:187], a[240:243]
    ds_read_b64_tr_b16 v[48:49], v6 offset:0
    v_mfma_f32_16x16x32_bf16 a[244:247], v[56:59], v[188:191], a[244:247]
    ds_read_b64_tr_b16 v[50:51], v6 offset:2048
    v_mfma_f32_16x16x32_bf16 a[252:255], v[60:63], v[188:191], a[252:255]
    ds_read_b64_tr_b16 v[52:53], v7 offset:0
    v_mfma_f32_16x16x32_bf16 a[248:251], v[60:63], v[184:187], a[248:251]
    ds_read_b64_tr_b16 v[54:55], v7 offset:2048
    s_waitcnt lgkmcnt(8)
    v_mfma_f32_16x16x32_bf16 a[128:131], v[32:35], v[192:195], a[128:131]
    ds_read_b64_tr_b16 v[56:57], v8 offset:0
    v_mfma_f32_16x16x32_bf16 a[132:135], v[32:35], v[196:199], a[132:135]
    ds_read_b64_tr_b16 v[58:59], v8 offset:2048
    v_mfma_f32_16x16x32_bf16 a[140:143], v[36:39], v[196:199], a[140:143]
    ds_read_b64_tr_b16 v[60:61], v9 offset:0
    v_mfma_f32_16x16x32_bf16 a[136:139], v[36:39], v[192:195], a[136:139]
    ds_read_b64_tr_b16 v[62:63], v9 offset:2048
    s_waitcnt lgkmcnt(8)
    v_mfma_f32_16x16x32_bf16 a[144:147], v[40:43], v[192:195], a[144:147]
    ds_read_b64_tr_b16 v[32:33], v2 offset:256
    v_mfma_f32_16x16x32_bf16 a[148:151], v[40:43], v[196:199], a[148:151]
    ds_read_b64_tr_b16 v[34:35], v2 offset:2304
    v_mfma_f32_16x16x32_bf16 a[156:159], v[44:47], v[196:199], a[156:159]
    ds_read_b64_tr_b16 v[36:37], v3 offset:256
    v_mfma_f32_16x16x32_bf16 a[152:155], v[44:47], v[192:195], a[152:155]
    ds_read_b64_tr_b16 v[38:39], v3 offset:2304
    s_waitcnt lgkmcnt(8)
    v_mfma_f32_16x16x32_bf16 a[160:163], v[48:51], v[192:195], a[160:163]
    ds_read_b64_tr_b16 v[40:41], v4 offset:256
    s_barrier
    v_mfma_f32_16x16x32_bf16 a[164:167], v[48:51], v[196:199], a[164:167]
    ds_read_b64_tr_b16 v[42:43], v4 offset:2304
    v_mfma_f32_16x16x32_bf16 a[172:175], v[52:55], v[196:199], a[172:175]
    ds_read_b64_tr_b16 v[44:45], v5 offset:256
    s_waitcnt vmcnt(1)
    s_lshl_b32 s3, s44, 2
    v_mov_b32 v13, s3
    v_mov_b32 v14, s7
    buffer_store_dword v14, v13, s[28:31], s6 offen sc1
    v_mfma_f32_16x16x32_bf16 a[168:171], v[52:55], v[192:195], a[168:171]
    ds_read_b64_tr_b16 v[46:47], v5 offset:2304
    s_waitcnt lgkmcnt(8)
    v_mfma_f32_16x16x32_bf16 a[176:179], v[56:59], v[192:195], a[176:179]
    ds_read_b64_tr_b16 v[48:49], v6 offset:256
    v_mfma_f32_16x16x32_bf16 a[180:183], v[56:59], v[196:199], a[180:183]
    ds_read_b64_tr_b16 v[50:51], v6 offset:2304
    v_mfma_f32_16x16x32_bf16 a[188:191], v[60:63], v[196:199], a[188:191]
    ds_read_b64_tr_b16 v[52:53], v7 offset:256
    v_mfma_f32_16x16x32_bf16 a[184:187], v[60:63], v[192:195], a[184:187]
    ds_read_b64_tr_b16 v[54:55], v7 offset:2304
    s_waitcnt lgkmcnt(8)
    v_mfma_f32_16x16x32_bf16 a[192:195], v[32:35], v[192:195], a[192:195]
    ds_read_b64_tr_b16 v[56:57], v8 offset:256
    v_mfma_f32_16x16x32_bf16 a[196:199], v[32:35], v[196:199], a[196:199]
    ds_read_b64_tr_b16 v[58:59], v8 offset:2304
    v_mfma_f32_16x16x32_bf16 a[204:207], v[36:39], v[196:199], a[204:207]
    ds_read_b64_tr_b16 v[60:61], v9 offset:256
    v_mfma_f32_16x16x32_bf16 a[200:203], v[36:39], v[192:195], a[200:203]
    ds_read_b64_tr_b16 v[62:63], v9 offset:2304
    s_waitcnt lgkmcnt(8)
    v_mfma_f32_16x16x32_bf16 a[208:211], v[40:43], v[192:195], a[208:211]
    ds_read_b64_tr_b16 v[32:33], v2 offset:16384
    v_mfma_f32_16x16x32_bf16 a[212:215], v[40:43], v[196:199], a[212:215]
    ds_read_b64_tr_b16 v[34:35], v2 offset:18432
    v_mfma_f32_16x16x32_bf16 a[220:223], v[44:47], v[196:199], a[220:223]
    ds_read_b64_tr_b16 v[36:37], v3 offset:16384
    v_mfma_f32_16x16x32_bf16 a[216:219], v[44:47], v[192:195], a[216:219]
    ds_read_b64_tr_b16 v[38:39], v3 offset:18432
    s_waitcnt lgkmcnt(8)
    v_mfma_f32_16x16x32_bf16 a[224:227], v[48:51], v[192:195], a[224:227]
    ds_read_b64_tr_b16 v[40:41], v4 offset:16384
    v_mfma_f32_16x16x32_bf16 a[228:231], v[48:51], v[196:199], a[228:231]
    ds_read_b64_tr_b16 v[42:43], v4 offset:18432
    v_mfma_f32_16x16x32_bf16 a[236:239], v[52:55], v[196:199], a[236:239]
    ds_read_b64_tr_b16 v[44:45], v5 offset:16384
    v_mfma_f32_16x16x32_bf16 a[232:235], v[52:55], v[192:195], a[232:235]
    ds_read_b64_tr_b16 v[46:47], v5 offset:18432
    s_waitcnt lgkmcnt(8)
    v_mfma_f32_16x16x32_bf16 a[240:243], v[56:59], v[192:195], a[240:243]
    ds_read_b64_tr_b16 v[48:49], v6 offset:16384
    v_mfma_f32_16x16x32_bf16 a[244:247], v[56:59], v[196:199], a[244:247]
    ds_read_b64_tr_b16 v[50:51], v6 offset:18432
    v_mfma_f32_16x16x32_bf16 a[252:255], v[60:63], v[196:199], a[252:255]
    ds_read_b64_tr_b16 v[52:53], v7 offset:16384
    v_mfma_f32_16x16x32_bf16 a[248:251], v[60:63], v[192:195], a[248:251]
    ds_read_b64_tr_b16 v[54:55], v7 offset:18432
    s_waitcnt lgkmcnt(8)
    v_mfma_f32_16x16x32_bf16 a[128:131], v[32:35], v[200:203], a[128:131]
    ds_read_b64_tr_b16 v[56:57], v8 offset:16384
    v_mfma_f32_16x16x32_bf16 a[132:135], v[32:35], v[204:207], a[132:135]
    ds_read_b64_tr_b16 v[58:59], v8 offset:18432
    v_mfma_f32_16x16x32_bf16 a[140:143], v[36:39], v[204:207], a[140:143]
    ds_read_b64_tr_b16 v[60:61], v9 offset:16384
    v_mfma_f32_16x16x32_bf16 a[136:139], v[36:39], v[200:203], a[136:139]
    ds_read_b64_tr_b16 v[62:63], v9 offset:18432
    s_waitcnt lgkmcnt(8)
    v_mfma_f32_16x16x32_bf16 a[144:147], v[40:43], v[200:203], a[144:147]
    ds_read_b64_tr_b16 v[32:33], v2 offset:16640
    v_mfma_f32_16x16x32_bf16 a[148:151], v[40:43], v[204:207], a[148:151]
    ds_read_b64_tr_b16 v[34:35], v2 offset:18688
    v_mfma_f32_16x16x32_bf16 a[156:159], v[44:47], v[204:207], a[156:159]
    ds_read_b64_tr_b16 v[36:37], v3 offset:16640
    v_mfma_f32_16x16x32_bf16 a[152:155], v[44:47], v[200:203], a[152:155]
    ds_read_b64_tr_b16 v[38:39], v3 offset:18688
    s_waitcnt lgkmcnt(8)
    v_mfma_f32_16x16x32_bf16 a[160:163], v[48:51], v[200:203], a[160:163]
    ds_read_b64_tr_b16 v[40:41], v4 offset:16640
    v_mfma_f32_16x16x32_bf16 a[164:167], v[48:51], v[204:207], a[164:167]
    ds_read_b64_tr_b16 v[42:43], v4 offset:18688
    v_mfma_f32_16x16x32_bf16 a[172:175], v[52:55], v[204:207], a[172:175]
    ds_read_b64_tr_b16 v[44:45], v5 offset:16640
    v_mfma_f32_16x16x32_bf16 a[168:171], v[52:55], v[200:203], a[168:171]
    ds_read_b64_tr_b16 v[46:47], v5 offset:18688
    s_waitcnt lgkmcnt(8)
    v_mfma_f32_16x16x32_bf16 a[176:179], v[56:59], v[200:203], a[176:179]
    ds_read_b64_tr_b16 v[48:49], v6 offset:16640
    v_mfma_f32_16x16x32_bf16 a[180:183], v[56:59], v[204:207], a[180:183]
    ds_read_b64_tr_b16 v[50:51], v6 offset:18688
    v_mfma_f32_16x16x32_bf16 a[188:191], v[60:63], v[204:207], a[188:191]
    ds_read_b64_tr_b16 v[52:53], v7 offset:16640
    v_mfma_f32_16x16x32_bf16 a[184:187], v[60:63], v[200:203], a[184:187]
    ds_read_b64_tr_b16 v[54:55], v7 offset:18688
    s_waitcnt lgkmcnt(8)
    v_mfma_f32_16x16x32_bf16 a[192:195], v[32:35], v[200:203], a[192:195]
    ds_read_b64_tr_b16 v[56:57], v8 offset:16640
    v_mfma_f32_16x16x32_bf16 a[196:199], v[32:35], v[204:207], a[196:199]
    ds_read_b64_tr_b16 v[58:59], v8 offset:18688
    v_mfma_f32_16x16x32_bf16 a[204:207], v[36:39], v[204:207], a[204:207]
    ds_read_b64_tr_b16 v[60:61], v9 offset:16640
    v_mfma_f32_16x16x32_bf16 a[200:203], v[36:39], v[200:203], a[200:203]
    ds_read_b64_tr_b16 v[62:63], v9 offset:18688
    s_waitcnt lgkmcnt(8)
    v_mfma_f32_16x16x32_bf16 a[208:211], v[40:43], v[200:203], a[208:211]
    ds_read_b64_tr_b16 v[32:33], v2 offset:32768
    v_mfma_f32_16x16x32_bf16 a[212:215], v[40:43], v[204:207], a[212:215]
    ds_read_b64_tr_b16 v[34:35], v2 offset:34816
    v_mfma_f32_16x16x32_bf16 a[220:223], v[44:47], v[204:207], a[220:223]
    ds_read_b64_tr_b16 v[36:37], v3 offset:32768
    v_mfma_f32_16x16x32_bf16 a[216:219], v[44:47], v[200:203], a[216:219]
    ds_read_b64_tr_b16 v[38:39], v3 offset:34816
    s_waitcnt lgkmcnt(8)
    v_mfma_f32_16x16x32_bf16 a[224:227], v[48:51], v[200:203], a[224:227]
    ds_read_b64_tr_b16 v[40:41], v4 offset:32768
    v_mfma_f32_16x16x32_bf16 a[228:231], v[48:51], v[204:207], a[228:231]
    ds_read_b64_tr_b16 v[42:43], v4 offset:34816
    v_mfma_f32_16x16x32_bf16 a[236:239], v[52:55], v[204:207], a[236:239]
    ds_read_b64_tr_b16 v[44:45], v5 offset:32768
    v_mfma_f32_16x16x32_bf16 a[232:235], v[52:55], v[200:203], a[232:235]
    ds_read_b64_tr_b16 v[46:47], v5 offset:34816
    s_waitcnt lgkmcnt(8)
    v_mfma_f32_16x16x32_bf16 a[240:243], v[56:59], v[200:203], a[240:243]
    ds_read_b64_tr_b16 v[48:49], v6 offset:32768
    v_mfma_f32_16x16x32_bf16 a[244:247], v[56:59], v[204:207], a[244:247]
    ds_read_b64_tr_b16 v[50:51], v6 offset:34816
    v_mfma_f32_16x16x32_bf16 a[252:255], v[60:63], v[204:207], a[252:255]
    ds_read_b64_tr_b16 v[52:53], v7 offset:32768
    v_mfma_f32_16x16x32_bf16 a[248:251], v[60:63], v[200:203], a[248:251]
    ds_read_b64_tr_b16 v[54:55], v7 offset:34816
    s_waitcnt lgkmcnt(8)
    v_mfma_f32_16x16x32_bf16 a[128:131], v[32:35], v[208:211], a[128:131]
    ds_read_b64_tr_b16 v[56:57], v8 offset:32768
    v_mfma_f32_16x16x32_bf16 a[132:135], v[32:35], v[212:215], a[132:135]
    ds_read_b64_tr_b16 v[58:59], v8 offset:34816
    v_mfma_f32_16x16x32_bf16 a[140:143], v[36:39], v[212:215], a[140:143]
    ds_read_b64_tr_b16 v[60:61], v9 offset:32768
    v_mfma_f32_16x16x32_bf16 a[136:139], v[36:39], v[208:211], a[136:139]
    ds_read_b64_tr_b16 v[62:63], v9 offset:34816
    s_waitcnt lgkmcnt(8)
    v_mfma_f32_16x16x32_bf16 a[144:147], v[40:43], v[208:211], a[144:147]
    ds_read_b64_tr_b16 v[32:33], v2 offset:33024
    v_mfma_f32_16x16x32_bf16 a[148:151], v[40:43], v[212:215], a[148:151]
    ds_read_b64_tr_b16 v[34:35], v2 offset:35072
    v_mfma_f32_16x16x32_bf16 a[156:159], v[44:47], v[212:215], a[156:159]
    ds_read_b64_tr_b16 v[36:37], v3 offset:33024
    v_mfma_f32_16x16x32_bf16 a[152:155], v[44:47], v[208:211], a[152:155]
    ds_read_b64_tr_b16 v[38:39], v3 offset:35072
    s_waitcnt lgkmcnt(8)
    v_mfma_f32_16x16x32_bf16 a[160:163], v[48:51], v[208:211], a[160:163]
    ds_read_b64_tr_b16 v[40:41], v4 offset:33024
    v_mfma_f32_16x16x32_bf16 a[164:167], v[48:51], v[212:215], a[164:167]
    ds_read_b64_tr_b16 v[42:43], v4 offset:35072
    v_mfma_f32_16x16x32_bf16 a[172:175], v[52:55], v[212:215], a[172:175]
    ds_read_b64_tr_b16 v[44:45], v5 offset:33024
    v_mfma_f32_16x16x32_bf16 a[168:171], v[52:55], v[208:211], a[168:171]
    ds_read_b64_tr_b16 v[46:47], v5 offset:35072
    s_waitcnt lgkmcnt(8)
    v_mfma_f32_16x16x32_bf16 a[176:179], v[56:59], v[208:211], a[176:179]
    ds_read_b64_tr_b16 v[48:49], v6 offset:33024
    v_mfma_f32_16x16x32_bf16 a[180:183], v[56:59], v[212:215], a[180:183]
    ds_read_b64_tr_b16 v[50:51], v6 offset:35072
    v_mfma_f32_16x16x32_bf16 a[188:191], v[60:63], v[212:215], a[188:191]
    ds_read_b64_tr_b16 v[52:53], v7 offset:33024
    v_mfma_f32_16x16x32_bf16 a[184:187], v[60:63], v[208:211], a[184:187]
    ds_read_b64_tr_b16 v[54:55], v7 offset:35072
    s_waitcnt lgkmcnt(8)
    v_mfma_f32_16x16x32_bf16 a[192:195], v[32:35], v[208:211], a[192:195]
    ds_read_b64_tr_b16 v[56:57], v8 offset:33024
    v_mfma_f32_16x16x32_bf16 a[196:199], v[32:35], v[212:215], a[196:199]
    ds_read_b64_tr_b16 v[58:59], v8 offset:35072
    v_mfma_f32_16x16x32_bf16 a[204:207], v[36:39], v[212:215], a[204:207]
    ds_read_b64_tr_b16 v[60:61], v9 offset:33024
    v_mfma_f32_16x16x32_bf16 a[200:203], v[36:39], v[208:211], a[200:203]
    ds_read_b64_tr_b16 v[62:63], v9 offset:35072
    s_waitcnt lgkmcnt(8)
    v_mfma_f32_16x16x32_bf16 a[208:211], v[40:43], v[208:211], a[208:211]
    ds_read_b64_tr_b16 v[32:33], v2 offset:49152
    v_mfma_f32_16x16x32_bf16 a[212:215], v[40:43], v[212:215], a[212:215]
    ds_read_b64_tr_b16 v[34:35], v2 offset:51200
    v_bfe_u32 v13, v0, 2, 4
    v_min_u32 v13, 15, v13
    v_and_b32 v14, 3, v0
    v_lshlrev_b32 v14, 2, v14
    v_lshl_add_u32 v13, v13, 7, v14
    buffer_load_dword v14, v13, s[28:31], s52 offen sc1
    v_mfma_f32_16x16x32_bf16 a[220:223], v[44:47], v[212:215], a[220:223]
    ds_read_b64_tr_b16 v[36:37], v3 offset:49152
    v_mfma_f32_16x16x32_bf16 a[216:219], v[44:47], v[208:211], a[216:219]
    ds_read_b64_tr_b16 v[38:39], v3 offset:51200
    s_waitcnt lgkmcnt(8)
    v_mfma_f32_16x16x32_bf16 a[224:227], v[48:51], v[208:211], a[224:227]
    ds_read_b64_tr_b16 v[40:41], v4 offset:49152
    v_mfma_f32_16x16x32_bf16 a[228:231], v[48:51], v[212:215], a[228:231]
    ds_read_b64_tr_b16 v[42:43], v4 offset:51200
    v_mfma_f32_16x16x32_bf16 a[236:239], v[52:55], v[212:215], a[236:239]
    ds_read_b64_tr_b16 v[44:45], v5 offset:49152
    v_mfma_f32_16x16x32_bf16 a[232:235], v[52:55], v[208:211], a[232:235]
    ds_read_b64_tr_b16 v[46:47], v5 offset:51200
    s_waitcnt lgkmcnt(8)
    v_mfma_f32_16x16x32_bf16 a[240:243], v[56:59], v[208:211], a[240:243]
    ds_read_b64_tr_b16 v[48:49], v6 offset:49152
    v_mfma_f32_16x16x32_bf16 a[244:247], v[56:59], v[212:215], a[244:247]
    ds_read_b64_tr_b16 v[50:51], v6 offset:51200
    v_mfma_f32_16x16x32_bf16 a[252:255], v[60:63], v[212:215], a[252:255]
    ds_read_b64_tr_b16 v[52:53], v7 offset:49152
    v_mfma_f32_16x16x32_bf16 a[248:251], v[60:63], v[208:211], a[248:251]
    ds_read_b64_tr_b16 v[54:55], v7 offset:51200
    s_waitcnt lgkmcnt(8)
    v_mfma_f32_16x16x32_bf16 a[128:131], v[32:35], v[216:219], a[128:131]
    ds_read_b64_tr_b16 v[56:57], v8 offset:49152
    v_mfma_f32_16x16x32_bf16 a[132:135], v[32:35], v[220:223], a[132:135]
    ds_read_b64_tr_b16 v[58:59], v8 offset:51200
    v_mfma_f32_16x16x32_bf16 a[140:143], v[36:39], v[220:223], a[140:143]
    ds_read_b64_tr_b16 v[60:61], v9 offset:49152
    v_mfma_f32_16x16x32_bf16 a[136:139], v[36:39], v[216:219], a[136:139]
    ds_read_b64_tr_b16 v[62:63], v9 offset:51200
    s_waitcnt lgkmcnt(8)
    v_mfma_f32_16x16x32_bf16 a[144:147], v[40:43], v[216:219], a[144:147]
    ds_read_b64_tr_b16 v[32:33], v2 offset:49408
    v_mfma_f32_16x16x32_bf16 a[148:151], v[40:43], v[220:223], a[148:151]
    ds_read_b64_tr_b16 v[34:35], v2 offset:51456
    v_mfma_f32_16x16x32_bf16 a[156:159], v[44:47], v[220:223], a[156:159]
    ds_read_b64_tr_b16 v[36:37], v3 offset:49408
    v_mfma_f32_16x16x32_bf16 a[152:155], v[44:47], v[216:219], a[152:155]
    ds_read_b64_tr_b16 v[38:39], v3 offset:51456
    s_waitcnt lgkmcnt(8)
    v_mfma_f32_16x16x32_bf16 a[160:163], v[48:51], v[216:219], a[160:163]
    ds_read_b64_tr_b16 v[40:41], v4 offset:49408
    v_mfma_f32_16x16x32_bf16 a[164:167], v[48:51], v[220:223], a[164:167]
    ds_read_b64_tr_b16 v[42:43], v4 offset:51456
    v_mfma_f32_16x16x32_bf16 a[172:175], v[52:55], v[220:223], a[172:175]
    ds_read_b64_tr_b16 v[44:45], v5 offset:49408
    v_mfma_f32_16x16x32_bf16 a[168:171], v[52:55], v[216:219], a[168:171]
    ds_read_b64_tr_b16 v[46:47], v5 offset:51456
    s_waitcnt lgkmcnt(8)
    v_mfma_f32_16x16x32_bf16 a[176:179], v[56:59], v[216:219], a[176:179]
    ds_read_b64_tr_b16 v[48:49], v6 offset:49408
    v_mfma_f32_16x16x32_bf16 a[180:183], v[56:59], v[220:223], a[180:183]
    ds_read_b64_tr_b16 v[50:51], v6 offset:51456
    v_mfma_f32_16x16x32_bf16 a[188:191], v[60:63], v[220:223], a[188:191]
    ds_read_b64_tr_b16 v[52:53], v7 offset:49408
    v_mfma_f32_16x16x32_bf16 a[184:187], v[60:63], v[216:219], a[184:187]
    ds_read_b64_tr_b16 v[54:55], v7 offset:51456
    s_waitcnt lgkmcnt(8)
    v_mfma_f32_16x16x32_bf16 a[192:195], v[32:35], v[216:219], a[192:195]
    ds_read_b64_tr_b16 v[56:57], v8 offset:49408
    v_mfma_f32_16x16x32_bf16 a[196:199], v[32:35], v[220:223], a[196:199]
    ds_read_b64_tr_b16 v[58:59], v8 offset:51456
    v_mfma_f32_16x16x32_bf16 a[204:207], v[36:39], v[220:223], a[204:207]
    ds_read_b64_tr_b16 v[60:61], v9 offset:49408
    v_mfma_f32_16x16x32_bf16 a[200:203], v[36:39], v[216:219], a[200:203]
    ds_read_b64_tr_b16 v[62:63], v9 offset:51456
    s_waitcnt lgkmcnt(8)
    v_mfma_f32_16x16x32_bf16 a[208:211], v[40:43], v[216:219], a[208:211]
    v_mfma_f32_16x16x32_bf16 a[212:215], v[40:43], v[220:223], a[212:215]
    v_mfma_f32_16x16x32_bf16 a[220:223], v[44:47], v[220:223], a[220:223]
    v_mfma_f32_16x16x32_bf16 a[216:219], v[44:47], v[216:219], a[216:219]
    s_waitcnt lgkmcnt(4)
    v_mfma_f32_16x16x32_bf16 a[224:227], v[48:51], v[216:219], a[224:227]
    v_mfma_f32_16x16x32_bf16 a[228:231], v[48:51], v[220:223], a[228:231]
    v_mfma_f32_16x16x32_bf16 a[236:239], v[52:55], v[220:223], a[236:239]
    v_mfma_f32_16x16x32_bf16 a[232:235], v[52:55], v[216:219], a[232:235]
    s_waitcnt lgkmcnt(0)
    v_mfma_f32_16x16x32_bf16 a[240:243], v[56:59], v[216:219], a[240:243]
    v_mfma_f32_16x16x32_bf16 a[244:247], v[56:59], v[220:223], a[244:247]
    v_mfma_f32_16x16x32_bf16 a[252:255], v[60:63], v[220:223], a[252:255]
    v_mfma_f32_16x16x32_bf16 a[248:251], v[60:63], v[216:219], a[248:251]
    s_waitcnt vmcnt(0)
L1_qend:
    v_cmp_ne_u32 vcc, s7, v14
    s_cbranch_vccz L2_ready
    v_bfe_u32 v13, v0, 2, 4
    v_min_u32 v13, 15, v13
    v_and_b32 v14, 3, v0
    v_lshlrev_b32 v14, 2, v14
    v_lshl_add_u32 v13, v13, 7, v14
    s_mov_b32 s55, 0x10000
L2_poll1:
    buffer_load_dword v14, v13, s[28:31], s52 offen sc1
    s_waitcnt vmcnt(0)
    v_cmp_ne_u32 vcc, s7, v14
    s_cbranch_vccz L2_got1
    s_sleep 2
    s_sub_u32 s55, s55, 1
    s_cbranch_scc0 L2_poll1
L2_got1:
L2_ready:
    s_load_dwordx2 s[52:53], s[0:1], 40
    s_load_dwordx4 s[56:59], s[0:1], 56
    s_load_dwordx2 s[54:55], s[0:1], 72
    s_nop 4
    s_mov_b32 m0, s35
    s_nop 0
    buffer_load_dwordx4 v20, s[8:11], s32 offen offset:0 sc1 lds
    v_accvgpr_read_b32 v96, a128
    v_accvgpr_read_b32 v97, a129
    v_accvgpr_read_b32 v98, a130
    v_accvgpr_read_b32 v99, a131
    v_accvgpr_read_b32 v100, a136
    v_accvgpr_read_b32 v101, a137
    v_accvgpr_read_b32 v102, a138
    v_accvgpr_read_b32 v103, a139
    v_cvt_pk_bf16_f32 v104, v96, v97
    v_cvt_pk_bf16_f32 v105, v98, v99
    v_cvt_pk_bf16_f32 v106, v100, v101
    v_cvt_pk_bf16_f32 v107, v102, v103
    v_accvgpr_write_b32 a0, v104
    v_accvgpr_write_b32 a1, v105
    buffer_load_dwordx4 v20, s[8:11], s32 offen offset:1024 sc1 lds
    v_accvgpr_write_b32 a2, v106
    v_accvgpr_write_b32 a3, v107
    v_accvgpr_read_b32 v108, a144
    v_accvgpr_read_b32 v109, a145
    v_accvgpr_read_b32 v110, a146
    v_accvgpr_read_b32 v111, a147
    v_accvgpr_read_b32 v112, a152
    v_accvgpr_read_b32 v113, a153
    v_accvgpr_read_b32 v114, a154
    v_accvgpr_read_b32 v115, a155
    v_cvt_pk_bf16_f32 v116, v108, v109
    v_cvt_pk_bf16_f32 v117, v110, v111
    v_cvt_pk_bf16_f32 v118, v112, v113
    buffer_load_dwordx4 v20, s[8:11], s32 offen offset:2048 sc1 lds
    v_cvt_pk_bf16_f32 v119, v114, v115
    v_accvgpr_write_b32 a4, v116
    v_accvgpr_write_b32 a5, v117
    v_accvgpr_write_b32 a6, v118
    v_accvgpr_write_b32 a7, v119
    v_accvgpr_read_b32 v96, a160
    v_accvgpr_read_b32 v97, a161
    v_accvgpr_read_b32 v98, a162
    v_accvgpr_read_b32 v99, a163
    v_accvgpr_read_b32 v100, a168
    v_accvgpr_read_b32 v101, a169
    v_accvgpr_read_b32 v102, a170
    v_accvgpr_read_b32 v103, a171
    buffer_load_dwordx4 v20, s[8:11], s32 offen offset:3072 sc1 lds
    v_cvt_pk_bf16_f32 v104, v96, v97
    v_cvt_pk_bf16_f32 v105, v98, v99
    v_cvt_pk_bf16_f32 v106, v100, v101
    v_cvt_pk_bf16_f32 v107, v102, v103
    v_accvgpr_write_b32 a8, v104
    v_accvgpr_write_b32 a9, v105
    v_accvgpr_write_b32 a10, v106
    v_accvgpr_write_b32 a11, v107
    v_accvgpr_read_b32 v108, a176
    v_accvgpr_read_b32 v109, a177
    v_accvgpr_read_b32 v110, a178
    v_accvgpr_read_b32 v111, a179
    v_accvgpr_read_b32 v112, a184
    v_accvgpr_read_b32 v113, a185
    s_add_u32 s32, s32, 16384
    s_add_u32 s35, s35, 32768
    s_mov_b32 m0, s35
    s_nop 0
    buffer_load_dwordx4 v20, s[8:11], s32 offen offset:0 sc1 lds
    v_accvgpr_read_b32 v114, a186
    v_accvgpr_read_b32 v115, a187
    v_cvt_pk_bf16_f32 v116, v108, v109
    v_cvt_pk_bf16_f32 v117, v110, v111
    v_cvt_pk_bf16_f32 v118, v112, v113
    v_cvt_pk_bf16_f32 v119, v114, v115
    v_accvgpr_write_b32 a12, v116
    v_accvgpr_write_b32 a13, v117
    v_accvgpr_write_b32 a14, v118
    v_accvgpr_write_b32 a15, v119
    v_accvgpr_read_b32 v96, a192
    v_accvgpr_read_b32 v97, a193
    v_accvgpr_read_b32 v98, a194
    buffer_load_dwordx4 v20, s[8:11], s32 offen offset:1024 sc1 lds
    v_accvgpr_read_b32 v99, a195
    v_accvgpr_read_b32 v100, a200
    v_accvgpr_read_b32 v101, a201
    v_accvgpr_read_b32 v102, a202
    v_accvgpr_read_b32 v103, a203
    v_cvt_pk_bf16_f32 v104, v96, v97
    v_cvt_pk_bf16_f32 v105, v98, v99
    v_cvt_pk_bf16_f32 v106, v100, v101
    v_cvt_pk_bf16_f32 v107, v102, v103
    v_accvgpr_write_b32 a16, v104
    v_accvgpr_write_b32 a17, v105
    v_accvgpr_write_b32 a18, v106
    v_accvgpr_write_b32 a19, v107
    buffer_load_dwordx4 v20, s[8:11], s32 offen offset:2048 sc1 lds
    v_accvgpr_read_b32 v108, a208
    v_accvgpr_read_b32 v109, a209
    v_accvgpr_read_b32 v110, a210
    v_accvgpr_read_b32 v111, a211
    v_accvgpr_read_b32 v112, a216
    v_accvgpr_read_b32 v113, a217
    v_accvgpr_read_b32 v114, a218
    v_accvgpr_read_b32 v115, a219
    v_cvt_pk_bf16_f32 v116, v108, v109
    v_cvt_pk_bf16_f32 v117, v110, v111
    v_cvt_pk_bf16_f32 v118, v112, v113
    v_cvt_pk_bf16_f32 v119, v114, v115
    v_accvgpr_write_b32 a20, v116
    v_accvgpr_write_b32 a21, v117
    buffer_load_dwordx4 v20, s[8:11], s32 offen offset:3072 sc1 lds
    v_accvgpr_write_b32 a22, v118
    v_accvgpr_write_b32 a23, v119
    v_accvgpr_read_b32 v96, a224
    v_accvgpr_read_b32 v97, a225
    v_accvgpr_read_b32 v98, a226
    v_accvgpr_read_b32 v99, a227
    v_accvgpr_read_b32 v100, a232
    v_accvgpr_read_b32 v101, a233
    v_accvgpr_read_b32 v102, a234
    v_accvgpr_read_b32 v103, a235
    v_cvt_pk_bf16_f32 v104, v96, v97
    v_cvt_pk_bf16_f32 v105, v98, v99
    v_cvt_pk_bf16_f32 v106, v100, v101
    s_add_u32 s32, s32, 16384
    s_add_u32 s35, s35, 32768
    s_mov_b32 m0, s35
    s_nop 0
    buffer_load_dwordx4 v20, s[8:11], s32 offen offset:0 sc1 lds
    v_cvt_pk_bf16_f32 v107, v102, v103
    v_accvgpr_write_b32 a24, v104
    v_accvgpr_write_b32 a25, v105
    v_accvgpr_write_b32 a26, v106
    v_accvgpr_write_b32 a27, v107
    v_accvgpr_read_b32 v108, a240
    v_accvgpr_read_b32 v109, a241
    v_accvgpr_read_b32 v110, a242
    v_accvgpr_read_b32 v111, a243
    v_accvgpr_read_b32 v112, a248
    v_accvgpr_read_b32 v113, a249
    v_accvgpr_read_b32 v114, a250
    v_accvgpr_read_b32 v115, a251
    buffer_load_dwordx4 v20, s[8:11], s32 offen offset:1024 sc1 lds
    v_cvt_pk_bf16_f32 v116, v108, v109
    v_cvt_pk_bf16_f32 v117, v110, v111
    v_cvt_pk_bf16_f32 v118, v112, v113
    v_cvt_pk_bf16_f32 v119, v114, v115
    v_accvgpr_write_b32 a28, v116
    v_accvgpr_write_b32 a29, v117
    v_accvgpr_write_b32 a30, v118
    v_accvgpr_write_b32 a31, v119
    v_accvgpr_read_b32 v96, a132
    v_accvgpr_read_b32 v97, a133
    v_accvgpr_read_b32 v98, a134
    v_accvgpr_read_b32 v99, a135
    v_accvgpr_read_b32 v100, a140
    v_accvgpr_read_b32 v101, a141
    buffer_load_dwordx4 v20, s[8:11], s32 offen offset:2048 sc1 lds
    v_accvgpr_read_b32 v102, a142
    v_accvgpr_read_b32 v103, a143
    v_cvt_pk_bf16_f32 v104, v96, v97
    v_cvt_pk_bf16_f32 v105, v98, v99
    v_cvt_pk_bf16_f32 v106, v100, v101
    v_cvt_pk_bf16_f32 v107, v102, v103
    v_accvgpr_write_b32 a32, v104
    v_accvgpr_write_b32 a33, v105
    v_accvgpr_write_b32 a34, v106
    v_accvgpr_write_b32 a35, v107
    v_accvgpr_read_b32 v108, a148
    v_accvgpr_read_b32 v109, a149
    v_accvgpr_read_b32 v110, a150
    buffer_load_dwordx4 v20, s[8:11], s32 offen offset:3072 sc1 lds
    v_accvgpr_read_b32 v111, a151
    v_accvgpr_read_b32 v112, a156
    v_accvgpr_read_b32 v113, a157
    v_accvgpr_read_b32 v114, a158
    v_accvgpr_read_b32 v115, a159
    v_cvt_pk_bf16_f32 v116, v108, v109
    v_cvt_pk_bf16_f32 v117, v110, v111
    v_cvt_pk_bf16_f32 v118, v112, v113
    v_cvt_pk_bf16_f32 v119, v114, v115
    v_accvgpr_write_b32 a36, v116
    v_accvgpr_write_b32 a37, v117
    v_accvgpr_write_b32 a38, v118
    v_accvgpr_write_b32 a39, v119
    s_add_u32 m0, s35, 16384
    s_nop 0
    buffer_load_dwordx4 v20, s[16:19], s32 offen offset:0 sc1 lds
    v_accvgpr_read_b32 v96, a164
    v_accvgpr_read_b32 v97, a165
    v_accvgpr_read_b32 v98, a166
    v_accvgpr_read_b32 v99, a167
    v_accvgpr_read_b32 v100, a172
    v_accvgpr_read_b32 v101, a173
    v_accvgpr_read_b32 v102, a174
    v_accvgpr_read_b32 v103, a175
    v_cvt_pk_bf16_f32 v104, v96, v97
    v_cvt_pk_bf16_f32 v105, v98, v99
    v_cvt_pk_bf16_f32 v106, v100, v101
    v_cvt_pk_bf16_f32 v107, v102, v103
    v_accvgpr_write_b32 a40, v104
    v_accvgpr_write_b32 a41, v105
    buffer_load_dwordx4 v20, s[16:19], s32 offen offset:1024 sc1 lds
    v_accvgpr_write_b32 a42, v106
    v_accvgpr_write_b32 a43, v107
    v_accvgpr_read_b32 v108, a180
    v_accvgpr_read_b32 v109, a181
    v_accvgpr_read_b32 v110, a182
    v_accvgpr_read_b32 v111, a183
    v_accvgpr_read_b32 v112, a188
    v_accvgpr_read_b32 v113, a189
    v_accvgpr_read_b32 v114, a190
    v_accvgpr_read_b32 v115, a191
    v_cvt_pk_bf16_f32 v116, v108, v109
    v_cvt_pk_bf16_f32 v117, v110, v111
    v_cvt_pk_bf16_f32 v118, v112, v113
    buffer_load_dwordx4 v20, s[16:19], s32 offen offset:2048 sc1 lds
    v_cvt_pk_bf16_f32 v119, v114, v115
    v_accvgpr_write_b32 a44, v116
    v_accvgpr_write_b32 a45, v117
    v_accvgpr_write_b32 a46, v118
    v_accvgpr_write_b32 a47, v119
    v_accvgpr_read_b32 v96, a196
    v_accvgpr_read_b32 v97, a197
    v_accvgpr_read_b32 v98, a198
    v_accvgpr_read_b32 v99, a199
    v_accvgpr_read_b32 v100, a204
    v_accvgpr_read_b32 v101, a205
    v_accvgpr_read_b32 v102, a206
    v_accvgpr_read_b32 v103, a207
    buffer_load_dwordx4 v20, s[16:19], s32 offen offset:3072 sc1 lds
    v_cvt_pk_bf16_f32 v104, v96, v97
    v_cvt_pk_bf16_f32 v105, v98, v99
    v_cvt_pk_bf16_f32 v106, v100, v101
    v_cvt_pk_bf16_f32 v107, v102, v103
    v_accvgpr_write_b32 a48, v104
    v_accvgpr_write_b32 a49, v105
    v_accvgpr_write_b32 a50, v106
    v_accvgpr_write_b32 a51, v107
    v_accvgpr_read_b32 v108, a212
    v_accvgpr_read_b32 v109, a213
    v_accvgpr_read_b32 v110, a214
    v_accvgpr_read_b32 v111, a215
    v_accvgpr_read_b32 v112, a220
    v_accvgpr_read_b32 v113, a221
    s_add_u32 s32, s32, 16384
    s_barrier
    s_mov_b32 s35, s37
    s_mov_b32 m0, s35
    s_nop 0
    buffer_load_dwordx4 v20, s[8:11], s32 offen offset:0 sc1 lds
    v_accvgpr_read_b32 v114, a222
    v_accvgpr_read_b32 v115, a223
    v_cvt_pk_bf16_f32 v116, v108, v109
    v_cvt_pk_bf16_f32 v117, v110, v111
    v_cvt_pk_bf16_f32 v118, v112, v113
    v_cvt_pk_bf16_f32 v119, v114, v115
    v_accvgpr_write_b32 a52, v116
    v_accvgpr_write_b32 a53, v117
    v_accvgpr_write_b32 a54, v118
    v_accvgpr_write_b32 a55, v119
    v_accvgpr_read_b32 v96, a228
    v_accvgpr_read_b32 v97, a229
    v_accvgpr_read_b32 v98, a230
    buffer_load_dwordx4 v20, s[8:11], s32 offen offset:1024 sc1 lds
    v_accvgpr_read_b32 v99, a231
    v_accvgpr_read_b32 v100, a236
    v_accvgpr_read_b32 v101, a237
    v_accvgpr_read_b32 v102, a238
    v_accvgpr_read_b32 v103, a239
    v_cvt_pk_bf16_f32 v104, v96, v97
    v_cvt_pk_bf16_f32 v105, v98, v99
    v_cvt_pk_bf16_f32 v106, v100, v101
    v_cvt_pk_bf16_f32 v107, v102, v103
    v_accvgpr_write_b32 a56, v104
    v_accvgpr_write_b32 a57, v105
    v_accvgpr_write_b32 a58, v106
    v_accvgpr_write_b32 a59, v107
    buffer_load_dwordx4 v20, s[8:11], s32 offen offset:2048 sc1 lds
    v_accvgpr_read_b32 v108, a244
    v_accvgpr_read_b32 v109, a245
    v_accvgpr_read_b32 v110, a246
    v_accvgpr_read_b32 v111, a247
    v_accvgpr_read_b32 v112, a252
    v_accvgpr_read_b32 v113, a253
    v_accvgpr_read_b32 v114, a254
    v_accvgpr_read_b32 v115, a255
    v_cvt_pk_bf16_f32 v116, v108, v109
    v_cvt_pk_bf16_f32 v117, v110, v111
    v_cvt_pk_bf16_f32 v118, v112, v113
    v_cvt_pk_bf16_f32 v119, v114, v115
    v_accvgpr_write_b32 a60, v116
    v_accvgpr_write_b32 a61, v117
    buffer_load_dwordx4 v20, s[8:11], s32 offen offset:3072 sc1 lds
    v_accvgpr_write_b32 a62, v118
    v_accvgpr_write_b32 a63, v119
    v_mov_b64 v[128:129], 0
    v_mov_b64 v[130:131], 0
    v_mov_b64 v[132:133], 0
    v_mov_b64 v[134:135], 0
    v_mov_b64 v[136:137], 0
    v_mov_b64 v[138:139], 0
    v_mov_b64 v[140:141], 0
    v_mov_b64 v[142:143], 0
    v_mov_b64 v[144:145], 0
    v_mov_b64 v[146:147], 0
    v_mov_b64 v[148:149], 0
    s_add_u32 m0, s35, 16384
    s_nop 0
    buffer_load_dwordx4 v20, s[16:19], s32 offen offset:0 sc1 lds
    v_mov_b64 v[150:151], 0
    v_mov_b64 v[152:153], 0
    v_mov_b64 v[154:155], 0
    v_mov_b64 v[156:157], 0
    v_mov_b64 v[158:159], 0
    v_mov_b64 v[160:161], 0
    v_mov_b64 v[162:163], 0
    v_mov_b64 v[164:165], 0
    v_mov_b64 v[166:167], 0
    v_mov_b64 v[168:169], 0
    v_mov_b64 v[170:171], 0
    v_mov_b64 v[172:173], 0
    v_mov_b64 v[174:175], 0
    buffer_load_dwordx4 v20, s[16:19], s32 offen offset:1024 sc1 lds
    v_mov_b64 v[176:177], 0
    v_mov_b64 v[178:179], 0
    v_mov_b64 v[180:181], 0
    v_mov_b64 v[182:183], 0
    v_mov_b64 v[184:185], 0
    v_mov_b64 v[186:187], 0
    v_mov_b64 v[188:189], 0
    v_mov_b64 v[190:191], 0
    v_mov_b64 v[192:193], 0
    v_mov_b64 v[194:195], 0
    v_mov_b64 v[196:197], 0
    v_mov_b64 v[198:199], 0
    v_mov_b64 v[200:201], 0
    v_mov_b64 v[202:203], 0
    buffer_load_dwordx4 v20, s[16:19], s32 offen offset:2048 sc1 lds
    v_mov_b64 v[204:205], 0
    v_mov_b64 v[206:207], 0
    v_mov_b64 v[208:209], 0
    v_mov_b64 v[210:211], 0
    v_mov_b64 v[212:213], 0
    v_mov_b64 v[214:215], 0
    v_mov_b64 v[216:217], 0
    v_mov_b64 v[218:219], 0
    v_mov_b64 v[220:221], 0
    v_mov_b64 v[222:223], 0
    v_mov_b64 v[224:225], 0
    v_mov_b64 v[226:227], 0
    v_mov_b64 v[228:229], 0
    buffer_load_dwordx4 v20, s[16:19], s32 offen offset:3072 sc1 lds
    s_add_u32 s32, s32, 16384
    s_add_u32 s35, s37, 32768
    s_add_u32 s34, s37, 65536
    s_add_u32 s36, s37, 163840
    v_mov_b64 v[230:231], 0
    v_mov_b64 v[232:233], 0
    v_mov_b64 v[234:235], 0
    v_mov_b64 v[236:237], 0
    v_mov_b64 v[238:239], 0
    v_mov_b64 v[240:241], 0
    v_mov_b64 v[242:243], 0
    v_mov_b64 v[244:245], 0
    v_mov_b64 v[246:247], 0
    v_mov_b64 v[248:249], 0
    v_mov_b64 v[250:251], 0
    v_mov_b64 v[252:253], 0
    v_mov_b64 v[254:255], 0
    s_waitcnt lgkmcnt(0)
    s_mov_b32 s64, s52
    s_mov_b32 s65, s53
    s_mov_b32 s66, 3670016
    s_mov_b32 s67, 0x20000
    s_mov_b32 s60, 0
    s_cmp_ge_u32 s2, 106
    s_cselect_b32 s64, s56, s64
    s_cselect_b32 s65, s57, s65
    s_cselect_b32 s66, 1605632, s66
    s_cselect_b32 s60, 106, s60
    s_cmp_ge_u32 s2, 153
    s_cselect_b32 s64, s58, s64
    s_cselect_b32 s65, s59, s65
    s_cselect_b32 s66, 1605632, s66
    s_cselect_b32 s60, 153, s60
    s_cmp_ge_u32 s2, 200
    s_cselect_b32 s64, s54, s64
    s_cselect_b32 s65, s55, s65
    s_cselect_b32 s66, 1605632, s66
    s_cselect_b32 s60, 200, s60
    s_sub_u32 s60, s2, s60
    s_mul_i32 s60, s60, 34816
    s_add_u32 s64, s64, s60
    s_addc_u32 s65, s65, 0
    s_sub_u32 s66, s66, s60
    s_cselect_b32 s66, 0, s66
    s_min_u32 s66, s66, 34816
    v_mov_b32 v3, v20
    v_subrev_u32 v4, s37, v1
    v_add_u32 v2, 0x10000, v1
    s_lshl_b32 s3, s45, 19
    s_add_u32 s3, s3, 0x2400000
    s_add_u32 s20, s14, s3
    s_addc_u32 s21, s15, 0
    s_mov_b32 s22, 0x80000
    s_mov_b32 s23, 0x20000
    s_mov_b32 s24, s14
    s_mov_b32 s25, s15
    s_mov_b32 s26, 0x10000000
    s_mov_b32 s27, 0x20000
    s_mov_b32 s38, 0x49800000
    s_mov_b32 s79, 0
    v_lshlrev_b32 v124, 5, v0
    s_waitcnt vmcnt(20)
    s_barrier
    s_lshl_b32 s54, s46, 16
    s_lshl_b32 s55, s44, 14
    s_add_u32 s54, s54, s55
    s_add_u32 s72, s20, s54
    s_addc_u32 s73, s21, 0
    s_mov_b32 s75, 0x20000
    s_movk_i32 s76, 4096
    s_movk_i32 s77, 8192
    s_movk_i32 s78, 12288
    s_cmp_eq_u32 s50, 2
    s_cselect_b32 s74, 16384, 0
    s_cselect_b32 s68, s4, 0
L2_seg:
    ds_read_b128 a[64:67], v2 offset:0
    ds_read_b128 a[68:71], v2 offset:4096
    ds_read_b128 a[72:75], v2 offset:1024
    ds_read_b128 a[76:79], v2 offset:5120
    ds_read_b128 a[80:83], v2 offset:2048
    ds_read_b128 a[84:87], v2 offset:6144
    ds_read_b128 a[88:91], v2 offset:3072
    ds_read_b128 a[92:95], v2 offset:7168
    v_and_b32 v13, 15, v0
    v_bfe_u32 v14, v0, 4, 2
    v_lshlrev_b32 v14, 2, v14
    v_sub_u32 v13, v13, v14
    s_lshl_b32 s40, s48, 7
    s_lshl_b32 s70, s44, 5
    s_add_u32 s70, s70, s40
    v_add_u32 v5, s70, v13
    v_add_u32 v6, 16, v5
    v_mov_b32 v7, 0
    v_mov_b32 v8, 0
    v_mov_b32 v9, 0
    v_mov_b32 v10, 0
    v_mov_b32 v11, 0
    v_mov_b32 v12, 0
    v_mov_b64 v[16:17], 0
    v_mov_b64 v[18:19], 0
    v_mov_b64 v[20:21], 0
    v_mov_b64 v[22:23], 0
    v_mov_b64 v[24:25], 0
    v_mov_b64 v[26:27], 0
    v_mov_b64 v[28:29], 0
    v_mov_b64 v[30:31], 0
    s_sub_u32 s39, s39, 1
    s_cbranch_scc1 L2_mk2
L2_mk2_ret:
    s_waitcnt lgkmcnt(4)
    v_mfma_f32_16x16x32_bf16 v[32:35], a[64:67], a[0:3], v[16:19]
    ds_read_b128 a[96:99], v2 offset:8192
    s_mov_b32 m0, s35
    v_mfma_f32_16x16x32_bf16 v[36:39], a[64:67], a[32:35], v[20:23]
    ds_read_b128 a[100:103], v2 offset:12288
    buffer_load_dwordx4 v3, s[8:11], s32 offen offset:0 sc1 lds
    v_mfma_f32_16x16x32_bf16 v[44:47], a[68:71], a[32:35], v[28:31]
    ds_read_b128 a[104:107], v2 offset:9216
    buffer_load_dwordx4 v3, s[8:11], s32 offen offset:1024 sc1 lds
    buffer_store_dwordx4 a[0:3], v1, s[72:75], 0 offen offset:0 sc1
    v_mfma_f32_16x16x32_bf16 v[40:43], a[68:71], a[0:3], v[24:27]
    ds_read_b128 a[108:111], v2 offset:13312
    buffer_load_dwordx4 v3, s[8:11], s32 offen offset:2048 sc1 lds
    v_mfma_f32_16x16x32_bf16 v[32:35], a[72:75], a[4:7], v[32:35]
    ds_read_b128 a[112:115], v2 offset:10240
    buffer_load_dwordx4 v3, s[8:11], s32 offen offset:3072 sc1 lds
    v_mfma_f32_16x16x32_bf16 v[36:39], a[72:75], a[36:39], v[36:39]
    ds_read_b128 a[116:119], v2 offset:14336
    s_add_u32 m0, s35, 16384
    v_mfma_f32_16x16x32_bf16 v[44:47], a[76:79], a[36:39], v[44:47]
    ds_read_b128 a[120:123], v2 offset:11264
    buffer_load_dwordx4 v3, s[16:19], s32 offen offset:0 sc1 lds
    buffer_store_dwordx4 a[4:7], v1, s[72:75], 0 offen offset:1024 sc1
    v_mfma_f32_16x16x32_bf16 v[40:43], a[76:79], a[4:7], v[40:43]
    s_waitcnt lgkmcnt(7)
    ds_read_b128 a[124:127], v2 offset:15360
    v_mfma_f32_16x16x32_bf16 v[32:35], a[80:83], a[8:11], v[32:35]
    buffer_load_dwordx4 v3, s[16:19], s32 offen offset:1024 sc1 lds
    v_mfma_f32_16x16x32_bf16 v[36:39], a[80:83], a[40:43], v[36:39]
    buffer_load_dwordx4 v3, s[16:19], s32 offen offset:2048 sc1 lds
    v_mfma_f32_16x16x32_bf16 v[44:47], a[84:87], a[40:43], v[44:47]
    buffer_load_dwordx4 v3, s[16:19], s32 offen offset:3072 sc1 lds
    buffer_store_dwordx4 a[8:11], v1, s[72:75], 0 offen offset:2048 sc1
    v_mfma_f32_16x16x32_bf16 v[40:43], a[84:87], a[8:11], v[40:43]
    s_add_u32 s32, s32, 16384
    v_mfma_f32_16x16x32_bf16 v[32:35], a[88:91], a[12:15], v[32:35]
    s_add_u32 s35, s34, 32768
    v_mfma_f32_16x16x32_bf16 v[36:39], a[88:91], a[44:47], v[36:39]
    s_cmp_eq_u32 s35, s36
    s_cselect_b32 s35, s37, s35
    v_mfma_f32_16x16x32_bf16 v[44:47], a[92:95], a[44:47], v[44:47]
    v_add_u32 v2, s35, v4
    buffer_store_dwordx4 a[12:15], v1, s[72:75], 0 offen offset:3072 sc1
    v_mfma_f32_16x16x32_bf16 v[40:43], a[92:95], a[12:15], v[40:43]
    s_waitcnt vmcnt(28) lgkmcnt(0)
    s_barrier
    v_mfma_f32_16x16x32_bf16 v[32:35], a[96:99], a[16:19], v[32:35]
    ds_read_b128 a[64:67], v2 offset:0
    v_mfma_f32_16x16x32_bf16 v[36:39], a[96:99], a[48:51], v[36:39]
    buffer_store_dwordx4 a[16:19], v1, s[72:75], s76 offen offset:0 sc1
    v_mfma_f32_16x16x32_bf16 v[44:47], a[100:103], a[48:51], v[44:47]
    ds_read_b128 a[68:71], v2 offset:4096
    v_mfma_f32_16x16x32_bf16 v[40:43], a[100:103], a[16:19], v[40:43]
    v_mfma_f32_16x16x32_bf16 v[32:35], a[104:107], a[20:23], v[32:35]
    ds_read_b128 a[72:75], v2 offset:1024
    v_mfma_f32_16x16x32_bf16 v[36:39], a[104:107], a[52:55], v[36:39]
    buffer_store_dwordx4 a[20:23], v1, s[72:75], s76 offen offset:1024 sc1
    v_mfma_f32_16x16x32_bf16 v[44:47], a[108:111], a[52:55], v[44:47]
    ds_read_b128 a[76:79], v2 offset:5120
    v_mfma_f32_16x16x32_bf16 v[40:43], a[108:111], a[20:23], v[40:43]
    v_mfma_f32_16x16x32_bf16 v[32:35], a[112:115], a[24:27], v[32:35]
    ds_read_b128 a[80:83], v2 offset:2048
    v_mfma_f32_16x16x32_bf16 v[36:39], a[112:115], a[56:59], v[36:39]
    buffer_store_dwordx4 a[24:27], v1, s[72:75], s76 offen offset:2048 sc1
    v_mfma_f32_16x16x32_bf16 v[44:47], a[116:119], a[56:59], v[44:47]
    ds_read_b128 a[84:87], v2 offset:6144
    v_mfma_f32_16x16x32_bf16 v[40:43], a[116:119], a[24:27], v[40:43]
    v_mfma_f32_16x16x32_bf16 v[32:35], a[120:123], a[28:31], v[32:35]
    ds_read_b128 a[88:91], v2 offset:3072
    v_mfma_f32_16x16x32_bf16 v[36:39], a[120:123], a[60:63], v[36:39]
    buffer_store_dwordx4 a[28:31], v1, s[72:75], s76 offen offset:3072 sc1
    v_mfma_f32_16x16x32_bf16 v[44:47], a[124:127], a[60:63], v[44:47]
    ds_read_b128 a[92:95], v2 offset:7168
    v_mfma_f32_16x16x32_bf16 v[40:43], a[124:127], a[28:31], v[40:43]
    s_nop 7
    v_max3_f32 v13, v32, v33, v34
    v_max3_f32 v13, v13, v35, v40
    v_max3_f32 v13, v13, v41, v42
    v_max_f32 v13, v13, v43
    v_max3_f32 v14, v36, v37, v38
    v_max3_f32 v14, v14, v39, v44
    v_max3_f32 v14, v14, v45, v46
    v_max_f32 v14, v14, v47
    v_mov_b32 v96, v13
    v_mov_b32 v97, v14
    s_nop 1
    v_permlane32_swap_b32 v13, v96
    v_permlane32_swap_b32 v14, v97
    v_max_f32 v13, v13, v96
    v_max_f32 v14, v14, v97
    v_mov_b32 v96, v13
    v_mov_b32 v97, v14
    s_nop 1
    v_permlane16_swap_b32 v13, v96
    v_permlane16_swap_b32 v14, v97
    v_max_f32 v13, v13, v96
    v_max_f32 v14, v14, v97
    v_sub_f32 v32, v32, v13
    v_sub_f32 v33, v33, v13
    v_sub_f32 v34, v34, v13
    v_sub_f32 v35, v35, v13
    v_sub_f32 v40, v40, v13
    v_sub_f32 v41, v41, v13
    v_sub_f32 v42, v42, v13
    v_sub_f32 v43, v43, v13
    v_sub_f32 v36, v36, v14
    v_sub_f32 v37, v37, v14
    v_sub_f32 v38, v38, v14
    v_sub_f32 v39, v39, v14
    v_sub_f32 v44, v44, v14
    v_sub_f32 v45, v45, v14
    v_sub_f32 v46, v46, v14
    v_sub_f32 v47, v47, v14
    v_sub_f32 v16, v16, v13
    v_sub_f32 v17, v17, v13
    v_sub_f32 v18, v18, v13
    v_sub_f32 v19, v19, v13
    v_sub_f32 v24, v24, v13
    v_sub_f32 v25, v25, v13
    v_sub_f32 v26, v26, v13
    v_sub_f32 v27, v27, v13
    v_sub_f32 v20, v20, v14
    v_sub_f32 v21, v21, v14
    v_sub_f32 v22, v22, v14
    v_sub_f32 v23, v23, v14
    v_sub_f32 v28, v28, v14
    v_sub_f32 v29, v29, v14
    v_sub_f32 v30, v30, v14
    v_sub_f32 v31, v31, v14
    v_sub_f32 v7, v7, v13
    v_sub_f32 v8, v8, v14
    s_sub_u32 s42, s49, 2
    s_lshr_b32 s42, s42, 1
    s_min_u32 s62, s42, 2
    s_cmp_eq_u32 s50, 1
    s_cselect_b32 s62, 0, s62
    s_sub_u32 s42, s42, s62
    s_sub_u32 s39, s39, 1
    s_cbranch_scc1 L2_mk3
L2_mk3_ret:
    s_waitcnt lgkmcnt(4)
    v_mfma_f32_16x16x32_bf16 v[48:51], a[64:67], a[0:3], v[16:19]
    ds_read_b128 a[96:99], v2 offset:8192
    s_mov_b32 m0, s34
    v_mfma_f32_16x16x32_bf16 v[52:55], a[64:67], a[32:35], v[20:23]
    ds_read_b128 a[100:103], v2 offset:12288
    buffer_load_dwordx4 v3, s[8:11], s32 offen offset:0 sc1 lds
    v_mfma_f32_16x16x32_bf16 v[60:63], a[68:71], a[32:35], v[28:31]
    ds_read_b128 a[104:107], v2 offset:9216
    buffer_load_dwordx4 v3, s[8:11], s32 offen offset:1024 sc1 lds
    buffer_store_dwordx4 a[32:35], v1, s[72:75], s77 offen offset:0 sc1
    v_mfma_f32_16x16x32_bf16 v[56:59], a[68:71], a[0:3], v[24:27]
    ds_read_b128 a[108:111], v2 offset:13312
    buffer_load_dwordx4 v3, s[8:11], s32 offen offset:2048 sc1 lds
    v_exp_f32 v64, v32
    v_mfma_f32_16x16x32_bf16 v[48:51], a[72:75], a[4:7], v[48:51]
    ds_read_b128 a[112:115], v2 offset:10240
    buffer_load_dwordx4 v3, s[8:11], s32 offen offset:3072 sc1 lds
    v_mfma_f32_16x16x32_bf16 v[52:55], a[72:75], a[36:39], v[52:55]
    ds_read_b128 a[116:119], v2 offset:14336
    s_add_u32 m0, s34, 16384
    v_exp_f32 v65, v33
    v_add_f32 v9, v11, v64
    v_mfma_f32_16x16x32_bf16 v[60:63], a[76:79], a[36:39], v[60:63]
    ds_read_b128 a[120:123], v2 offset:11264
    buffer_load_dwordx4 v3, s[16:19], s32 offen offset:0 sc1 lds
    buffer_store_dwordx4 a[36:39], v1, s[72:75], s77 offen offset:1024 sc1
    v_mfma_f32_16x16x32_bf16 v[56:59], a[76:79], a[4:7], v[56:59]
    s_waitcnt lgkmcnt(7)
    ds_read_b128 a[124:127], v2 offset:15360
    v_exp_f32 v66, v34
    v_mfma_f32_16x16x32_bf16 v[48:51], a[80:83], a[8:11], v[48:51]
    buffer_load_dwordx4 v3, s[16:19], s32 offen offset:1024 sc1 lds
    v_add_f32 v9, v9, v65
    v_cvt_pk_bf16_f32 v80, v64, v65
    v_mfma_f32_16x16x32_bf16 v[52:55], a[80:83], a[40:43], v[52:55]
    buffer_load_dwordx4 v3, s[16:19], s32 offen offset:2048 sc1 lds
    v_exp_f32 v67, v35
    v_add_f32 v9, v9, v66
    v_mfma_f32_16x16x32_bf16 v[60:63], a[84:87], a[40:43], v[60:63]
    buffer_load_dwordx4 v3, s[16:19], s32 offen offset:3072 sc1 lds
    buffer_store_dwordx4 a[40:43], v1, s[72:75], s77 offen offset:2048 sc1
    v_exp_f32 v72, v40
    v_mfma_f32_16x16x32_bf16 v[56:59], a[84:87], a[8:11], v[56:59]
    s_add_u32 s32, s32, 16384
    v_add_f32 v9, v9, v67
    v_cvt_pk_bf16_f32 v81, v66, v67
    v_mfma_f32_16x16x32_bf16 v[48:51], a[88:91], a[12:15], v[48:51]
    s_add_u32 s34, s35, 32768
    v_exp_f32 v73, v41
    v_add_f32 v9, v9, v72
    v_mfma_f32_16x16x32_bf16 v[52:55], a[88:91], a[44:47], v[52:55]
    s_cmp_eq_u32 s34, s36
    s_cselect_b32 s34, s37, s34
    v_mfma_f32_16x16x32_bf16 v[60:63], a[92:95], a[44:47], v[60:63]
    v_add_u32 v2, s34, v4
    buffer_store_dwordx4 a[44:47], v1, s[72:75], s77 offen offset:3072 sc1
    v_exp_f32 v74, v42
    v_add_f32 v9, v9, v73
    v_mfma_f32_16x16x32_bf16 v[56:59], a[92:95], a[12:15], v[56:59]
    s_waitcnt vmcnt(36) lgkmcnt(0)
    s_barrier
    v_mfma_f32_16x16x32_bf16 v[48:51], a[96:99], a[16:19], v[48:51]
    ds_read_b128 a[64:67], v2 offset:16384
    v_cvt_pk_bf16_f32 v82, v72, v73
    v_exp_f32 v75, v43
    v_mfma_f32_16x16x32_bf16 v[52:55], a[96:99], a[48:51], v[52:55]
    buffer_store_dwordx4 a[48:51], v1, s[72:75], s78 offen offset:0 sc1
    v_add_f32 v9, v9, v74
    v_mfma_f32_16x16x32_bf16 v[60:63], a[100:103], a[48:51], v[60:63]
    ds_read_b128 a[68:71], v2 offset:17408
    v_exp_f32 v68, v36
    v_add_f32 v9, v9, v75
    v_mfma_f32_16x16x32_bf16 v[56:59], a[100:103], a[16:19], v[56:59]
    v_cvt_pk_bf16_f32 v83, v74, v75
    v_exp_f32 v69, v37
    v_add_f32 v10, v12, v68
    v_mfma_f32_16x16x32_bf16 v[48:51], a[104:107], a[20:23], v[48:51]
    ds_read_b128 a[72:75], v2 offset:18432
    v_exp_f32 v70, v38
    v_mfma_f32_16x16x32_bf16 v[52:55], a[104:107], a[52:55], v[52:55]
    buffer_store_dwordx4 a[52:55], v1, s[72:75], s78 offen offset:1024 sc1
    v_add_f32 v10, v10, v69
    v_cvt_pk_bf16_f32 v84, v68, v69
    v_mfma_f32_16x16x32_bf16 v[60:63], a[108:111], a[52:55], v[60:63]
    ds_read_b128 a[76:79], v2 offset:19456
    v_exp_f32 v71, v39
    v_add_f32 v10, v10, v70
    v_mfma_f32_16x16x32_bf16 v[56:59], a[108:111], a[20:23], v[56:59]
    v_exp_f32 v76, v44
    v_add_f32 v10, v10, v71
    v_mfma_f32_16x16x32_bf16 v[48:51], a[112:115], a[24:27], v[48:51]
    ds_read_b128 a[80:83], v2 offset:20480
    v_cvt_pk_bf16_f32 v85, v70, v71
    v_exp_f32 v77, v45
    v_mfma_f32_16x16x32_bf16 v[52:55], a[112:115], a[56:59], v[52:55]
    buffer_store_dwordx4 a[56:59], v1, s[72:75], s78 offen offset:2048 sc1
    v_add_f32 v10, v10, v76
    v_mfma_f32_16x16x32_bf16 v[60:63], a[116:119], a[56:59], v[60:63]
    ds_read_b128 a[84:87], v2 offset:21504
    v_exp_f32 v78, v46
    v_add_f32 v10, v10, v77
    v_cvt_pk_bf16_f32 v86, v76, v77
    v_mfma_f32_16x16x32_bf16 v[56:59], a[116:119], a[24:27], v[56:59]
    v_exp_f32 v79, v47
    v_add_f32 v10, v10, v78
    v_mfma_f32_16x16x32_bf16 v[48:51], a[120:123], a[28:31], v[48:51]
    ds_read_b128 a[88:91], v2 offset:22528
    v_add_f32 v13, v9, v10
    v_add_f32 v10, v10, v79
    v_cvt_pk_bf16_f32 v87, v78, v79
    v_mfma_f32_16x16x32_bf16 v[52:55], a[120:123], a[60:63], v[52:55]
    buffer_store_dwordx4 a[60:63], v1, s[72:75], s78 offen offset:3072 sc1
    v_add_f32 v13, v13, v10
    v_cmp_lt_f32 vcc, s38, v13
    v_mfma_f32_16x16x32_bf16 v[60:63], a[124:127], a[60:63], v[60:63]
    ds_read_b128 a[92:95], v2 offset:23552
    v_mfma_f32_16x16x32_bf16 v[56:59], a[124:127], a[28:31], v[56:59]
    s_cbranch_vccnz L2_rare3
L2_rare3_ret:
    s_mov_b32 s74, 0
    s_lshl_b32 s3, s42, 1
    s_sub_u32 s39, s39, s3
    s_sub_u32 s42, s42, 1
    s_cbranch_scc1 L2_loopc0
    .p2align 6
L2_loop:
    s_waitcnt lgkmcnt(4)
    v_mfma_f32_16x16x32_bf16 v[128:131], a[64:67], v[80:83], v[128:131]
    s_mov_b32 m0, s35
    ds_read_b128 a[96:99], v2 offset:24576
    v_mfma_f32_16x16x32_bf16 v[132:135], a[64:67], v[84:87], v[132:135]
    buffer_load_dwordx4 v3, s[8:11], s32 offen offset:0 sc1 lds
    v_mfma_f32_16x16x32_bf16 v[140:143], a[68:71], v[84:87], v[140:143]
    v_exp_f32_e64 v64, v48
    v_mfma_f32_16x16x32_bf16 v[136:139], a[68:71], v[80:83], v[136:139]
    ds_read_b128 a[100:103], v2 offset:25600
    v_add_f32_e64 v11, v9, v64
    v_mfma_f32_16x16x32_bf16 v[144:147], a[72:75], v[80:83], v[144:147]
    ds_read_b128 a[104:107], v2 offset:26624
    v_mfma_f32_16x16x32_bf16 v[148:151], a[72:75], v[84:87], v[148:151]
    v_exp_f32_e64 v65, v49
    v_mfma_f32_16x16x32_bf16 v[156:159], a[76:79], v[84:87], v[156:159]
    buffer_load_dwordx4 v3, s[8:11], s32 offen offset:1024 sc1 lds
    v_mfma_f32_16x16x32_bf16 v[152:155], a[76:79], v[80:83], v[152:155]
    s_waitcnt lgkmcnt(3)
    ds_read_b128 a[108:111], v2 offset:27648
    v_mfma_f32_16x16x32_bf16 v[160:163], a[80:83], v[80:83], v[160:163]
    ds_read_b128 a[112:115], v2 offset:28672
    v_add_f32 v11, v11, v65
    v_mfma_f32_16x16x32_bf16 v[164:167], a[80:83], v[84:87], v[164:167]
    v_exp_f32_e64 v66, v50
    v_mfma_f32_16x16x32_bf16 v[172:175], a[84:87], v[84:87], v[172:175]
    ds_read_b128 a[116:119], v2 offset:29696
    v_cvt_pk_bf16_f32 v88, v64, v65
    v_mfma_f32_16x16x32_bf16 v[168:171], a[84:87], v[80:83], v[168:171]
    buffer_load_dwordx4 v3, s[8:11], s32 offen offset:2048 sc1 lds
    v_mfma_f32_16x16x32_bf16 v[176:179], a[88:91], v[80:83], v[176:179]
    ds_read_b128 a[120:123], v2 offset:30720
    v_add_f32_e64 v11, v11, v66
    v_mfma_f32_16x16x32_bf16 v[180:183], a[88:91], v[84:87], v[180:183]
    v_exp_f32_e64 v67, v51
    v_mfma_f32_16x16x32_bf16 v[188:191], a[92:95], v[84:87], v[188:191]
    ds_read_b128 a[124:127], v2 offset:31744
    v_add_f32_e64 v11, v11, v67
    v_mfma_f32_16x16x32_bf16 v[184:187], a[92:95], v[80:83], v[184:187]
    s_waitcnt lgkmcnt(2)
    ds_read_b128 a[64:67], v2 offset:0
    v_mfma_f32_16x16x32_bf16 v[192:195], a[96:99], v[80:83], v[192:195]
    v_exp_f32 v72, v56
    v_mfma_f32_16x16x32_bf16 v[196:199], a[96:99], v[84:87], v[196:199]
    buffer_load_dwordx4 v3, s[8:11], s32 offen offset:3072 sc1 lds
    v_mfma_f32_16x16x32_bf16 v[204:207], a[100:103], v[84:87], v[204:207]
    s_add_u32 m0, s35, 16384
    ds_read_b128 a[68:71], v2 offset:4096
    v_mfma_f32_16x16x32_bf16 v[200:203], a[100:103], v[80:83], v[200:203]
    ds_read_b128 a[72:75], v2 offset:1024
    v_cvt_pk_bf16_f32 v89, v66, v67
    v_mfma_f32_16x16x32_bf16 v[208:211], a[104:107], v[80:83], v[208:211]
    v_exp_f32_e64 v73, v57
    v_mfma_f32_16x16x32_bf16 v[212:215], a[104:107], v[84:87], v[212:215]
    buffer_load_dwordx4 v3, s[16:19], s32 offen offset:0 sc1 lds
    v_mfma_f32_16x16x32_bf16 v[220:223], a[108:111], v[84:87], v[220:223]
    ds_read_b128 a[76:79], v2 offset:5120
    v_add_f32_e64 v11, v11, v72
    v_mfma_f32_16x16x32_bf16 v[216:219], a[108:111], v[80:83], v[216:219]
    ds_read_b128 a[80:83], v2 offset:2048
    v_add_f32_e64 v11, v11, v73
    v_mfma_f32_16x16x32_bf16 v[224:227], a[112:115], v[80:83], v[224:227]
    v_exp_f32_e64 v74, v58
    v_mfma_f32_16x16x32_bf16 v[228:231], a[112:115], v[84:87], v[228:231]
    ds_read_b128 a[84:87], v2 offset:6144
    v_cvt_pk_bf16_f32 v90, v72, v73
    v_mfma_f32_16x16x32_bf16 v[236:239], a[116:119], v[84:87], v[236:239]
    buffer_load_dwordx4 v3, s[16:19], s32 offen offset:1024 sc1 lds
    v_mfma_f32_16x16x32_bf16 v[232:235], a[116:119], v[80:83], v[232:235]
    s_waitcnt lgkmcnt(2)
    ds_read_b128 a[88:91], v2 offset:3072
    v_mfma_f32_16x16x32_bf16 v[240:243], a[120:123], v[80:83], v[240:243]
    v_exp_f32 v75, v59
    v_mfma_f32_16x16x32_bf16 v[244:247], a[120:123], v[84:87], v[244:247]
    ds_read_b128 a[92:95], v2 offset:7168
    v_add_f32_e64 v11, v11, v74
    v_mfma_f32_16x16x32_bf16 v[252:255], a[124:127], v[84:87], v[252:255]
    ds_read_b128 a[96:99], v2 offset:8192
    v_add_f32_e64 v11, v11, v75
    v_mfma_f32_16x16x32_bf16 v[248:251], a[124:127], v[80:83], v[248:251]
    v_exp_f32_e64 v68, v52
    v_mfma_f32_16x16x32_bf16 v[32:35], a[64:67], a[0:3], v[16:19]
    buffer_load_dwordx4 v3, s[16:19], s32 offen offset:2048 sc1 lds
    v_mfma_f32_16x16x32_bf16 v[36:39], a[64:67], a[32:35], v[20:23]
    ds_read_b128 a[100:103], v2 offset:12288
    v_cvt_pk_bf16_f32 v91, v74, v75
    v_mfma_f32_16x16x32_bf16 v[44:47], a[68:71], a[32:35], v[28:31]
    ds_read_b128 a[104:107], v2 offset:9216
    v_add_f32_e64 v12, v10, v68
    v_mfma_f32_16x16x32_bf16 v[40:43], a[68:71], a[0:3], v[24:27]
    v_exp_f32_e64 v69, v53
    v_mfma_f32_16x16x32_bf16 v[32:35], a[72:75], a[4:7], v[32:35]
    buffer_load_dwordx4 v3, s[16:19], s32 offen offset:3072 sc1 lds
    v_mfma_f32_16x16x32_bf16 v[36:39], a[72:75], a[36:39], v[36:39]
    s_add_u32 s32, s32, 16384
    ds_read_b128 a[108:111], v2 offset:13312
    v_mfma_f32_16x16x32_bf16 v[44:47], a[76:79], a[36:39], v[44:47]
    ds_read_b128 a[112:115], v2 offset:10240
    v_add_f32_e64 v12, v12, v69
    v_mfma_f32_16x16x32_bf16 v[40:43], a[76:79], a[4:7], v[40:43]
    s_waitcnt lgkmcnt(5)
    ds_read_b128 a[116:119], v2 offset:14336
    v_mfma_f32_16x16x32_bf16 v[32:35], a[80:83], a[8:11], v[32:35]
    v_exp_f32 v70, v54
    v_mfma_f32_16x16x32_bf16 v[36:39], a[80:83], a[40:43], v[36:39]
    ds_read_b128 a[120:123], v2 offset:11264
    v_cvt_pk_bf16_f32 v92, v68, v69
    v_mfma_f32_16x16x32_bf16 v[44:47], a[84:87], a[40:43], v[44:47]
    ds_read_b128 a[124:127], v2 offset:15360
    v_add_f32_e64 v12, v12, v70
    v_mfma_f32_16x16x32_bf16 v[40:43], a[84:87], a[8:11], v[40:43]
    v_exp_f32_e64 v71, v55
    v_mfma_f32_16x16x32_bf16 v[32:35], a[88:91], a[12:15], v[32:35]
    s_add_u32 s35, s34, 32768
    v_add_f32_e64 v12, v12, v71
    v_mfma_f32_16x16x32_bf16 v[36:39], a[88:91], a[44:47], v[36:39]
    s_cmp_eq_u32 s35, s36
    s_cselect_b32 s35, s37, s35
    v_mfma_f32_16x16x32_bf16 v[44:47], a[92:95], a[44:47], v[44:47]
    v_add_u32_e64 v2, s35, v4
    v_cvt_pk_bf16_f32 v93, v70, v71
    v_mfma_f32_16x16x32_bf16 v[40:43], a[92:95], a[12:15], v[40:43]
    s_waitcnt vmcnt(24) lgkmcnt(0)
    s_barrier
    v_mfma_f32_16x16x32_bf16 v[32:35], a[96:99], a[16:19], v[32:35]
    buffer_load_dword v125, v124, s[64:67], s79 offen
    ds_read_b128 a[64:67], v2 offset:16384
    v_mfma_f32_16x16x32_bf16 v[36:39], a[96:99], a[48:51], v[36:39]
    v_exp_f32_e64 v76, v60
    v_mfma_f32_16x16x32_bf16 v[44:47], a[100:103], a[48:51], v[44:47]
    v_exp_f32_e64 v77, v61
    v_mfma_f32_16x16x32_bf16 v[40:43], a[100:103], a[16:19], v[40:43]
    ds_read_b128 a[68:71], v2 offset:17408
    v_add_f32_e64 v12, v12, v76
    v_mfma_f32_16x16x32_bf16 v[32:35], a[104:107], a[20:23], v[32:35]
    ds_read_b128 a[72:75], v2 offset:18432
    v_add_f32_e64 v12, v12, v77
    v_mfma_f32_16x16x32_bf16 v[36:39], a[104:107], a[52:55], v[36:39]
    v_cvt_pk_bf16_f32 v94, v76, v77
    v_mfma_f32_16x16x32_bf16 v[44:47], a[108:111], a[52:55], v[44:47]
    v_exp_f32_e64 v78, v62
    v_mfma_f32_16x16x32_bf16 v[40:43], a[108:111], a[20:23], v[40:43]
    ds_read_b128 a[76:79], v2 offset:19456
    v_add_f32_e64 v12, v12, v78
    v_mfma_f32_16x16x32_bf16 v[32:35], a[112:115], a[24:27], v[32:35]
    ds_read_b128 a[80:83], v2 offset:20480
    v_mfma_f32_16x16x32_bf16 v[36:39], a[112:115], a[56:59], v[36:39]
    ds_read_b128 a[84:87], v2 offset:21504
    v_mfma_f32_16x16x32_bf16 v[44:47], a[116:119], a[56:59], v[44:47]
    v_exp_f32_e64 v79, v63
    v_mfma_f32_16x16x32_bf16 v[40:43], a[116:119], a[24:27], v[40:43]
    ds_read_b128 a[88:91], v2 offset:22528
    v_add_f32_e64 v12, v12, v79
    v_mfma_f32_16x16x32_bf16 v[32:35], a[120:123], a[28:31], v[32:35]
    v_add_f32_e64 v13, v11, v12
    v_cvt_pk_bf16_f32 v95, v78, v79
    v_mfma_f32_16x16x32_bf16 v[36:39], a[120:123], a[60:63], v[36:39]
    ds_read_b128 a[92:95], v2 offset:23552
    v_cmp_lt_f32_e64 vcc, s38, v13
    v_mfma_f32_16x16x32_bf16 v[44:47], a[124:127], a[60:63], v[44:47]
    v_mfma_f32_16x16x32_bf16 v[40:43], a[124:127], a[28:31], v[40:43]
    s_cbranch_vccnz L2_rare4
L2_rare4_ret:
    s_add_u32 s79, s79, 8192
    s_waitcnt lgkmcnt(4)
    v_mfma_f32_16x16x32_bf16 v[128:131], a[64:67], v[88:91], v[128:131]
    s_mov_b32 m0, s34
    ds_read_b128 a[96:99], v2 offset:24576
    v_mfma_f32_16x16x32_bf16 v[132:135], a[64:67], v[92:95], v[132:135]
    buffer_load_dwordx4 v3, s[8:11], s32 offen offset:0 sc1 lds
    v_mfma_f32_16x16x32_bf16 v[140:143], a[68:71], v[92:95], v[140:143]
    v_exp_f32 v64, v32
    v_mfma_f32_16x16x32_bf16 v[136:139], a[68:71], v[88:91], v[136:139]
    ds_read_b128 a[100:103], v2 offset:25600
    v_add_f32_e64 v9, v11, v64
    v_mfma_f32_16x16x32_bf16 v[144:147], a[72:75], v[88:91], v[144:147]
    ds_read_b128 a[104:107], v2 offset:26624
    v_mfma_f32_16x16x32_bf16 v[148:151], a[72:75], v[92:95], v[148:151]
    v_exp_f32_e64 v65, v33
    v_mfma_f32_16x16x32_bf16 v[156:159], a[76:79], v[92:95], v[156:159]
    buffer_load_dwordx4 v3, s[8:11], s32 offen offset:1024 sc1 lds
    v_mfma_f32_16x16x32_bf16 v[152:155], a[76:79], v[88:91], v[152:155]
    s_waitcnt lgkmcnt(3)
    ds_read_b128 a[108:111], v2 offset:27648
    v_mfma_f32_16x16x32_bf16 v[160:163], a[80:83], v[88:91], v[160:163]
    ds_read_b128 a[112:115], v2 offset:28672
    v_add_f32 v9, v9, v65
    v_mfma_f32_16x16x32_bf16 v[164:167], a[80:83], v[92:95], v[164:167]
    v_exp_f32_e64 v66, v34
    v_mfma_f32_16x16x32_bf16 v[172:175], a[84:87], v[92:95], v[172:175]
    ds_read_b128 a[116:119], v2 offset:29696
    v_cvt_pk_bf16_f32 v80, v64, v65
    v_mfma_f32_16x16x32_bf16 v[168:171], a[84:87], v[88:91], v[168:171]
    buffer_load_dwordx4 v3, s[8:11], s32 offen offset:2048 sc1 lds
    v_mfma_f32_16x16x32_bf16 v[176:179], a[88:91], v[88:91], v[176:179]
    ds_read_b128 a[120:123], v2 offset:30720
    v_add_f32_e64 v9, v9, v66
    v_mfma_f32_16x16x32_bf16 v[180:183], a[88:91], v[92:95], v[180:183]
    v_exp_f32_e64 v67, v35
    v_mfma_f32_16x16x32_bf16 v[188:191], a[92:95], v[92:95], v[188:191]
    ds_read_b128 a[124:127], v2 offset:31744
    v_add_f32_e64 v9, v9, v67
    v_mfma_f32_16x16x32_bf16 v[184:187], a[92:95], v[88:91], v[184:187]
    s_waitcnt lgkmcnt(2)
    ds_read_b128 a[64:67], v2 offset:0
    v_mfma_f32_16x16x32_bf16 v[192:195], a[96:99], v[88:91], v[192:195]
    v_exp_f32 v72, v40
    v_mfma_f32_16x16x32_bf16 v[196:199], a[96:99], v[92:95], v[196:199]
    buffer_load_dwordx4 v3, s[8:11], s32 offen offset:3072 sc1 lds
    v_mfma_f32_16x16x32_bf16 v[204:207], a[100:103], v[92:95], v[204:207]
    s_add_u32 m0, s34, 16384
    ds_read_b128 a[68:71], v2 offset:4096
    v_mfma_f32_16x16x32_bf16 v[200:203], a[100:103], v[88:91], v[200:203]
    ds_read_b128 a[72:75], v2 offset:1024
    v_cvt_pk_bf16_f32 v81, v66, v67
    v_mfma_f32_16x16x32_bf16 v[208:211], a[104:107], v[88:91], v[208:211]
    v_exp_f32_e64 v73, v41
    v_mfma_f32_16x16x32_bf16 v[212:215], a[104:107], v[92:95], v[212:215]
    buffer_load_dwordx4 v3, s[16:19], s32 offen offset:0 sc1 lds
    v_mfma_f32_16x16x32_bf16 v[220:223], a[108:111], v[92:95], v[220:223]
    ds_read_b128 a[76:79], v2 offset:5120
    v_add_f32_e64 v9, v9, v72
    v_mfma_f32_16x16x32_bf16 v[216:219], a[108:111], v[88:91], v[216:219]
    ds_read_b128 a[80:83], v2 offset:2048
    v_add_f32_e64 v9, v9, v73
    v_mfma_f32_16x16x32_bf16 v[224:227], a[112:115], v[88:91], v[224:227]
    v_exp_f32_e64 v74, v42
    v_mfma_f32_16x16x32_bf16 v[228:231], a[112:115], v[92:95], v[228:231]
    ds_read_b128 a[84:87], v2 offset:6144
    v_cvt_pk_bf16_f32 v82, v72, v73
    v_mfma_f32_16x16x32_bf16 v[236:239], a[116:119], v[92:95], v[236:239]
    buffer_load_dwordx4 v3, s[16:19], s32 offen offset:1024 sc1 lds
    v_mfma_f32_16x16x32_bf16 v[232:235], a[116:119], v[88:91], v[232:235]
    s_waitcnt lgkmcnt(2)
    ds_read_b128 a[88:91], v2 offset:3072
    v_mfma_f32_16x16x32_bf16 v[240:243], a[120:123], v[88:91], v[240:243]
    v_exp_f32 v75, v43
    v_mfma_f32_16x16x32_bf16 v[244:247], a[120:123], v[92:95], v[244:247]
    ds_read_b128 a[92:95], v2 offset:7168
    v_add_f32_e64 v9, v9, v74
    v_mfma_f32_16x16x32_bf16 v[252:255], a[124:127], v[92:95], v[252:255]
    ds_read_b128 a[96:99], v2 offset:8192
    v_add_f32_e64 v9, v9, v75
    v_mfma_f32_16x16x32_bf16 v[248:251], a[124:127], v[88:91], v[248:251]
    v_exp_f32_e64 v68, v36
    v_mfma_f32_16x16x32_bf16 v[48:51], a[64:67], a[0:3], v[16:19]
    buffer_load_dwordx4 v3, s[16:19], s32 offen offset:2048 sc1 lds
    v_mfma_f32_16x16x32_bf16 v[52:55], a[64:67], a[32:35], v[20:23]
    ds_read_b128 a[100:103], v2 offset:12288
    v_cvt_pk_bf16_f32 v83, v74, v75
    v_mfma_f32_16x16x32_bf16 v[60:63], a[68:71], a[32:35], v[28:31]
    ds_read_b128 a[104:107], v2 offset:9216
    v_add_f32_e64 v10, v12, v68
    v_mfma_f32_16x16x32_bf16 v[56:59], a[68:71], a[0:3], v[24:27]
    v_exp_f32_e64 v69, v37
    v_mfma_f32_16x16x32_bf16 v[48:51], a[72:75], a[4:7], v[48:51]
    buffer_load_dwordx4 v3, s[16:19], s32 offen offset:3072 sc1 lds
    v_mfma_f32_16x16x32_bf16 v[52:55], a[72:75], a[36:39], v[52:55]
    s_add_u32 s32, s32, 16384
    ds_read_b128 a[108:111], v2 offset:13312
    v_mfma_f32_16x16x32_bf16 v[60:63], a[76:79], a[36:39], v[60:63]
    ds_read_b128 a[112:115], v2 offset:10240
    v_add_f32_e64 v10, v10, v69
    v_mfma_f32_16x16x32_bf16 v[56:59], a[76:79], a[4:7], v[56:59]
    s_waitcnt lgkmcnt(5)
    ds_read_b128 a[116:119], v2 offset:14336
    v_mfma_f32_16x16x32_bf16 v[48:51], a[80:83], a[8:11], v[48:51]
    v_exp_f32 v70, v38
    v_mfma_f32_16x16x32_bf16 v[52:55], a[80:83], a[40:43], v[52:55]
    ds_read_b128 a[120:123], v2 offset:11264
    v_cvt_pk_bf16_f32 v84, v68, v69
    v_mfma_f32_16x16x32_bf16 v[60:63], a[84:87], a[40:43], v[60:63]
    ds_read_b128 a[124:127], v2 offset:15360
    v_add_f32_e64 v10, v10, v70
    v_mfma_f32_16x16x32_bf16 v[56:59], a[84:87], a[8:11], v[56:59]
    v_exp_f32_e64 v71, v39
    v_mfma_f32_16x16x32_bf16 v[48:51], a[88:91], a[12:15], v[48:51]
    s_add_u32 s34, s35, 32768
    v_add_f32_e64 v10, v10, v71
    v_mfma_f32_16x16x32_bf16 v[52:55], a[88:91], a[44:47], v[52:55]
    s_cmp_eq_u32 s34, s36
    s_cselect_b32 s34, s37, s34
    v_mfma_f32_16x16x32_bf16 v[60:63], a[92:95], a[44:47], v[60:63]
    v_add_u32_e64 v2, s34, v4
    v_cvt_pk_bf16_f32 v85, v70, v71
    v_mfma_f32_16x16x32_bf16 v[56:59], a[92:95], a[12:15], v[56:59]
    s_waitcnt vmcnt(25) lgkmcnt(0)
    s_barrier
    v_mfma_f32_16x16x32_bf16 v[48:51], a[96:99], a[16:19], v[48:51]
    s_cmp_lg_u32 s68, 0
    s_cbranch_scc1 L2_pub1
L2_pub1_ret:
    ds_read_b128 a[64:67], v2 offset:16384
    v_mfma_f32_16x16x32_bf16 v[52:55], a[96:99], a[48:51], v[52:55]
    v_exp_f32_e64 v76, v44
    v_mfma_f32_16x16x32_bf16 v[60:63], a[100:103], a[48:51], v[60:63]
    v_exp_f32_e64 v77, v45
    v_mfma_f32_16x16x32_bf16 v[56:59], a[100:103], a[16:19], v[56:59]
    ds_read_b128 a[68:71], v2 offset:17408
    v_add_f32_e64 v10, v10, v76
    v_mfma_f32_16x16x32_bf16 v[48:51], a[104:107], a[20:23], v[48:51]
    ds_read_b128 a[72:75], v2 offset:18432
    v_add_f32_e64 v10, v10, v77
    v_mfma_f32_16x16x32_bf16 v[52:55], a[104:107], a[52:55], v[52:55]
    v_cvt_pk_bf16_f32 v86, v76, v77
    v_mfma_f32_16x16x32_bf16 v[60:63], a[108:111], a[52:55], v[60:63]
    v_exp_f32_e64 v78, v46
    v_mfma_f32_16x16x32_bf16 v[56:59], a[108:111], a[20:23], v[56:59]
    ds_read_b128 a[76:79], v2 offset:19456
    v_add_f32_e64 v10, v10, v78
    v_mfma_f32_16x16x32_bf16 v[48:51], a[112:115], a[24:27], v[48:51]
    ds_read_b128 a[80:83], v2 offset:20480
    v_mfma_f32_16x16x32_bf16 v[52:55], a[112:115], a[56:59], v[52:55]
    ds_read_b128 a[84:87], v2 offset:21504
    v_mfma_f32_16x16x32_bf16 v[60:63], a[116:119], a[56:59], v[60:63]
    v_exp_f32_e64 v79, v47
    v_mfma_f32_16x16x32_bf16 v[56:59], a[116:119], a[24:27], v[56:59]
    ds_read_b128 a[88:91], v2 offset:22528
    v_add_f32_e64 v10, v10, v79
    v_mfma_f32_16x16x32_bf16 v[48:51], a[120:123], a[28:31], v[48:51]
    v_add_f32_e64 v13, v9, v10
    v_cvt_pk_bf16_f32 v87, v78, v79
    v_mfma_f32_16x16x32_bf16 v[52:55], a[120:123], a[60:63], v[52:55]
    ds_read_b128 a[92:95], v2 offset:23552
    v_cmp_lt_f32_e64 vcc, s38, v13
    v_mfma_f32_16x16x32_bf16 v[60:63], a[124:127], a[60:63], v[60:63]
    v_mfma_f32_16x16x32_bf16 v[56:59], a[124:127], a[28:31], v[56:59]
    s_sub_u32 s42, s42, 1
    s_cbranch_vccnz L2_rare5
L2_rare5_ret:
    s_cbranch_scc0 L2_loop
L2_loopc0:
    s_lshr_b32 s56, s2, 3
    s_getpc_b64 s[52:53]
    s_add_u32 s52, s52, L2_tail@rel32@lo+4
    s_addc_u32 s53, s53, L2_tail@rel32@hi+12
    s_mul_i32 s3, s56, (((L_hot_end-L2_tail)/32+63)&~63)
    s_add_u32 s52, s52, s3
    s_addc_u32 s53, s53, 0
    s_sub_u32 s54, L_hot_end-L2_tail, s3
    s_cselect_b32 s54, 0, s54
    s_min_u32 s54, s54, (((L_hot_end-L2_tail)/32+63)&~63)
    s_mov_b32 s55, 0x20000
    v_lshlrev_b32 v126, 6, v0
    buffer_load_dword v127, v126, s[52:55], 0 offen
    s_sub_u32 s62, s62, 1
    s_cbranch_scc1 L2_tail
    .p2align 6
L2_loopc:
    s_waitcnt lgkmcnt(4)
    v_mfma_f32_16x16x32_bf16 v[128:131], a[64:67], v[80:83], v[128:131]
    s_sub_u32 s39, s39, 1
    s_cbranch_scc1 L2_mk6
L2_mk6_ret:
    v_mfma_f32_16x16x32_bf16 v[132:135], a[64:67], v[84:87], v[132:135]
    s_mov_b32 m0, s35
    ds_read_b128 a[96:99], v2 offset:24576
    v_mfma_f32_16x16x32_bf16 v[140:143], a[68:71], v[84:87], v[140:143]
    v_exp_f32 v64, v48
    v_mfma_f32_16x16x32_bf16 v[136:139], a[68:71], v[80:83], v[136:139]
    buffer_load_dwordx4 v3, s[8:11], s32 offen offset:0 sc1 lds
    v_mfma_f32_16x16x32_bf16 v[144:147], a[72:75], v[80:83], v[144:147]
    ds_read_b128 a[100:103], v2 offset:25600
    v_add_f32 v11, v9, v64
    v_mfma_f32_16x16x32_bf16 v[148:151], a[72:75], v[84:87], v[148:151]
    v_exp_f32 v65, v49
    v_mfma_f32_16x16x32_bf16 v[156:159], a[76:79], v[84:87], v[156:159]
    ds_read_b128 a[104:107], v2 offset:26624
    v_add_f32 v11, v11, v65
    v_mfma_f32_16x16x32_bf16 v[152:155], a[76:79], v[80:83], v[152:155]
    s_waitcnt lgkmcnt(3)
    ds_read_b128 a[108:111], v2 offset:27648
    v_mfma_f32_16x16x32_bf16 v[160:163], a[80:83], v[80:83], v[160:163]
    buffer_load_dwordx4 v3, s[8:11], s32 offen offset:1024 sc1 lds
    v_mfma_f32_16x16x32_bf16 v[164:167], a[80:83], v[84:87], v[164:167]
    v_exp_f32 v66, v50
    v_mfma_f32_16x16x32_bf16 v[172:175], a[84:87], v[84:87], v[172:175]
    ds_read_b128 a[112:115], v2 offset:28672
    v_cvt_pk_bf16_f32 v88, v64, v65
    v_mfma_f32_16x16x32_bf16 v[168:171], a[84:87], v[80:83], v[168:171]
    ds_read_b128 a[116:119], v2 offset:29696
    v_add_f32 v11, v11, v66
    v_mfma_f32_16x16x32_bf16 v[176:179], a[88:91], v[80:83], v[176:179]
    buffer_load_dwordx4 v3, s[8:11], s32 offen offset:2048 sc1 lds
    v_mfma_f32_16x16x32_bf16 v[180:183], a[88:91], v[84:87], v[180:183]
    v_exp_f32 v67, v51
    v_mfma_f32_16x16x32_bf16 v[188:191], a[92:95], v[84:87], v[188:191]
    ds_read_b128 a[120:123], v2 offset:30720
    v_add_f32 v11, v11, v67
    v_mfma_f32_16x16x32_bf16 v[184:187], a[92:95], v[80:83], v[184:187]
    s_waitcnt lgkmcnt(3)
    ds_read_b128 a[124:127], v2 offset:31744
    v_mfma_f32_16x16x32_bf16 v[192:195], a[96:99], v[80:83], v[192:195]
    v_exp_f32 v72, v56
    v_mfma_f32_16x16x32_bf16 v[196:199], a[96:99], v[84:87], v[196:199]
    buffer_load_dwordx4 v3, s[8:11], s32 offen offset:3072 sc1 lds
    v_mfma_f32_16x16x32_bf16 v[204:207], a[100:103], v[84:87], v[204:207]
    ds_read_b128 a[64:67], v2 offset:0
    v_cvt_pk_bf16_f32 v89, v66, v67
    v_mfma_f32_16x16x32_bf16 v[200:203], a[100:103], v[80:83], v[200:203]
    s_add_u32 m0, s35, 16384
    ds_read_b128 a[68:71], v2 offset:4096
    v_mfma_f32_16x16x32_bf16 v[208:211], a[104:107], v[80:83], v[208:211]
    v_exp_f32 v73, v57
    v_mfma_f32_16x16x32_bf16 v[212:215], a[104:107], v[84:87], v[212:215]
    ds_read_b128 a[72:75], v2 offset:1024
    v_add_f32 v11, v11, v72
    v_mfma_f32_16x16x32_bf16 v[220:223], a[108:111], v[84:87], v[220:223]
    buffer_load_dwordx4 v3, s[16:19], s32 offen offset:0 sc1 lds
    v_mfma_f32_16x16x32_bf16 v[216:219], a[108:111], v[80:83], v[216:219]
    s_waitcnt lgkmcnt(3)
    ds_read_b128 a[76:79], v2 offset:5120
    v_mfma_f32_16x16x32_bf16 v[224:227], a[112:115], v[80:83], v[224:227]
    v_exp_f32 v74, v58
    v_mfma_f32_16x16x32_bf16 v[228:231], a[112:115], v[84:87], v[228:231]
    ds_read_b128 a[80:83], v2 offset:2048
    v_add_f32 v11, v11, v73
    v_mfma_f32_16x16x32_bf16 v[236:239], a[116:119], v[84:87], v[236:239]
    ds_read_b128 a[84:87], v2 offset:6144
    v_cvt_pk_bf16_f32 v90, v72, v73
    v_mfma_f32_16x16x32_bf16 v[232:235], a[116:119], v[80:83], v[232:235]
    buffer_load_dwordx4 v3, s[16:19], s32 offen offset:1024 sc1 lds
    v_mfma_f32_16x16x32_bf16 v[240:243], a[120:123], v[80:83], v[240:243]
    v_exp_f32 v75, v59
    v_mfma_f32_16x16x32_bf16 v[244:247], a[120:123], v[84:87], v[244:247]
    ds_read_b128 a[88:91], v2 offset:3072
    v_add_f32 v11, v11, v74
    v_mfma_f32_16x16x32_bf16 v[252:255], a[124:127], v[84:87], v[252:255]
    ds_read_b128 a[92:95], v2 offset:7168
    v_add_f32 v11, v11, v75
    v_mfma_f32_16x16x32_bf16 v[248:251], a[124:127], v[80:83], v[248:251]
    s_waitcnt lgkmcnt(4)
    ds_read_b128 a[96:99], v2 offset:8192
    v_mfma_f32_16x16x32_bf16 v[32:35], a[64:67], a[0:3], v[16:19]
    v_exp_f32 v68, v52
    v_mfma_f32_16x16x32_bf16 v[36:39], a[64:67], a[32:35], v[20:23]
    buffer_load_dwordx4 v3, s[16:19], s32 offen offset:2048 sc1 lds
    v_mfma_f32_16x16x32_bf16 v[44:47], a[68:71], a[32:35], v[28:31]
    ds_read_b128 a[100:103], v2 offset:12288
    v_cvt_pk_bf16_f32 v91, v74, v75
    v_mfma_f32_16x16x32_bf16 v[40:43], a[68:71], a[0:3], v[24:27]
    v_exp_f32 v69, v53
    v_mfma_f32_16x16x32_bf16 v[32:35], a[72:75], a[4:7], v[32:35]
    ds_read_b128 a[104:107], v2 offset:9216
    v_add_f32 v12, v10, v68
    v_mfma_f32_16x16x32_bf16 v[36:39], a[72:75], a[36:39], v[36:39]
    buffer_load_dwordx4 v3, s[16:19], s32 offen offset:3072 sc1 lds
    v_mfma_f32_16x16x32_bf16 v[44:47], a[76:79], a[36:39], v[44:47]
    s_add_u32 s32, s32, 16384
    ds_read_b128 a[108:111], v2 offset:13312
    v_mfma_f32_16x16x32_bf16 v[40:43], a[76:79], a[4:7], v[40:43]
    s_waitcnt lgkmcnt(4)
    ds_read_b128 a[112:115], v2 offset:10240
    v_mfma_f32_16x16x32_bf16 v[32:35], a[80:83], a[8:11], v[32:35]
    v_exp_f32 v70, v54
    v_mfma_f32_16x16x32_bf16 v[36:39], a[80:83], a[40:43], v[36:39]
    ds_read_b128 a[116:119], v2 offset:14336
    v_add_f32 v12, v12, v69
    v_mfma_f32_16x16x32_bf16 v[44:47], a[84:87], a[40:43], v[44:47]
    ds_read_b128 a[120:123], v2 offset:11264
    v_cvt_pk_bf16_f32 v92, v68, v69
    v_mfma_f32_16x16x32_bf16 v[40:43], a[84:87], a[8:11], v[40:43]
    v_exp_f32 v71, v55
    v_mfma_f32_16x16x32_bf16 v[32:35], a[88:91], a[12:15], v[32:35]
    s_add_u32 s35, s34, 32768
    ds_read_b128 a[124:127], v2 offset:15360
    v_mfma_f32_16x16x32_bf16 v[36:39], a[88:91], a[44:47], v[36:39]
    s_cmp_eq_u32 s35, s36
    s_cselect_b32 s35, s37, s35
    v_mfma_f32_16x16x32_bf16 v[44:47], a[92:95], a[44:47], v[44:47]
    v_add_u32 v2, s35, v4
    v_add_f32 v12, v12, v70
    v_mfma_f32_16x16x32_bf16 v[40:43], a[92:95], a[12:15], v[40:43]
    s_waitcnt vmcnt(24) lgkmcnt(0)
    s_barrier
    v_mfma_f32_16x16x32_bf16 v[32:35], a[96:99], a[16:19], v[32:35]
    v_exp_f32 v76, v60
    v_mfma_f32_16x16x32_bf16 v[36:39], a[96:99], a[48:51], v[36:39]
    ds_read_b128 a[64:67], v2 offset:16384
    v_add_f32 v12, v12, v71
    v_mfma_f32_16x16x32_bf16 v[44:47], a[100:103], a[48:51], v[44:47]
    v_exp_f32 v77, v61
    v_mfma_f32_16x16x32_bf16 v[40:43], a[100:103], a[16:19], v[40:43]
    ds_read_b128 a[68:71], v2 offset:17408
    v_cvt_pk_bf16_f32 v93, v70, v71
    v_mfma_f32_16x16x32_bf16 v[32:35], a[104:107], a[20:23], v[32:35]
    ds_read_b128 a[72:75], v2 offset:18432
    v_add_f32 v12, v12, v76
    v_mfma_f32_16x16x32_bf16 v[36:39], a[104:107], a[52:55], v[36:39]
    v_add_f32 v12, v12, v77
    v_cvt_pk_bf16_f32 v94, v76, v77
    v_mfma_f32_16x16x32_bf16 v[44:47], a[108:111], a[52:55], v[44:47]
    v_exp_f32 v78, v62
    v_mfma_f32_16x16x32_bf16 v[40:43], a[108:111], a[20:23], v[40:43]
    ds_read_b128 a[76:79], v2 offset:19456
    v_add_f32 v12, v12, v78
    v_mfma_f32_16x16x32_bf16 v[32:35], a[112:115], a[24:27], v[32:35]
    ds_read_b128 a[80:83], v2 offset:20480
    v_mfma_f32_16x16x32_bf16 v[36:39], a[112:115], a[56:59], v[36:39]
    ds_read_b128 a[84:87], v2 offset:21504
    v_mfma_f32_16x16x32_bf16 v[44:47], a[116:119], a[56:59], v[44:47]
    v_exp_f32 v79, v63
    v_mfma_f32_16x16x32_bf16 v[40:43], a[116:119], a[24:27], v[40:43]
    ds_read_b128 a[88:91], v2 offset:22528
    v_add_f32 v12, v12, v79
    v_mfma_f32_16x16x32_bf16 v[32:35], a[120:123], a[28:31], v[32:35]
    v_add_f32 v13, v11, v12
    v_cvt_pk_bf16_f32 v95, v78, v79
    v_mfma_f32_16x16x32_bf16 v[36:39], a[120:123], a[60:63], v[36:39]
    ds_read_b128 a[92:95], v2 offset:23552
    v_cmp_lt_f32 vcc, s38, v13
    v_mfma_f32_16x16x32_bf16 v[44:47], a[124:127], a[60:63], v[44:47]
    v_mfma_f32_16x16x32_bf16 v[40:43], a[124:127], a[28:31], v[40:43]
    s_cbranch_vccnz L2_rare6
L2_rare6_ret:
    s_waitcnt lgkmcnt(4)
    v_mfma_f32_16x16x32_bf16 v[128:131], a[64:67], v[88:91], v[128:131]
    s_sub_u32 s39, s39, 1
    s_cbranch_scc1 L2_mk7
L2_mk7_ret:
    v_mfma_f32_16x16x32_bf16 v[132:135], a[64:67], v[92:95], v[132:135]
    s_mov_b32 m0, s34
    ds_read_b128 a[96:99], v2 offset:24576
    v_mfma_f32_16x16x32_bf16 v[140:143], a[68:71], v[92:95], v[140:143]
    v_exp_f32 v64, v32
    v_mfma_f32_16x16x32_bf16 v[136:139], a[68:71], v[88:91], v[136:139]
    buffer_load_dwordx4 v3, s[8:11], s32 offen offset:0 sc1 lds
    v_mfma_f32_16x16x32_bf16 v[144:147], a[72:75], v[88:91], v[144:147]
    ds_read_b128 a[100:103], v2 offset:25600
    v_add_f32 v9, v11, v64
    v_mfma_f32_16x16x32_bf16 v[148:151], a[72:75], v[92:95], v[148:151]
    v_exp_f32 v65, v33
    v_mfma_f32_16x16x32_bf16 v[156:159], a[76:79], v[92:95], v[156:159]
    ds_read_b128 a[104:107], v2 offset:26624
    v_add_f32 v9, v9, v65
    v_mfma_f32_16x16x32_bf16 v[152:155], a[76:79], v[88:91], v[152:155]
    s_waitcnt lgkmcnt(3)
    ds_read_b128 a[108:111], v2 offset:27648
    v_mfma_f32_16x16x32_bf16 v[160:163], a[80:83], v[88:91], v[160:163]
    buffer_load_dwordx4 v3, s[8:11], s32 offen offset:1024 sc1 lds
    v_mfma_f32_16x16x32_bf16 v[164:167], a[80:83], v[92:95], v[164:167]
    v_exp_f32 v66, v34
    v_mfma_f32_16x16x32_bf16 v[172:175], a[84:87], v[92:95], v[172:175]
    ds_read_b128 a[112:115], v2 offset:28672
    v_cvt_pk_bf16_f32 v80, v64, v65
    v_mfma_f32_16x16x32_bf16 v[168:171], a[84:87], v[88:91], v[168:171]
    ds_read_b128 a[116:119], v2 offset:29696
    v_add_f32 v9, v9, v66
    v_mfma_f32_16x16x32_bf16 v[176:179], a[88:91], v[88:91], v[176:179]
    buffer_load_dwordx4 v3, s[8:11], s32 offen offset:2048 sc1 lds
    v_mfma_f32_16x16x32_bf16 v[180:183], a[88:91], v[92:95], v[180:183]
    v_exp_f32 v67, v35
    v_mfma_f32_16x16x32_bf16 v[188:191], a[92:95], v[92:95], v[188:191]
    ds_read_b128 a[120:123], v2 offset:30720
    v_add_f32 v9, v9, v67
    v_mfma_f32_16x16x32_bf16 v[184:187], a[92:95], v[88:91], v[184:187]
    s_waitcnt lgkmcnt(3)
    ds_read_b128 a[124:127], v2 offset:31744
    v_mfma_f32_16x16x32_bf16 v[192:195], a[96:99], v[88:91], v[192:195]
    v_exp_f32 v72, v40
    v_mfma_f32_16x16x32_bf16 v[196:199], a[96:99], v[92:95], v[196:199]
    buffer_load_dwordx4 v3, s[8:11], s32 offen offset:3072 sc1 lds
    v_mfma_f32_16x16x32_bf16 v[204:207], a[100:103], v[92:95], v[204:207]
    ds_read_b128 a[64:67], v2 offset:0
    v_cvt_pk_bf16_f32 v81, v66, v67
    v_mfma_f32_16x16x32_bf16 v[200:203], a[100:103], v[88:91], v[200:203]
    s_add_u32 m0, s34, 16384
    ds_read_b128 a[68:71], v2 offset:4096
    v_mfma_f32_16x16x32_bf16 v[208:211], a[104:107], v[88:91], v[208:211]
    v_exp_f32 v73, v41
    v_mfma_f32_16x16x32_bf16 v[212:215], a[104:107], v[92:95], v[212:215]
    ds_read_b128 a[72:75], v2 offset:1024
    v_add_f32 v9, v9, v72
    v_mfma_f32_16x16x32_bf16 v[220:223], a[108:111], v[92:95], v[220:223]
    buffer_load_dwordx4 v3, s[16:19], s32 offen offset:0 sc1 lds
    v_mfma_f32_16x16x32_bf16 v[216:219], a[108:111], v[88:91], v[216:219]
    s_waitcnt lgkmcnt(3)
    ds_read_b128 a[76:79], v2 offset:5120
    v_mfma_f32_16x16x32_bf16 v[224:227], a[112:115], v[88:91], v[224:227]
    v_exp_f32 v74, v42
    v_mfma_f32_16x16x32_bf16 v[228:231], a[112:115], v[92:95], v[228:231]
    ds_read_b128 a[80:83], v2 offset:2048
    v_add_f32 v9, v9, v73
    v_mfma_f32_16x16x32_bf16 v[236:239], a[116:119], v[92:95], v[236:239]
    ds_read_b128 a[84:87], v2 offset:6144
    v_cvt_pk_bf16_f32 v82, v72, v73
    v_mfma_f32_16x16x32_bf16 v[232:235], a[116:119], v[88:91], v[232:235]
    buffer_load_dwordx4 v3, s[16:19], s32 offen offset:1024 sc1 lds
    v_mfma_f32_16x16x32_bf16 v[240:243], a[120:123], v[88:91], v[240:243]
    v_exp_f32 v75, v43
    v_mfma_f32_16x16x32_bf16 v[244:247], a[120:123], v[92:95], v[244:247]
    ds_read_b128 a[88:91], v2 offset:3072
    v_add_f32 v9, v9, v74
    v_mfma_f32_16x16x32_bf16 v[252:255], a[124:127], v[92:95], v[252:255]
    ds_read_b128 a[92:95], v2 offset:7168
    v_add_f32 v9, v9, v75
    v_mfma_f32_16x16x32_bf16 v[248:251], a[124:127], v[88:91], v[248:251]
    s_waitcnt lgkmcnt(4)
    ds_read_b128 a[96:99], v2 offset:8192
    v_mfma_f32_16x16x32_bf16 v[48:51], a[64:67], a[0:3], v[16:19]
    v_exp_f32 v68, v36
    v_mfma_f32_16x16x32_bf16 v[52:55], a[64:67], a[32:35], v[20:23]
    buffer_load_dwordx4 v3, s[16:19], s32 offen offset:2048 sc1 lds
    v_mfma_f32_16x16x32_bf16 v[60:63], a[68:71], a[32:35], v[28:31]
    ds_read_b128 a[100:103], v2 offset:12288
    v_cvt_pk_bf16_f32 v83, v74, v75
    v_mfma_f32_16x16x32_bf16 v[56:59], a[68:71], a[0:3], v[24:27]
    v_exp_f32 v69, v37
    v_mfma_f32_16x16x32_bf16 v[48:51], a[72:75], a[4:7], v[48:51]
    ds_read_b128 a[104:107], v2 offset:9216
    v_add_f32 v10, v12, v68
    v_mfma_f32_16x16x32_bf16 v[52:55], a[72:75], a[36:39], v[52:55]
    buffer_load_dwordx4 v3, s[16:19], s32 offen offset:3072 sc1 lds
    v_mfma_f32_16x16x32_bf16 v[60:63], a[76:79], a[36:39], v[60:63]
    s_add_u32 s32, s32, 16384
    ds_read_b128 a[108:111], v2 offset:13312
    v_mfma_f32_16x16x32_bf16 v[56:59], a[76:79], a[4:7], v[56:59]
    s_waitcnt lgkmcnt(4)
    ds_read_b128 a[112:115], v2 offset:10240
    v_mfma_f32_16x16x32_bf16 v[48:51], a[80:83], a[8:11], v[48:51]
    v_exp_f32 v70, v38
    v_mfma_f32_16x16x32_bf16 v[52:55], a[80:83], a[40:43], v[52:55]
    ds_read_b128 a[116:119], v2 offset:14336
    v_add_f32 v10, v10, v69
    v_mfma_f32_16x16x32_bf16 v[60:63], a[84:87], a[40:43], v[60:63]
    ds_read_b128 a[120:123], v2 offset:11264
    v_cvt_pk_bf16_f32 v84, v68, v69
    v_mfma_f32_16x16x32_bf16 v[56:59], a[84:87], a[8:11], v[56:59]
    v_exp_f32 v71, v39
    v_mfma_f32_16x16x32_bf16 v[48:51], a[88:91], a[12:15], v[48:51]
    s_add_u32 s34, s35, 32768
    ds_read_b128 a[124:127], v2 offset:15360
    v_mfma_f32_16x16x32_bf16 v[52:55], a[88:91], a[44:47], v[52:55]
    s_cmp_eq_u32 s34, s36
    s_cselect_b32 s34, s37, s34
    v_mfma_f32_16x16x32_bf16 v[60:63], a[92:95], a[44:47], v[60:63]
    v_add_u32 v2, s34, v4
    v_add_f32 v10, v10, v70
    v_mfma_f32_16x16x32_bf16 v[56:59], a[92:95], a[12:15], v[56:59]
    s_waitcnt vmcnt(24) lgkmcnt(0)
    s_barrier
    v_mfma_f32_16x16x32_bf16 v[48:51], a[96:99], a[16:19], v[48:51]
    v_exp_f32 v76, v44
    v_mfma_f32_16x16x32_bf16 v[52:55], a[96:99], a[48:51], v[52:55]
    ds_read_b128 a[64:67], v2 offset:16384
    v_add_f32 v10, v10, v71
    v_mfma_f32_16x16x32_bf16 v[60:63], a[100:103], a[48:51], v[60:63]
    v_exp_f32 v77, v45
    v_mfma_f32_16x16x32_bf16 v[56:59], a[100:103], a[16:19], v[56:59]
    ds_read_b128 a[68:71], v2 offset:17408
    v_cvt_pk_bf16_f32 v85, v70, v71
    v_mfma_f32_16x16x32_bf16 v[48:51], a[104:107], a[20:23], v[48:51]
    ds_read_b128 a[72:75], v2 offset:18432
    v_add_f32 v10, v10, v76
    v_mfma_f32_16x16x32_bf16 v[52:55], a[104:107], a[52:55], v[52:55]
    v_add_f32 v10, v10, v77
    v_cvt_pk_bf16_f32 v86, v76, v77
    v_mfma_f32_16x16x32_bf16 v[60:63], a[108:111], a[52:55], v[60:63]
    v_exp_f32 v78, v46
    v_mfma_f32_16x16x32_bf16 v[56:59], a[108:111], a[20:23], v[56:59]
    ds_read_b128 a[76:79], v2 offset:19456
    v_add_f32 v10, v10, v78
    v_mfma_f32_16x16x32_bf16 v[48:51], a[112:115], a[24:27], v[48:51]
    ds_read_b128 a[80:83], v2 offset:20480
    v_mfma_f32_16x16x32_bf16 v[52:55], a[112:115], a[56:59], v[52:55]
    ds_read_b128 a[84:87], v2 offset:21504
    v_mfma_f32_16x16x32_bf16 v[60:63], a[116:119], a[56:59], v[60:63]
    v_exp_f32 v79, v47
    v_mfma_f32_16x16x32_bf16 v[56:59], a[116:119], a[24:27], v[56:59]
    ds_read_b128 a[88:91], v2 offset:22528
    v_add_f32 v10, v10, v79
    v_mfma_f32_16x16x32_bf16 v[48:51], a[120:123], a[28:31], v[48:51]
    v_add_f32 v13, v9, v10
    v_cvt_pk_bf16_f32 v87, v78, v79
    v_mfma_f32_16x16x32_bf16 v[52:55], a[120:123], a[60:63], v[52:55]
    ds_read_b128 a[92:95], v2 offset:23552
    v_cmp_lt_f32 vcc, s38, v13
    v_mfma_f32_16x16x32_bf16 v[60:63], a[124:127], a[60:63], v[60:63]
    v_mfma_f32_16x16x32_bf16 v[56:59], a[124:127], a[28:31], v[56:59]
    s_sub_u32 s62, s62, 1
    s_cbranch_vccnz L2_rare7
L2_rare7_ret:
    s_cbranch_scc0 L2_loopc
L2_tail:
    s_cmp_lg_u32 s68, 0
    s_cbranch_scc1 L2_pub2
L2_pub2_ret:
    s_cmp_eq_u32 s47, 1
    s_cbranch_scc0 L2_noq
    s_cmp_eq_u32 s33, 0
    s_cbranch_scc0 L2_noq
    s_cmp_ge_u32 s46, 6
    s_cbranch_scc1 L2_noq
    v_bfe_u32 v13, v0, 2, 4
    v_min_u32 v13, 0, v13
    v_and_b32 v14, 3, v0
    v_lshlrev_b32 v14, 2, v14
    v_lshl_add_u32 v13, v13, 7, v14
    s_mov_b32 s55, 0x10000
L2_poll8:
    buffer_load_dword v14, v13, s[28:31], s4 offen sc1
    s_waitcnt vmcnt(0)
    v_cmp_ne_u32 vcc, s7, v14
    s_cbranch_vccz L2_got8
    s_sleep 2
    s_sub_u32 s55, s55, 1
    s_cbranch_scc0 L2_poll8
L2_got8:
    s_lshl_b32 s54, s46, 16
    s_lshl_b32 s55, s44, 14
    s_add_u32 s54, s54, s55
    buffer_load_dwordx4 a[0:3], v1, s[20:23], s54 offen offset:0 sc1
    buffer_load_dwordx4 a[4:7], v1, s[20:23], s54 offen offset:1024 sc1
    buffer_load_dwordx4 a[8:11], v1, s[20:23], s54 offen offset:2048 sc1
    buffer_load_dwordx4 a[12:15], v1, s[20:23], s54 offen offset:3072 sc1
    s_add_u32 s54, s54, 4096
    buffer_load_dwordx4 a[16:19], v1, s[20:23], s54 offen offset:0 sc1
    buffer_load_dwordx4 a[20:23], v1, s[20:23], s54 offen offset:1024 sc1
    buffer_load_dwordx4 a[24:27], v1, s[20:23], s54 offen offset:2048 sc1
    buffer_load_dwordx4 a[28:31], v1, s[20:23], s54 offen offset:3072 sc1
    s_add_u32 s54, s54, 4096
    buffer_load_dwordx4 a[32:35], v1, s[20:23], s54 offen offset:0 sc1
    buffer_load_dwordx4 a[36:39], v1, s[20:23], s54 offen offset:1024 sc1
    buffer_load_dwordx4 a[40:43], v1, s[20:23], s54 offen offset:2048 sc1
    buffer_load_dwordx4 a[44:47], v1, s[20:23], s54 offen offset:3072 sc1
    s_add_u32 s54, s54, 4096
    buffer_load_dwordx4 a[48:51], v1, s[20:23], s54 offen offset:0 sc1
    buffer_load_dwordx4 a[52:55], v1, s[20:23], s54 offen offset:1024 sc1
    buffer_load_dwordx4 a[56:59], v1, s[20:23], s54 offen offset:2048 sc1
    buffer_load_dwordx4 a[60:63], v1, s[20:23], s54 offen offset:3072 sc1
    s_mov_b32 s33, 2
L2_noq:
    s_lshl_b32 s56, s45, 3
    s_add_u32 s56, s56, s46
    s_lshl_b32 s57, s56, 16
    s_lshl_b32 s3, s44, 14
    s_add_u32 s57, s57, s3
    s_add_u32 s57, s57, 0x4000000
    s_lshl_b32 s58, s56, 12
    s_lshl_b32 s3, s44, 10
    s_add_u32 s58, s58, s3
    s_add_u32 s58, s58, 0x5000000
    s_lshl_b32 s3, s44, 2
    v_mov_b32 v122, s3
    buffer_load_dword v123, v122, s[28:31], s5 offen sc1
    s_mov_b32 s63, 0
    s_cmp_eq_u32 s33, 2
    s_cbranch_scc1 L2_lmid
    s_waitcnt lgkmcnt(4)
    v_mfma_f32_16x16x32_bf16 v[128:131], a[64:67], v[80:83], v[128:131]
    ds_read_b128 a[96:99], v2 offset:24576
    v_mfma_f32_16x16x32_bf16 v[132:135], a[64:67], v[84:87], v[132:135]
    ds_read_b128 a[100:103], v2 offset:25600
    v_mfma_f32_16x16x32_bf16 v[140:143], a[68:71], v[84:87], v[140:143]
    ds_read_b128 a[104:107], v2 offset:26624
    v_mfma_f32_16x16x32_bf16 v[136:139], a[68:71], v[80:83], v[136:139]
    ds_read_b128 a[108:111], v2 offset:27648
    v_exp_f32 v64, v48
    v_mfma_f32_16x16x32_bf16 v[144:147], a[72:75], v[80:83], v[144:147]
    ds_read_b128 a[112:115], v2 offset:28672
    v_exp_f32 v65, v49
    v_mfma_f32_16x16x32_bf16 v[148:151], a[72:75], v[84:87], v[148:151]
    ds_read_b128 a[116:119], v2 offset:29696
    v_add_f32 v11, v9, v64
    v_mfma_f32_16x16x32_bf16 v[156:159], a[76:79], v[84:87], v[156:159]
    ds_read_b128 a[120:123], v2 offset:30720
    v_exp_f32 v66, v50
    v_add_f32 v11, v11, v65
    v_mfma_f32_16x16x32_bf16 v[152:155], a[76:79], v[80:83], v[152:155]
    s_waitcnt lgkmcnt(7)
    ds_read_b128 a[124:127], v2 offset:31744
    v_cvt_pk_bf16_f32 v88, v64, v65
    v_mfma_f32_16x16x32_bf16 v[160:163], a[80:83], v[80:83], v[160:163]
    v_exp_f32 v67, v51
    v_add_f32 v11, v11, v66
    v_mfma_f32_16x16x32_bf16 v[164:167], a[80:83], v[84:87], v[164:167]
    v_exp_f32 v72, v56
    v_add_f32 v11, v11, v67
    v_mfma_f32_16x16x32_bf16 v[172:175], a[84:87], v[84:87], v[172:175]
    v_cvt_pk_bf16_f32 v89, v66, v67
    v_mfma_f32_16x16x32_bf16 v[168:171], a[84:87], v[80:83], v[168:171]
    v_exp_f32 v73, v57
    v_add_f32 v11, v11, v72
    v_mfma_f32_16x16x32_bf16 v[176:179], a[88:91], v[80:83], v[176:179]
    s_add_u32 s35, s34, 32768
    v_exp_f32 v74, v58
    v_add_f32 v11, v11, v73
    v_mfma_f32_16x16x32_bf16 v[180:183], a[88:91], v[84:87], v[180:183]
    s_cmp_eq_u32 s35, s36
    s_cselect_b32 s35, s37, s35
    v_cvt_pk_bf16_f32 v90, v72, v73
    v_mfma_f32_16x16x32_bf16 v[188:191], a[92:95], v[84:87], v[188:191]
    v_add_u32 v2, s35, v4
    v_exp_f32 v75, v59
    v_mfma_f32_16x16x32_bf16 v[184:187], a[92:95], v[80:83], v[184:187]
    s_waitcnt vmcnt(16) lgkmcnt(0)
    s_barrier
    v_mfma_f32_16x16x32_bf16 v[192:195], a[96:99], v[80:83], v[192:195]
    ds_read_b128 a[64:67], v2 offset:16384
    v_add_f32 v11, v11, v74
    v_mfma_f32_16x16x32_bf16 v[196:199], a[96:99], v[84:87], v[196:199]
    v_exp_f32 v68, v52
    v_add_f32 v11, v11, v75
    v_cvt_pk_bf16_f32 v91, v74, v75
    v_mfma_f32_16x16x32_bf16 v[204:207], a[100:103], v[84:87], v[204:207]
    ds_read_b128 a[68:71], v2 offset:17408
    v_exp_f32 v69, v53
    v_mfma_f32_16x16x32_bf16 v[200:203], a[100:103], v[80:83], v[200:203]
    v_add_f32 v12, v10, v68
    v_exp_f32 v70, v54
    v_mfma_f32_16x16x32_bf16 v[208:211], a[104:107], v[80:83], v[208:211]
    ds_read_b128 a[72:75], v2 offset:18432
    v_add_f32 v12, v12, v69
    v_cvt_pk_bf16_f32 v92, v68, v69
    v_mfma_f32_16x16x32_bf16 v[212:215], a[104:107], v[84:87], v[212:215]
    v_exp_f32 v71, v55
    v_add_f32 v12, v12, v70
    v_mfma_f32_16x16x32_bf16 v[220:223], a[108:111], v[84:87], v[220:223]
    ds_read_b128 a[76:79], v2 offset:19456
    v_exp_f32 v76, v60
    v_mfma_f32_16x16x32_bf16 v[216:219], a[108:111], v[80:83], v[216:219]
    v_add_f32 v12, v12, v71
    v_cvt_pk_bf16_f32 v93, v70, v71
    v_mfma_f32_16x16x32_bf16 v[224:227], a[112:115], v[80:83], v[224:227]
    ds_read_b128 a[80:83], v2 offset:20480
    v_exp_f32 v77, v61
    v_mfma_f32_16x16x32_bf16 v[228:231], a[112:115], v[84:87], v[228:231]
    v_add_f32 v12, v12, v76
    v_exp_f32 v78, v62
    v_mfma_f32_16x16x32_bf16 v[236:239], a[116:119], v[84:87], v[236:239]
    ds_read_b128 a[84:87], v2 offset:21504
    v_add_f32 v12, v12, v77
    v_cvt_pk_bf16_f32 v94, v76, v77
    v_mfma_f32_16x16x32_bf16 v[232:235], a[116:119], v[80:83], v[232:235]
    v_exp_f32 v79, v63
    v_add_f32 v12, v12, v78
    v_mfma_f32_16x16x32_bf16 v[240:243], a[120:123], v[80:83], v[240:243]
    ds_read_b128 a[88:91], v2 offset:22528
    v_add_f32 v13, v11, v12
    v_add_f32 v12, v12, v79
    v_mfma_f32_16x16x32_bf16 v[244:247], a[120:123], v[84:87], v[244:247]
    v_cvt_pk_bf16_f32 v95, v78, v79
    v_add_f32 v13, v13, v12
    v_cmp_lt_f32 vcc, s38, v13
    v_mfma_f32_16x16x32_bf16 v[252:255], a[124:127], v[84:87], v[252:255]
    ds_read_b128 a[92:95], v2 offset:23552
    v_mfma_f32_16x16x32_bf16 v[248:251], a[124:127], v[80:83], v[248:251]
    s_cbranch_vccnz L2_rare9
L2_rare9_ret:
    s_waitcnt vmcnt(0)
    s_branch L2_ld
L2_lmid:
    s_waitcnt lgkmcnt(4)
    v_mfma_f32_16x16x32_bf16 v[128:131], a[64:67], v[80:83], v[128:131]
    ds_read_b128 a[96:99], v2 offset:24576
    s_mov_b32 m0, s35
    v_mfma_f32_16x16x32_bf16 v[132:135], a[64:67], v[84:87], v[132:135]
    ds_read_b128 a[100:103], v2 offset:25600
    buffer_load_dwordx4 v3, s[8:11], s32 offen offset:0 sc1 lds
    v_mfma_f32_16x16x32_bf16 v[140:143], a[68:71], v[84:87], v[140:143]
    ds_read_b128 a[104:107], v2 offset:26624
    buffer_load_dwordx4 v3, s[8:11], s32 offen offset:1024 sc1 lds
    v_mfma_f32_16x16x32_bf16 v[136:139], a[68:71], v[80:83], v[136:139]
    ds_read_b128 a[108:111], v2 offset:27648
    buffer_load_dwordx4 v3, s[8:11], s32 offen offset:2048 sc1 lds
    v_mfma_f32_16x16x32_bf16 v[144:147], a[72:75], v[80:83], v[144:147]
    ds_read_b128 a[112:115], v2 offset:28672
    buffer_load_dwordx4 v3, s[8:11], s32 offen offset:3072 sc1 lds
    v_exp_f32 v64, v48
    v_mfma_f32_16x16x32_bf16 v[148:151], a[72:75], v[84:87], v[148:151]
    ds_read_b128 a[116:119], v2 offset:29696
    s_add_u32 m0, s35, 16384
    v_exp_f32 v65, v49
    v_mfma_f32_16x16x32_bf16 v[156:159], a[76:79], v[84:87], v[156:159]
    ds_read_b128 a[120:123], v2 offset:30720
    buffer_load_dwordx4 v3, s[16:19], s32 offen offset:0 sc1 lds
    v_add_f32 v11, v9, v64
    v_mfma_f32_16x16x32_bf16 v[152:155], a[76:79], v[80:83], v[152:155]
    s_waitcnt lgkmcnt(7)
    ds_read_b128 a[124:127], v2 offset:31744
    v_exp_f32 v66, v50
    v_mfma_f32_16x16x32_bf16 v[160:163], a[80:83], v[80:83], v[160:163]
    buffer_load_dwordx4 v3, s[16:19], s32 offen offset:1024 sc1 lds
    v_add_f32 v11, v11, v65
    v_cvt_pk_bf16_f32 v88, v64, v65
    v_mfma_f32_16x16x32_bf16 v[164:167], a[80:83], v[84:87], v[164:167]
    buffer_load_dwordx4 v3, s[16:19], s32 offen offset:2048 sc1 lds
    v_exp_f32 v67, v51
    v_add_f32 v11, v11, v66
    v_mfma_f32_16x16x32_bf16 v[172:175], a[84:87], v[84:87], v[172:175]
    buffer_load_dwordx4 v3, s[16:19], s32 offen offset:3072 sc1 lds
    v_exp_f32 v72, v56
    v_mfma_f32_16x16x32_bf16 v[168:171], a[84:87], v[80:83], v[168:171]
    s_add_u32 s32, s32, 16384
    v_add_f32 v11, v11, v67
    v_cvt_pk_bf16_f32 v89, v66, v67
    v_mfma_f32_16x16x32_bf16 v[176:179], a[88:91], v[80:83], v[176:179]
    s_add_u32 s35, s34, 32768
    v_exp_f32 v73, v57
    v_add_f32 v11, v11, v72
    v_mfma_f32_16x16x32_bf16 v[180:183], a[88:91], v[84:87], v[180:183]
    s_cmp_eq_u32 s35, s36
    s_cselect_b32 s35, s37, s35
    v_mfma_f32_16x16x32_bf16 v[188:191], a[92:95], v[84:87], v[188:191]
    v_add_u32 v2, s35, v4
    v_exp_f32 v74, v58
    v_add_f32 v11, v11, v73
    v_mfma_f32_16x16x32_bf16 v[184:187], a[92:95], v[80:83], v[184:187]
    s_waitcnt vmcnt(24) lgkmcnt(0)
    s_barrier
    v_mfma_f32_16x16x32_bf16 v[192:195], a[96:99], v[80:83], v[192:195]
    ds_read_b128 a[64:67], v2 offset:16384
    v_cvt_pk_bf16_f32 v90, v72, v73
    v_exp_f32 v75, v59
    v_mfma_f32_16x16x32_bf16 v[196:199], a[96:99], v[84:87], v[196:199]
    v_add_f32 v11, v11, v74
    v_exp_f32 v68, v52
    v_mfma_f32_16x16x32_bf16 v[204:207], a[100:103], v[84:87], v[204:207]
    ds_read_b128 a[68:71], v2 offset:17408
    v_add_f32 v11, v11, v75
    v_cvt_pk_bf16_f32 v91, v74, v75
    v_mfma_f32_16x16x32_bf16 v[200:203], a[100:103], v[80:83], v[200:203]
    v_exp_f32 v69, v53
    v_add_f32 v12, v10, v68
    v_mfma_f32_16x16x32_bf16 v[208:211], a[104:107], v[80:83], v[208:211]
    ds_read_b128 a[72:75], v2 offset:18432
    v_exp_f32 v70, v54
    v_mfma_f32_16x16x32_bf16 v[212:215], a[104:107], v[84:87], v[212:215]
    v_add_f32 v12, v12, v69
    v_cvt_pk_bf16_f32 v92, v68, v69
    v_mfma_f32_16x16x32_bf16 v[220:223], a[108:111], v[84:87], v[220:223]
    ds_read_b128 a[76:79], v2 offset:19456
    v_exp_f32 v71, v55
    v_add_f32 v12, v12, v70
    v_mfma_f32_16x16x32_bf16 v[216:219], a[108:111], v[80:83], v[216:219]
    v_exp_f32 v76, v60
    v_add_f32 v12, v12, v71
    v_mfma_f32_16x16x32_bf16 v[224:227], a[112:115], v[80:83], v[224:227]
    ds_read_b128 a[80:83], v2 offset:20480
    v_cvt_pk_bf16_f32 v93, v70, v71
    v_exp_f32 v77, v61
    v_mfma_f32_16x16x32_bf16 v[228:231], a[112:115], v[84:87], v[228:231]
    v_add_f32 v12, v12, v76
    v_exp_f32 v78, v62
    v_mfma_f32_16x16x32_bf16 v[236:239], a[116:119], v[84:87], v[236:239]
    ds_read_b128 a[84:87], v2 offset:21504
    v_add_f32 v12, v12, v77
    v_cvt_pk_bf16_f32 v94, v76, v77
    v_mfma_f32_16x16x32_bf16 v[232:235], a[116:119], v[80:83], v[232:235]
    v_exp_f32 v79, v63
    v_add_f32 v12, v12, v78
    v_mfma_f32_16x16x32_bf16 v[240:243], a[120:123], v[80:83], v[240:243]
    ds_read_b128 a[88:91], v2 offset:22528
    v_add_f32 v13, v11, v12
    v_add_f32 v12, v12, v79
    v_mfma_f32_16x16x32_bf16 v[244:247], a[120:123], v[84:87], v[244:247]
    v_cvt_pk_bf16_f32 v95, v78, v79
    v_add_f32 v13, v13, v12
    v_cmp_lt_f32 vcc, s38, v13
    v_mfma_f32_16x16x32_bf16 v[252:255], a[124:127], v[84:87], v[252:255]
    ds_read_b128 a[92:95], v2 offset:23552
    v_mfma_f32_16x16x32_bf16 v[248:251], a[124:127], v[80:83], v[248:251]
    s_cbranch_vccnz L2_rare10
L2_rare10_ret:
L2_ld:
    s_cmp_eq_u32 s50, 2
    s_cbranch_scc0 L2_epi
    s_waitcnt vmcnt(8)
    v_cmp_ne_u32 vcc, s7, v123
    s_cbranch_vccnz L2_epi
    s_add_u32 s72, s14, s57
    s_addc_u32 s73, s15, 0
    s_movk_i32 s74, 16384
    s_mov_b32 s63, 1
    buffer_load_dwordx2 v[120:121], v1, s[24:27], s58 offen sc1
    s_waitcnt lgkmcnt(4)
    v_mfma_f32_16x16x32_bf16 v[128:131], a[64:67], v[88:91], v[128:131]
    ds_read_b128 a[96:99], v2 offset:24576
    buffer_load_dwordx4 v[16:19], v1, s[72:75], 0 offen offset:0 sc1
    v_mfma_f32_16x16x32_bf16 v[132:135], a[64:67], v[92:95], v[132:135]
    ds_read_b128 a[100:103], v2 offset:25600
    buffer_load_dwordx4 v[20:23], v1, s[72:75], 0 offen offset:1024 sc1
    v_mfma_f32_16x16x32_bf16 v[140:143], a[68:71], v[92:95], v[140:143]
    ds_read_b128 a[104:107], v2 offset:26624
    v_mfma_f32_16x16x32_bf16 v[136:139], a[68:71], v[88:91], v[136:139]
    ds_read_b128 a[108:111], v2 offset:27648
    buffer_load_dwordx4 v[24:27], v1, s[72:75], 0 offen offset:2048 sc1
    v_mfma_f32_16x16x32_bf16 v[144:147], a[72:75], v[88:91], v[144:147]
    ds_read_b128 a[112:115], v2 offset:28672
    buffer_load_dwordx4 v[28:31], v1, s[72:75], 0 offen offset:3072 sc1
    v_mfma_f32_16x16x32_bf16 v[148:151], a[72:75], v[92:95], v[148:151]
    ds_read_b128 a[116:119], v2 offset:29696
    v_mfma_f32_16x16x32_bf16 v[156:159], a[76:79], v[92:95], v[156:159]
    ds_read_b128 a[120:123], v2 offset:30720
    buffer_load_dwordx4 v[32:35], v1, s[72:75], s76 offen offset:0 sc1
    v_mfma_f32_16x16x32_bf16 v[152:155], a[76:79], v[88:91], v[152:155]
    s_waitcnt lgkmcnt(7)
    ds_read_b128 a[124:127], v2 offset:31744
    buffer_load_dwordx4 v[36:39], v1, s[72:75], s76 offen offset:1024 sc1
    v_mfma_f32_16x16x32_bf16 v[160:163], a[80:83], v[88:91], v[160:163]
    v_mfma_f32_16x16x32_bf16 v[164:167], a[80:83], v[92:95], v[164:167]
    buffer_load_dwordx4 v[40:43], v1, s[72:75], s76 offen offset:2048 sc1
    v_mfma_f32_16x16x32_bf16 v[172:175], a[84:87], v[92:95], v[172:175]
    buffer_load_dwordx4 v[44:47], v1, s[72:75], s76 offen offset:3072 sc1
    v_mfma_f32_16x16x32_bf16 v[168:171], a[84:87], v[88:91], v[168:171]
    v_mfma_f32_16x16x32_bf16 v[176:179], a[88:91], v[88:91], v[176:179]
    s_add_u32 s34, s35, 32768
    buffer_load_dwordx4 v[48:51], v1, s[72:75], s77 offen offset:0 sc1
    v_mfma_f32_16x16x32_bf16 v[180:183], a[88:91], v[92:95], v[180:183]
    s_cmp_eq_u32 s34, s36
    s_cselect_b32 s34, s37, s34
    buffer_load_dwordx4 v[52:55], v1, s[72:75], s77 offen offset:1024 sc1
    v_mfma_f32_16x16x32_bf16 v[188:191], a[92:95], v[92:95], v[188:191]
    v_add_u32 v2, s34, v4
    v_mfma_f32_16x16x32_bf16 v[184:187], a[92:95], v[88:91], v[184:187]
    s_waitcnt vmcnt(40) lgkmcnt(0)
    s_barrier
    buffer_load_dwordx4 v[56:59], v1, s[72:75], s77 offen offset:2048 sc1
    v_mfma_f32_16x16x32_bf16 v[192:195], a[96:99], v[88:91], v[192:195]
    buffer_load_dwordx4 v[60:63], v1, s[72:75], s77 offen offset:3072 sc1
    v_mfma_f32_16x16x32_bf16 v[196:199], a[96:99], v[92:95], v[196:199]
    v_mfma_f32_16x16x32_bf16 v[204:207], a[100:103], v[92:95], v[204:207]
    buffer_load_dwordx4 v[64:67], v1, s[72:75], s78 offen offset:0 sc1
    v_mfma_f32_16x16x32_bf16 v[200:203], a[100:103], v[88:91], v[200:203]
    buffer_load_dwordx4 v[68:71], v1, s[72:75], s78 offen offset:1024 sc1
    v_mfma_f32_16x16x32_bf16 v[208:211], a[104:107], v[88:91], v[208:211]
    v_mfma_f32_16x16x32_bf16 v[212:215], a[104:107], v[92:95], v[212:215]
    buffer_load_dwordx4 v[72:75], v1, s[72:75], s78 offen offset:2048 sc1
    v_mfma_f32_16x16x32_bf16 v[220:223], a[108:111], v[92:95], v[220:223]
    buffer_load_dwordx4 v[76:79], v1, s[72:75], s78 offen offset:3072 sc1
    v_mfma_f32_16x16x32_bf16 v[216:219], a[108:111], v[88:91], v[216:219]
    v_mfma_f32_16x16x32_bf16 v[224:227], a[112:115], v[88:91], v[224:227]
    v_mfma_f32_16x16x32_bf16 v[228:231], a[112:115], v[92:95], v[228:231]
    v_mfma_f32_16x16x32_bf16 v[236:239], a[116:119], v[92:95], v[236:239]
    v_mfma_f32_16x16x32_bf16 v[232:235], a[116:119], v[88:91], v[232:235]
    v_mfma_f32_16x16x32_bf16 v[240:243], a[120:123], v[88:91], v[240:243]
    v_mfma_f32_16x16x32_bf16 v[244:247], a[120:123], v[92:95], v[244:247]
    v_mfma_f32_16x16x32_bf16 v[252:255], a[124:127], v[92:95], v[252:255]
    v_mfma_f32_16x16x32_bf16 v[248:251], a[124:127], v[88:91], v[248:251]
    s_branch L2_epd
L2_epi:
    s_waitcnt lgkmcnt(4)
    v_mfma_f32_16x16x32_bf16 v[128:131], a[64:67], v[88:91], v[128:131]
    ds_read_b128 a[96:99], v2 offset:24576
    s_mov_b32 m0, s34
    v_mfma_f32_16x16x32_bf16 v[132:135], a[64:67], v[92:95], v[132:135]
    ds_read_b128 a[100:103], v2 offset:25600
    buffer_load_dwordx4 v3, s[8:11], s32 offen offset:0 sc1 lds
    v_mfma_f32_16x16x32_bf16 v[140:143], a[68:71], v[92:95], v[140:143]
    ds_read_b128 a[104:107], v2 offset:26624
    buffer_load_dwordx4 v3, s[8:11], s32 offen offset:1024 sc1 lds
    v_mfma_f32_16x16x32_bf16 v[136:139], a[68:71], v[88:91], v[136:139]
    ds_read_b128 a[108:111], v2 offset:27648
    buffer_load_dwordx4 v3, s[8:11], s32 offen offset:2048 sc1 lds
    v_mfma_f32_16x16x32_bf16 v[144:147], a[72:75], v[88:91], v[144:147]
    ds_read_b128 a[112:115], v2 offset:28672
    buffer_load_dwordx4 v3, s[8:11], s32 offen offset:3072 sc1 lds
    v_mfma_f32_16x16x32_bf16 v[148:151], a[72:75], v[92:95], v[148:151]
    ds_read_b128 a[116:119], v2 offset:29696
    s_add_u32 m0, s34, 16384
    v_mfma_f32_16x16x32_bf16 v[156:159], a[76:79], v[92:95], v[156:159]
    ds_read_b128 a[120:123], v2 offset:30720
    buffer_load_dwordx4 v3, s[16:19], s32 offen offset:0 sc1 lds
    v_mfma_f32_16x16x32_bf16 v[152:155], a[76:79], v[88:91], v[152:155]
    s_waitcnt lgkmcnt(7)
    ds_read_b128 a[124:127], v2 offset:31744
    v_mfma_f32_16x16x32_bf16 v[160:163], a[80:83], v[88:91], v[160:163]
    buffer_load_dwordx4 v3, s[16:19], s32 offen offset:1024 sc1 lds
    v_mfma_f32_16x16x32_bf16 v[164:167], a[80:83], v[92:95], v[164:167]
    buffer_load_dwordx4 v3, s[16:19], s32 offen offset:2048 sc1 lds
    v_mfma_f32_16x16x32_bf16 v[172:175], a[84:87], v[92:95], v[172:175]
    buffer_load_dwordx4 v3, s[16:19], s32 offen offset:3072 sc1 lds
    v_mfma_f32_16x16x32_bf16 v[168:171], a[84:87], v[88:91], v[168:171]
    s_add_u32 s32, s32, 16384
    v_mfma_f32_16x16x32_bf16 v[176:179], a[88:91], v[88:91], v[176:179]
    s_add_u32 s34, s35, 32768
    v_mfma_f32_16x16x32_bf16 v[180:183], a[88:91], v[92:95], v[180:183]
    s_cmp_eq_u32 s34, s36
    s_cselect_b32 s34, s37, s34
    v_mfma_f32_16x16x32_bf16 v[188:191], a[92:95], v[92:95], v[188:191]
    v_add_u32 v2, s34, v4
    v_mfma_f32_16x16x32_bf16 v[184:187], a[92:95], v[88:91], v[184:187]
    s_waitcnt vmcnt(16) lgkmcnt(0)
    s_barrier
    v_mfma_f32_16x16x32_bf16 v[192:195], a[96:99], v[88:91], v[192:195]
    v_mfma_f32_16x16x32_bf16 v[196:199], a[96:99], v[92:95], v[196:199]
    v_mfma_f32_16x16x32_bf16 v[204:207], a[100:103], v[92:95], v[204:207]
    v_mfma_f32_16x16x32_bf16 v[200:203], a[100:103], v[88:91], v[200:203]
    v_mfma_f32_16x16x32_bf16 v[208:211], a[104:107], v[88:91], v[208:211]
    v_mfma_f32_16x16x32_bf16 v[212:215], a[104:107], v[92:95], v[212:215]
    v_mfma_f32_16x16x32_bf16 v[220:223], a[108:111], v[92:95], v[220:223]
    v_mfma_f32_16x16x32_bf16 v[216:219], a[108:111], v[88:91], v[216:219]
    v_mfma_f32_16x16x32_bf16 v[224:227], a[112:115], v[88:91], v[224:227]
    v_mfma_f32_16x16x32_bf16 v[228:231], a[112:115], v[92:95], v[228:231]
    v_mfma_f32_16x16x32_bf16 v[236:239], a[116:119], v[92:95], v[236:239]
    v_mfma_f32_16x16x32_bf16 v[232:235], a[116:119], v[88:91], v[232:235]
    v_mfma_f32_16x16x32_bf16 v[240:243], a[120:123], v[88:91], v[240:243]
    v_mfma_f32_16x16x32_bf16 v[244:247], a[120:123], v[92:95], v[244:247]
    v_mfma_f32_16x16x32_bf16 v[252:255], a[124:127], v[92:95], v[252:255]
    v_mfma_f32_16x16x32_bf16 v[248:251], a[124:127], v[88:91], v[248:251]
L2_epd:
    v_mov_b32 v96, v11
    v_mov_b32 v97, v12
    s_nop 1
    v_permlane32_swap_b32 v11, v96
    v_permlane32_swap_b32 v12, v97
    v_add_f32 v11, v11, v96
    v_add_f32 v12, v12, v97
    v_mov_b32 v96, v11
    v_mov_b32 v97, v12
    s_nop 1
    v_permlane16_swap_b32 v11, v96
    v_permlane16_swap_b32 v12, v97
    v_add_f32 v11, v11, v96
    v_add_f32 v12, v12, v97
    v_log_f32 v9, v11
    v_log_f32 v10, v12
    v_rcp_f32 v122, v11
    v_rcp_f32 v123, v12
    v_sub_f32 v9, v9, v7
    v_sub_f32 v10, v10, v8
    s_lshl_b32 s59, s48, 20
    s_lshl_b32 s3, s44, 18
    s_add_u32 s59, s59, s3
    s_lshl_b32 s3, s45, 13
    s_add_u32 s59, s59, s3
    s_add_u32 s59, s59, 0x3000000
    s_mov_b32 s60, 0x1f000
    s_lshl_b32 s69, s48, 4
    s_add_u32 s69, s69, s45
    s_lshl_b32 s69, s69, 7
    s_add_u32 s69, s69, 65536
    s_cmp_eq_u32 s50, 2
    s_cbranch_scc1 L2_merge
    s_cmp_eq_u32 s50, 1
    s_cbranch_scc0 L2_final
    s_mov_b32 s59, s57
    s_movk_i32 s60, 4096
    s_mov_b32 s69, s5
    v_mov_b32 v120, v9
    v_mov_b32 v121, v10
    buffer_store_dwordx2 v[120:121], v1, s[24:27], s58 offen sc1
L2_final:
    v_pk_mul_f32 v[96:97], v[128:129], v[122:123] op_sel_hi:[1,0]
    v_mov_b64 v[128:129], 0
    v_pk_mul_f32 v[98:99], v[130:131], v[122:123] op_sel_hi:[1,0]
    v_mov_b64 v[130:131], 0
    v_pk_mul_f32 v[100:101], v[136:137], v[122:123] op_sel_hi:[1,0]
    v_mov_b64 v[136:137], 0
    v_pk_mul_f32 v[102:103], v[138:139], v[122:123] op_sel_hi:[1,0]
    v_mov_b64 v[138:139], 0
    v_cvt_pk_bf16_f32 v104, v96, v97
    v_cvt_pk_bf16_f32 v105, v98, v99
    v_cvt_pk_bf16_f32 v106, v100, v101
    v_cvt_pk_bf16_f32 v107, v102, v103
    buffer_store_dwordx4 v[104:107], v1, s[24:27], s59 offen offset:0 sc1
    v_pk_mul_f32 v[108:109], v[144:145], v[122:123] op_sel_hi:[1,0]
    v_mov_b64 v[144:145], 0
    v_pk_mul_f32 v[110:111], v[146:147], v[122:123] op_sel_hi:[1,0]
    v_mov_b64 v[146:147], 0
    v_pk_mul_f32 v[112:113], v[152:153], v[122:123] op_sel_hi:[1,0]
    v_mov_b64 v[152:153], 0
    v_pk_mul_f32 v[114:115], v[154:155], v[122:123] op_sel_hi:[1,0]
    v_mov_b64 v[154:155], 0
    v_cvt_pk_bf16_f32 v116, v108, v109
    v_cvt_pk_bf16_f32 v117, v110, v111
    v_cvt_pk_bf16_f32 v118, v112, v113
    v_cvt_pk_bf16_f32 v119, v114, v115
    buffer_store_dwordx4 v[116:119], v1, s[24:27], s59 offen offset:1024 sc1
    v_pk_mul_f32 v[96:97], v[160:161], v[122:123] op_sel_hi:[1,0]
    v_mov_b64 v[160:161], 0
    v_pk_mul_f32 v[98:99], v[162:163], v[122:123] op_sel_hi:[1,0]
    v_mov_b64 v[162:163], 0
    v_pk_mul_f32 v[100:101], v[168:169], v[122:123] op_sel_hi:[1,0]
    v_mov_b64 v[168:169], 0
    v_pk_mul_f32 v[102:103], v[170:171], v[122:123] op_sel_hi:[1,0]
    v_mov_b64 v[170:171], 0
    v_cvt_pk_bf16_f32 v104, v96, v97
    v_cvt_pk_bf16_f32 v105, v98, v99
    v_cvt_pk_bf16_f32 v106, v100, v101
    v_cvt_pk_bf16_f32 v107, v102, v103
    buffer_store_dwordx4 v[104:107], v1, s[24:27], s59 offen offset:2048 sc1
    v_pk_mul_f32 v[108:109], v[176:177], v[122:123] op_sel_hi:[1,0]
    v_mov_b64 v[176:177], 0
    v_pk_mul_f32 v[110:111], v[178:179], v[122:123] op_sel_hi:[1,0]
    v_mov_b64 v[178:179], 0
    v_pk_mul_f32 v[112:113], v[184:185], v[122:123] op_sel_hi:[1,0]
    v_mov_b64 v[184:185], 0
    v_pk_mul_f32 v[114:115], v[186:187], v[122:123] op_sel_hi:[1,0]
    v_mov_b64 v[186:187], 0
    v_cvt_pk_bf16_f32 v116, v108, v109
    v_cvt_pk_bf16_f32 v117, v110, v111
    v_cvt_pk_bf16_f32 v118, v112, v113
    v_cvt_pk_bf16_f32 v119, v114, v115
    buffer_store_dwordx4 v[116:119], v1, s[24:27], s59 offen offset:3072 sc1
    v_pk_mul_f32 v[96:97], v[192:193], v[122:123] op_sel_hi:[1,0]
    v_mov_b64 v[192:193], 0
    v_pk_mul_f32 v[98:99], v[194:195], v[122:123] op_sel_hi:[1,0]
    v_mov_b64 v[194:195], 0
    v_pk_mul_f32 v[100:101], v[200:201], v[122:123] op_sel_hi:[1,0]
    v_mov_b64 v[200:201], 0
    v_pk_mul_f32 v[102:103], v[202:203], v[122:123] op_sel_hi:[1,0]
    v_mov_b64 v[202:203], 0
    v_cvt_pk_bf16_f32 v104, v96, v97
    v_cvt_pk_bf16_f32 v105, v98, v99
    v_cvt_pk_bf16_f32 v106, v100, v101
    v_cvt_pk_bf16_f32 v107, v102, v103
    s_add_u32 s59, s59, 4096
    buffer_store_dwordx4 v[104:107], v1, s[24:27], s59 offen offset:0 sc1
    v_pk_mul_f32 v[108:109], v[208:209], v[122:123] op_sel_hi:[1,0]
    v_mov_b64 v[208:209], 0
    v_pk_mul_f32 v[110:111], v[210:211], v[122:123] op_sel_hi:[1,0]
    v_mov_b64 v[210:211], 0
    v_pk_mul_f32 v[112:113], v[216:217], v[122:123] op_sel_hi:[1,0]
    v_mov_b64 v[216:217], 0
    v_pk_mul_f32 v[114:115], v[218:219], v[122:123] op_sel_hi:[1,0]
    v_mov_b64 v[218:219], 0
    v_cvt_pk_bf16_f32 v116, v108, v109
    v_cvt_pk_bf16_f32 v117, v110, v111
    v_cvt_pk_bf16_f32 v118, v112, v113
    v_cvt_pk_bf16_f32 v119, v114, v115
    buffer_store_dwordx4 v[116:119], v1, s[24:27], s59 offen offset:1024 sc1
    v_pk_mul_f32 v[96:97], v[224:225], v[122:123] op_sel_hi:[1,0]
    v_mov_b64 v[224:225], 0
    v_pk_mul_f32 v[98:99], v[226:227], v[122:123] op_sel_hi:[1,0]
    v_mov_b64 v[226:227], 0
    v_pk_mul_f32 v[100:101], v[232:233], v[122:123] op_sel_hi:[1,0]
    v_mov_b64 v[232:233], 0
    v_pk_mul_f32 v[102:103], v[234:235], v[122:123] op_sel_hi:[1,0]
    v_mov_b64 v[234:235], 0
    v_cvt_pk_bf16_f32 v104, v96, v97
    v_cvt_pk_bf16_f32 v105, v98, v99
    v_cvt_pk_bf16_f32 v106, v100, v101
    v_cvt_pk_bf16_f32 v107, v102, v103
    buffer_store_dwordx4 v[104:107], v1, s[24:27], s59 offen offset:2048 sc1
    v_pk_mul_f32 v[108:109], v[240:241], v[122:123] op_sel_hi:[1,0]
    v_mov_b64 v[240:241], 0
    v_pk_mul_f32 v[110:111], v[242:243], v[122:123] op_sel_hi:[1,0]
    v_mov_b64 v[242:243], 0
    v_pk_mul_f32 v[112:113], v[248:249], v[122:123] op_sel_hi:[1,0]
    v_mov_b64 v[248:249], 0
    v_pk_mul_f32 v[114:115], v[250:251], v[122:123] op_sel_hi:[1,0]
    v_mov_b64 v[250:251], 0
    v_cvt_pk_bf16_f32 v116, v108, v109
    v_cvt_pk_bf16_f32 v117, v110, v111
    v_cvt_pk_bf16_f32 v118, v112, v113
    v_cvt_pk_bf16_f32 v119, v114, v115
    buffer_store_dwordx4 v[116:119], v1, s[24:27], s59 offen offset:3072 sc1
    s_add_u32 s59, s59, s60
    v_pk_mul_f32 v[96:97], v[132:133], v[122:123] op_sel:[0,1] op_sel_hi:[1,1]
    v_mov_b64 v[132:133], 0
    v_pk_mul_f32 v[98:99], v[134:135], v[122:123] op_sel:[0,1] op_sel_hi:[1,1]
    v_mov_b64 v[134:135], 0
    v_pk_mul_f32 v[100:101], v[140:141], v[122:123] op_sel:[0,1] op_sel_hi:[1,1]
    v_mov_b64 v[140:141], 0
    v_pk_mul_f32 v[102:103], v[142:143], v[122:123] op_sel:[0,1] op_sel_hi:[1,1]
    v_mov_b64 v[142:143], 0
    v_cvt_pk_bf16_f32 v104, v96, v97
    v_cvt_pk_bf16_f32 v105, v98, v99
    v_cvt_pk_bf16_f32 v106, v100, v101
    v_cvt_pk_bf16_f32 v107, v102, v103
    buffer_store_dwordx4 v[104:107], v1, s[24:27], s59 offen offset:0 sc1
    v_pk_mul_f32 v[108:109], v[148:149], v[122:123] op_sel:[0,1] op_sel_hi:[1,1]
    v_mov_b64 v[148:149], 0
    v_pk_mul_f32 v[110:111], v[150:151], v[122:123] op_sel:[0,1] op_sel_hi:[1,1]
    v_mov_b64 v[150:151], 0
    v_pk_mul_f32 v[112:113], v[156:157], v[122:123] op_sel:[0,1] op_sel_hi:[1,1]
    v_mov_b64 v[156:157], 0
    v_pk_mul_f32 v[114:115], v[158:159], v[122:123] op_sel:[0,1] op_sel_hi:[1,1]
    v_mov_b64 v[158:159], 0
    v_cvt_pk_bf16_f32 v116, v108, v109
    v_cvt_pk_bf16_f32 v117, v110, v111
    v_cvt_pk_bf16_f32 v118, v112, v113
    v_cvt_pk_bf16_f32 v119, v114, v115
    buffer_store_dwordx4 v[116:119], v1, s[24:27], s59 offen offset:1024 sc1
    v_pk_mul_f32 v[96:97], v[164:165], v[122:123] op_sel:[0,1] op_sel_hi:[1,1]
    v_mov_b64 v[164:165], 0
    v_pk_mul_f32 v[98:99], v[166:167], v[122:123] op_sel:[0,1] op_sel_hi:[1,1]
    v_mov_b64 v[166:167], 0
    v_pk_mul_f32 v[100:101], v[172:173], v[122:123] op_sel:[0,1] op_sel_hi:[1,1]
    v_mov_b64 v[172:173], 0
    v_pk_mul_f32 v[102:103], v[174:175], v[122:123] op_sel:[0,1] op_sel_hi:[1,1]
    v_mov_b64 v[174:175], 0
    v_cvt_pk_bf16_f32 v104, v96, v97
    v_cvt_pk_bf16_f32 v105, v98, v99
    v_cvt_pk_bf16_f32 v106, v100, v101
    v_cvt_pk_bf16_f32 v107, v102, v103
    buffer_store_dwordx4 v[104:107], v1, s[24:27], s59 offen offset:2048 sc1
    v_pk_mul_f32 v[108:109], v[180:181], v[122:123] op_sel:[0,1] op_sel_hi:[1,1]
    v_mov_b64 v[180:181], 0
    v_pk_mul_f32 v[110:111], v[182:183], v[122:123] op_sel:[0,1] op_sel_hi:[1,1]
    v_mov_b64 v[182:183], 0
    v_pk_mul_f32 v[112:113], v[188:189], v[122:123] op_sel:[0,1] op_sel_hi:[1,1]
    v_mov_b64 v[188:189], 0
    v_pk_mul_f32 v[114:115], v[190:191], v[122:123] op_sel:[0,1] op_sel_hi:[1,1]
    v_mov_b64 v[190:191], 0
    v_cvt_pk_bf16_f32 v116, v108, v109
    v_cvt_pk_bf16_f32 v117, v110, v111
    v_cvt_pk_bf16_f32 v118, v112, v113
    v_cvt_pk_bf16_f32 v119, v114, v115
    buffer_store_dwordx4 v[116:119], v1, s[24:27], s59 offen offset:3072 sc1
    v_pk_mul_f32 v[96:97], v[196:197], v[122:123] op_sel:[0,1] op_sel_hi:[1,1]
    v_mov_b64 v[196:197], 0
    v_pk_mul_f32 v[98:99], v[198:199], v[122:123] op_sel:[0,1] op_sel_hi:[1,1]
    v_mov_b64 v[198:199], 0
    v_pk_mul_f32 v[100:101], v[204:205], v[122:123] op_sel:[0,1] op_sel_hi:[1,1]
    v_mov_b64 v[204:205], 0
    v_pk_mul_f32 v[102:103], v[206:207], v[122:123] op_sel:[0,1] op_sel_hi:[1,1]
    v_mov_b64 v[206:207], 0
    v_cvt_pk_bf16_f32 v104, v96, v97
    v_cvt_pk_bf16_f32 v105, v98, v99
    v_cvt_pk_bf16_f32 v106, v100, v101
    v_cvt_pk_bf16_f32 v107, v102, v103
    s_add_u32 s59, s59, 4096
    buffer_store_dwordx4 v[104:107], v1, s[24:27], s59 offen offset:0 sc1
    v_pk_mul_f32 v[108:109], v[212:213], v[122:123] op_sel:[0,1] op_sel_hi:[1,1]
    v_mov_b64 v[212:213], 0
    v_pk_mul_f32 v[110:111], v[214:215], v[122:123] op_sel:[0,1] op_sel_hi:[1,1]
    v_mov_b64 v[214:215], 0
    v_pk_mul_f32 v[112:113], v[220:221], v[122:123] op_sel:[0,1] op_sel_hi:[1,1]
    v_mov_b64 v[220:221], 0
    v_pk_mul_f32 v[114:115], v[222:223], v[122:123] op_sel:[0,1] op_sel_hi:[1,1]
    v_mov_b64 v[222:223], 0
    v_cvt_pk_bf16_f32 v116, v108, v109
    v_cvt_pk_bf16_f32 v117, v110, v111
    v_cvt_pk_bf16_f32 v118, v112, v113
    v_cvt_pk_bf16_f32 v119, v114, v115
    buffer_store_dwordx4 v[116:119], v1, s[24:27], s59 offen offset:1024 sc1
    v_pk_mul_f32 v[96:97], v[228:229], v[122:123] op_sel:[0,1] op_sel_hi:[1,1]
    v_mov_b64 v[228:229], 0
    v_pk_mul_f32 v[98:99], v[230:231], v[122:123] op_sel:[0,1] op_sel_hi:[1,1]
    v_mov_b64 v[230:231], 0
    v_pk_mul_f32 v[100:101], v[236:237], v[122:123] op_sel:[0,1] op_sel_hi:[1,1]
    v_mov_b64 v[236:237], 0
    v_pk_mul_f32 v[102:103], v[238:239], v[122:123] op_sel:[0,1] op_sel_hi:[1,1]
    v_mov_b64 v[238:239], 0
    v_cvt_pk_bf16_f32 v104, v96, v97
    v_cvt_pk_bf16_f32 v105, v98, v99
    v_cvt_pk_bf16_f32 v106, v100, v101
    v_cvt_pk_bf16_f32 v107, v102, v103
    buffer_store_dwordx4 v[104:107], v1, s[24:27], s59 offen offset:2048 sc1
    v_pk_mul_f32 v[108:109], v[244:245], v[122:123] op_sel:[0,1] op_sel_hi:[1,1]
    v_mov_b64 v[244:245], 0
    v_pk_mul_f32 v[110:111], v[246:247], v[122:123] op_sel:[0,1] op_sel_hi:[1,1]
    v_mov_b64 v[246:247], 0
    v_pk_mul_f32 v[112:113], v[252:253], v[122:123] op_sel:[0,1] op_sel_hi:[1,1]
    v_mov_b64 v[252:253], 0
    v_pk_mul_f32 v[114:115], v[254:255], v[122:123] op_sel:[0,1] op_sel_hi:[1,1]
    v_mov_b64 v[254:255], 0
    v_cvt_pk_bf16_f32 v116, v108, v109
    v_cvt_pk_bf16_f32 v117, v110, v111
    v_cvt_pk_bf16_f32 v118, v112, v113
    v_cvt_pk_bf16_f32 v119, v114, v115
    buffer_store_dwordx4 v[116:119], v1, s[24:27], s59 offen offset:3072 sc1
    s_cmp_eq_u32 s50, 1
    s_cbranch_scc0 L2_np
    s_waitcnt vmcnt(0)
    s_lshl_b32 s3, s44, 2
    v_mov_b32 v13, s3
    v_mov_b32 v14, s7
    buffer_store_dword v14, v13, s[28:31], s69 offen sc1
    s_branch L2_end
L2_np:
    s_cmp_eq_u32 s33, 2
    s_cbranch_scc0 L2_end
    s_mov_b32 s33, 1
    s_sub_u32 s48, 15, s46
    s_mov_b32 s49, s43
    s_mov_b32 s39, -1
    s_mov_b32 s50, 1
    s_mov_b32 s68, s69
    s_waitcnt vmcnt(24)
    s_branch L2_seg
L2_merge:
    s_cmp_eq_u32 s63, 1
    s_cbranch_scc1 L2_have
    v_bfe_u32 v13, v0, 2, 4
    v_min_u32 v13, 0, v13
    v_and_b32 v14, 3, v0
    v_lshlrev_b32 v14, 2, v14
    v_lshl_add_u32 v13, v13, 7, v14
    s_mov_b32 s55, 0x10000
L2_poll13:
    buffer_load_dword v14, v13, s[28:31], s5 offen sc1
    s_waitcnt vmcnt(0)
    v_cmp_ne_u32 vcc, s7, v14
    s_cbranch_vccz L2_got13
    s_sleep 2
    s_sub_u32 s55, s55, 1
    s_cbranch_scc0 L2_poll13
L2_got13:
    buffer_load_dwordx2 v[120:121], v1, s[24:27], s58 offen sc1
    buffer_load_dwordx4 v[16:19], v1, s[24:27], s57 offen offset:0 sc1
    buffer_load_dwordx4 v[20:23], v1, s[24:27], s57 offen offset:1024 sc1
    buffer_load_dwordx4 v[24:27], v1, s[24:27], s57 offen offset:2048 sc1
    buffer_load_dwordx4 v[28:31], v1, s[24:27], s57 offen offset:3072 sc1
    s_add_u32 s57, s57, 4096
    buffer_load_dwordx4 v[32:35], v1, s[24:27], s57 offen offset:0 sc1
    buffer_load_dwordx4 v[36:39], v1, s[24:27], s57 offen offset:1024 sc1
    buffer_load_dwordx4 v[40:43], v1, s[24:27], s57 offen offset:2048 sc1
    buffer_load_dwordx4 v[44:47], v1, s[24:27], s57 offen offset:3072 sc1
    s_add_u32 s57, s57, 4096
    buffer_load_dwordx4 v[48:51], v1, s[24:27], s57 offen offset:0 sc1
    buffer_load_dwordx4 v[52:55], v1, s[24:27], s57 offen offset:1024 sc1
    buffer_load_dwordx4 v[56:59], v1, s[24:27], s57 offen offset:2048 sc1
    buffer_load_dwordx4 v[60:63], v1, s[24:27], s57 offen offset:3072 sc1
    s_add_u32 s57, s57, 4096
    buffer_load_dwordx4 v[64:67], v1, s[24:27], s57 offen offset:0 sc1
    buffer_load_dwordx4 v[68:71], v1, s[24:27], s57 offen offset:1024 sc1
    buffer_load_dwordx4 v[72:75], v1, s[24:27], s57 offen offset:2048 sc1
    buffer_load_dwordx4 v[76:79], v1, s[24:27], s57 offen offset:3072 sc1
L2_have:
    s_mov_b32 s61, 0xffff0000
    s_waitcnt vmcnt(16)
    v_sub_f32 v96, v120, v9
    v_exp_f32 v98, v96
    v_exp_f32 v100, -v96
    s_nop 0
    v_add_f32 v98, 1.0, v98
    v_add_f32 v100, 1.0, v100
    v_rcp_f32 v98, v98
    v_rcp_f32 v14, v100
    s_nop 0
    v_mul_f32 v122, v122, v98
    v_sub_f32 v97, v121, v10
    v_exp_f32 v99, v97
    v_exp_f32 v101, -v97
    s_nop 0
    v_add_f32 v99, 1.0, v99
    v_add_f32 v101, 1.0, v101
    v_rcp_f32 v99, v99
    v_rcp_f32 v15, v101
    s_nop 0
    v_mul_f32 v123, v123, v99
    s_waitcnt vmcnt(15)
    v_lshlrev_b32 v96, 16, v16
    v_and_b32 v97, s61, v16
    v_pk_mul_f32 v[96:97], v[96:97], v[14:15] op_sel_hi:[1,0]
    v_pk_fma_f32 v[96:97], v[128:129], v[122:123], v[96:97] op_sel_hi:[1,0,1]
    v_lshlrev_b32 v98, 16, v17
    v_and_b32 v99, s61, v17
    v_pk_mul_f32 v[98:99], v[98:99], v[14:15] op_sel_hi:[1,0]
    v_pk_fma_f32 v[98:99], v[130:131], v[122:123], v[98:99] op_sel_hi:[1,0,1]
    v_lshlrev_b32 v100, 16, v18
    v_and_b32 v101, s61, v18
    v_pk_mul_f32 v[100:101], v[100:101], v[14:15] op_sel_hi:[1,0]
    v_pk_fma_f32 v[100:101], v[136:137], v[122:123], v[100:101] op_sel_hi:[1,0,1]
    v_lshlrev_b32 v102, 16, v19
    v_and_b32 v103, s61, v19
    v_pk_mul_f32 v[102:103], v[102:103], v[14:15] op_sel_hi:[1,0]
    v_pk_fma_f32 v[102:103], v[138:139], v[122:123], v[102:103] op_sel_hi:[1,0,1]
    v_cvt_pk_bf16_f32 v104, v96, v97
    v_cvt_pk_bf16_f32 v105, v98, v99
    v_cvt_pk_bf16_f32 v106, v100, v101
    v_cvt_pk_bf16_f32 v107, v102, v103
    buffer_store_dwordx4 v[104:107], v1, s[24:27], s59 offen offset:0 sc1
    s_waitcnt vmcnt(15)
    v_lshlrev_b32 v108, 16, v20
    v_and_b32 v109, s61, v20
    v_pk_mul_f32 v[108:109], v[108:109], v[14:15] op_sel_hi:[1,0]
    v_pk_fma_f32 v[108:109], v[144:145], v[122:123], v[108:109] op_sel_hi:[1,0,1]
    v_lshlrev_b32 v110, 16, v21
    v_and_b32 v111, s61, v21
    v_pk_mul_f32 v[110:111], v[110:111], v[14:15] op_sel_hi:[1,0]
    v_pk_fma_f32 v[110:111], v[146:147], v[122:123], v[110:111] op_sel_hi:[1,0,1]
    v_lshlrev_b32 v112, 16, v22
    v_and_b32 v113, s61, v22
    v_pk_mul_f32 v[112:113], v[112:113], v[14:15] op_sel_hi:[1,0]
    v_pk_fma_f32 v[112:113], v[152:153], v[122:123], v[112:113] op_sel_hi:[1,0,1]
    v_lshlrev_b32 v114, 16, v23
    v_and_b32 v115, s61, v23
    v_pk_mul_f32 v[114:115], v[114:115], v[14:15] op_sel_hi:[1,0]
    v_pk_fma_f32 v[114:115], v[154:155], v[122:123], v[114:115] op_sel_hi:[1,0,1]
    v_cvt_pk_bf16_f32 v116, v108, v109
    v_cvt_pk_bf16_f32 v117, v110, v111
    v_cvt_pk_bf16_f32 v118, v112, v113
    v_cvt_pk_bf16_f32 v119, v114, v115
    buffer_store_dwordx4 v[116:119], v1, s[24:27], s59 offen offset:1024 sc1
    s_waitcnt vmcnt(15)
    v_lshlrev_b32 v96, 16, v24
    v_and_b32 v97, s61, v24
    v_pk_mul_f32 v[96:97], v[96:97], v[14:15] op_sel_hi:[1,0]
    v_pk_fma_f32 v[96:97], v[160:161], v[122:123], v[96:97] op_sel_hi:[1,0,1]
    v_lshlrev_b32 v98, 16, v25
    v_and_b32 v99, s61, v25
    v_pk_mul_f32 v[98:99], v[98:99], v[14:15] op_sel_hi:[1,0]
    v_pk_fma_f32 v[98:99], v[162:163], v[122:123], v[98:99] op_sel_hi:[1,0,1]
    v_lshlrev_b32 v100, 16, v26
    v_and_b32 v101, s61, v26
    v_pk_mul_f32 v[100:101], v[100:101], v[14:15] op_sel_hi:[1,0]
    v_pk_fma_f32 v[100:101], v[168:169], v[122:123], v[100:101] op_sel_hi:[1,0,1]
    v_lshlrev_b32 v102, 16, v27
    v_and_b32 v103, s61, v27
    v_pk_mul_f32 v[102:103], v[102:103], v[14:15] op_sel_hi:[1,0]
    v_pk_fma_f32 v[102:103], v[170:171], v[122:123], v[102:103] op_sel_hi:[1,0,1]
    v_cvt_pk_bf16_f32 v104, v96, v97
    v_cvt_pk_bf16_f32 v105, v98, v99
    v_cvt_pk_bf16_f32 v106, v100, v101
    v_cvt_pk_bf16_f32 v107, v102, v103
    buffer_store_dwordx4 v[104:107], v1, s[24:27], s59 offen offset:2048 sc1
    s_waitcnt vmcnt(15)
    v_lshlrev_b32 v108, 16, v28
    v_and_b32 v109, s61, v28
    v_pk_mul_f32 v[108:109], v[108:109], v[14:15] op_sel_hi:[1,0]
    v_pk_fma_f32 v[108:109], v[176:177], v[122:123], v[108:109] op_sel_hi:[1,0,1]
    v_lshlrev_b32 v110, 16, v29
    v_and_b32 v111, s61, v29
    v_pk_mul_f32 v[110:111], v[110:111], v[14:15] op_sel_hi:[1,0]
    v_pk_fma_f32 v[110:111], v[178:179], v[122:123], v[110:111] op_sel_hi:[1,0,1]
    v_lshlrev_b32 v112, 16, v30
    v_and_b32 v113, s61, v30
    v_pk_mul_f32 v[112:113], v[112:113], v[14:15] op_sel_hi:[1,0]
    v_pk_fma_f32 v[112:113], v[184:185], v[122:123], v[112:113] op_sel_hi:[1,0,1]
    v_lshlrev_b32 v114, 16, v31
    v_and_b32 v115, s61, v31
    v_pk_mul_f32 v[114:115], v[114:115], v[14:15] op_sel_hi:[1,0]
    v_pk_fma_f32 v[114:115], v[186:187], v[122:123], v[114:115] op_sel_hi:[1,0,1]
    v_cvt_pk_bf16_f32 v116, v108, v109
    v_cvt_pk_bf16_f32 v117, v110, v111
    v_cvt_pk_bf16_f32 v118, v112, v113
    v_cvt_pk_bf16_f32 v119, v114, v115
    buffer_store_dwordx4 v[116:119], v1, s[24:27], s59 offen offset:3072 sc1
    s_waitcnt vmcnt(15)
    v_lshlrev_b32 v96, 16, v32
    v_and_b32 v97, s61, v32
    v_pk_mul_f32 v[96:97], v[96:97], v[14:15] op_sel_hi:[1,0]
    v_pk_fma_f32 v[96:97], v[192:193], v[122:123], v[96:97] op_sel_hi:[1,0,1]
    v_lshlrev_b32 v98, 16, v33
    v_and_b32 v99, s61, v33
    v_pk_mul_f32 v[98:99], v[98:99], v[14:15] op_sel_hi:[1,0]
    v_pk_fma_f32 v[98:99], v[194:195], v[122:123], v[98:99] op_sel_hi:[1,0,1]
    v_lshlrev_b32 v100, 16, v34
    v_and_b32 v101, s61, v34
    v_pk_mul_f32 v[100:101], v[100:101], v[14:15] op_sel_hi:[1,0]
    v_pk_fma_f32 v[100:101], v[200:201], v[122:123], v[100:101] op_sel_hi:[1,0,1]
    v_lshlrev_b32 v102, 16, v35
    v_and_b32 v103, s61, v35
    v_pk_mul_f32 v[102:103], v[102:103], v[14:15] op_sel_hi:[1,0]
    v_pk_fma_f32 v[102:103], v[202:203], v[122:123], v[102:103] op_sel_hi:[1,0,1]
    v_cvt_pk_bf16_f32 v104, v96, v97
    v_cvt_pk_bf16_f32 v105, v98, v99
    v_cvt_pk_bf16_f32 v106, v100, v101
    v_cvt_pk_bf16_f32 v107, v102, v103
    s_add_u32 s59, s59, 4096
    buffer_store_dwordx4 v[104:107], v1, s[24:27], s59 offen offset:0 sc1
    s_waitcnt vmcnt(15)
    v_lshlrev_b32 v108, 16, v36
    v_and_b32 v109, s61, v36
    v_pk_mul_f32 v[108:109], v[108:109], v[14:15] op_sel_hi:[1,0]
    v_pk_fma_f32 v[108:109], v[208:209], v[122:123], v[108:109] op_sel_hi:[1,0,1]
    v_lshlrev_b32 v110, 16, v37
    v_and_b32 v111, s61, v37
    v_pk_mul_f32 v[110:111], v[110:111], v[14:15] op_sel_hi:[1,0]
    v_pk_fma_f32 v[110:111], v[210:211], v[122:123], v[110:111] op_sel_hi:[1,0,1]
    v_lshlrev_b32 v112, 16, v38
    v_and_b32 v113, s61, v38
    v_pk_mul_f32 v[112:113], v[112:113], v[14:15] op_sel_hi:[1,0]
    v_pk_fma_f32 v[112:113], v[216:217], v[122:123], v[112:113] op_sel_hi:[1,0,1]
    v_lshlrev_b32 v114, 16, v39
    v_and_b32 v115, s61, v39
    v_pk_mul_f32 v[114:115], v[114:115], v[14:15] op_sel_hi:[1,0]
    v_pk_fma_f32 v[114:115], v[218:219], v[122:123], v[114:115] op_sel_hi:[1,0,1]
    v_cvt_pk_bf16_f32 v116, v108, v109
    v_cvt_pk_bf16_f32 v117, v110, v111
    v_cvt_pk_bf16_f32 v118, v112, v113
    v_cvt_pk_bf16_f32 v119, v114, v115
    buffer_store_dwordx4 v[116:119], v1, s[24:27], s59 offen offset:1024 sc1
    s_waitcnt vmcnt(15)
    v_lshlrev_b32 v96, 16, v40
    v_and_b32 v97, s61, v40
    v_pk_mul_f32 v[96:97], v[96:97], v[14:15] op_sel_hi:[1,0]
    v_pk_fma_f32 v[96:97], v[224:225], v[122:123], v[96:97] op_sel_hi:[1,0,1]
    v_lshlrev_b32 v98, 16, v41
    v_and_b32 v99, s61, v41
    v_pk_mul_f32 v[98:99], v[98:99], v[14:15] op_sel_hi:[1,0]
    v_pk_fma_f32 v[98:99], v[226:227], v[122:123], v[98:99] op_sel_hi:[1,0,1]
    v_lshlrev_b32 v100, 16, v42
    v_and_b32 v101, s61, v42
    v_pk_mul_f32 v[100:101], v[100:101], v[14:15] op_sel_hi:[1,0]
    v_pk_fma_f32 v[100:101], v[232:233], v[122:123], v[100:101] op_sel_hi:[1,0,1]
    v_lshlrev_b32 v102, 16, v43
    v_and_b32 v103, s61, v43
    v_pk_mul_f32 v[102:103], v[102:103], v[14:15] op_sel_hi:[1,0]
    v_pk_fma_f32 v[102:103], v[234:235], v[122:123], v[102:103] op_sel_hi:[1,0,1]
    v_cvt_pk_bf16_f32 v104, v96, v97
    v_cvt_pk_bf16_f32 v105, v98, v99
    v_cvt_pk_bf16_f32 v106, v100, v101
    v_cvt_pk_bf16_f32 v107, v102, v103
    buffer_store_dwordx4 v[104:107], v1, s[24:27], s59 offen offset:2048 sc1
    s_waitcnt vmcnt(15)
    v_lshlrev_b32 v108, 16, v44
    v_and_b32 v109, s61, v44
    v_pk_mul_f32 v[108:109], v[108:109], v[14:15] op_sel_hi:[1,0]
    v_pk_fma_f32 v[108:109], v[240:241], v[122:123], v[108:109] op_sel_hi:[1,0,1]
    v_lshlrev_b32 v110, 16, v45
    v_and_b32 v111, s61, v45
    v_pk_mul_f32 v[110:111], v[110:111], v[14:15] op_sel_hi:[1,0]
    v_pk_fma_f32 v[110:111], v[242:243], v[122:123], v[110:111] op_sel_hi:[1,0,1]
    v_lshlrev_b32 v112, 16, v46
    v_and_b32 v113, s61, v46
    v_pk_mul_f32 v[112:113], v[112:113], v[14:15] op_sel_hi:[1,0]
    v_pk_fma_f32 v[112:113], v[248:249], v[122:123], v[112:113] op_sel_hi:[1,0,1]
    v_lshlrev_b32 v114, 16, v47
    v_and_b32 v115, s61, v47
    v_pk_mul_f32 v[114:115], v[114:115], v[14:15] op_sel_hi:[1,0]
    v_pk_fma_f32 v[114:115], v[250:251], v[122:123], v[114:115] op_sel_hi:[1,0,1]
    v_cvt_pk_bf16_f32 v116, v108, v109
    v_cvt_pk_bf16_f32 v117, v110, v111
    v_cvt_pk_bf16_f32 v118, v112, v113
    v_cvt_pk_bf16_f32 v119, v114, v115
    buffer_store_dwordx4 v[116:119], v1, s[24:27], s59 offen offset:3072 sc1
    s_add_u32 s59, s59, s60
    s_waitcnt vmcnt(15)
    v_lshlrev_b32 v96, 16, v48
    v_and_b32 v97, s61, v48
    v_pk_mul_f32 v[96:97], v[96:97], v[14:15] op_sel:[0,1] op_sel_hi:[1,1]
    v_pk_fma_f32 v[96:97], v[132:133], v[122:123], v[96:97] op_sel:[0,1,0] op_sel_hi:[1,1,1]
    v_lshlrev_b32 v98, 16, v49
    v_and_b32 v99, s61, v49
    v_pk_mul_f32 v[98:99], v[98:99], v[14:15] op_sel:[0,1] op_sel_hi:[1,1]
    v_pk_fma_f32 v[98:99], v[134:135], v[122:123], v[98:99] op_sel:[0,1,0] op_sel_hi:[1,1,1]
    v_lshlrev_b32 v100, 16, v50
    v_and_b32 v101, s61, v50
    v_pk_mul_f32 v[100:101], v[100:101], v[14:15] op_sel:[0,1] op_sel_hi:[1,1]
    v_pk_fma_f32 v[100:101], v[140:141], v[122:123], v[100:101] op_sel:[0,1,0] op_sel_hi:[1,1,1]
    v_lshlrev_b32 v102, 16, v51
    v_and_b32 v103, s61, v51
    v_pk_mul_f32 v[102:103], v[102:103], v[14:15] op_sel:[0,1] op_sel_hi:[1,1]
    v_pk_fma_f32 v[102:103], v[142:143], v[122:123], v[102:103] op_sel:[0,1,0] op_sel_hi:[1,1,1]
    v_cvt_pk_bf16_f32 v104, v96, v97
    v_cvt_pk_bf16_f32 v105, v98, v99
    v_cvt_pk_bf16_f32 v106, v100, v101
    v_cvt_pk_bf16_f32 v107, v102, v103
    buffer_store_dwordx4 v[104:107], v1, s[24:27], s59 offen offset:0 sc1
    s_waitcnt vmcnt(15)
    v_lshlrev_b32 v108, 16, v52
    v_and_b32 v109, s61, v52
    v_pk_mul_f32 v[108:109], v[108:109], v[14:15] op_sel:[0,1] op_sel_hi:[1,1]
    v_pk_fma_f32 v[108:109], v[148:149], v[122:123], v[108:109] op_sel:[0,1,0] op_sel_hi:[1,1,1]
    v_lshlrev_b32 v110, 16, v53
    v_and_b32 v111, s61, v53
    v_pk_mul_f32 v[110:111], v[110:111], v[14:15] op_sel:[0,1] op_sel_hi:[1,1]
    v_pk_fma_f32 v[110:111], v[150:151], v[122:123], v[110:111] op_sel:[0,1,0] op_sel_hi:[1,1,1]
    v_lshlrev_b32 v112, 16, v54
    v_and_b32 v113, s61, v54
    v_pk_mul_f32 v[112:113], v[112:113], v[14:15] op_sel:[0,1] op_sel_hi:[1,1]
    v_pk_fma_f32 v[112:113], v[156:157], v[122:123], v[112:113] op_sel:[0,1,0] op_sel_hi:[1,1,1]
    v_lshlrev_b32 v114, 16, v55
    v_and_b32 v115, s61, v55
    v_pk_mul_f32 v[114:115], v[114:115], v[14:15] op_sel:[0,1] op_sel_hi:[1,1]
    v_pk_fma_f32 v[114:115], v[158:159], v[122:123], v[114:115] op_sel:[0,1,0] op_sel_hi:[1,1,1]
    v_cvt_pk_bf16_f32 v116, v108, v109
    v_cvt_pk_bf16_f32 v117, v110, v111
    v_cvt_pk_bf16_f32 v118, v112, v113
    v_cvt_pk_bf16_f32 v119, v114, v115
    buffer_store_dwordx4 v[116:119], v1, s[24:27], s59 offen offset:1024 sc1
    s_waitcnt vmcnt(15)
    v_lshlrev_b32 v96, 16, v56
    v_and_b32 v97, s61, v56
    v_pk_mul_f32 v[96:97], v[96:97], v[14:15] op_sel:[0,1] op_sel_hi:[1,1]
    v_pk_fma_f32 v[96:97], v[164:165], v[122:123], v[96:97] op_sel:[0,1,0] op_sel_hi:[1,1,1]
    v_lshlrev_b32 v98, 16, v57
    v_and_b32 v99, s61, v57
    v_pk_mul_f32 v[98:99], v[98:99], v[14:15] op_sel:[0,1] op_sel_hi:[1,1]
    v_pk_fma_f32 v[98:99], v[166:167], v[122:123], v[98:99] op_sel:[0,1,0] op_sel_hi:[1,1,1]
    v_lshlrev_b32 v100, 16, v58
    v_and_b32 v101, s61, v58
    v_pk_mul_f32 v[100:101], v[100:101], v[14:15] op_sel:[0,1] op_sel_hi:[1,1]
    v_pk_fma_f32 v[100:101], v[172:173], v[122:123], v[100:101] op_sel:[0,1,0] op_sel_hi:[1,1,1]
    v_lshlrev_b32 v102, 16, v59
    v_and_b32 v103, s61, v59
    v_pk_mul_f32 v[102:103], v[102:103], v[14:15] op_sel:[0,1] op_sel_hi:[1,1]
    v_pk_fma_f32 v[102:103], v[174:175], v[122:123], v[102:103] op_sel:[0,1,0] op_sel_hi:[1,1,1]
    v_cvt_pk_bf16_f32 v104, v96, v97
    v_cvt_pk_bf16_f32 v105, v98, v99
    v_cvt_pk_bf16_f32 v106, v100, v101
    v_cvt_pk_bf16_f32 v107, v102, v103
    buffer_store_dwordx4 v[104:107], v1, s[24:27], s59 offen offset:2048 sc1
    s_waitcnt vmcnt(15)
    v_lshlrev_b32 v108, 16, v60
    v_and_b32 v109, s61, v60
    v_pk_mul_f32 v[108:109], v[108:109], v[14:15] op_sel:[0,1] op_sel_hi:[1,1]
    v_pk_fma_f32 v[108:109], v[180:181], v[122:123], v[108:109] op_sel:[0,1,0] op_sel_hi:[1,1,1]
    v_lshlrev_b32 v110, 16, v61
    v_and_b32 v111, s61, v61
    v_pk_mul_f32 v[110:111], v[110:111], v[14:15] op_sel:[0,1] op_sel_hi:[1,1]
    v_pk_fma_f32 v[110:111], v[182:183], v[122:123], v[110:111] op_sel:[0,1,0] op_sel_hi:[1,1,1]
    v_lshlrev_b32 v112, 16, v62
    v_and_b32 v113, s61, v62
    v_pk_mul_f32 v[112:113], v[112:113], v[14:15] op_sel:[0,1] op_sel_hi:[1,1]
    v_pk_fma_f32 v[112:113], v[188:189], v[122:123], v[112:113] op_sel:[0,1,0] op_sel_hi:[1,1,1]
    v_lshlrev_b32 v114, 16, v63
    v_and_b32 v115, s61, v63
    v_pk_mul_f32 v[114:115], v[114:115], v[14:15] op_sel:[0,1] op_sel_hi:[1,1]
    v_pk_fma_f32 v[114:115], v[190:191], v[122:123], v[114:115] op_sel:[0,1,0] op_sel_hi:[1,1,1]
    v_cvt_pk_bf16_f32 v116, v108, v109
    v_cvt_pk_bf16_f32 v117, v110, v111
    v_cvt_pk_bf16_f32 v118, v112, v113
    v_cvt_pk_bf16_f32 v119, v114, v115
    buffer_store_dwordx4 v[116:119], v1, s[24:27], s59 offen offset:3072 sc1
    s_waitcnt vmcnt(15)
    v_lshlrev_b32 v96, 16, v64
    v_and_b32 v97, s61, v64
    v_pk_mul_f32 v[96:97], v[96:97], v[14:15] op_sel:[0,1] op_sel_hi:[1,1]
    v_pk_fma_f32 v[96:97], v[196:197], v[122:123], v[96:97] op_sel:[0,1,0] op_sel_hi:[1,1,1]
    v_lshlrev_b32 v98, 16, v65
    v_and_b32 v99, s61, v65
    v_pk_mul_f32 v[98:99], v[98:99], v[14:15] op_sel:[0,1] op_sel_hi:[1,1]
    v_pk_fma_f32 v[98:99], v[198:199], v[122:123], v[98:99] op_sel:[0,1,0] op_sel_hi:[1,1,1]
    v_lshlrev_b32 v100, 16, v66
    v_and_b32 v101, s61, v66
    v_pk_mul_f32 v[100:101], v[100:101], v[14:15] op_sel:[0,1] op_sel_hi:[1,1]
    v_pk_fma_f32 v[100:101], v[204:205], v[122:123], v[100:101] op_sel:[0,1,0] op_sel_hi:[1,1,1]
    v_lshlrev_b32 v102, 16, v67
    v_and_b32 v103, s61, v67
    v_pk_mul_f32 v[102:103], v[102:103], v[14:15] op_sel:[0,1] op_sel_hi:[1,1]
    v_pk_fma_f32 v[102:103], v[206:207], v[122:123], v[102:103] op_sel:[0,1,0] op_sel_hi:[1,1,1]
    v_cvt_pk_bf16_f32 v104, v96, v97
    v_cvt_pk_bf16_f32 v105, v98, v99
    v_cvt_pk_bf16_f32 v106, v100, v101
    v_cvt_pk_bf16_f32 v107, v102, v103
    s_add_u32 s59, s59, 4096
    buffer_store_dwordx4 v[104:107], v1, s[24:27], s59 offen offset:0 sc1
    s_waitcnt vmcnt(15)
    v_lshlrev_b32 v108, 16, v68
    v_and_b32 v109, s61, v68
    v_pk_mul_f32 v[108:109], v[108:109], v[14:15] op_sel:[0,1] op_sel_hi:[1,1]
    v_pk_fma_f32 v[108:109], v[212:213], v[122:123], v[108:109] op_sel:[0,1,0] op_sel_hi:[1,1,1]
    v_lshlrev_b32 v110, 16, v69
    v_and_b32 v111, s61, v69
    v_pk_mul_f32 v[110:111], v[110:111], v[14:15] op_sel:[0,1] op_sel_hi:[1,1]
    v_pk_fma_f32 v[110:111], v[214:215], v[122:123], v[110:111] op_sel:[0,1,0] op_sel_hi:[1,1,1]
    v_lshlrev_b32 v112, 16, v70
    v_and_b32 v113, s61, v70
    v_pk_mul_f32 v[112:113], v[112:113], v[14:15] op_sel:[0,1] op_sel_hi:[1,1]
    v_pk_fma_f32 v[112:113], v[220:221], v[122:123], v[112:113] op_sel:[0,1,0] op_sel_hi:[1,1,1]
    v_lshlrev_b32 v114, 16, v71
    v_and_b32 v115, s61, v71
    v_pk_mul_f32 v[114:115], v[114:115], v[14:15] op_sel:[0,1] op_sel_hi:[1,1]
    v_pk_fma_f32 v[114:115], v[222:223], v[122:123], v[114:115] op_sel:[0,1,0] op_sel_hi:[1,1,1]
    v_cvt_pk_bf16_f32 v116, v108, v109
    v_cvt_pk_bf16_f32 v117, v110, v111
    v_cvt_pk_bf16_f32 v118, v112, v113
    v_cvt_pk_bf16_f32 v119, v114, v115
    buffer_store_dwordx4 v[116:119], v1, s[24:27], s59 offen offset:1024 sc1
    s_waitcnt vmcnt(15)
    v_lshlrev_b32 v96, 16, v72
    v_and_b32 v97, s61, v72
    v_pk_mul_f32 v[96:97], v[96:97], v[14:15] op_sel:[0,1] op_sel_hi:[1,1]
    v_pk_fma_f32 v[96:97], v[228:229], v[122:123], v[96:97] op_sel:[0,1,0] op_sel_hi:[1,1,1]
    v_lshlrev_b32 v98, 16, v73
    v_and_b32 v99, s61, v73
    v_pk_mul_f32 v[98:99], v[98:99], v[14:15] op_sel:[0,1] op_sel_hi:[1,1]
    v_pk_fma_f32 v[98:99], v[230:231], v[122:123], v[98:99] op_sel:[0,1,0] op_sel_hi:[1,1,1]
    v_lshlrev_b32 v100, 16, v74
    v_and_b32 v101, s61, v74
    v_pk_mul_f32 v[100:101], v[100:101], v[14:15] op_sel:[0,1] op_sel_hi:[1,1]
    v_pk_fma_f32 v[100:101], v[236:237], v[122:123], v[100:101] op_sel:[0,1,0] op_sel_hi:[1,1,1]
    v_lshlrev_b32 v102, 16, v75
    v_and_b32 v103, s61, v75
    v_pk_mul_f32 v[102:103], v[102:103], v[14:15] op_sel:[0,1] op_sel_hi:[1,1]
    v_pk_fma_f32 v[102:103], v[238:239], v[122:123], v[102:103] op_sel:[0,1,0] op_sel_hi:[1,1,1]
    v_cvt_pk_bf16_f32 v104, v96, v97
    v_cvt_pk_bf16_f32 v105, v98, v99
    v_cvt_pk_bf16_f32 v106, v100, v101
    v_cvt_pk_bf16_f32 v107, v102, v103
    buffer_store_dwordx4 v[104:107], v1, s[24:27], s59 offen offset:2048 sc1
    s_waitcnt vmcnt(15)
    v_lshlrev_b32 v108, 16, v76
    v_and_b32 v109, s61, v76
    v_pk_mul_f32 v[108:109], v[108:109], v[14:15] op_sel:[0,1] op_sel_hi:[1,1]
    v_pk_fma_f32 v[108:109], v[244:245], v[122:123], v[108:109] op_sel:[0,1,0] op_sel_hi:[1,1,1]
    v_lshlrev_b32 v110, 16, v77
    v_and_b32 v111, s61, v77
    v_pk_mul_f32 v[110:111], v[110:111], v[14:15] op_sel:[0,1] op_sel_hi:[1,1]
    v_pk_fma_f32 v[110:111], v[246:247], v[122:123], v[110:111] op_sel:[0,1,0] op_sel_hi:[1,1,1]
    v_lshlrev_b32 v112, 16, v78
    v_and_b32 v113, s61, v78
    v_pk_mul_f32 v[112:113], v[112:113], v[14:15] op_sel:[0,1] op_sel_hi:[1,1]
    v_pk_fma_f32 v[112:113], v[252:253], v[122:123], v[112:113] op_sel:[0,1,0] op_sel_hi:[1,1,1]
    v_lshlrev_b32 v114, 16, v79
    v_and_b32 v115, s61, v79
    v_pk_mul_f32 v[114:115], v[114:115], v[14:15] op_sel:[0,1] op_sel_hi:[1,1]
    v_pk_fma_f32 v[114:115], v[254:255], v[122:123], v[114:115] op_sel:[0,1,0] op_sel_hi:[1,1,1]
    v_cvt_pk_bf16_f32 v116, v108, v109
    v_cvt_pk_bf16_f32 v117, v110, v111
    v_cvt_pk_bf16_f32 v118, v112, v113
    v_cvt_pk_bf16_f32 v119, v114, v115
    buffer_store_dwordx4 v[116:119], v1, s[24:27], s59 offen offset:3072 sc1
L2_end:
    s_load_dwordx2 s[10:11], s[0:1], 40
    s_load_dwordx2 s[60:61], s[0:1], 72
    s_load_dwordx4 s[56:59], s[0:1], 56
    s_load_dwordx2 s[12:13], s[0:1], 0
    s_and_b32 s3, s2, 7
    s_lshr_b32 s74, s2, 3
    s_sub_u32 s72, 15, s3
    s_bitcmp0_b32 s74, 1
    s_cselect_b32 s72, s3, s72
    s_lshr_b32 s73, s74, 2
    s_lshl_b32 s73, s73, 1
    s_and_b32 s3, s74, 1
    s_add_u32 s73, s73, s3
    s_cmp_ge_u32 s73, 7
    s_cselect_b32 s75, 1, 0
    s_cselect_b32 s71, 7, 0
    s_sub_u32 s71, s73, s71
    s_lshl_b32 s70, s72, 1
    s_add_u32 s70, s70, s75
    s_and_b32 s76, s2, 6
    s_add_u32 s76, s76, s75
    s_sub_u32 s3, 15, s76
    s_bitcmp0_b32 s74, 1
    s_cselect_b32 s76, s76, s3
    s_and_b32 s3, s2, 1
    s_mul_i32 s73, s3, 7
    s_add_u32 s73, s73, s71
    s_cmp_ge_u32 s74, 28
    s_cbranch_scc0 L3_act
    s_waitcnt vmcnt(0)
    s_lshl_b32 s3, s44, 2
    v_mov_b32 v13, s3
    v_mov_b32 v14, s7
    buffer_store_dword v14, v13, s[28:31], s69 offen sc1
    s_and_b32 s3, s2, 7
    s_lshl_b32 s3, s3, 2
    s_add_u32 s73, s74, s3
    s_sub_u32 s73, s73, 28
    s_cmp_ge_u32 s73, 14
    s_cbranch_scc1 L_fin
    s_mov_b32 s77, 1
    s_mov_b32 s71, 0
    s_branch L4_entry
L3_act:
    s_mov_b32 s77, 0
    v_and_b32 v12, 63, v0
    v_lshrrev_b32 v13, 3, v12
    v_mul_u32_u24 v13, 896, v13
    v_lshrrev_b32 v14, 4, v12
    v_lshlrev_b32 v14, 1, v14
    v_and_b32 v15, 7, v12
    v_xor_b32 v14, v14, v15
    v_lshl_add_u32 v4, v14, 4, v13
    v_add_u32 v5, 6144, v4
    v_accvgpr_write_b32 a249, v5
    v_add_u32 v6, 12288, v4
    v_accvgpr_write_b32 a250, v6
    v_add_u32 v7, 18432, v4
    v_accvgpr_write_b32 a251, v7
    v_accvgpr_write_b32 a248, v4
    v_and_b32 v13, 15, v12
    v_lshrrev_b32 v14, 4, v12
    v_lshrrev_b32 v15, 2, v13
    v_lshl_add_u32 v14, v14, 2, v15
    v_and_b32 v13, 3, v13
    v_lshlrev_b32 v13, 3, v13
    v_lshl_add_u32 v13, v14, 7, v13
    s_mul_i32 s37, s44, 40960
    v_add_u32 v13, s37, v13
    v_bfe_u32 v14, v14, 1, 2
    v_xor_b32 v15, 0, v14
    v_lshl_add_u32 v8, v15, 5, v13
    v_xor_b32 v15, 1, v14
    v_lshl_add_u32 v9, v15, 5, v13
    v_xor_b32 v15, 2, v14
    v_lshl_add_u32 v10, v15, 5, v13
    v_xor_b32 v15, 3, v14
    v_lshl_add_u32 v11, v15, 5, v13
    s_waitcnt lgkmcnt(0)
    s_mul_i32 s38, s44, 917504
    s_lshl_b32 s3, s71, 7
    s_add_u32 s38, s38, s3
    s_add_u32 s16, s10, s38
    s_addc_u32 s17, s11, 0
    s_sub_u32 s18, 3670016, s38
    s_mov_b32 s19, 0x20000
    s_mul_i32 s38, s70, 524288
    s_mul_i32 s3, s44, 32768
    s_add_u32 s38, s38, s3
    s_add_u32 s38, s38, 0x3000000
    s_add_u32 s8, s14, s38
    s_addc_u32 s9, s15, 0
    s_mov_b32 s10, 0x68000
    s_mov_b32 s11, 0x20000
    s_add_u32 s3, s44, 0
    s_and_b32 s3, s3, 3
    s_mul_i32 s3, s3, 131072
    v_add_u32 v112, s3, v1
    s_add_u32 s3, s44, 1
    s_and_b32 s3, s3, 3
    s_mul_i32 s3, s3, 131072
    v_add_u32 v113, s3, v1
    s_add_u32 s3, s44, 2
    s_and_b32 s3, s3, 3
    s_mul_i32 s3, s3, 131072
    v_add_u32 v114, s3, v1
    s_add_u32 s3, s44, 3
    s_and_b32 s3, s3, 3
    s_mul_i32 s3, s3, 131072
    v_add_u32 v115, s3, v1
    s_sub_u32 s3, s44, 1
    s_and_b32 s3, s3, 3
    s_mul_i32 s3, s3, 40960
    s_add_u32 s3, s3, 0
    v_add_u32 v116, s3, v1
    s_sub_u32 s3, s44, 2
    s_and_b32 s3, s3, 3
    s_mul_i32 s3, s3, 40960
    s_add_u32 s3, s3, 4096
    v_add_u32 v117, s3, v1
    s_sub_u32 s3, s44, 3
    s_and_b32 s3, s3, 3
    s_mul_i32 s3, s3, 40960
    s_add_u32 s3, s3, 8192
    v_add_u32 v118, s3, v1
    v_add_u32 v119, s37, v1
    s_and_b32 s33, s71, 3
    s_lshl_b32 s33, s33, 13
    s_mov_b32 s33, 0
    s_mov_b32 s32, s33
    s_mul_i32 s36, s33, 28
    s_lshl_b32 s39, s72, 11
    s_add_u32 s39, s39, 65536
    s_lshl_b32 s3, s44, 9
    s_add_u32 s39, s39, s3
    v_bfe_u32 v3, v0, 2, 2
    v_and_b32 v13, 3, v0
    v_lshlrev_b32 v13, 2, v13
    v_lshl_add_u32 v3, v3, 7, v13
    s_waitcnt vmcnt(16) lgkmcnt(0)
    s_barrier
    s_add_u32 m0, s37, 0
    s_nop 0
    buffer_load_dwordx4 v4, s[16:19], s36 offen offset:0 lds
    buffer_load_dwordx4 v5, s[16:19], s36 offen offset:1024 lds
    buffer_load_dwordx4 v6, s[16:19], s36 offen offset:2048 lds
    buffer_load_dwordx4 v7, s[16:19], s36 offen offset:3072 lds
    s_add_u32 s33, s33, 1024
    s_and_b32 s33, s33, 0x7fff
    s_mul_i32 s36, s33, 28
    s_add_u32 m0, s37, 4096
    s_nop 0
    buffer_load_dwordx4 v4, s[16:19], s36 offen offset:0 lds
    buffer_load_dwordx4 v5, s[16:19], s36 offen offset:1024 lds
    buffer_load_dwordx4 v6, s[16:19], s36 offen offset:2048 lds
    buffer_load_dwordx4 v7, s[16:19], s36 offen offset:3072 lds
    s_add_u32 s33, s33, 1024
    s_and_b32 s33, s33, 0x7fff
    s_mul_i32 s36, s33, 28
    s_waitcnt vmcnt(8)
    s_lshl_b32 s3, s44, 2
    v_mov_b32 v13, s3
    v_mov_b32 v14, s7
    buffer_store_dword v14, v13, s[28:31], s69 offen sc1
    s_add_u32 m0, s37, 8192
    s_nop 0
    buffer_load_dwordx4 v4, s[16:19], s36 offen offset:0 lds
    buffer_load_dwordx4 v5, s[16:19], s36 offen offset:1024 lds
    buffer_load_dwordx4 v6, s[16:19], s36 offen offset:2048 lds
    buffer_load_dwordx4 v7, s[16:19], s36 offen offset:3072 lds
    s_add_u32 s33, s33, 1024
    s_and_b32 s33, s33, 0x7fff
    s_mul_i32 s36, s33, 28
    s_add_u32 m0, s37, 12288
    s_nop 0
    buffer_load_dwordx4 v4, s[16:19], s36 offen offset:0 lds
    buffer_load_dwordx4 v5, s[16:19], s36 offen offset:1024 lds
    buffer_load_dwordx4 v6, s[16:19], s36 offen offset:2048 lds
    buffer_load_dwordx4 v7, s[16:19], s36 offen offset:3072 lds
    s_add_u32 s33, s33, 1024
    s_and_b32 s33, s33, 0x7fff
    s_mul_i32 s36, s33, 28
    s_add_u32 m0, s37, 16384
    s_nop 0
    buffer_load_dwordx4 v4, s[16:19], s36 offen offset:0 lds
    buffer_load_dwordx4 v5, s[16:19], s36 offen offset:1024 lds
    buffer_load_dwordx4 v6, s[16:19], s36 offen offset:2048 lds
    buffer_load_dwordx4 v7, s[16:19], s36 offen offset:3072 lds
    s_add_u32 s33, s33, 1024
    s_and_b32 s33, s33, 0x7fff
    s_mul_i32 s36, s33, 28
    s_add_u32 m0, s37, 20480
    s_nop 0
    buffer_load_dwordx4 v4, s[16:19], s36 offen offset:0 lds
    buffer_load_dwordx4 v5, s[16:19], s36 offen offset:1024 lds
    buffer_load_dwordx4 v6, s[16:19], s36 offen offset:2048 lds
    buffer_load_dwordx4 v7, s[16:19], s36 offen offset:3072 lds
    s_add_u32 s33, s33, 1024
    s_and_b32 s33, s33, 0x7fff
    s_mul_i32 s36, s33, 28
    s_add_u32 m0, s37, 24576
    s_nop 0
    buffer_load_dwordx4 v4, s[16:19], s36 offen offset:0 lds
    buffer_load_dwordx4 v5, s[16:19], s36 offen offset:1024 lds
    buffer_load_dwordx4 v6, s[16:19], s36 offen offset:2048 lds
    buffer_load_dwordx4 v7, s[16:19], s36 offen offset:3072 lds
    s_add_u32 s33, s33, 1024
    s_and_b32 s33, s33, 0x7fff
    s_mul_i32 s36, s33, 28
    s_add_u32 m0, s37, 28672
    s_nop 0
    buffer_load_dwordx4 v4, s[16:19], s36 offen offset:0 lds
    buffer_load_dwordx4 v5, s[16:19], s36 offen offset:1024 lds
    buffer_load_dwordx4 v6, s[16:19], s36 offen offset:2048 lds
    buffer_load_dwordx4 v7, s[16:19], s36 offen offset:3072 lds
    s_add_u32 s33, s33, 1024
    s_and_b32 s33, s33, 0x7fff
    s_mul_i32 s36, s33, 28
    s_add_u32 m0, s37, 32768
    s_nop 0
    buffer_load_dwordx4 v4, s[16:19], s36 offen offset:0 lds
    buffer_load_dwordx4 v5, s[16:19], s36 offen offset:1024 lds
    buffer_load_dwordx4 v6, s[16:19], s36 offen offset:2048 lds
    buffer_load_dwordx4 v7, s[16:19], s36 offen offset:3072 lds
    s_add_u32 s33, s33, 1024
    s_and_b32 s33, s33, 0x7fff
    s_mul_i32 s36, s33, 28
    s_add_u32 m0, s37, 36864
    s_nop 0
    buffer_load_dwordx4 v4, s[16:19], s36 offen offset:0 lds
    buffer_load_dwordx4 v5, s[16:19], s36 offen offset:1024 lds
    buffer_load_dwordx4 v6, s[16:19], s36 offen offset:2048 lds
    buffer_load_dwordx4 v7, s[16:19], s36 offen offset:3072 lds
    s_add_u32 s33, s33, 1024
    s_and_b32 s33, s33, 0x7fff
    s_mul_i32 s36, s33, 28
    s_getpc_b64 s[40:41]
    s_add_u32 s40, s40, L3_act@rel32@lo+4
    s_addc_u32 s41, s41, L3_act@rel32@hi+12
    s_mul_i32 s3, s74, (((L4_entry-L3_act)/28+63)&~63)
    s_add_u32 s40, s40, s3
    s_addc_u32 s41, s41, 0
    s_sub_u32 s42, L4_entry-L3_act, s3
    s_cselect_b32 s42, 0, s42
    s_min_u32 s42, s42, (((L4_entry-L3_act)/28+63)&~63)
    s_mov_b32 s43, 0x20000
    v_lshlrev_b32 v12, 6, v0
    buffer_load_dword v120, v12, s[40:43], 0 offen
    s_mov_b32 s20, s12
    s_mov_b32 s21, s13
    s_mov_b32 s22, 0x1c0000
    s_mov_b32 s23, 0x20000
    v_and_b32 v13, 15, v0
    v_bfe_u32 v14, v0, 4, 2
    s_lshl_b32 s3, s70, 6
    s_lshl_b32 s38, s44, 4
    s_add_u32 s3, s3, s38
    v_add_u32 v13, s3, v13
    v_mul_u32_u24 v13, 896, v13
    v_lshl_add_u32 v2, v14, 3, v13
    s_lshl_b32 s38, s71, 7
    buffer_load_dwordx2 a[240:241], v2, s[20:23], s38 offen offset:0
    buffer_load_dwordx2 a[242:243], v2, s[20:23], s38 offen offset:32
    buffer_load_dwordx2 a[244:245], v2, s[20:23], s38 offen offset:64
    buffer_load_dwordx2 a[246:247], v2, s[20:23], s38 offen offset:96
    s_waitcnt vmcnt(42)
    ds_read_b64_tr_b16 a[0:1], v8 offset:0
    ds_read_b64_tr_b16 a[2:3], v8 offset:2048
    ds_read_b64_tr_b16 a[4:5], v9 offset:0
    ds_read_b64_tr_b16 a[6:7], v9 offset:2048
    ds_read_b64_tr_b16 a[8:9], v10 offset:0
    ds_read_b64_tr_b16 a[10:11], v10 offset:2048
    ds_read_b64_tr_b16 a[12:13], v11 offset:0
    ds_read_b64_tr_b16 a[14:15], v11 offset:2048
    s_waitcnt vmcnt(38)
    ds_read_b64_tr_b16 a[16:17], v8 offset:4096
    ds_read_b64_tr_b16 a[18:19], v8 offset:6144
    ds_read_b64_tr_b16 a[20:21], v9 offset:4096
    ds_read_b64_tr_b16 a[22:23], v9 offset:6144
    ds_read_b64_tr_b16 a[24:25], v10 offset:4096
    ds_read_b64_tr_b16 a[26:27], v10 offset:6144
    ds_read_b64_tr_b16 a[28:29], v11 offset:4096
    ds_read_b64_tr_b16 a[30:31], v11 offset:6144
    s_waitcnt lgkmcnt(8)
    s_add_u32 m0, s37, 0
    s_nop 0
    buffer_load_dwordx4 v4, s[16:19], s36 offen offset:0 lds
    buffer_load_dwordx4 v5, s[16:19], s36 offen offset:1024 lds
    buffer_load_dwordx4 v6, s[16:19], s36 offen offset:2048 lds
    buffer_load_dwordx4 v7, s[16:19], s36 offen offset:3072 lds
    s_add_u32 s33, s33, 1024
    s_and_b32 s33, s33, 0x7fff
    s_mul_i32 s36, s33, 28
    s_waitcnt vmcnt(37)
    ds_read_b64_tr_b16 a[32:33], v8 offset:8192
    ds_read_b64_tr_b16 a[34:35], v8 offset:10240
    ds_read_b64_tr_b16 a[36:37], v9 offset:8192
    ds_read_b64_tr_b16 a[38:39], v9 offset:10240
    ds_read_b64_tr_b16 a[40:41], v10 offset:8192
    ds_read_b64_tr_b16 a[42:43], v10 offset:10240
    ds_read_b64_tr_b16 a[44:45], v11 offset:8192
    ds_read_b64_tr_b16 a[46:47], v11 offset:10240
    s_waitcnt lgkmcnt(8)
    s_add_u32 m0, s37, 4096
    s_nop 0
    buffer_load_dwordx4 v4, s[16:19], s36 offen offset:0 lds
    buffer_load_dwordx4 v5, s[16:19], s36 offen offset:1024 lds
    buffer_load_dwordx4 v6, s[16:19], s36 offen offset:2048 lds
    buffer_load_dwordx4 v7, s[16:19], s36 offen offset:3072 lds
    s_add_u32 s33, s33, 1024
    s_and_b32 s33, s33, 0x7fff
    s_mul_i32 s36, s33, 28
    s_waitcnt vmcnt(37)
    ds_read_b64_tr_b16 a[48:49], v8 offset:12288
    ds_read_b64_tr_b16 a[50:51], v8 offset:14336
    ds_read_b64_tr_b16 a[52:53], v9 offset:12288
    ds_read_b64_tr_b16 a[54:55], v9 offset:14336
    ds_read_b64_tr_b16 a[56:57], v10 offset:12288
    ds_read_b64_tr_b16 a[58:59], v10 offset:14336
    ds_read_b64_tr_b16 a[60:61], v11 offset:12288
    ds_read_b64_tr_b16 a[62:63], v11 offset:14336
    s_waitcnt lgkmcnt(8)
    s_add_u32 m0, s37, 8192
    s_nop 0
    buffer_load_dwordx4 v4, s[16:19], s36 offen offset:0 lds
    buffer_load_dwordx4 v5, s[16:19], s36 offen offset:1024 lds
    buffer_load_dwordx4 v6, s[16:19], s36 offen offset:2048 lds
    buffer_load_dwordx4 v7, s[16:19], s36 offen offset:3072 lds
    s_add_u32 s33, s33, 1024
    s_and_b32 s33, s33, 0x7fff
    s_mul_i32 s36, s33, 28
    s_waitcnt vmcnt(37)
    ds_read_b64_tr_b16 a[64:65], v8 offset:16384
    ds_read_b64_tr_b16 a[66:67], v8 offset:18432
    ds_read_b64_tr_b16 a[68:69], v9 offset:16384
    ds_read_b64_tr_b16 a[70:71], v9 offset:18432
    ds_read_b64_tr_b16 a[72:73], v10 offset:16384
    ds_read_b64_tr_b16 a[74:75], v10 offset:18432
    ds_read_b64_tr_b16 a[76:77], v11 offset:16384
    ds_read_b64_tr_b16 a[78:79], v11 offset:18432
    s_waitcnt lgkmcnt(8)
    s_add_u32 m0, s37, 12288
    s_nop 0
    buffer_load_dwordx4 v4, s[16:19], s36 offen offset:0 lds
    buffer_load_dwordx4 v5, s[16:19], s36 offen offset:1024 lds
    buffer_load_dwordx4 v6, s[16:19], s36 offen offset:2048 lds
    buffer_load_dwordx4 v7, s[16:19], s36 offen offset:3072 lds
    s_add_u32 s33, s33, 1024
    s_and_b32 s33, s33, 0x7fff
    s_mul_i32 s36, s33, 28
    s_waitcnt vmcnt(37)
    ds_read_b64_tr_b16 a[80:81], v8 offset:20480
    ds_read_b64_tr_b16 a[82:83], v8 offset:22528
    ds_read_b64_tr_b16 a[84:85], v9 offset:20480
    ds_read_b64_tr_b16 a[86:87], v9 offset:22528
    ds_read_b64_tr_b16 a[88:89], v10 offset:20480
    ds_read_b64_tr_b16 a[90:91], v10 offset:22528
    ds_read_b64_tr_b16 a[92:93], v11 offset:20480
    ds_read_b64_tr_b16 a[94:95], v11 offset:22528
    s_waitcnt lgkmcnt(8)
    s_add_u32 m0, s37, 16384
    s_nop 0
    buffer_load_dwordx4 v4, s[16:19], s36 offen offset:0 lds
    buffer_load_dwordx4 v5, s[16:19], s36 offen offset:1024 lds
    buffer_load_dwordx4 v6, s[16:19], s36 offen offset:2048 lds
    buffer_load_dwordx4 v7, s[16:19], s36 offen offset:3072 lds
    s_add_u32 s33, s33, 1024
    s_and_b32 s33, s33, 0x7fff
    s_mul_i32 s36, s33, 28
    s_waitcnt vmcnt(37)
    ds_read_b64_tr_b16 a[96:97], v8 offset:24576
    ds_read_b64_tr_b16 a[98:99], v8 offset:26624
    ds_read_b64_tr_b16 a[100:101], v9 offset:24576
    ds_read_b64_tr_b16 a[102:103], v9 offset:26624
    ds_read_b64_tr_b16 a[104:105], v10 offset:24576
    ds_read_b64_tr_b16 a[106:107], v10 offset:26624
    ds_read_b64_tr_b16 a[108:109], v11 offset:24576
    ds_read_b64_tr_b16 a[110:111], v11 offset:26624
    s_waitcnt lgkmcnt(8)
    s_add_u32 m0, s37, 20480
    s_nop 0
    buffer_load_dwordx4 v4, s[16:19], s36 offen offset:0 lds
    buffer_load_dwordx4 v5, s[16:19], s36 offen offset:1024 lds
    buffer_load_dwordx4 v6, s[16:19], s36 offen offset:2048 lds
    buffer_load_dwordx4 v7, s[16:19], s36 offen offset:3072 lds
    s_add_u32 s33, s33, 1024
    s_and_b32 s33, s33, 0x7fff
    s_mul_i32 s36, s33, 28
    s_waitcnt vmcnt(37)
    ds_read_b64_tr_b16 a[112:113], v8 offset:28672
    ds_read_b64_tr_b16 a[114:115], v8 offset:30720
    ds_read_b64_tr_b16 a[116:117], v9 offset:28672
    ds_read_b64_tr_b16 a[118:119], v9 offset:30720
    ds_read_b64_tr_b16 a[120:121], v10 offset:28672
    ds_read_b64_tr_b16 a[122:123], v10 offset:30720
    ds_read_b64_tr_b16 a[124:125], v11 offset:28672
    ds_read_b64_tr_b16 a[126:127], v11 offset:30720
    s_waitcnt lgkmcnt(8)
    s_add_u32 m0, s37, 24576
    s_nop 0
    buffer_load_dwordx4 v4, s[16:19], s36 offen offset:0 lds
    buffer_load_dwordx4 v5, s[16:19], s36 offen offset:1024 lds
    buffer_load_dwordx4 v6, s[16:19], s36 offen offset:2048 lds
    buffer_load_dwordx4 v7, s[16:19], s36 offen offset:3072 lds
    s_add_u32 s33, s33, 1024
    s_and_b32 s33, s33, 0x7fff
    s_mul_i32 s36, s33, 28
    s_waitcnt vmcnt(37)
    ds_read_b64_tr_b16 a[128:129], v8 offset:32768
    ds_read_b64_tr_b16 a[130:131], v8 offset:34816
    ds_read_b64_tr_b16 a[132:133], v9 offset:32768
    ds_read_b64_tr_b16 a[134:135], v9 offset:34816
    ds_read_b64_tr_b16 a[136:137], v10 offset:32768
    ds_read_b64_tr_b16 a[138:139], v10 offset:34816
    ds_read_b64_tr_b16 a[140:141], v11 offset:32768
    ds_read_b64_tr_b16 a[142:143], v11 offset:34816
    s_waitcnt lgkmcnt(8)
    s_add_u32 m0, s37, 28672
    s_nop 0
    buffer_load_dwordx4 v4, s[16:19], s36 offen offset:0 lds
    buffer_load_dwordx4 v5, s[16:19], s36 offen offset:1024 lds
    buffer_load_dwordx4 v6, s[16:19], s36 offen offset:2048 lds
    buffer_load_dwordx4 v7, s[16:19], s36 offen offset:3072 lds
    s_add_u32 s33, s33, 1024
    s_and_b32 s33, s33, 0x7fff
    s_mul_i32 s36, s33, 28
    s_waitcnt vmcnt(37)
    ds_read_b64_tr_b16 a[144:145], v8 offset:36864
    ds_read_b64_tr_b16 a[146:147], v8 offset:38912
    ds_read_b64_tr_b16 a[148:149], v9 offset:36864
    ds_read_b64_tr_b16 a[150:151], v9 offset:38912
    ds_read_b64_tr_b16 a[152:153], v10 offset:36864
    ds_read_b64_tr_b16 a[154:155], v10 offset:38912
    ds_read_b64_tr_b16 a[156:157], v11 offset:36864
    ds_read_b64_tr_b16 a[158:159], v11 offset:38912
    s_waitcnt lgkmcnt(8)
    s_add_u32 m0, s37, 32768
    s_nop 0
    buffer_load_dwordx4 v4, s[16:19], s36 offen offset:0 lds
    buffer_load_dwordx4 v5, s[16:19], s36 offen offset:1024 lds
    buffer_load_dwordx4 v6, s[16:19], s36 offen offset:2048 lds
    buffer_load_dwordx4 v7, s[16:19], s36 offen offset:3072 lds
    s_add_u32 s33, s33, 1024
    s_and_b32 s33, s33, 0x7fff
    s_mul_i32 s36, s33, 28
    s_waitcnt vmcnt(32)
    ds_read_b64_tr_b16 a[160:161], v8 offset:0
    ds_read_b64_tr_b16 a[162:163], v8 offset:2048
    ds_read_b64_tr_b16 a[164:165], v9 offset:0
    ds_read_b64_tr_b16 a[166:167], v9 offset:2048
    ds_read_b64_tr_b16 a[168:169], v10 offset:0
    ds_read_b64_tr_b16 a[170:171], v10 offset:2048
    ds_read_b64_tr_b16 a[172:173], v11 offset:0
    ds_read_b64_tr_b16 a[174:175], v11 offset:2048
    s_waitcnt lgkmcnt(8)
    s_add_u32 m0, s37, 36864
    s_nop 0
    buffer_load_dwordx4 v4, s[16:19], s36 offen offset:0 lds
    buffer_load_dwordx4 v5, s[16:19], s36 offen offset:1024 lds
    buffer_load_dwordx4 v6, s[16:19], s36 offen offset:2048 lds
    buffer_load_dwordx4 v7, s[16:19], s36 offen offset:3072 lds
    s_add_u32 s33, s33, 1024
    s_and_b32 s33, s33, 0x7fff
    s_mul_i32 s36, s33, 28
    s_waitcnt vmcnt(32)
    ds_read_b64_tr_b16 a[176:177], v8 offset:4096
    ds_read_b64_tr_b16 a[178:179], v8 offset:6144
    ds_read_b64_tr_b16 a[180:181], v9 offset:4096
    ds_read_b64_tr_b16 a[182:183], v9 offset:6144
    ds_read_b64_tr_b16 a[184:185], v10 offset:4096
    ds_read_b64_tr_b16 a[186:187], v10 offset:6144
    ds_read_b64_tr_b16 a[188:189], v11 offset:4096
    ds_read_b64_tr_b16 a[190:191], v11 offset:6144
    s_waitcnt lgkmcnt(8)
    s_add_u32 m0, s37, 0
    s_nop 0
    buffer_load_dwordx4 v4, s[16:19], s36 offen offset:0 lds
    buffer_load_dwordx4 v5, s[16:19], s36 offen offset:1024 lds
    buffer_load_dwordx4 v6, s[16:19], s36 offen offset:2048 lds
    buffer_load_dwordx4 v7, s[16:19], s36 offen offset:3072 lds
    s_add_u32 s33, s33, 1024
    s_and_b32 s33, s33, 0x7fff
    s_mul_i32 s36, s33, 28
    buffer_load_dword v15, v3, s[28:31], s39 offen sc1
    s_waitcnt vmcnt(33)
    ds_read_b64_tr_b16 a[192:193], v8 offset:8192
    ds_read_b64_tr_b16 a[194:195], v8 offset:10240
    ds_read_b64_tr_b16 a[196:197], v9 offset:8192
    ds_read_b64_tr_b16 a[198:199], v9 offset:10240
    ds_read_b64_tr_b16 a[200:201], v10 offset:8192
    ds_read_b64_tr_b16 a[202:203], v10 offset:10240
    ds_read_b64_tr_b16 a[204:205], v11 offset:8192
    ds_read_b64_tr_b16 a[206:207], v11 offset:10240
    s_waitcnt lgkmcnt(8)
    s_add_u32 m0, s37, 4096
    s_nop 0
    buffer_load_dwordx4 v4, s[16:19], s36 offen offset:0 lds
    buffer_load_dwordx4 v5, s[16:19], s36 offen offset:1024 lds
    buffer_load_dwordx4 v6, s[16:19], s36 offen offset:2048 lds
    buffer_load_dwordx4 v7, s[16:19], s36 offen offset:3072 lds
    s_add_u32 s33, s33, 1024
    s_and_b32 s33, s33, 0x7fff
    s_mul_i32 s36, s33, 28
    s_waitcnt vmcnt(33)
    ds_read_b64_tr_b16 a[208:209], v8 offset:12288
    ds_read_b64_tr_b16 a[210:211], v8 offset:14336
    ds_read_b64_tr_b16 a[212:213], v9 offset:12288
    ds_read_b64_tr_b16 a[214:215], v9 offset:14336
    ds_read_b64_tr_b16 a[216:217], v10 offset:12288
    ds_read_b64_tr_b16 a[218:219], v10 offset:14336
    ds_read_b64_tr_b16 a[220:221], v11 offset:12288
    ds_read_b64_tr_b16 a[222:223], v11 offset:14336
    s_waitcnt lgkmcnt(8)
    s_add_u32 m0, s37, 8192
    s_nop 0
    buffer_load_dwordx4 v4, s[16:19], s36 offen offset:0 lds
    buffer_load_dwordx4 v5, s[16:19], s36 offen offset:1024 lds
    buffer_load_dwordx4 v6, s[16:19], s36 offen offset:2048 lds
    buffer_load_dwordx4 v7, s[16:19], s36 offen offset:3072 lds
    s_add_u32 s33, s33, 1024
    s_and_b32 s33, s33, 0x7fff
    s_mul_i32 s36, s33, 28
    s_waitcnt vmcnt(33)
    ds_read_b64_tr_b16 a[224:225], v8 offset:16384
    ds_read_b64_tr_b16 a[226:227], v8 offset:18432
    ds_read_b64_tr_b16 a[228:229], v9 offset:16384
    ds_read_b64_tr_b16 a[230:231], v9 offset:18432
    ds_read_b64_tr_b16 a[232:233], v10 offset:16384
    ds_read_b64_tr_b16 a[234:235], v10 offset:18432
    ds_read_b64_tr_b16 a[236:237], v11 offset:16384
    ds_read_b64_tr_b16 a[238:239], v11 offset:18432
    s_waitcnt lgkmcnt(8)
    s_add_u32 m0, s37, 12288
    s_nop 0
    buffer_load_dwordx4 v4, s[16:19], s36 offen offset:0 lds
    buffer_load_dwordx4 v5, s[16:19], s36 offen offset:1024 lds
    buffer_load_dwordx4 v6, s[16:19], s36 offen offset:2048 lds
    buffer_load_dwordx4 v7, s[16:19], s36 offen offset:3072 lds
    s_add_u32 s33, s33, 1024
    s_and_b32 s33, s33, 0x7fff
    s_mul_i32 s36, s33, 28
    s_waitcnt lgkmcnt(0)
    s_add_u32 m0, s37, 16384
    s_nop 0
    buffer_load_dwordx4 v4, s[16:19], s36 offen offset:0 lds
    buffer_load_dwordx4 v5, s[16:19], s36 offen offset:1024 lds
    buffer_load_dwordx4 v6, s[16:19], s36 offen offset:2048 lds
    buffer_load_dwordx4 v7, s[16:19], s36 offen offset:3072 lds
    s_add_u32 s33, s33, 1024
    s_and_b32 s33, s33, 0x7fff
    s_mul_i32 s36, s33, 28
    s_waitcnt vmcnt(16)
    v_cmp_ne_u32 vcc, s7, v15
    s_and_b32 s3, vcc_lo, 0xf
    s_cbranch_scc1 L3_cP0
L3_cP0_r:
    buffer_load_dwordx4 v[176:179], v112, s[8:11], s32 offen sc1
    buffer_load_dwordx4 v[180:183], v113, s[8:11], s32 offen sc1
    buffer_load_dwordx4 v[184:187], v114, s[8:11], s32 offen sc1
    buffer_load_dwordx4 v[188:191], v115, s[8:11], s32 offen sc1
    s_add_u32 s32, s32, 1024
    s_and_b32 s32, s32, 0x7fff
    buffer_load_dwordx4 v[192:195], v112, s[8:11], s32 offen sc1
    buffer_load_dwordx4 v[196:199], v113, s[8:11], s32 offen sc1
    buffer_load_dwordx4 v[200:203], v114, s[8:11], s32 offen sc1
    buffer_load_dwordx4 v[204:207], v115, s[8:11], s32 offen sc1
    s_add_u32 s32, s32, 1024
    s_and_b32 s32, s32, 0x7fff
    buffer_load_dwordx4 v[208:211], v112, s[8:11], s32 offen sc1
    buffer_load_dwordx4 v[212:215], v113, s[8:11], s32 offen sc1
    buffer_load_dwordx4 v[216:219], v114, s[8:11], s32 offen sc1
    buffer_load_dwordx4 v[220:223], v115, s[8:11], s32 offen sc1
    s_add_u32 s32, s32, 1024
    s_and_b32 s32, s32, 0x7fff
    buffer_load_dwordx4 v[224:227], v112, s[8:11], s32 offen sc1
    buffer_load_dwordx4 v[228:231], v113, s[8:11], s32 offen sc1
    buffer_load_dwordx4 v[232:235], v114, s[8:11], s32 offen sc1
    buffer_load_dwordx4 v[236:239], v115, s[8:11], s32 offen sc1
    s_add_u32 s32, s32, 1024
    s_and_b32 s32, s32, 0x7fff
    s_waitcnt vmcnt(12) lgkmcnt(0)
    v_mfma_f32_16x16x32_bf16 v[48:51], a[0:3], v[176:179], 0
    v_mfma_f32_16x16x32_bf16 v[52:55], a[0:3], v[180:183], 0
    v_mfma_f32_16x16x32_bf16 v[56:59], a[0:3], v[184:187], 0
    v_mfma_f32_16x16x32_bf16 v[60:63], a[0:3], v[188:191], 0
    v_mfma_f32_16x16x32_bf16 v[76:79], a[4:7], v[188:191], 0
    buffer_load_dwordx4 v[240:243], v112, s[8:11], s32 offen sc1
    buffer_load_dwordx4 v[244:247], v113, s[8:11], s32 offen sc1
    v_mfma_f32_16x16x32_bf16 v[72:75], a[4:7], v[184:187], 0
    buffer_load_dwordx4 v[248:251], v114, s[8:11], s32 offen sc1
    buffer_load_dwordx4 v[252:255], v115, s[8:11], s32 offen sc1
    v_mfma_f32_16x16x32_bf16 v[68:71], a[4:7], v[180:183], 0
    s_add_u32 s32, s32, 1024
    v_mfma_f32_16x16x32_bf16 v[64:67], a[4:7], v[176:179], 0
    s_and_b32 s32, s32, 0x7fff
    v_mfma_f32_16x16x32_bf16 v[80:83], a[8:11], v[176:179], 0
    v_mfma_f32_16x16x32_bf16 v[84:87], a[8:11], v[180:183], 0
    v_mfma_f32_16x16x32_bf16 v[88:91], a[8:11], v[184:187], 0
    v_mfma_f32_16x16x32_bf16 v[92:95], a[8:11], v[188:191], 0
    v_mfma_f32_16x16x32_bf16 v[108:111], a[12:15], v[188:191], 0
    v_mfma_f32_16x16x32_bf16 v[104:107], a[12:15], v[184:187], 0
    v_mfma_f32_16x16x32_bf16 v[100:103], a[12:15], v[180:183], 0
    v_mfma_f32_16x16x32_bf16 v[96:99], a[12:15], v[176:179], 0
    s_waitcnt vmcnt(12) lgkmcnt(0)
    v_mfma_f32_16x16x32_bf16 v[48:51], a[16:19], v[192:195], v[48:51]
    v_mfma_f32_16x16x32_bf16 v[52:55], a[16:19], v[196:199], v[52:55]
    v_mfma_f32_16x16x32_bf16 v[56:59], a[16:19], v[200:203], v[56:59]
    v_mfma_f32_16x16x32_bf16 v[60:63], a[16:19], v[204:207], v[60:63]
    buffer_load_dword v15, v3, s[28:31], s39 offen sc1
    v_mfma_f32_16x16x32_bf16 v[76:79], a[20:23], v[204:207], v[76:79]
    buffer_load_dwordx4 v[176:179], v112, s[8:11], s32 offen sc1
    buffer_load_dwordx4 v[180:183], v113, s[8:11], s32 offen sc1
    v_mfma_f32_16x16x32_bf16 v[72:75], a[20:23], v[200:203], v[72:75]
    buffer_load_dwordx4 v[184:187], v114, s[8:11], s32 offen sc1
    buffer_load_dwordx4 v[188:191], v115, s[8:11], s32 offen sc1
    v_mfma_f32_16x16x32_bf16 v[68:71], a[20:23], v[196:199], v[68:71]
    s_add_u32 s32, s32, 1024
    v_mfma_f32_16x16x32_bf16 v[64:67], a[20:23], v[192:195], v[64:67]
    s_and_b32 s32, s32, 0x7fff
    v_mfma_f32_16x16x32_bf16 v[80:83], a[24:27], v[192:195], v[80:83]
    v_mfma_f32_16x16x32_bf16 v[84:87], a[24:27], v[196:199], v[84:87]
    v_mfma_f32_16x16x32_bf16 v[88:91], a[24:27], v[200:203], v[88:91]
    v_mfma_f32_16x16x32_bf16 v[92:95], a[24:27], v[204:207], v[92:95]
    v_mfma_f32_16x16x32_bf16 v[108:111], a[28:31], v[204:207], v[108:111]
    v_mfma_f32_16x16x32_bf16 v[104:107], a[28:31], v[200:203], v[104:107]
    v_mfma_f32_16x16x32_bf16 v[100:103], a[28:31], v[196:199], v[100:103]
    v_mfma_f32_16x16x32_bf16 v[96:99], a[28:31], v[192:195], v[96:99]
    s_waitcnt vmcnt(13) lgkmcnt(0)
    v_mfma_f32_16x16x32_bf16 v[48:51], a[32:35], v[208:211], v[48:51]
    v_mfma_f32_16x16x32_bf16 v[52:55], a[32:35], v[212:215], v[52:55]
    v_mfma_f32_16x16x32_bf16 v[56:59], a[32:35], v[216:219], v[56:59]
    v_mfma_f32_16x16x32_bf16 v[60:63], a[32:35], v[220:223], v[60:63]
    v_mfma_f32_16x16x32_bf16 v[76:79], a[36:39], v[220:223], v[76:79]
    buffer_load_dwordx4 v[192:195], v112, s[8:11], s32 offen sc1
    buffer_load_dwordx4 v[196:199], v113, s[8:11], s32 offen sc1
    v_mfma_f32_16x16x32_bf16 v[72:75], a[36:39], v[216:219], v[72:75]
    buffer_load_dwordx4 v[200:203], v114, s[8:11], s32 offen sc1
    buffer_load_dwordx4 v[204:207], v115, s[8:11], s32 offen sc1
    v_mfma_f32_16x16x32_bf16 v[68:71], a[36:39], v[212:215], v[68:71]
    s_add_u32 s32, s32, 1024
    v_mfma_f32_16x16x32_bf16 v[64:67], a[36:39], v[208:211], v[64:67]
    s_and_b32 s32, s32, 0x7fff
    v_mfma_f32_16x16x32_bf16 v[80:83], a[40:43], v[208:211], v[80:83]
    v_mfma_f32_16x16x32_bf16 v[84:87], a[40:43], v[212:215], v[84:87]
    v_mfma_f32_16x16x32_bf16 v[88:91], a[40:43], v[216:219], v[88:91]
    v_mfma_f32_16x16x32_bf16 v[92:95], a[40:43], v[220:223], v[92:95]
    v_mfma_f32_16x16x32_bf16 v[108:111], a[44:47], v[220:223], v[108:111]
    v_mfma_f32_16x16x32_bf16 v[104:107], a[44:47], v[216:219], v[104:107]
    v_mfma_f32_16x16x32_bf16 v[100:103], a[44:47], v[212:215], v[100:103]
    v_mfma_f32_16x16x32_bf16 v[96:99], a[44:47], v[208:211], v[96:99]
    s_waitcnt vmcnt(13) lgkmcnt(0)
    v_mfma_f32_16x16x32_bf16 v[48:51], a[48:51], v[224:227], v[48:51]
    v_mfma_f32_16x16x32_bf16 v[52:55], a[48:51], v[228:231], v[52:55]
    v_mfma_f32_16x16x32_bf16 v[56:59], a[48:51], v[232:235], v[56:59]
    v_mfma_f32_16x16x32_bf16 v[60:63], a[48:51], v[236:239], v[60:63]
    v_mfma_f32_16x16x32_bf16 v[76:79], a[52:55], v[236:239], v[76:79]
    buffer_load_dwordx4 v[208:211], v112, s[8:11], s32 offen sc1
    buffer_load_dwordx4 v[212:215], v113, s[8:11], s32 offen sc1
    v_mfma_f32_16x16x32_bf16 v[72:75], a[52:55], v[232:235], v[72:75]
    buffer_load_dwordx4 v[216:219], v114, s[8:11], s32 offen sc1
    buffer_load_dwordx4 v[220:223], v115, s[8:11], s32 offen sc1
    v_mfma_f32_16x16x32_bf16 v[68:71], a[52:55], v[228:231], v[68:71]
    s_add_u32 s32, s32, 1024
    v_mfma_f32_16x16x32_bf16 v[64:67], a[52:55], v[224:227], v[64:67]
    s_and_b32 s32, s32, 0x7fff
    v_mfma_f32_16x16x32_bf16 v[80:83], a[56:59], v[224:227], v[80:83]
    v_mfma_f32_16x16x32_bf16 v[84:87], a[56:59], v[228:231], v[84:87]
    v_mfma_f32_16x16x32_bf16 v[88:91], a[56:59], v[232:235], v[88:91]
    v_mfma_f32_16x16x32_bf16 v[92:95], a[56:59], v[236:239], v[92:95]
    v_mfma_f32_16x16x32_bf16 v[108:111], a[60:63], v[236:239], v[108:111]
    v_mfma_f32_16x16x32_bf16 v[104:107], a[60:63], v[232:235], v[104:107]
    v_mfma_f32_16x16x32_bf16 v[100:103], a[60:63], v[228:231], v[100:103]
    v_mfma_f32_16x16x32_bf16 v[96:99], a[60:63], v[224:227], v[96:99]
    s_waitcnt vmcnt(13) lgkmcnt(0)
    v_mfma_f32_16x16x32_bf16 v[48:51], a[64:67], v[240:243], v[48:51]
    v_mfma_f32_16x16x32_bf16 v[52:55], a[64:67], v[244:247], v[52:55]
    v_mfma_f32_16x16x32_bf16 v[56:59], a[64:67], v[248:251], v[56:59]
    s_waitcnt vmcnt(12)
    v_cmp_ne_u32 vcc, s7, v15
    s_and_b32 s3, vcc_lo, 0xf0
    s_cbranch_scc1 L3_cP4
L3_cP4_r:
    v_mfma_f32_16x16x32_bf16 v[60:63], a[64:67], v[252:255], v[60:63]
    v_mfma_f32_16x16x32_bf16 v[76:79], a[68:71], v[252:255], v[76:79]
    buffer_load_dwordx4 v[224:227], v112, s[8:11], s32 offen sc1
    buffer_load_dwordx4 v[228:231], v113, s[8:11], s32 offen sc1
    v_mfma_f32_16x16x32_bf16 v[72:75], a[68:71], v[248:251], v[72:75]
    buffer_load_dwordx4 v[232:235], v114, s[8:11], s32 offen sc1
    buffer_load_dwordx4 v[236:239], v115, s[8:11], s32 offen sc1
    v_mfma_f32_16x16x32_bf16 v[68:71], a[68:71], v[244:247], v[68:71]
    s_add_u32 s32, s32, 1024
    v_mfma_f32_16x16x32_bf16 v[64:67], a[68:71], v[240:243], v[64:67]
    s_and_b32 s32, s32, 0x7fff
    v_mfma_f32_16x16x32_bf16 v[80:83], a[72:75], v[240:243], v[80:83]
    v_mfma_f32_16x16x32_bf16 v[84:87], a[72:75], v[244:247], v[84:87]
    v_mfma_f32_16x16x32_bf16 v[88:91], a[72:75], v[248:251], v[88:91]
    v_mfma_f32_16x16x32_bf16 v[92:95], a[72:75], v[252:255], v[92:95]
    v_mfma_f32_16x16x32_bf16 v[108:111], a[76:79], v[252:255], v[108:111]
    v_mfma_f32_16x16x32_bf16 v[104:107], a[76:79], v[248:251], v[104:107]
    v_mfma_f32_16x16x32_bf16 v[100:103], a[76:79], v[244:247], v[100:103]
    v_mfma_f32_16x16x32_bf16 v[96:99], a[76:79], v[240:243], v[96:99]
    s_waitcnt vmcnt(12) lgkmcnt(0)
    v_mfma_f32_16x16x32_bf16 v[48:51], a[80:83], v[176:179], v[48:51]
    v_mfma_f32_16x16x32_bf16 v[52:55], a[80:83], v[180:183], v[52:55]
    v_mfma_f32_16x16x32_bf16 v[56:59], a[80:83], v[184:187], v[56:59]
    v_mfma_f32_16x16x32_bf16 v[60:63], a[80:83], v[188:191], v[60:63]
    v_mfma_f32_16x16x32_bf16 v[76:79], a[84:87], v[188:191], v[76:79]
    buffer_load_dwordx4 v[240:243], v112, s[8:11], s32 offen sc1
    buffer_load_dwordx4 v[244:247], v113, s[8:11], s32 offen sc1
    v_mfma_f32_16x16x32_bf16 v[72:75], a[84:87], v[184:187], v[72:75]
    buffer_load_dwordx4 v[248:251], v114, s[8:11], s32 offen sc1
    buffer_load_dwordx4 v[252:255], v115, s[8:11], s32 offen sc1
    v_mfma_f32_16x16x32_bf16 v[68:71], a[84:87], v[180:183], v[68:71]
    s_add_u32 s32, s32, 1024
    v_mfma_f32_16x16x32_bf16 v[64:67], a[84:87], v[176:179], v[64:67]
    s_and_b32 s32, s32, 0x7fff
    v_mfma_f32_16x16x32_bf16 v[80:83], a[88:91], v[176:179], v[80:83]
    v_mfma_f32_16x16x32_bf16 v[84:87], a[88:91], v[180:183], v[84:87]
    v_mfma_f32_16x16x32_bf16 v[88:91], a[88:91], v[184:187], v[88:91]
    v_mfma_f32_16x16x32_bf16 v[92:95], a[88:91], v[188:191], v[92:95]
    v_mfma_f32_16x16x32_bf16 v[108:111], a[92:95], v[188:191], v[108:111]
    v_mfma_f32_16x16x32_bf16 v[104:107], a[92:95], v[184:187], v[104:107]
    v_mfma_f32_16x16x32_bf16 v[100:103], a[92:95], v[180:183], v[100:103]
    v_mfma_f32_16x16x32_bf16 v[96:99], a[92:95], v[176:179], v[96:99]
    s_waitcnt vmcnt(12) lgkmcnt(0)
    v_mfma_f32_16x16x32_bf16 v[48:51], a[96:99], v[192:195], v[48:51]
    v_mfma_f32_16x16x32_bf16 v[52:55], a[96:99], v[196:199], v[52:55]
    v_mfma_f32_16x16x32_bf16 v[56:59], a[96:99], v[200:203], v[56:59]
    v_mfma_f32_16x16x32_bf16 v[60:63], a[96:99], v[204:207], v[60:63]
    v_mfma_f32_16x16x32_bf16 v[76:79], a[100:103], v[204:207], v[76:79]
    buffer_load_dwordx4 v[176:179], v112, s[8:11], s32 offen sc1
    buffer_load_dwordx4 v[180:183], v113, s[8:11], s32 offen sc1
    v_mfma_f32_16x16x32_bf16 v[72:75], a[100:103], v[200:203], v[72:75]
    buffer_load_dwordx4 v[184:187], v114, s[8:11], s32 offen sc1
    buffer_load_dwordx4 v[188:191], v115, s[8:11], s32 offen sc1
    v_mfma_f32_16x16x32_bf16 v[68:71], a[100:103], v[196:199], v[68:71]
    s_add_u32 s32, s32, 1024
    v_mfma_f32_16x16x32_bf16 v[64:67], a[100:103], v[192:195], v[64:67]
    s_and_b32 s32, s32, 0x7fff
    v_mfma_f32_16x16x32_bf16 v[80:83], a[104:107], v[192:195], v[80:83]
    v_mfma_f32_16x16x32_bf16 v[84:87], a[104:107], v[196:199], v[84:87]
    v_mfma_f32_16x16x32_bf16 v[88:91], a[104:107], v[200:203], v[88:91]
    v_mfma_f32_16x16x32_bf16 v[92:95], a[104:107], v[204:207], v[92:95]
    v_mfma_f32_16x16x32_bf16 v[108:111], a[108:111], v[204:207], v[108:111]
    v_mfma_f32_16x16x32_bf16 v[104:107], a[108:111], v[200:203], v[104:107]
    v_mfma_f32_16x16x32_bf16 v[100:103], a[108:111], v[196:199], v[100:103]
    v_mfma_f32_16x16x32_bf16 v[96:99], a[108:111], v[192:195], v[96:99]
    s_waitcnt vmcnt(12) lgkmcnt(0)
    v_mfma_f32_16x16x32_bf16 v[48:51], a[112:115], v[208:211], v[48:51]
    v_mfma_f32_16x16x32_bf16 v[52:55], a[112:115], v[212:215], v[52:55]
    v_mfma_f32_16x16x32_bf16 v[56:59], a[112:115], v[216:219], v[56:59]
    v_mfma_f32_16x16x32_bf16 v[60:63], a[112:115], v[220:223], v[60:63]
    v_mfma_f32_16x16x32_bf16 v[76:79], a[116:119], v[220:223], v[76:79]
    buffer_load_dwordx4 v[192:195], v112, s[8:11], s32 offen sc1
    buffer_load_dwordx4 v[196:199], v113, s[8:11], s32 offen sc1
    v_mfma_f32_16x16x32_bf16 v[72:75], a[116:119], v[216:219], v[72:75]
    buffer_load_dwordx4 v[200:203], v114, s[8:11], s32 offen sc1
    buffer_load_dwordx4 v[204:207], v115, s[8:11], s32 offen sc1
    v_mfma_f32_16x16x32_bf16 v[68:71], a[116:119], v[212:215], v[68:71]
    s_add_u32 s32, s32, 1024
    v_mfma_f32_16x16x32_bf16 v[64:67], a[116:119], v[208:211], v[64:67]
    s_and_b32 s32, s32, 0x7fff
    v_mfma_f32_16x16x32_bf16 v[80:83], a[120:123], v[208:211], v[80:83]
    v_mfma_f32_16x16x32_bf16 v[84:87], a[120:123], v[212:215], v[84:87]
    v_mfma_f32_16x16x32_bf16 v[88:91], a[120:123], v[216:219], v[88:91]
    v_mfma_f32_16x16x32_bf16 v[92:95], a[120:123], v[220:223], v[92:95]
    v_mfma_f32_16x16x32_bf16 v[108:111], a[124:127], v[220:223], v[108:111]
    v_mfma_f32_16x16x32_bf16 v[104:107], a[124:127], v[216:219], v[104:107]
    v_mfma_f32_16x16x32_bf16 v[100:103], a[124:127], v[212:215], v[100:103]
    v_mfma_f32_16x16x32_bf16 v[96:99], a[124:127], v[208:211], v[96:99]
    s_waitcnt vmcnt(12) lgkmcnt(0)
    v_mfma_f32_16x16x32_bf16 v[48:51], a[128:131], v[224:227], v[48:51]
    v_mfma_f32_16x16x32_bf16 v[52:55], a[128:131], v[228:231], v[52:55]
    v_mfma_f32_16x16x32_bf16 v[56:59], a[128:131], v[232:235], v[56:59]
    v_mfma_f32_16x16x32_bf16 v[60:63], a[128:131], v[236:239], v[60:63]
    v_mfma_f32_16x16x32_bf16 v[76:79], a[132:135], v[236:239], v[76:79]
    buffer_load_dwordx4 v[208:211], v112, s[8:11], s32 offen sc1
    buffer_load_dwordx4 v[212:215], v113, s[8:11], s32 offen sc1
    v_mfma_f32_16x16x32_bf16 v[72:75], a[132:135], v[232:235], v[72:75]
    buffer_load_dwordx4 v[216:219], v114, s[8:11], s32 offen sc1
    buffer_load_dwordx4 v[220:223], v115, s[8:11], s32 offen sc1
    v_mfma_f32_16x16x32_bf16 v[68:71], a[132:135], v[228:231], v[68:71]
    s_add_u32 s32, s32, 1024
    v_mfma_f32_16x16x32_bf16 v[64:67], a[132:135], v[224:227], v[64:67]
    s_and_b32 s32, s32, 0x7fff
    v_mfma_f32_16x16x32_bf16 v[80:83], a[136:139], v[224:227], v[80:83]
    v_mfma_f32_16x16x32_bf16 v[84:87], a[136:139], v[228:231], v[84:87]
    v_mfma_f32_16x16x32_bf16 v[88:91], a[136:139], v[232:235], v[88:91]
    v_mfma_f32_16x16x32_bf16 v[92:95], a[136:139], v[236:239], v[92:95]
    v_mfma_f32_16x16x32_bf16 v[108:111], a[140:143], v[236:239], v[108:111]
    v_mfma_f32_16x16x32_bf16 v[104:107], a[140:143], v[232:235], v[104:107]
    v_mfma_f32_16x16x32_bf16 v[100:103], a[140:143], v[228:231], v[100:103]
    v_mfma_f32_16x16x32_bf16 v[96:99], a[140:143], v[224:227], v[96:99]
    s_waitcnt vmcnt(12) lgkmcnt(0)
    v_mfma_f32_16x16x32_bf16 v[48:51], a[144:147], v[240:243], v[48:51]
    v_mfma_f32_16x16x32_bf16 v[52:55], a[144:147], v[244:247], v[52:55]
    v_mfma_f32_16x16x32_bf16 v[56:59], a[144:147], v[248:251], v[56:59]
    v_mfma_f32_16x16x32_bf16 v[60:63], a[144:147], v[252:255], v[60:63]
    buffer_load_dword v15, v3, s[28:31], s39 offen sc1
    v_mfma_f32_16x16x32_bf16 v[76:79], a[148:151], v[252:255], v[76:79]
    buffer_load_dwordx4 v[224:227], v112, s[8:11], s32 offen sc1
    buffer_load_dwordx4 v[228:231], v113, s[8:11], s32 offen sc1
    v_mfma_f32_16x16x32_bf16 v[72:75], a[148:151], v[248:251], v[72:75]
    buffer_load_dwordx4 v[232:235], v114, s[8:11], s32 offen sc1
    buffer_load_dwordx4 v[236:239], v115, s[8:11], s32 offen sc1
    v_mfma_f32_16x16x32_bf16 v[68:71], a[148:151], v[244:247], v[68:71]
    s_add_u32 s32, s32, 1024
    v_mfma_f32_16x16x32_bf16 v[64:67], a[148:151], v[240:243], v[64:67]
    s_and_b32 s32, s32, 0x7fff
    v_mfma_f32_16x16x32_bf16 v[80:83], a[152:155], v[240:243], v[80:83]
    v_mfma_f32_16x16x32_bf16 v[84:87], a[152:155], v[244:247], v[84:87]
    v_mfma_f32_16x16x32_bf16 v[88:91], a[152:155], v[248:251], v[88:91]
    v_mfma_f32_16x16x32_bf16 v[92:95], a[152:155], v[252:255], v[92:95]
    v_mfma_f32_16x16x32_bf16 v[108:111], a[156:159], v[252:255], v[108:111]
    v_mfma_f32_16x16x32_bf16 v[104:107], a[156:159], v[248:251], v[104:107]
    v_mfma_f32_16x16x32_bf16 v[100:103], a[156:159], v[244:247], v[100:103]
    v_mfma_f32_16x16x32_bf16 v[96:99], a[156:159], v[240:243], v[96:99]
    s_waitcnt vmcnt(13) lgkmcnt(0)
    v_mfma_f32_16x16x32_bf16 v[48:51], a[160:163], v[176:179], v[48:51]
    v_mfma_f32_16x16x32_bf16 v[52:55], a[160:163], v[180:183], v[52:55]
    v_mfma_f32_16x16x32_bf16 v[56:59], a[160:163], v[184:187], v[56:59]
    v_mfma_f32_16x16x32_bf16 v[60:63], a[160:163], v[188:191], v[60:63]
    v_mfma_f32_16x16x32_bf16 v[76:79], a[164:167], v[188:191], v[76:79]
    buffer_load_dwordx4 v[240:243], v112, s[8:11], s32 offen sc1
    buffer_load_dwordx4 v[244:247], v113, s[8:11], s32 offen sc1
    v_mfma_f32_16x16x32_bf16 v[72:75], a[164:167], v[184:187], v[72:75]
    buffer_load_dwordx4 v[248:251], v114, s[8:11], s32 offen sc1
    buffer_load_dwordx4 v[252:255], v115, s[8:11], s32 offen sc1
    v_mfma_f32_16x16x32_bf16 v[68:71], a[164:167], v[180:183], v[68:71]
    s_add_u32 s32, s32, 1024
    v_mfma_f32_16x16x32_bf16 v[64:67], a[164:167], v[176:179], v[64:67]
    s_and_b32 s32, s32, 0x7fff
    v_mfma_f32_16x16x32_bf16 v[80:83], a[168:171], v[176:179], v[80:83]
    v_mfma_f32_16x16x32_bf16 v[84:87], a[168:171], v[180:183], v[84:87]
    v_mfma_f32_16x16x32_bf16 v[88:91], a[168:171], v[184:187], v[88:91]
    v_mfma_f32_16x16x32_bf16 v[92:95], a[168:171], v[188:191], v[92:95]
    v_mfma_f32_16x16x32_bf16 v[108:111], a[172:175], v[188:191], v[108:111]
    v_mfma_f32_16x16x32_bf16 v[104:107], a[172:175], v[184:187], v[104:107]
    v_mfma_f32_16x16x32_bf16 v[100:103], a[172:175], v[180:183], v[100:103]
    v_mfma_f32_16x16x32_bf16 v[96:99], a[172:175], v[176:179], v[96:99]
    s_waitcnt vmcnt(13) lgkmcnt(0)
    v_mfma_f32_16x16x32_bf16 v[48:51], a[176:179], v[192:195], v[48:51]
    v_mfma_f32_16x16x32_bf16 v[52:55], a[176:179], v[196:199], v[52:55]
    v_mfma_f32_16x16x32_bf16 v[56:59], a[176:179], v[200:203], v[56:59]
    v_mfma_f32_16x16x32_bf16 v[60:63], a[176:179], v[204:207], v[60:63]
    v_mfma_f32_16x16x32_bf16 v[76:79], a[180:183], v[204:207], v[76:79]
    buffer_load_dwordx4 v[176:179], v112, s[8:11], s32 offen sc1
    buffer_load_dwordx4 v[180:183], v113, s[8:11], s32 offen sc1
    v_mfma_f32_16x16x32_bf16 v[72:75], a[180:183], v[200:203], v[72:75]
    buffer_load_dwordx4 v[184:187], v114, s[8:11], s32 offen sc1
    buffer_load_dwordx4 v[188:191], v115, s[8:11], s32 offen sc1
    v_mfma_f32_16x16x32_bf16 v[68:71], a[180:183], v[196:199], v[68:71]
    s_add_u32 s32, s32, 1024
    v_mfma_f32_16x16x32_bf16 v[64:67], a[180:183], v[192:195], v[64:67]
    s_and_b32 s32, s32, 0x7fff
    v_mfma_f32_16x16x32_bf16 v[80:83], a[184:187], v[192:195], v[80:83]
    v_mfma_f32_16x16x32_bf16 v[84:87], a[184:187], v[196:199], v[84:87]
    v_mfma_f32_16x16x32_bf16 v[88:91], a[184:187], v[200:203], v[88:91]
    v_mfma_f32_16x16x32_bf16 v[92:95], a[184:187], v[204:207], v[92:95]
    v_mfma_f32_16x16x32_bf16 v[108:111], a[188:191], v[204:207], v[108:111]
    v_mfma_f32_16x16x32_bf16 v[104:107], a[188:191], v[200:203], v[104:107]
    v_mfma_f32_16x16x32_bf16 v[100:103], a[188:191], v[196:199], v[100:103]
    v_mfma_f32_16x16x32_bf16 v[96:99], a[188:191], v[192:195], v[96:99]
    s_waitcnt vmcnt(13) lgkmcnt(0)
    v_mfma_f32_16x16x32_bf16 v[48:51], a[192:195], v[208:211], v[48:51]
    v_mfma_f32_16x16x32_bf16 v[52:55], a[192:195], v[212:215], v[52:55]
    v_mfma_f32_16x16x32_bf16 v[56:59], a[192:195], v[216:219], v[56:59]
    s_waitcnt vmcnt(12)
    v_cmp_ne_u32 vcc, s7, v15
    s_and_b32 s3, vcc_lo, 0xf00
    s_cbranch_scc1 L3_cP12
L3_cP12_r:
    v_mfma_f32_16x16x32_bf16 v[60:63], a[192:195], v[220:223], v[60:63]
    v_mfma_f32_16x16x32_bf16 v[76:79], a[196:199], v[220:223], v[76:79]
    buffer_load_dwordx4 v[192:195], v112, s[8:11], s32 offen sc1
    buffer_load_dwordx4 v[196:199], v113, s[8:11], s32 offen sc1
    v_mfma_f32_16x16x32_bf16 v[72:75], a[196:199], v[216:219], v[72:75]
    buffer_load_dwordx4 v[200:203], v114, s[8:11], s32 offen sc1
    buffer_load_dwordx4 v[204:207], v115, s[8:11], s32 offen sc1
    v_mfma_f32_16x16x32_bf16 v[68:71], a[196:199], v[212:215], v[68:71]
    s_add_u32 s32, s32, 1024
    v_mfma_f32_16x16x32_bf16 v[64:67], a[196:199], v[208:211], v[64:67]
    s_and_b32 s32, s32, 0x7fff
    v_mfma_f32_16x16x32_bf16 v[80:83], a[200:203], v[208:211], v[80:83]
    v_mfma_f32_16x16x32_bf16 v[84:87], a[200:203], v[212:215], v[84:87]
    v_mfma_f32_16x16x32_bf16 v[88:91], a[200:203], v[216:219], v[88:91]
    v_mfma_f32_16x16x32_bf16 v[92:95], a[200:203], v[220:223], v[92:95]
    v_mfma_f32_16x16x32_bf16 v[108:111], a[204:207], v[220:223], v[108:111]
    v_mfma_f32_16x16x32_bf16 v[104:107], a[204:207], v[216:219], v[104:107]
    v_mfma_f32_16x16x32_bf16 v[100:103], a[204:207], v[212:215], v[100:103]
    v_mfma_f32_16x16x32_bf16 v[96:99], a[204:207], v[208:211], v[96:99]
    s_waitcnt vmcnt(12) lgkmcnt(0)
    v_mfma_f32_16x16x32_bf16 v[48:51], a[208:211], v[224:227], v[48:51]
    v_mfma_f32_16x16x32_bf16 v[52:55], a[208:211], v[228:231], v[52:55]
    v_mfma_f32_16x16x32_bf16 v[56:59], a[208:211], v[232:235], v[56:59]
    v_mfma_f32_16x16x32_bf16 v[60:63], a[208:211], v[236:239], v[60:63]
    v_mfma_f32_16x16x32_bf16 v[76:79], a[212:215], v[236:239], v[76:79]
    buffer_load_dwordx4 v[208:211], v112, s[8:11], s32 offen sc1
    buffer_load_dwordx4 v[212:215], v113, s[8:11], s32 offen sc1
    v_mfma_f32_16x16x32_bf16 v[72:75], a[212:215], v[232:235], v[72:75]
    buffer_load_dwordx4 v[216:219], v114, s[8:11], s32 offen sc1
    buffer_load_dwordx4 v[220:223], v115, s[8:11], s32 offen sc1
    v_mfma_f32_16x16x32_bf16 v[68:71], a[212:215], v[228:231], v[68:71]
    s_add_u32 s32, s32, 1024
    v_mfma_f32_16x16x32_bf16 v[64:67], a[212:215], v[224:227], v[64:67]
    s_and_b32 s32, s32, 0x7fff
    v_mfma_f32_16x16x32_bf16 v[80:83], a[216:219], v[224:227], v[80:83]
    v_mfma_f32_16x16x32_bf16 v[84:87], a[216:219], v[228:231], v[84:87]
    v_mfma_f32_16x16x32_bf16 v[88:91], a[216:219], v[232:235], v[88:91]
    v_mfma_f32_16x16x32_bf16 v[92:95], a[216:219], v[236:239], v[92:95]
    v_mfma_f32_16x16x32_bf16 v[108:111], a[220:223], v[236:239], v[108:111]
    v_mfma_f32_16x16x32_bf16 v[104:107], a[220:223], v[232:235], v[104:107]
    v_mfma_f32_16x16x32_bf16 v[100:103], a[220:223], v[228:231], v[100:103]
    v_mfma_f32_16x16x32_bf16 v[96:99], a[220:223], v[224:227], v[96:99]
    s_waitcnt vmcnt(12) lgkmcnt(0)
    v_mfma_f32_16x16x32_bf16 v[48:51], a[224:227], v[240:243], v[48:51]
    s_waitcnt vmcnt(63)
    ds_read_b64_tr_b16 v[32:33], v8 offset:20480
    ds_read_b64_tr_b16 v[34:35], v8 offset:22528
    v_mfma_f32_16x16x32_bf16 v[52:55], a[224:227], v[244:247], v[52:55]
    ds_read_b64_tr_b16 v[36:37], v9 offset:20480
    ds_read_b64_tr_b16 v[38:39], v9 offset:22528
    v_mfma_f32_16x16x32_bf16 v[56:59], a[224:227], v[248:251], v[56:59]
    ds_read_b64_tr_b16 v[40:41], v10 offset:20480
    ds_read_b64_tr_b16 v[42:43], v10 offset:22528
    v_mfma_f32_16x16x32_bf16 v[60:63], a[224:227], v[252:255], v[60:63]
    ds_read_b64_tr_b16 v[44:45], v11 offset:20480
    ds_read_b64_tr_b16 v[46:47], v11 offset:22528
    v_mfma_f32_16x16x32_bf16 v[76:79], a[228:231], v[252:255], v[76:79]
    buffer_load_dwordx4 v[224:227], v112, s[8:11], s32 offen sc1
    buffer_load_dwordx4 v[228:231], v113, s[8:11], s32 offen sc1
    v_mfma_f32_16x16x32_bf16 v[72:75], a[228:231], v[248:251], v[72:75]
    buffer_load_dwordx4 v[232:235], v114, s[8:11], s32 offen sc1
    buffer_load_dwordx4 v[236:239], v115, s[8:11], s32 offen sc1
    v_mfma_f32_16x16x32_bf16 v[68:71], a[228:231], v[244:247], v[68:71]
    s_add_u32 s32, s32, 1024
    v_mfma_f32_16x16x32_bf16 v[64:67], a[228:231], v[240:243], v[64:67]
    s_and_b32 s32, s32, 0x7fff
    v_mfma_f32_16x16x32_bf16 v[80:83], a[232:235], v[240:243], v[80:83]
    v_mfma_f32_16x16x32_bf16 v[84:87], a[232:235], v[244:247], v[84:87]
    v_mfma_f32_16x16x32_bf16 v[88:91], a[232:235], v[248:251], v[88:91]
    v_mfma_f32_16x16x32_bf16 v[92:95], a[232:235], v[252:255], v[92:95]
    v_mfma_f32_16x16x32_bf16 v[108:111], a[236:239], v[252:255], v[108:111]
    v_mfma_f32_16x16x32_bf16 v[104:107], a[236:239], v[248:251], v[104:107]
    v_mfma_f32_16x16x32_bf16 v[100:103], a[236:239], v[244:247], v[100:103]
    v_mfma_f32_16x16x32_bf16 v[96:99], a[236:239], v[240:243], v[96:99]
    s_waitcnt vmcnt(12) lgkmcnt(0)
    v_mfma_f32_16x16x32_bf16 v[48:51], v[32:35], v[176:179], v[48:51]
    s_waitcnt vmcnt(63)
    ds_read_b64_tr_b16 v[16:17], v8 offset:24576
    ds_read_b64_tr_b16 v[18:19], v8 offset:26624
    v_mfma_f32_16x16x32_bf16 v[52:55], v[32:35], v[180:183], v[52:55]
    ds_read_b64_tr_b16 v[20:21], v9 offset:24576
    ds_read_b64_tr_b16 v[22:23], v9 offset:26624
    v_mfma_f32_16x16x32_bf16 v[56:59], v[32:35], v[184:187], v[56:59]
    ds_read_b64_tr_b16 v[24:25], v10 offset:24576
    ds_read_b64_tr_b16 v[26:27], v10 offset:26624
    v_mfma_f32_16x16x32_bf16 v[60:63], v[32:35], v[188:191], v[60:63]
    ds_read_b64_tr_b16 v[28:29], v11 offset:24576
    ds_read_b64_tr_b16 v[30:31], v11 offset:26624
    v_mfma_f32_16x16x32_bf16 v[76:79], v[36:39], v[188:191], v[76:79]
    buffer_load_dwordx4 v[240:243], v112, s[8:11], s32 offen sc1
    buffer_load_dwordx4 v[244:247], v113, s[8:11], s32 offen sc1
    v_mfma_f32_16x16x32_bf16 v[72:75], v[36:39], v[184:187], v[72:75]
    buffer_load_dwordx4 v[248:251], v114, s[8:11], s32 offen sc1
    buffer_load_dwordx4 v[252:255], v115, s[8:11], s32 offen sc1
    v_mfma_f32_16x16x32_bf16 v[68:71], v[36:39], v[180:183], v[68:71]
    s_add_u32 s32, s32, 1024
    v_mfma_f32_16x16x32_bf16 v[64:67], v[36:39], v[176:179], v[64:67]
    s_and_b32 s32, s32, 0x7fff
    s_add_u32 m0, s37, 20480
    v_mfma_f32_16x16x32_bf16 v[80:83], v[40:43], v[176:179], v[80:83]
    s_nop 0
    v_mfma_f32_16x16x32_bf16 v[84:87], v[40:43], v[180:183], v[84:87]
    buffer_load_dwordx4 v4, s[16:19], s36 offen offset:0 lds
    buffer_load_dwordx4 v5, s[16:19], s36 offen offset:1024 lds
    v_mfma_f32_16x16x32_bf16 v[88:91], v[40:43], v[184:187], v[88:91]
    buffer_load_dwordx4 v6, s[16:19], s36 offen offset:2048 lds
    v_mfma_f32_16x16x32_bf16 v[92:95], v[40:43], v[188:191], v[92:95]
    buffer_load_dwordx4 v7, s[16:19], s36 offen offset:3072 lds
    s_add_u32 s33, s33, 1024
    v_mfma_f32_16x16x32_bf16 v[108:111], v[44:47], v[188:191], v[108:111]
    s_and_b32 s33, s33, 0x7fff
    v_mfma_f32_16x16x32_bf16 v[104:107], v[44:47], v[184:187], v[104:107]
    s_mul_i32 s36, s33, 28
    v_mfma_f32_16x16x32_bf16 v[100:103], v[44:47], v[180:183], v[100:103]
    v_mfma_f32_16x16x32_bf16 v[96:99], v[44:47], v[176:179], v[96:99]
    s_waitcnt vmcnt(16) lgkmcnt(0)
    v_mfma_f32_16x16x32_bf16 v[48:51], v[16:19], v[192:195], v[48:51]
    s_waitcnt vmcnt(63)
    ds_read_b64_tr_b16 v[32:33], v8 offset:28672
    ds_read_b64_tr_b16 v[34:35], v8 offset:30720
    v_mfma_f32_16x16x32_bf16 v[52:55], v[16:19], v[196:199], v[52:55]
    ds_read_b64_tr_b16 v[36:37], v9 offset:28672
    ds_read_b64_tr_b16 v[38:39], v9 offset:30720
    v_mfma_f32_16x16x32_bf16 v[56:59], v[16:19], v[200:203], v[56:59]
    ds_read_b64_tr_b16 v[40:41], v10 offset:28672
    ds_read_b64_tr_b16 v[42:43], v10 offset:30720
    v_mfma_f32_16x16x32_bf16 v[60:63], v[16:19], v[204:207], v[60:63]
    ds_read_b64_tr_b16 v[44:45], v11 offset:28672
    ds_read_b64_tr_b16 v[46:47], v11 offset:30720
    v_mfma_f32_16x16x32_bf16 v[76:79], v[20:23], v[204:207], v[76:79]
    buffer_load_dwordx4 v[176:179], v112, s[8:11], s32 offen sc1
    buffer_load_dwordx4 v[180:183], v113, s[8:11], s32 offen sc1
    v_mfma_f32_16x16x32_bf16 v[72:75], v[20:23], v[200:203], v[72:75]
    buffer_load_dwordx4 v[184:187], v114, s[8:11], s32 offen sc1
    buffer_load_dwordx4 v[188:191], v115, s[8:11], s32 offen sc1
    v_mfma_f32_16x16x32_bf16 v[68:71], v[20:23], v[196:199], v[68:71]
    s_add_u32 s32, s32, 1024
    v_mfma_f32_16x16x32_bf16 v[64:67], v[20:23], v[192:195], v[64:67]
    s_and_b32 s32, s32, 0x7fff
    s_add_u32 m0, s37, 24576
    v_mfma_f32_16x16x32_bf16 v[80:83], v[24:27], v[192:195], v[80:83]
    s_nop 0
    v_mfma_f32_16x16x32_bf16 v[84:87], v[24:27], v[196:199], v[84:87]
    buffer_load_dwordx4 v4, s[16:19], s36 offen offset:0 lds
    buffer_load_dwordx4 v5, s[16:19], s36 offen offset:1024 lds
    v_mfma_f32_16x16x32_bf16 v[88:91], v[24:27], v[200:203], v[88:91]
    buffer_load_dwordx4 v6, s[16:19], s36 offen offset:2048 lds
    v_mfma_f32_16x16x32_bf16 v[92:95], v[24:27], v[204:207], v[92:95]
    buffer_load_dwordx4 v7, s[16:19], s36 offen offset:3072 lds
    s_add_u32 s33, s33, 1024
    v_mfma_f32_16x16x32_bf16 v[108:111], v[28:31], v[204:207], v[108:111]
    s_and_b32 s33, s33, 0x7fff
    v_mfma_f32_16x16x32_bf16 v[104:107], v[28:31], v[200:203], v[104:107]
    s_mul_i32 s36, s33, 28
    v_mfma_f32_16x16x32_bf16 v[100:103], v[28:31], v[196:199], v[100:103]
    v_mfma_f32_16x16x32_bf16 v[96:99], v[28:31], v[192:195], v[96:99]
    s_waitcnt vmcnt(20) lgkmcnt(0)
    v_mfma_f32_16x16x32_bf16 v[48:51], v[32:35], v[208:211], v[48:51]
    s_waitcnt vmcnt(63)
    ds_read_b64_tr_b16 v[16:17], v8 offset:32768
    ds_read_b64_tr_b16 v[18:19], v8 offset:34816
    v_mfma_f32_16x16x32_bf16 v[52:55], v[32:35], v[212:215], v[52:55]
    ds_read_b64_tr_b16 v[20:21], v9 offset:32768
    ds_read_b64_tr_b16 v[22:23], v9 offset:34816
    v_mfma_f32_16x16x32_bf16 v[56:59], v[32:35], v[216:219], v[56:59]
    ds_read_b64_tr_b16 v[24:25], v10 offset:32768
    ds_read_b64_tr_b16 v[26:27], v10 offset:34816
    v_mfma_f32_16x16x32_bf16 v[60:63], v[32:35], v[220:223], v[60:63]
    ds_read_b64_tr_b16 v[28:29], v11 offset:32768
    ds_read_b64_tr_b16 v[30:31], v11 offset:34816
    buffer_load_dword v15, v3, s[28:31], s39 offen sc1
    v_mfma_f32_16x16x32_bf16 v[76:79], v[36:39], v[220:223], v[76:79]
    buffer_load_dwordx4 v[192:195], v112, s[8:11], s32 offen sc1
    buffer_load_dwordx4 v[196:199], v113, s[8:11], s32 offen sc1
    v_mfma_f32_16x16x32_bf16 v[72:75], v[36:39], v[216:219], v[72:75]
    buffer_load_dwordx4 v[200:203], v114, s[8:11], s32 offen sc1
    buffer_load_dwordx4 v[204:207], v115, s[8:11], s32 offen sc1
    v_mfma_f32_16x16x32_bf16 v[68:71], v[36:39], v[212:215], v[68:71]
    s_add_u32 s32, s32, 1024
    v_mfma_f32_16x16x32_bf16 v[64:67], v[36:39], v[208:211], v[64:67]
    s_and_b32 s32, s32, 0x7fff
    s_add_u32 m0, s37, 28672
    v_mfma_f32_16x16x32_bf16 v[80:83], v[40:43], v[208:211], v[80:83]
    s_nop 0
    v_mfma_f32_16x16x32_bf16 v[84:87], v[40:43], v[212:215], v[84:87]
    buffer_load_dwordx4 v4, s[16:19], s36 offen offset:0 lds
    buffer_load_dwordx4 v5, s[16:19], s36 offen offset:1024 lds
    v_mfma_f32_16x16x32_bf16 v[88:91], v[40:43], v[216:219], v[88:91]
    buffer_load_dwordx4 v6, s[16:19], s36 offen offset:2048 lds
    v_mfma_f32_16x16x32_bf16 v[92:95], v[40:43], v[220:223], v[92:95]
    buffer_load_dwordx4 v7, s[16:19], s36 offen offset:3072 lds
    s_add_u32 s33, s33, 1024
    v_mfma_f32_16x16x32_bf16 v[108:111], v[44:47], v[220:223], v[108:111]
    s_and_b32 s33, s33, 0x7fff
    v_mfma_f32_16x16x32_bf16 v[104:107], v[44:47], v[216:219], v[104:107]
    s_mul_i32 s36, s33, 28
    v_mfma_f32_16x16x32_bf16 v[100:103], v[44:47], v[212:215], v[100:103]
    v_mfma_f32_16x16x32_bf16 v[96:99], v[44:47], v[208:211], v[96:99]
    s_waitcnt vmcnt(25) lgkmcnt(0)
    v_mfma_f32_16x16x32_bf16 v[48:51], v[16:19], v[224:227], v[48:51]
    s_waitcnt vmcnt(63)
    ds_read_b64_tr_b16 v[32:33], v8 offset:36864
    ds_read_b64_tr_b16 v[34:35], v8 offset:38912
    v_mfma_f32_16x16x32_bf16 v[52:55], v[16:19], v[228:231], v[52:55]
    ds_read_b64_tr_b16 v[36:37], v9 offset:36864
    ds_read_b64_tr_b16 v[38:39], v9 offset:38912
    v_mfma_f32_16x16x32_bf16 v[56:59], v[16:19], v[232:235], v[56:59]
    ds_read_b64_tr_b16 v[40:41], v10 offset:36864
    ds_read_b64_tr_b16 v[42:43], v10 offset:38912
    v_mfma_f32_16x16x32_bf16 v[60:63], v[16:19], v[236:239], v[60:63]
    ds_read_b64_tr_b16 v[44:45], v11 offset:36864
    ds_read_b64_tr_b16 v[46:47], v11 offset:38912
    v_mfma_f32_16x16x32_bf16 v[76:79], v[20:23], v[236:239], v[76:79]
    buffer_load_dwordx4 v[208:211], v112, s[8:11], s32 offen sc1
    buffer_load_dwordx4 v[212:215], v113, s[8:11], s32 offen sc1
    v_mfma_f32_16x16x32_bf16 v[72:75], v[20:23], v[232:235], v[72:75]
    buffer_load_dwordx4 v[216:219], v114, s[8:11], s32 offen sc1
    buffer_load_dwordx4 v[220:223], v115, s[8:11], s32 offen sc1
    v_mfma_f32_16x16x32_bf16 v[68:71], v[20:23], v[228:231], v[68:71]
    s_add_u32 s32, s32, 1024
    v_mfma_f32_16x16x32_bf16 v[64:67], v[20:23], v[224:227], v[64:67]
    s_and_b32 s32, s32, 0x7fff
    s_add_u32 m0, s37, 32768
    v_mfma_f32_16x16x32_bf16 v[80:83], v[24:27], v[224:227], v[80:83]
    s_nop 0
    v_mfma_f32_16x16x32_bf16 v[84:87], v[24:27], v[228:231], v[84:87]
    buffer_load_dwordx4 v4, s[16:19], s36 offen offset:0 lds
    buffer_load_dwordx4 v5, s[16:19], s36 offen offset:1024 lds
    v_mfma_f32_16x16x32_bf16 v[88:91], v[24:27], v[232:235], v[88:91]
    buffer_load_dwordx4 v6, s[16:19], s36 offen offset:2048 lds
    v_mfma_f32_16x16x32_bf16 v[92:95], v[24:27], v[236:239], v[92:95]
    buffer_load_dwordx4 v7, s[16:19], s36 offen offset:3072 lds
    s_add_u32 s33, s33, 1024
    v_mfma_f32_16x16x32_bf16 v[108:111], v[28:31], v[236:239], v[108:111]
    s_and_b32 s33, s33, 0x7fff
    v_mfma_f32_16x16x32_bf16 v[104:107], v[28:31], v[232:235], v[104:107]
    s_mul_i32 s36, s33, 28
    v_mfma_f32_16x16x32_bf16 v[100:103], v[28:31], v[228:231], v[100:103]
    v_mfma_f32_16x16x32_bf16 v[96:99], v[28:31], v[224:227], v[96:99]
    s_waitcnt vmcnt(29) lgkmcnt(0)
    v_mfma_f32_16x16x32_bf16 v[48:51], v[32:35], v[240:243], v[48:51]
    s_waitcnt vmcnt(63)
    ds_read_b64_tr_b16 v[16:17], v8 offset:0
    ds_read_b64_tr_b16 v[18:19], v8 offset:2048
    v_mfma_f32_16x16x32_bf16 v[52:55], v[32:35], v[244:247], v[52:55]
    ds_read_b64_tr_b16 v[20:21], v9 offset:0
    ds_read_b64_tr_b16 v[22:23], v9 offset:2048
    v_mfma_f32_16x16x32_bf16 v[56:59], v[32:35], v[248:251], v[56:59]
    ds_read_b64_tr_b16 v[24:25], v10 offset:0
    ds_read_b64_tr_b16 v[26:27], v10 offset:2048
    v_mfma_f32_16x16x32_bf16 v[60:63], v[32:35], v[252:255], v[60:63]
    ds_read_b64_tr_b16 v[28:29], v11 offset:0
    ds_read_b64_tr_b16 v[30:31], v11 offset:2048
    v_mfma_f32_16x16x32_bf16 v[76:79], v[36:39], v[252:255], v[76:79]
    buffer_load_dwordx4 v[224:227], v112, s[8:11], s32 offen sc1
    buffer_load_dwordx4 v[228:231], v113, s[8:11], s32 offen sc1
    v_mfma_f32_16x16x32_bf16 v[72:75], v[36:39], v[248:251], v[72:75]
    buffer_load_dwordx4 v[232:235], v114, s[8:11], s32 offen sc1
    buffer_load_dwordx4 v[236:239], v115, s[8:11], s32 offen sc1
    v_mfma_f32_16x16x32_bf16 v[68:71], v[36:39], v[244:247], v[68:71]
    s_add_u32 s32, s32, 1024
    v_mfma_f32_16x16x32_bf16 v[64:67], v[36:39], v[240:243], v[64:67]
    s_and_b32 s32, s32, 0x7fff
    s_add_u32 m0, s37, 36864
    v_mfma_f32_16x16x32_bf16 v[80:83], v[40:43], v[240:243], v[80:83]
    s_nop 0
    v_mfma_f32_16x16x32_bf16 v[84:87], v[40:43], v[244:247], v[84:87]
    buffer_load_dwordx4 v4, s[16:19], s36 offen offset:0 lds
    buffer_load_dwordx4 v5, s[16:19], s36 offen offset:1024 lds
    v_mfma_f32_16x16x32_bf16 v[88:91], v[40:43], v[248:251], v[88:91]
    buffer_load_dwordx4 v6, s[16:19], s36 offen offset:2048 lds
    v_mfma_f32_16x16x32_bf16 v[92:95], v[40:43], v[252:255], v[92:95]
    buffer_load_dwordx4 v7, s[16:19], s36 offen offset:3072 lds
    s_add_u32 s33, s33, 1024
    v_mfma_f32_16x16x32_bf16 v[108:111], v[44:47], v[252:255], v[108:111]
    s_and_b32 s33, s33, 0x7fff
    v_mfma_f32_16x16x32_bf16 v[104:107], v[44:47], v[248:251], v[104:107]
    s_mul_i32 s36, s33, 28
    v_mfma_f32_16x16x32_bf16 v[100:103], v[44:47], v[244:247], v[100:103]
    v_mfma_f32_16x16x32_bf16 v[96:99], v[44:47], v[240:243], v[96:99]
    s_waitcnt vmcnt(29) lgkmcnt(0)
    v_mfma_f32_16x16x32_bf16 v[48:51], v[16:19], v[176:179], v[48:51]
    s_waitcnt vmcnt(63)
    ds_read_b64_tr_b16 v[32:33], v8 offset:4096
    ds_read_b64_tr_b16 v[34:35], v8 offset:6144
    v_mfma_f32_16x16x32_bf16 v[52:55], v[16:19], v[180:183], v[52:55]
    ds_read_b64_tr_b16 v[36:37], v9 offset:4096
    ds_read_b64_tr_b16 v[38:39], v9 offset:6144
    v_mfma_f32_16x16x32_bf16 v[56:59], v[16:19], v[184:187], v[56:59]
    ds_read_b64_tr_b16 v[40:41], v10 offset:4096
    ds_read_b64_tr_b16 v[42:43], v10 offset:6144
    s_waitcnt vmcnt(24)
    v_cmp_ne_u32 vcc, s7, v15
    s_and_b32 s3, vcc_lo, 0xf000
    s_cbranch_scc1 L3_cP20
L3_cP20_r:
    v_mfma_f32_16x16x32_bf16 v[60:63], v[16:19], v[188:191], v[60:63]
    ds_read_b64_tr_b16 v[44:45], v11 offset:4096
    ds_read_b64_tr_b16 v[46:47], v11 offset:6144
    v_mfma_f32_16x16x32_bf16 v[76:79], v[20:23], v[188:191], v[76:79]
    buffer_load_dwordx4 v[240:243], v112, s[8:11], s32 offen sc1
    buffer_load_dwordx4 v[244:247], v113, s[8:11], s32 offen sc1
    v_mfma_f32_16x16x32_bf16 v[72:75], v[20:23], v[184:187], v[72:75]
    buffer_load_dwordx4 v[248:251], v114, s[8:11], s32 offen sc1
    buffer_load_dwordx4 v[252:255], v115, s[8:11], s32 offen sc1
    v_mfma_f32_16x16x32_bf16 v[68:71], v[20:23], v[180:183], v[68:71]
    s_add_u32 s32, s32, 1024
    v_mfma_f32_16x16x32_bf16 v[64:67], v[20:23], v[176:179], v[64:67]
    s_and_b32 s32, s32, 0x7fff
    s_add_u32 m0, s37, 0
    v_mfma_f32_16x16x32_bf16 v[80:83], v[24:27], v[176:179], v[80:83]
    s_nop 0
    v_mfma_f32_16x16x32_bf16 v[84:87], v[24:27], v[180:183], v[84:87]
    buffer_load_dwordx4 v4, s[16:19], s36 offen offset:0 lds
    buffer_load_dwordx4 v5, s[16:19], s36 offen offset:1024 lds
    v_mfma_f32_16x16x32_bf16 v[88:91], v[24:27], v[184:187], v[88:91]
    buffer_load_dwordx4 v6, s[16:19], s36 offen offset:2048 lds
    v_mfma_f32_16x16x32_bf16 v[92:95], v[24:27], v[188:191], v[92:95]
    buffer_load_dwordx4 v7, s[16:19], s36 offen offset:3072 lds
    s_add_u32 s33, s33, 1024
    v_mfma_f32_16x16x32_bf16 v[108:111], v[28:31], v[188:191], v[108:111]
    s_and_b32 s33, s33, 0x7fff
    v_mfma_f32_16x16x32_bf16 v[104:107], v[28:31], v[184:187], v[104:107]
    s_mul_i32 s36, s33, 28
    v_mfma_f32_16x16x32_bf16 v[100:103], v[28:31], v[180:183], v[100:103]
    v_mfma_f32_16x16x32_bf16 v[96:99], v[28:31], v[176:179], v[96:99]
    s_getpc_b64 s[40:41]
    s_add_u32 s40, s40, L4_entry@rel32@lo+4
    s_addc_u32 s41, s41, L4_entry@rel32@hi+12
    s_mul_i32 s3, s74, (((L_hot_end-L4_entry)/28+63)&~63)
    s_add_u32 s40, s40, s3
    s_addc_u32 s41, s41, 0
    s_sub_u32 s42, L_hot_end-L4_entry, s3
    s_cselect_b32 s42, 0, s42
    s_min_u32 s42, s42, (((L_hot_end-L4_entry)/28+63)&~63)
    s_mov_b32 s43, 0x20000
    v_lshlrev_b32 v12, 6, v0
    buffer_load_dword v120, v12, s[40:43], 0 offen
    s_waitcnt vmcnt(29) lgkmcnt(0)
    v_mfma_f32_16x16x32_bf16 v[48:51], v[32:35], v[192:195], v[48:51]
    s_waitcnt vmcnt(63)
    ds_read_b64_tr_b16 v[16:17], v8 offset:8192
    ds_read_b64_tr_b16 v[18:19], v8 offset:10240
    v_mfma_f32_16x16x32_bf16 v[52:55], v[32:35], v[196:199], v[52:55]
    ds_read_b64_tr_b16 v[20:21], v9 offset:8192
    ds_read_b64_tr_b16 v[22:23], v9 offset:10240
    v_mfma_f32_16x16x32_bf16 v[56:59], v[32:35], v[200:203], v[56:59]
    ds_read_b64_tr_b16 v[24:25], v10 offset:8192
    ds_read_b64_tr_b16 v[26:27], v10 offset:10240
    v_mfma_f32_16x16x32_bf16 v[60:63], v[32:35], v[204:207], v[60:63]
    ds_read_b64_tr_b16 v[28:29], v11 offset:8192
    ds_read_b64_tr_b16 v[30:31], v11 offset:10240
    v_mfma_f32_16x16x32_bf16 v[76:79], v[36:39], v[204:207], v[76:79]
    buffer_load_dwordx4 v[176:179], v112, s[8:11], s32 offen sc1
    buffer_load_dwordx4 v[180:183], v113, s[8:11], s32 offen sc1
    v_mfma_f32_16x16x32_bf16 v[72:75], v[36:39], v[200:203], v[72:75]
    buffer_load_dwordx4 v[184:187], v114, s[8:11], s32 offen sc1
    buffer_load_dwordx4 v[188:191], v115, s[8:11], s32 offen sc1
    v_mfma_f32_16x16x32_bf16 v[68:71], v[36:39], v[196:199], v[68:71]
    s_add_u32 s32, s32, 1024
    v_mfma_f32_16x16x32_bf16 v[64:67], v[36:39], v[192:195], v[64:67]
    s_and_b32 s32, s32, 0x7fff
    s_add_u32 m0, s37, 4096
    v_mfma_f32_16x16x32_bf16 v[80:83], v[40:43], v[192:195], v[80:83]
    s_nop 0
    v_mfma_f32_16x16x32_bf16 v[84:87], v[40:43], v[196:199], v[84:87]
    buffer_load_dwordx4 v4, s[16:19], s36 offen offset:0 lds
    buffer_load_dwordx4 v5, s[16:19], s36 offen offset:1024 lds
    v_mfma_f32_16x16x32_bf16 v[88:91], v[40:43], v[200:203], v[88:91]
    buffer_load_dwordx4 v6, s[16:19], s36 offen offset:2048 lds
    v_mfma_f32_16x16x32_bf16 v[92:95], v[40:43], v[204:207], v[92:95]
    buffer_load_dwordx4 v7, s[16:19], s36 offen offset:3072 lds
    s_add_u32 s33, s33, 1024
    v_mfma_f32_16x16x32_bf16 v[108:111], v[44:47], v[204:207], v[108:111]
    s_and_b32 s33, s33, 0x7fff
    v_mfma_f32_16x16x32_bf16 v[104:107], v[44:47], v[200:203], v[104:107]
    s_mul_i32 s36, s33, 28
    v_mfma_f32_16x16x32_bf16 v[100:103], v[44:47], v[196:199], v[100:103]
    v_mfma_f32_16x16x32_bf16 v[96:99], v[44:47], v[192:195], v[96:99]
    s_waitcnt vmcnt(29) lgkmcnt(0)
    v_mfma_f32_16x16x32_bf16 v[48:51], v[16:19], v[208:211], v[48:51]
    s_waitcnt vmcnt(63)
    ds_read_b64_tr_b16 v[32:33], v8 offset:12288
    ds_read_b64_tr_b16 v[34:35], v8 offset:14336
    v_mfma_f32_16x16x32_bf16 v[52:55], v[16:19], v[212:215], v[52:55]
    ds_read_b64_tr_b16 v[36:37], v9 offset:12288
    ds_read_b64_tr_b16 v[38:39], v9 offset:14336
    v_mfma_f32_16x16x32_bf16 v[56:59], v[16:19], v[216:219], v[56:59]
    ds_read_b64_tr_b16 v[40:41], v10 offset:12288
    ds_read_b64_tr_b16 v[42:43], v10 offset:14336
    v_mfma_f32_16x16x32_bf16 v[60:63], v[16:19], v[220:223], v[60:63]
    ds_read_b64_tr_b16 v[44:45], v11 offset:12288
    ds_read_b64_tr_b16 v[46:47], v11 offset:14336
    v_mfma_f32_16x16x32_bf16 v[76:79], v[20:23], v[220:223], v[76:79]
    buffer_load_dwordx4 v[192:195], v112, s[8:11], s32 offen sc1
    buffer_load_dwordx4 v[196:199], v113, s[8:11], s32 offen sc1
    v_mfma_f32_16x16x32_bf16 v[72:75], v[20:23], v[216:219], v[72:75]
    buffer_load_dwordx4 v[200:203], v114, s[8:11], s32 offen sc1
    buffer_load_dwordx4 v[204:207], v115, s[8:11], s32 offen sc1
    v_mfma_f32_16x16x32_bf16 v[68:71], v[20:23], v[212:215], v[68:71]
    s_add_u32 s32, s32, 1024
    v_mfma_f32_16x16x32_bf16 v[64:67], v[20:23], v[208:211], v[64:67]
    s_and_b32 s32, s32, 0x7fff
    v_mfma_f32_16x16x32_bf16 v[80:83], v[24:27], v[208:211], v[80:83]
    v_mfma_f32_16x16x32_bf16 v[84:87], v[24:27], v[212:215], v[84:87]
    v_mfma_f32_16x16x32_bf16 v[88:91], v[24:27], v[216:219], v[88:91]
    v_mfma_f32_16x16x32_bf16 v[92:95], v[24:27], v[220:223], v[92:95]
    v_mfma_f32_16x16x32_bf16 v[108:111], v[28:31], v[220:223], v[108:111]
    v_mfma_f32_16x16x32_bf16 v[104:107], v[28:31], v[216:219], v[104:107]
    v_mfma_f32_16x16x32_bf16 v[100:103], v[28:31], v[212:215], v[100:103]
    v_mfma_f32_16x16x32_bf16 v[96:99], v[28:31], v[208:211], v[96:99]
    s_waitcnt vmcnt(25) lgkmcnt(0)
    v_mfma_f32_16x16x32_bf16 v[48:51], v[32:35], v[224:227], v[48:51]
    s_waitcnt vmcnt(63)
    ds_read_b64_tr_b16 v[16:17], v8 offset:16384
    ds_read_b64_tr_b16 v[18:19], v8 offset:18432
    v_mfma_f32_16x16x32_bf16 v[52:55], v[32:35], v[228:231], v[52:55]
    ds_read_b64_tr_b16 v[20:21], v9 offset:16384
    ds_read_b64_tr_b16 v[22:23], v9 offset:18432
    v_mfma_f32_16x16x32_bf16 v[56:59], v[32:35], v[232:235], v[56:59]
    ds_read_b64_tr_b16 v[24:25], v10 offset:16384
    ds_read_b64_tr_b16 v[26:27], v10 offset:18432
    v_mfma_f32_16x16x32_bf16 v[60:63], v[32:35], v[236:239], v[60:63]
    ds_read_b64_tr_b16 v[28:29], v11 offset:16384
    ds_read_b64_tr_b16 v[30:31], v11 offset:18432
    v_mfma_f32_16x16x32_bf16 v[76:79], v[36:39], v[236:239], v[76:79]
    buffer_load_dwordx4 v[208:211], v112, s[8:11], s32 offen sc1
    buffer_load_dwordx4 v[212:215], v113, s[8:11], s32 offen sc1
    v_mfma_f32_16x16x32_bf16 v[72:75], v[36:39], v[232:235], v[72:75]
    buffer_load_dwordx4 v[216:219], v114, s[8:11], s32 offen sc1
    buffer_load_dwordx4 v[220:223], v115, s[8:11], s32 offen sc1
    v_mfma_f32_16x16x32_bf16 v[68:71], v[36:39], v[228:231], v[68:71]
    s_add_u32 s32, s32, 1024
    v_mfma_f32_16x16x32_bf16 v[64:67], v[36:39], v[224:227], v[64:67]
    s_and_b32 s32, s32, 0x7fff
    v_mfma_f32_16x16x32_bf16 v[80:83], v[40:43], v[224:227], v[80:83]
    v_mfma_f32_16x16x32_bf16 v[84:87], v[40:43], v[228:231], v[84:87]
    v_mfma_f32_16x16x32_bf16 v[88:91], v[40:43], v[232:235], v[88:91]
    v_mfma_f32_16x16x32_bf16 v[92:95], v[40:43], v[236:239], v[92:95]
    v_mfma_f32_16x16x32_bf16 v[108:111], v[44:47], v[236:239], v[108:111]
    v_mfma_f32_16x16x32_bf16 v[104:107], v[44:47], v[232:235], v[104:107]
    v_mfma_f32_16x16x32_bf16 v[100:103], v[44:47], v[228:231], v[100:103]
    v_mfma_f32_16x16x32_bf16 v[96:99], v[44:47], v[224:227], v[96:99]
    s_waitcnt vmcnt(20) lgkmcnt(0)
    v_mfma_f32_16x16x32_bf16 v[48:51], v[16:19], v[240:243], v[48:51]
    s_waitcnt vmcnt(58)
    ds_read_b64_tr_b16 v[32:33], v8 offset:20480
    ds_read_b64_tr_b16 v[34:35], v8 offset:22528
    v_mfma_f32_16x16x32_bf16 v[52:55], v[16:19], v[244:247], v[52:55]
    ds_read_b64_tr_b16 v[36:37], v9 offset:20480
    ds_read_b64_tr_b16 v[38:39], v9 offset:22528
    v_mfma_f32_16x16x32_bf16 v[56:59], v[16:19], v[248:251], v[56:59]
    ds_read_b64_tr_b16 v[40:41], v10 offset:20480
    ds_read_b64_tr_b16 v[42:43], v10 offset:22528
    v_mfma_f32_16x16x32_bf16 v[60:63], v[16:19], v[252:255], v[60:63]
    ds_read_b64_tr_b16 v[44:45], v11 offset:20480
    ds_read_b64_tr_b16 v[46:47], v11 offset:22528
    v_mfma_f32_16x16x32_bf16 v[76:79], v[20:23], v[252:255], v[76:79]
    buffer_load_dwordx4 v[224:227], v112, s[8:11], s32 offen sc1
    buffer_load_dwordx4 v[228:231], v113, s[8:11], s32 offen sc1
    v_mfma_f32_16x16x32_bf16 v[72:75], v[20:23], v[248:251], v[72:75]
    buffer_load_dwordx4 v[232:235], v114, s[8:11], s32 offen sc1
    buffer_load_dwordx4 v[236:239], v115, s[8:11], s32 offen sc1
    v_mfma_f32_16x16x32_bf16 v[68:71], v[20:23], v[244:247], v[68:71]
    s_add_u32 s32, s32, 1024
    v_mfma_f32_16x16x32_bf16 v[64:67], v[20:23], v[240:243], v[64:67]
    s_and_b32 s32, s32, 0x7fff
    v_mfma_f32_16x16x32_bf16 v[80:83], v[24:27], v[240:243], v[80:83]
    v_mfma_f32_16x16x32_bf16 v[84:87], v[24:27], v[244:247], v[84:87]
    v_mfma_f32_16x16x32_bf16 v[88:91], v[24:27], v[248:251], v[88:91]
    v_mfma_f32_16x16x32_bf16 v[92:95], v[24:27], v[252:255], v[92:95]
    v_mfma_f32_16x16x32_bf16 v[108:111], v[28:31], v[252:255], v[108:111]
    v_mfma_f32_16x16x32_bf16 v[104:107], v[28:31], v[248:251], v[104:107]
    v_mfma_f32_16x16x32_bf16 v[100:103], v[28:31], v[244:247], v[100:103]
    v_mfma_f32_16x16x32_bf16 v[96:99], v[28:31], v[240:243], v[96:99]
    s_waitcnt vmcnt(16) lgkmcnt(0)
    v_mfma_f32_16x16x32_bf16 v[48:51], v[32:35], v[176:179], v[48:51]
    s_waitcnt vmcnt(54)
    ds_read_b64_tr_b16 v[16:17], v8 offset:24576
    ds_read_b64_tr_b16 v[18:19], v8 offset:26624
    v_mfma_f32_16x16x32_bf16 v[52:55], v[32:35], v[180:183], v[52:55]
    ds_read_b64_tr_b16 v[20:21], v9 offset:24576
    ds_read_b64_tr_b16 v[22:23], v9 offset:26624
    v_mfma_f32_16x16x32_bf16 v[56:59], v[32:35], v[184:187], v[56:59]
    ds_read_b64_tr_b16 v[24:25], v10 offset:24576
    ds_read_b64_tr_b16 v[26:27], v10 offset:26624
    v_mfma_f32_16x16x32_bf16 v[60:63], v[32:35], v[188:191], v[60:63]
    ds_read_b64_tr_b16 v[28:29], v11 offset:24576
    ds_read_b64_tr_b16 v[30:31], v11 offset:26624
    v_mfma_f32_16x16x32_bf16 v[76:79], v[36:39], v[188:191], v[76:79]
    buffer_load_dwordx4 v[240:243], v112, s[8:11], s32 offen sc1
    buffer_load_dwordx4 v[244:247], v113, s[8:11], s32 offen sc1
    v_mfma_f32_16x16x32_bf16 v[72:75], v[36:39], v[184:187], v[72:75]
    buffer_load_dwordx4 v[248:251], v114, s[8:11], s32 offen sc1
    buffer_load_dwordx4 v[252:255], v115, s[8:11], s32 offen sc1
    v_mfma_f32_16x16x32_bf16 v[68:71], v[36:39], v[180:183], v[68:71]
    s_add_u32 s32, s32, 1024
    v_mfma_f32_16x16x32_bf16 v[64:67], v[36:39], v[176:179], v[64:67]
    s_and_b32 s32, s32, 0x7fff
    v_mfma_f32_16x16x32_bf16 v[80:83], v[40:43], v[176:179], v[80:83]
    v_mfma_f32_16x16x32_bf16 v[84:87], v[40:43], v[180:183], v[84:87]
    v_mfma_f32_16x16x32_bf16 v[88:91], v[40:43], v[184:187], v[88:91]
    v_mfma_f32_16x16x32_bf16 v[92:95], v[40:43], v[188:191], v[92:95]
    v_mfma_f32_16x16x32_bf16 v[108:111], v[44:47], v[188:191], v[108:111]
    v_mfma_f32_16x16x32_bf16 v[104:107], v[44:47], v[184:187], v[104:107]
    v_mfma_f32_16x16x32_bf16 v[100:103], v[44:47], v[180:183], v[100:103]
    v_mfma_f32_16x16x32_bf16 v[96:99], v[44:47], v[176:179], v[96:99]
    s_waitcnt vmcnt(12) lgkmcnt(0)
    v_mfma_f32_16x16x32_bf16 v[48:51], v[16:19], v[192:195], v[48:51]
    s_waitcnt vmcnt(49)
    ds_read_b64_tr_b16 v[32:33], v8 offset:28672
    ds_read_b64_tr_b16 v[34:35], v8 offset:30720
    v_mfma_f32_16x16x32_bf16 v[52:55], v[16:19], v[196:199], v[52:55]
    ds_read_b64_tr_b16 v[36:37], v9 offset:28672
    ds_read_b64_tr_b16 v[38:39], v9 offset:30720
    v_mfma_f32_16x16x32_bf16 v[56:59], v[16:19], v[200:203], v[56:59]
    ds_read_b64_tr_b16 v[40:41], v10 offset:28672
    ds_read_b64_tr_b16 v[42:43], v10 offset:30720
    v_mfma_f32_16x16x32_bf16 v[60:63], v[16:19], v[204:207], v[60:63]
    ds_read_b64_tr_b16 v[44:45], v11 offset:28672
    ds_read_b64_tr_b16 v[46:47], v11 offset:30720
    v_mfma_f32_16x16x32_bf16 v[76:79], v[20:23], v[204:207], v[76:79]
    buffer_load_dwordx4 v[176:179], v112, s[8:11], s32 offen sc1
    buffer_load_dwordx4 v[180:183], v113, s[8:11], s32 offen sc1
    v_mfma_f32_16x16x32_bf16 v[72:75], v[20:23], v[200:203], v[72:75]
    buffer_load_dwordx4 v[184:187], v114, s[8:11], s32 offen sc1
    buffer_load_dwordx4 v[188:191], v115, s[8:11], s32 offen sc1
    v_mfma_f32_16x16x32_bf16 v[68:71], v[20:23], v[196:199], v[68:71]
    s_add_u32 s32, s32, 1024
    v_mfma_f32_16x16x32_bf16 v[64:67], v[20:23], v[192:195], v[64:67]
    s_and_b32 s32, s32, 0x7fff
    v_mfma_f32_16x16x32_bf16 v[80:83], v[24:27], v[192:195], v[80:83]
    v_mfma_f32_16x16x32_bf16 v[84:87], v[24:27], v[196:199], v[84:87]
    v_mfma_f32_16x16x32_bf16 v[88:91], v[24:27], v[200:203], v[88:91]
    v_mfma_f32_16x16x32_bf16 v[92:95], v[24:27], v[204:207], v[92:95]
    v_mfma_f32_16x16x32_bf16 v[108:111], v[28:31], v[204:207], v[108:111]
    v_mfma_f32_16x16x32_bf16 v[104:107], v[28:31], v[200:203], v[104:107]
    v_mfma_f32_16x16x32_bf16 v[100:103], v[28:31], v[196:199], v[100:103]
    v_mfma_f32_16x16x32_bf16 v[96:99], v[28:31], v[192:195], v[96:99]
    s_waitcnt vmcnt(12) lgkmcnt(0)
    v_mfma_f32_16x16x32_bf16 v[48:51], v[32:35], v[208:211], v[48:51]
    s_waitcnt vmcnt(45)
    ds_read_b64_tr_b16 v[16:17], v8 offset:32768
    ds_read_b64_tr_b16 v[18:19], v8 offset:34816
    v_mfma_f32_16x16x32_bf16 v[52:55], v[32:35], v[212:215], v[52:55]
    ds_read_b64_tr_b16 v[20:21], v9 offset:32768
    ds_read_b64_tr_b16 v[22:23], v9 offset:34816
    v_mfma_f32_16x16x32_bf16 v[56:59], v[32:35], v[216:219], v[56:59]
    ds_read_b64_tr_b16 v[24:25], v10 offset:32768
    ds_read_b64_tr_b16 v[26:27], v10 offset:34816
    v_mfma_f32_16x16x32_bf16 v[60:63], v[32:35], v[220:223], v[60:63]
    ds_read_b64_tr_b16 v[28:29], v11 offset:32768
    ds_read_b64_tr_b16 v[30:31], v11 offset:34816
    v_mfma_f32_16x16x32_bf16 v[76:79], v[36:39], v[220:223], v[76:79]
    buffer_load_dwordx4 v[192:195], v112, s[8:11], s32 offen sc1
    buffer_load_dwordx4 v[196:199], v113, s[8:11], s32 offen sc1
    v_mfma_f32_16x16x32_bf16 v[72:75], v[36:39], v[216:219], v[72:75]
    buffer_load_dwordx4 v[200:203], v114, s[8:11], s32 offen sc1
    buffer_load_dwordx4 v[204:207], v115, s[8:11], s32 offen sc1
    v_mfma_f32_16x16x32_bf16 v[68:71], v[36:39], v[212:215], v[68:71]
    s_add_u32 s32, s32, 1024
    v_mfma_f32_16x16x32_bf16 v[64:67], v[36:39], v[208:211], v[64:67]
    s_and_b32 s32, s32, 0x7fff
    v_mfma_f32_16x16x32_bf16 v[80:83], v[40:43], v[208:211], v[80:83]
    v_mfma_f32_16x16x32_bf16 v[84:87], v[40:43], v[212:215], v[84:87]
    v_mfma_f32_16x16x32_bf16 v[88:91], v[40:43], v[216:219], v[88:91]
    v_mfma_f32_16x16x32_bf16 v[92:95], v[40:43], v[220:223], v[92:95]
    v_mfma_f32_16x16x32_bf16 v[108:111], v[44:47], v[220:223], v[108:111]
    v_mfma_f32_16x16x32_bf16 v[104:107], v[44:47], v[216:219], v[104:107]
    v_mfma_f32_16x16x32_bf16 v[100:103], v[44:47], v[212:215], v[100:103]
    v_mfma_f32_16x16x32_bf16 v[96:99], v[44:47], v[208:211], v[96:99]
    s_waitcnt vmcnt(12) lgkmcnt(0)
    v_mfma_f32_16x16x32_bf16 v[48:51], v[16:19], v[224:227], v[48:51]
    s_waitcnt vmcnt(41)
    ds_read_b64_tr_b16 v[32:33], v8 offset:36864
    ds_read_b64_tr_b16 v[34:35], v8 offset:38912
    v_mfma_f32_16x16x32_bf16 v[52:55], v[16:19], v[228:231], v[52:55]
    ds_read_b64_tr_b16 v[36:37], v9 offset:36864
    ds_read_b64_tr_b16 v[38:39], v9 offset:38912
    v_mfma_f32_16x16x32_bf16 v[56:59], v[16:19], v[232:235], v[56:59]
    ds_read_b64_tr_b16 v[40:41], v10 offset:36864
    ds_read_b64_tr_b16 v[42:43], v10 offset:38912
    v_mfma_f32_16x16x32_bf16 v[60:63], v[16:19], v[236:239], v[60:63]
    ds_read_b64_tr_b16 v[44:45], v11 offset:36864
    ds_read_b64_tr_b16 v[46:47], v11 offset:38912
    v_mfma_f32_16x16x32_bf16 v[76:79], v[20:23], v[236:239], v[76:79]
    v_mfma_f32_16x16x32_bf16 v[72:75], v[20:23], v[232:235], v[72:75]
    v_mfma_f32_16x16x32_bf16 v[68:71], v[20:23], v[228:231], v[68:71]
    v_mfma_f32_16x16x32_bf16 v[64:67], v[20:23], v[224:227], v[64:67]
    v_mfma_f32_16x16x32_bf16 v[80:83], v[24:27], v[224:227], v[80:83]
    v_mfma_f32_16x16x32_bf16 v[84:87], v[24:27], v[228:231], v[84:87]
    v_mfma_f32_16x16x32_bf16 v[88:91], v[24:27], v[232:235], v[88:91]
    v_mfma_f32_16x16x32_bf16 v[92:95], v[24:27], v[236:239], v[92:95]
    v_mfma_f32_16x16x32_bf16 v[108:111], v[28:31], v[236:239], v[108:111]
    v_mfma_f32_16x16x32_bf16 v[104:107], v[28:31], v[232:235], v[104:107]
    v_mfma_f32_16x16x32_bf16 v[100:103], v[28:31], v[228:231], v[100:103]
    v_mfma_f32_16x16x32_bf16 v[96:99], v[28:31], v[224:227], v[96:99]
    s_waitcnt vmcnt(8) lgkmcnt(0)
    v_mfma_f32_16x16x32_bf16 v[48:51], v[32:35], v[240:243], v[48:51]
    s_waitcnt vmcnt(32)
    ds_read_b64_tr_b16 v[16:17], v8 offset:0
    ds_read_b64_tr_b16 v[18:19], v8 offset:2048
    v_mfma_f32_16x16x32_bf16 v[52:55], v[32:35], v[244:247], v[52:55]
    ds_read_b64_tr_b16 v[20:21], v9 offset:0
    ds_read_b64_tr_b16 v[22:23], v9 offset:2048
    v_mfma_f32_16x16x32_bf16 v[56:59], v[32:35], v[248:251], v[56:59]
    ds_read_b64_tr_b16 v[24:25], v10 offset:0
    ds_read_b64_tr_b16 v[26:27], v10 offset:2048
    v_mfma_f32_16x16x32_bf16 v[60:63], v[32:35], v[252:255], v[60:63]
    ds_read_b64_tr_b16 v[28:29], v11 offset:0
    ds_read_b64_tr_b16 v[30:31], v11 offset:2048
    v_mfma_f32_16x16x32_bf16 v[76:79], v[36:39], v[252:255], v[76:79]
    v_mfma_f32_16x16x32_bf16 v[72:75], v[36:39], v[248:251], v[72:75]
    v_mfma_f32_16x16x32_bf16 v[68:71], v[36:39], v[244:247], v[68:71]
    v_mfma_f32_16x16x32_bf16 v[64:67], v[36:39], v[240:243], v[64:67]
    v_mfma_f32_16x16x32_bf16 v[80:83], v[40:43], v[240:243], v[80:83]
    v_mfma_f32_16x16x32_bf16 v[84:87], v[40:43], v[244:247], v[84:87]
    v_mfma_f32_16x16x32_bf16 v[88:91], v[40:43], v[248:251], v[88:91]
    v_mfma_f32_16x16x32_bf16 v[92:95], v[40:43], v[252:255], v[92:95]
    v_mfma_f32_16x16x32_bf16 v[108:111], v[44:47], v[252:255], v[108:111]
    v_mfma_f32_16x16x32_bf16 v[104:107], v[44:47], v[248:251], v[104:107]
    v_mfma_f32_16x16x32_bf16 v[100:103], v[44:47], v[244:247], v[100:103]
    v_mfma_f32_16x16x32_bf16 v[96:99], v[44:47], v[240:243], v[96:99]
    s_waitcnt vmcnt(4) lgkmcnt(0)
    v_mfma_f32_16x16x32_bf16 v[48:51], v[16:19], v[176:179], v[48:51]
    s_waitcnt vmcnt(24)
    ds_read_b64_tr_b16 v[32:33], v8 offset:4096
    ds_read_b64_tr_b16 v[34:35], v8 offset:6144
    v_mfma_f32_16x16x32_bf16 v[52:55], v[16:19], v[180:183], v[52:55]
    ds_read_b64_tr_b16 v[36:37], v9 offset:4096
    ds_read_b64_tr_b16 v[38:39], v9 offset:6144
    v_mfma_f32_16x16x32_bf16 v[56:59], v[16:19], v[184:187], v[56:59]
    ds_read_b64_tr_b16 v[40:41], v10 offset:4096
    ds_read_b64_tr_b16 v[42:43], v10 offset:6144
    v_mfma_f32_16x16x32_bf16 v[60:63], v[16:19], v[188:191], v[60:63]
    ds_read_b64_tr_b16 v[44:45], v11 offset:4096
    ds_read_b64_tr_b16 v[46:47], v11 offset:6144
    v_mfma_f32_16x16x32_bf16 v[76:79], v[20:23], v[188:191], v[76:79]
    v_mfma_f32_16x16x32_bf16 v[72:75], v[20:23], v[184:187], v[72:75]
    v_mfma_f32_16x16x32_bf16 v[68:71], v[20:23], v[180:183], v[68:71]
    v_mfma_f32_16x16x32_bf16 v[64:67], v[20:23], v[176:179], v[64:67]
    v_mfma_f32_16x16x32_bf16 v[80:83], v[24:27], v[176:179], v[80:83]
    v_mfma_f32_16x16x32_bf16 v[84:87], v[24:27], v[180:183], v[84:87]
    v_mfma_f32_16x16x32_bf16 v[88:91], v[24:27], v[184:187], v[88:91]
    v_mfma_f32_16x16x32_bf16 v[92:95], v[24:27], v[188:191], v[92:95]
    v_mfma_f32_16x16x32_bf16 v[108:111], v[28:31], v[188:191], v[108:111]
    v_mfma_f32_16x16x32_bf16 v[104:107], v[28:31], v[184:187], v[104:107]
    v_mfma_f32_16x16x32_bf16 v[100:103], v[28:31], v[180:183], v[100:103]
    v_mfma_f32_16x16x32_bf16 v[96:99], v[28:31], v[176:179], v[96:99]
    s_waitcnt vmcnt(0) lgkmcnt(0)
    v_mfma_f32_16x16x32_bf16 v[48:51], v[32:35], v[192:195], v[48:51]
    v_mfma_f32_16x16x32_bf16 v[52:55], v[32:35], v[196:199], v[52:55]
    v_mfma_f32_16x16x32_bf16 v[56:59], v[32:35], v[200:203], v[56:59]
    v_mfma_f32_16x16x32_bf16 v[60:63], v[32:35], v[204:207], v[60:63]
    v_mfma_f32_16x16x32_bf16 v[76:79], v[36:39], v[204:207], v[76:79]
    v_mfma_f32_16x16x32_bf16 v[72:75], v[36:39], v[200:203], v[72:75]
    v_mfma_f32_16x16x32_bf16 v[68:71], v[36:39], v[196:199], v[68:71]
    v_mfma_f32_16x16x32_bf16 v[64:67], v[36:39], v[192:195], v[64:67]
    v_mfma_f32_16x16x32_bf16 v[80:83], v[40:43], v[192:195], v[80:83]
    v_mfma_f32_16x16x32_bf16 v[84:87], v[40:43], v[196:199], v[84:87]
    v_mfma_f32_16x16x32_bf16 v[88:91], v[40:43], v[200:203], v[88:91]
    v_mfma_f32_16x16x32_bf16 v[92:95], v[40:43], v[204:207], v[92:95]
    v_mfma_f32_16x16x32_bf16 v[108:111], v[44:47], v[204:207], v[108:111]
    v_mfma_f32_16x16x32_bf16 v[104:107], v[44:47], v[200:203], v[104:107]
    v_mfma_f32_16x16x32_bf16 v[100:103], v[44:47], v[196:199], v[100:103]
    v_mfma_f32_16x16x32_bf16 v[96:99], v[44:47], v[192:195], v[96:99]
    s_add_u32 s24, s14, 0x6000000
    s_addc_u32 s25, s15, 0
    s_mov_b32 s26, 0x1c0000
    s_mov_b32 s27, 0x20000
    s_mov_b32 s34, 0xffff0000
    ds_write_b128 v119, v[52:55] offset:0
    ds_write_b128 v119, v[68:71] offset:1024
    ds_write_b128 v119, v[84:87] offset:2048
    ds_write_b128 v119, v[100:103] offset:3072
    ds_write_b128 v119, v[56:59] offset:4096
    ds_write_b128 v119, v[72:75] offset:5120
    ds_write_b128 v119, v[88:91] offset:6144
    ds_write_b128 v119, v[104:107] offset:7168
    ds_write_b128 v119, v[60:63] offset:8192
    ds_write_b128 v119, v[76:79] offset:9216
    ds_write_b128 v119, v[92:95] offset:10240
    ds_write_b128 v119, v[108:111] offset:11264
    v_accvgpr_read_b32 v176, a240
    v_accvgpr_read_b32 v177, a241
    v_accvgpr_read_b32 v178, a242
    v_accvgpr_read_b32 v179, a243
    v_accvgpr_read_b32 v180, a244
    v_accvgpr_read_b32 v181, a245
    v_accvgpr_read_b32 v182, a246
    v_accvgpr_read_b32 v183, a247
    v_lshlrev_b32 v16, 16, v176
    v_and_b32 v17, s34, v176
    v_pk_add_f32 v[48:49], v[48:49], v[16:17]
    v_lshlrev_b32 v16, 16, v177
    v_and_b32 v17, s34, v177
    v_pk_add_f32 v[50:51], v[50:51], v[16:17]
    v_lshlrev_b32 v16, 16, v178
    v_and_b32 v17, s34, v178
    v_pk_add_f32 v[64:65], v[64:65], v[16:17]
    v_lshlrev_b32 v16, 16, v179
    v_and_b32 v17, s34, v179
    v_pk_add_f32 v[66:67], v[66:67], v[16:17]
    v_lshlrev_b32 v16, 16, v180
    v_and_b32 v17, s34, v180
    v_pk_add_f32 v[80:81], v[80:81], v[16:17]
    v_lshlrev_b32 v16, 16, v181
    v_and_b32 v17, s34, v181
    v_pk_add_f32 v[82:83], v[82:83], v[16:17]
    v_lshlrev_b32 v16, 16, v182
    v_and_b32 v17, s34, v182
    v_pk_add_f32 v[96:97], v[96:97], v[16:17]
    v_lshlrev_b32 v16, 16, v183
    v_and_b32 v17, s34, v183
    v_pk_add_f32 v[98:99], v[98:99], v[16:17]
    s_waitcnt lgkmcnt(0)
    s_barrier
    ds_read_b128 v[52:55], v116 offset:0
    ds_read_b128 v[56:59], v117 offset:0
    ds_read_b128 v[60:63], v118 offset:0
    ds_read_b128 v[68:71], v116 offset:1024
    ds_read_b128 v[72:75], v117 offset:1024
    ds_read_b128 v[76:79], v118 offset:1024
    ds_read_b128 v[84:87], v116 offset:2048
    ds_read_b128 v[88:91], v117 offset:2048
    ds_read_b128 v[92:95], v118 offset:2048
    ds_read_b128 v[100:103], v116 offset:3072
    ds_read_b128 v[104:107], v117 offset:3072
    ds_read_b128 v[108:111], v118 offset:3072
    s_waitcnt lgkmcnt(9)
    v_pk_add_f32 v[52:53], v[52:53], v[56:57]
    v_pk_add_f32 v[48:49], v[48:49], v[60:61]
    v_pk_add_f32 v[54:55], v[54:55], v[58:59]
    v_pk_add_f32 v[50:51], v[50:51], v[62:63]
    v_pk_add_f32 v[48:49], v[48:49], v[52:53]
    v_pk_add_f32 v[50:51], v[50:51], v[54:55]
    v_cvt_pk_bf16_f32 v24, v48, v49
    v_cvt_pk_bf16_f32 v25, v50, v51
    s_waitcnt lgkmcnt(6)
    v_pk_add_f32 v[68:69], v[68:69], v[72:73]
    v_pk_add_f32 v[64:65], v[64:65], v[76:77]
    v_pk_add_f32 v[70:71], v[70:71], v[74:75]
    v_pk_add_f32 v[66:67], v[66:67], v[78:79]
    v_pk_add_f32 v[64:65], v[64:65], v[68:69]
    v_pk_add_f32 v[66:67], v[66:67], v[70:71]
    v_cvt_pk_bf16_f32 v26, v64, v65
    v_cvt_pk_bf16_f32 v27, v66, v67
    s_waitcnt lgkmcnt(3)
    v_pk_add_f32 v[84:85], v[84:85], v[88:89]
    v_pk_add_f32 v[80:81], v[80:81], v[92:93]
    v_pk_add_f32 v[86:87], v[86:87], v[90:91]
    v_pk_add_f32 v[82:83], v[82:83], v[94:95]
    v_pk_add_f32 v[80:81], v[80:81], v[84:85]
    v_pk_add_f32 v[82:83], v[82:83], v[86:87]
    v_cvt_pk_bf16_f32 v28, v80, v81
    v_cvt_pk_bf16_f32 v29, v82, v83
    s_waitcnt lgkmcnt(0)
    v_pk_add_f32 v[100:101], v[100:101], v[104:105]
    v_pk_add_f32 v[96:97], v[96:97], v[108:109]
    v_pk_add_f32 v[102:103], v[102:103], v[106:107]
    v_pk_add_f32 v[98:99], v[98:99], v[110:111]
    v_pk_add_f32 v[96:97], v[96:97], v[100:101]
    v_pk_add_f32 v[98:99], v[98:99], v[102:103]
    v_cvt_pk_bf16_f32 v30, v96, v97
    v_cvt_pk_bf16_f32 v31, v98, v99
    s_lshl_b32 s3, s70, 2
    s_add_u32 s3, s3, s44
    s_mul_i32 s3, s3, 14
    s_lshl_b32 s38, s71, 1
    s_add_u32 s3, s3, s38
    s_lshl_b32 s38, s3, 10
    buffer_store_dwordx4 v[24:27], v1, s[24:27], s38 offen offset:0 sc1
    buffer_store_dwordx4 v[28:31], v1, s[24:27], s38 offen offset:1024 sc1
    v_pk_add_f32 v[12:13], v[48:49], v[50:51]
    v_pk_mul_f32 v[14:15], v[48:49], v[48:49]
    v_pk_fma_f32 v[14:15], v[50:51], v[50:51], v[14:15]
    v_pk_add_f32 v[12:13], v[12:13], v[64:65]
    v_pk_fma_f32 v[14:15], v[64:65], v[64:65], v[14:15]
    v_pk_add_f32 v[12:13], v[12:13], v[66:67]
    v_pk_fma_f32 v[14:15], v[66:67], v[66:67], v[14:15]
    v_pk_add_f32 v[12:13], v[12:13], v[80:81]
    v_pk_fma_f32 v[14:15], v[80:81], v[80:81], v[14:15]
    v_pk_add_f32 v[12:13], v[12:13], v[82:83]
    v_pk_fma_f32 v[14:15], v[82:83], v[82:83], v[14:15]
    v_pk_add_f32 v[12:13], v[12:13], v[96:97]
    v_pk_fma_f32 v[14:15], v[96:97], v[96:97], v[14:15]
    v_pk_add_f32 v[12:13], v[12:13], v[98:99]
    v_pk_fma_f32 v[14:15], v[98:99], v[98:99], v[14:15]
    v_add_f32 v12, v12, v13
    v_add_f32 v13, v14, v15
    v_mov_b32 v14, v12
    v_mov_b32 v15, v13
    s_nop 1
    v_permlane32_swap_b32 v12, v14
    v_permlane32_swap_b32 v13, v15
    v_add_f32 v12, v12, v14
    v_add_f32 v13, v13, v15
    v_mov_b32 v14, v12
    v_mov_b32 v15, v13
    s_nop 1
    v_permlane16_swap_b32 v12, v14
    v_permlane16_swap_b32 v13, v15
    v_add_f32 v12, v12, v14
    v_add_f32 v13, v13, v15
    s_lshl_b32 s3, s70, 2
    s_add_u32 s3, s3, s44
    s_lshl_b32 s3, s3, 10
    s_add_u32 s3, s3, 0x6400000
    s_add_u32 s20, s14, s3
    s_addc_u32 s21, s15, 0
    s_movk_i32 s22, 1024
    v_lshlrev_b32 v14, 2, v1
    s_lshl_b32 s3, s71, 3
    buffer_store_dwordx2 v[12:13], v14, s[20:23], s3 offen sc1
    v_accvgpr_write_b32 a240, v24
    v_accvgpr_write_b32 a241, v25
    v_accvgpr_write_b32 a242, v26
    v_accvgpr_write_b32 a243, v27
    v_accvgpr_write_b32 a244, v28
    v_accvgpr_write_b32 a245, v29
    v_accvgpr_write_b32 a246, v30
    v_accvgpr_write_b32 a247, v31
    s_and_b32 s3, s70, 1
    s_mul_i32 s3, s3, 7
    s_add_u32 s3, s3, s71
    s_lshl_b32 s69, s72, 4
    s_add_u32 s69, s69, s3
    s_lshl_b32 s69, s69, 7
    s_add_u32 s69, s69, 98304
L4_entry:
    v_and_b32 v200, 63, v0
    v_and_b32 v204, 15, v200
    v_lshrrev_b32 v205, 4, v200
    s_add_u32 s20, s14, 0x6000000
    s_addc_u32 s21, s15, 0
    s_mov_b32 s22, 0x1c0000
    s_mov_b32 s23, 0x20000
    s_add_u32 s24, s14, 0x6800000
    s_addc_u32 s25, s15, 0
    s_mov_b32 s26, 0x700000
    s_mov_b32 s27, 0x20000
    s_lshl_b32 s3, s76, 3
    s_lshl_b32 s36, s44, 1
    s_add_u32 s36, s36, s3
    s_lshl_b32 s3, s44, 3
    v_add_u32 v206, s3, v205
    v_mul_u32_u24 v206, 3584, v206
    v_lshlrev_b32 v207, 1, v205
    v_xor_b32 v207, v207, v204
    v_xor_b32 v208, 8, v207
    v_lshl_add_u32 v10, v207, 4, v206
    v_lshl_add_u32 v208, v208, 4, v206
    v_add_u32 v11, 13312, v208
    s_lshl_b32 s38, s44, 11
    s_mov_b32 s50, 0
    s_lshl_b32 s3, s73, 8
    s_waitcnt lgkmcnt(0)
    s_add_u32 s8, s56, s3
    s_addc_u32 s9, s57, 0
    s_sub_u32 s10, 1605632, s3
    s_mov_b32 s11, 0x20000
    s_add_u32 s16, s58, s3
    s_addc_u32 s17, s59, 0
    s_sub_u32 s18, 1605632, s3
    s_mov_b32 s19, 0x20000
    s_barrier
    s_add_u32 m0, s38, 0
    s_nop 0
    buffer_load_dwordx4 v10, s[8:11], s50 offen offset:0 lds
    buffer_load_dwordx4 v11, s[8:11], s50 offen offset:1024 lds
    s_add_u32 m0, s38, 8192
    s_nop 0
    buffer_load_dwordx4 v10, s[16:19], s50 offen offset:0 lds
    buffer_load_dwordx4 v11, s[16:19], s50 offen offset:1024 lds
    s_add_u32 s50, s50, 114688
    s_waitcnt vmcnt(4)
    s_lshl_b32 s3, s44, 2
    v_mov_b32 v13, s3
    v_mov_b32 v14, s7
    buffer_store_dword v14, v13, s[28:31], s69 offen sc1
    s_lshl_b32 s39, s76, 11
    s_add_u32 s39, s39, 98304
    s_add_u32 m0, s38, 16384
    s_nop 0
    buffer_load_dwordx4 v10, s[8:11], s50 offen offset:0 lds
    buffer_load_dwordx4 v11, s[8:11], s50 offen offset:1024 lds
    s_add_u32 m0, s38, 24576
    s_nop 0
    buffer_load_dwordx4 v10, s[16:19], s50 offen offset:0 lds
    buffer_load_dwordx4 v11, s[16:19], s50 offen offset:1024 lds
    s_add_u32 s50, s50, 114688
    s_add_u32 m0, s38, 32768
    s_nop 0
    buffer_load_dwordx4 v10, s[8:11], s50 offen offset:0 lds
    buffer_load_dwordx4 v11, s[8:11], s50 offen offset:1024 lds
    s_add_u32 m0, s38, 40960
    s_nop 0
    buffer_load_dwordx4 v10, s[16:19], s50 offen offset:0 lds
    buffer_load_dwordx4 v11, s[16:19], s50 offen offset:1024 lds
    s_add_u32 s50, s50, 114688
    s_add_u32 m0, s38, 49152
    s_nop 0
    buffer_load_dwordx4 v10, s[8:11], s50 offen offset:0 lds
    buffer_load_dwordx4 v11, s[8:11], s50 offen offset:1024 lds
    s_add_u32 m0, s38, 57344
    s_nop 0
    buffer_load_dwordx4 v10, s[16:19], s50 offen offset:0 lds
    buffer_load_dwordx4 v11, s[16:19], s50 offen offset:1024 lds
    s_add_u32 s50, s50, 114688
    s_add_u32 m0, s38, 65536
    s_nop 0
    buffer_load_dwordx4 v10, s[8:11], s50 offen offset:0 lds
    buffer_load_dwordx4 v11, s[8:11], s50 offen offset:1024 lds
    s_add_u32 m0, s38, 73728
    s_nop 0
    buffer_load_dwordx4 v10, s[16:19], s50 offen offset:0 lds
    buffer_load_dwordx4 v11, s[16:19], s50 offen offset:1024 lds
    s_add_u32 s50, s50, 114688
    s_add_u32 m0, s38, 81920
    s_nop 0
    buffer_load_dwordx4 v10, s[8:11], s50 offen offset:0 lds
    buffer_load_dwordx4 v11, s[8:11], s50 offen offset:1024 lds
    s_add_u32 m0, s38, 90112
    s_nop 0
    buffer_load_dwordx4 v10, s[16:19], s50 offen offset:0 lds
    buffer_load_dwordx4 v11, s[16:19], s50 offen offset:1024 lds
    s_add_u32 s50, s50, 114688
    s_add_u32 m0, s38, 98304
    s_nop 0
    buffer_load_dwordx4 v10, s[8:11], s50 offen offset:0 lds
    buffer_load_dwordx4 v11, s[8:11], s50 offen offset:1024 lds
    s_add_u32 m0, s38, 106496
    s_nop 0
    buffer_load_dwordx4 v10, s[16:19], s50 offen offset:0 lds
    buffer_load_dwordx4 v11, s[16:19], s50 offen offset:1024 lds
    s_add_u32 s50, s50, 114688
    v_bfe_u32 v13, v0, 2, 4
    v_min_u32 v13, 13, v13
    v_and_b32 v14, 3, v0
    v_lshlrev_b32 v14, 2, v14
    v_lshl_add_u32 v13, v13, 7, v14
    buffer_load_dword v15, v13, s[28:31], s39 offen sc1
    s_add_u32 m0, s38, 114688
    s_nop 0
    buffer_load_dwordx4 v10, s[8:11], s50 offen offset:0 lds
    buffer_load_dwordx4 v11, s[8:11], s50 offen offset:1024 lds
    s_add_u32 m0, s38, 122880
    s_nop 0
    buffer_load_dwordx4 v10, s[16:19], s50 offen offset:0 lds
    buffer_load_dwordx4 v11, s[16:19], s50 offen offset:1024 lds
    s_add_u32 s50, s50, 114688
    s_add_u32 m0, s38, 131072
    s_nop 0
    buffer_load_dwordx4 v10, s[8:11], s50 offen offset:0 lds
    buffer_load_dwordx4 v11, s[8:11], s50 offen offset:1024 lds
    s_add_u32 m0, s38, 139264
    s_nop 0
    buffer_load_dwordx4 v10, s[16:19], s50 offen offset:0 lds
    buffer_load_dwordx4 v11, s[16:19], s50 offen offset:1024 lds
    s_add_u32 s50, s50, 114688
    s_add_u32 m0, s38, 147456
    s_nop 0
    buffer_load_dwordx4 v10, s[8:11], s50 offen offset:0 lds
    buffer_load_dwordx4 v11, s[8:11], s50 offen offset:1024 lds
    s_add_u32 m0, s38, 155648
    s_nop 0
    buffer_load_dwordx4 v10, s[16:19], s50 offen offset:0 lds
    buffer_load_dwordx4 v11, s[16:19], s50 offen offset:1024 lds
    s_add_u32 s50, s50, 114688
    v_lshrrev_b32 v206, 2, v204
    v_lshl_add_u32 v206, v205, 2, v206
    v_and_b32 v207, 3, v204
    v_lshlrev_b32 v207, 3, v207
    v_lshl_add_u32 v207, v206, 8, v207
    v_and_b32 v208, 7, v206
    v_xor_b32 v209, 0, v208
    v_lshl_add_u32 v2, v209, 5, v207
    v_xor_b32 v209, 1, v208
    v_lshl_add_u32 v3, v209, 5, v207
    v_xor_b32 v209, 2, v208
    v_lshl_add_u32 v4, v209, 5, v207
    v_xor_b32 v209, 3, v208
    v_lshl_add_u32 v5, v209, 5, v207
    v_xor_b32 v209, 4, v208
    v_lshl_add_u32 v6, v209, 5, v207
    v_xor_b32 v209, 5, v208
    v_lshl_add_u32 v7, v209, 5, v207
    v_xor_b32 v209, 6, v208
    v_lshl_add_u32 v8, v209, 5, v207
    v_xor_b32 v209, 7, v208
    v_lshl_add_u32 v9, v209, 5, v207
    s_lshl_b32 s3, s36, 10
    s_add_u32 s3, s3, 0x6400000
    s_add_u32 s40, s14, s3
    s_addc_u32 s41, s15, 0
    s_movk_i32 s42, 2048
    s_mov_b32 s43, 0x20000
    v_cmp_eq_u32 s[48:49], 3, v205
    s_cmp_eq_u32 s77, 1
    s_cselect_b32 s52, 0, 0x1000000
    s_cselect_b32 s42, 0, s42
    s_cbranch_scc1 L4_ones
    s_cmp_eq_u32 s44, 0
    s_cbranch_scc0 L4_s
    s_waitcnt vmcnt(12)
    v_cmp_ne_u32 vcc, s7, v15
    s_cbranch_vccz L4_s
    v_bfe_u32 v13, v0, 2, 4
    v_min_u32 v13, 13, v13
    v_and_b32 v14, 3, v0
    v_lshlrev_b32 v14, 2, v14
    v_lshl_add_u32 v13, v13, 7, v14
    s_mov_b32 s55, 0x10000
L2_poll14:
    buffer_load_dword v14, v13, s[28:31], s39 offen sc1
    s_waitcnt vmcnt(0)
    v_cmp_ne_u32 vcc, s7, v14
    s_cbranch_vccz L2_got14
    s_sleep 2
    s_sub_u32 s55, s55, 1
    s_cbranch_scc0 L2_poll14
L2_got14:
L4_s:
    s_barrier
    s_mul_i32 s37, s36, 14336
    s_add_u32 s45, s37, 14336
    buffer_load_dwordx4 v[16:19], v1, s[20:23], s37 offen offset:0 sc1
    buffer_load_dwordx4 v[20:23], v1, s[20:23], s45 offen offset:0 sc1
    buffer_load_dwordx4 v[24:27], v1, s[20:23], s37 offen offset:1024 sc1
    buffer_load_dwordx4 v[28:31], v1, s[20:23], s45 offen offset:1024 sc1
    buffer_load_dwordx4 v[32:35], v1, s[20:23], s37 offen offset:2048 sc1
    buffer_load_dwordx4 v[36:39], v1, s[20:23], s45 offen offset:2048 sc1
    buffer_load_dwordx4 v[40:43], v1, s[20:23], s37 offen offset:3072 sc1
    buffer_load_dwordx4 v[44:47], v1, s[20:23], s45 offen offset:3072 sc1
    s_add_u32 s37, s37, 4096
    s_add_u32 s45, s45, 4096
    buffer_load_dwordx4 v[48:51], v1, s[20:23], s37 offen offset:0 sc1
    buffer_load_dwordx4 v[52:55], v1, s[20:23], s45 offen offset:0 sc1
    buffer_load_dwordx4 v[56:59], v1, s[20:23], s37 offen offset:1024 sc1
    buffer_load_dwordx4 v[60:63], v1, s[20:23], s45 offen offset:1024 sc1
    buffer_load_dwordx4 v[64:67], v1, s[20:23], s37 offen offset:2048 sc1
    buffer_load_dwordx4 v[68:71], v1, s[20:23], s45 offen offset:2048 sc1
    buffer_load_dwordx4 v[72:75], v1, s[20:23], s37 offen offset:3072 sc1
    buffer_load_dwordx4 v[76:79], v1, s[20:23], s45 offen offset:3072 sc1
    s_add_u32 s37, s37, 4096
    s_add_u32 s45, s45, 4096
    buffer_load_dwordx4 v[80:83], v1, s[20:23], s37 offen offset:0 sc1
    buffer_load_dwordx4 v[84:87], v1, s[20:23], s45 offen offset:0 sc1
    buffer_load_dwordx4 v[88:91], v1, s[20:23], s37 offen offset:1024 sc1
    buffer_load_dwordx4 v[92:95], v1, s[20:23], s45 offen offset:1024 sc1
    buffer_load_dwordx4 v[96:99], v1, s[20:23], s37 offen offset:2048 sc1
    buffer_load_dwordx4 v[100:103], v1, s[20:23], s45 offen offset:2048 sc1
    buffer_load_dwordx4 v[104:107], v1, s[20:23], s37 offen offset:3072 sc1
    buffer_load_dwordx4 v[108:111], v1, s[20:23], s45 offen offset:3072 sc1
    s_add_u32 s37, s37, 4096
    s_add_u32 s45, s45, 4096
    buffer_load_dwordx4 v[112:115], v1, s[20:23], s37 offen offset:0 sc1
    buffer_load_dwordx4 v[116:119], v1, s[20:23], s45 offen offset:0 sc1
    buffer_load_dwordx4 v[120:123], v1, s[20:23], s37 offen offset:1024 sc1
    buffer_load_dwordx4 v[124:127], v1, s[20:23], s45 offen offset:1024 sc1
    s_waitcnt vmcnt(26)
L4_go:
    s_barrier
    ds_read_b64_tr_b16 a[0:1], v2 offset:0
    ds_read_b64_tr_b16 a[2:3], v2 offset:4096
    ds_read_b64_tr_b16 a[4:5], v2 offset:8192
    ds_read_b64_tr_b16 a[6:7], v2 offset:12288
    ds_read_b64_tr_b16 a[8:9], v3 offset:0
    ds_read_b64_tr_b16 a[10:11], v3 offset:4096
    ds_read_b64_tr_b16 a[12:13], v3 offset:8192
    ds_read_b64_tr_b16 a[14:15], v3 offset:12288
    ds_read_b64_tr_b16 a[16:17], v4 offset:0
    ds_read_b64_tr_b16 a[18:19], v4 offset:4096
    ds_read_b64_tr_b16 a[20:21], v4 offset:8192
    ds_read_b64_tr_b16 a[22:23], v4 offset:12288
    ds_read_b64_tr_b16 a[24:25], v5 offset:0
    ds_read_b64_tr_b16 a[26:27], v5 offset:4096
    s_waitcnt lgkmcnt(10)
    v_mfma_f32_16x16x32_bf16 v[128:131], a[0:3], v[16:19], 0
    ds_read_b64_tr_b16 a[28:29], v5 offset:8192
    v_mfma_f32_16x16x32_bf16 v[132:135], a[0:3], v[20:23], 0
    ds_read_b64_tr_b16 a[30:31], v5 offset:12288
    v_mfma_f32_16x16x32_bf16 v[140:143], a[4:7], v[20:23], 0
    ds_read_b64_tr_b16 a[32:33], v6 offset:0
    v_mfma_f32_16x16x32_bf16 v[136:139], a[4:7], v[16:19], 0
    ds_read_b64_tr_b16 a[34:35], v6 offset:4096
    s_waitcnt lgkmcnt(10)
    v_mfma_f32_16x16x32_bf16 v[144:147], a[8:11], v[16:19], 0
    ds_read_b64_tr_b16 a[36:37], v6 offset:8192
    v_mfma_f32_16x16x32_bf16 v[148:151], a[8:11], v[20:23], 0
    ds_read_b64_tr_b16 a[38:39], v6 offset:12288
    v_mfma_f32_16x16x32_bf16 v[156:159], a[12:15], v[20:23], 0
    ds_read_b64_tr_b16 a[40:41], v7 offset:0
    v_mfma_f32_16x16x32_bf16 v[152:155], a[12:15], v[16:19], 0
    ds_read_b64_tr_b16 a[42:43], v7 offset:4096
    s_waitcnt lgkmcnt(10)
    v_mfma_f32_16x16x32_bf16 v[160:163], a[16:19], v[16:19], 0
    ds_read_b64_tr_b16 a[44:45], v7 offset:8192
    v_mfma_f32_16x16x32_bf16 v[164:167], a[16:19], v[20:23], 0
    ds_read_b64_tr_b16 a[46:47], v7 offset:12288
    v_mfma_f32_16x16x32_bf16 v[172:175], a[20:23], v[20:23], 0
    ds_read_b64_tr_b16 a[48:49], v8 offset:0
    v_mfma_f32_16x16x32_bf16 v[168:171], a[20:23], v[16:19], 0
    ds_read_b64_tr_b16 a[50:51], v8 offset:4096
    s_waitcnt lgkmcnt(10)
    v_mfma_f32_16x16x32_bf16 v[176:179], a[24:27], v[16:19], 0
    ds_read_b64_tr_b16 a[52:53], v8 offset:8192
    v_mfma_f32_16x16x32_bf16 v[180:183], a[24:27], v[20:23], 0
    ds_read_b64_tr_b16 a[54:55], v8 offset:12288
    v_mfma_f32_16x16x32_bf16 v[188:191], a[28:31], v[20:23], 0
    ds_read_b64_tr_b16 a[56:57], v9 offset:0
    v_mfma_f32_16x16x32_bf16 v[184:187], a[28:31], v[16:19], 0
    ds_read_b64_tr_b16 a[58:59], v9 offset:4096
    s_waitcnt lgkmcnt(10)
    v_mfma_f32_16x16x32_bf16 v[192:195], a[32:35], v[16:19], 0
    ds_read_b64_tr_b16 a[60:61], v9 offset:8192
    v_mfma_f32_16x16x32_bf16 v[196:199], a[32:35], v[20:23], 0
    ds_read_b64_tr_b16 a[62:63], v9 offset:12288
    v_mfma_f32_16x16x32_bf16 v[204:207], a[36:39], v[20:23], 0
    ds_read_b64_tr_b16 a[0:1], v2 offset:16384
    v_mfma_f32_16x16x32_bf16 v[200:203], a[36:39], v[16:19], 0
    ds_read_b64_tr_b16 a[2:3], v2 offset:20480
    s_waitcnt lgkmcnt(10)
    v_mfma_f32_16x16x32_bf16 v[208:211], a[40:43], v[16:19], 0
    ds_read_b64_tr_b16 a[4:5], v2 offset:24576
    v_mfma_f32_16x16x32_bf16 v[212:215], a[40:43], v[20:23], 0
    ds_read_b64_tr_b16 a[6:7], v2 offset:28672
    v_mfma_f32_16x16x32_bf16 v[220:223], a[44:47], v[20:23], 0
    ds_read_b64_tr_b16 a[8:9], v3 offset:16384
    v_mfma_f32_16x16x32_bf16 v[216:219], a[44:47], v[16:19], 0
    ds_read_b64_tr_b16 a[10:11], v3 offset:20480
    s_waitcnt lgkmcnt(10)
    v_mfma_f32_16x16x32_bf16 v[224:227], a[48:51], v[16:19], 0
    ds_read_b64_tr_b16 a[12:13], v3 offset:24576
    v_mfma_f32_16x16x32_bf16 v[228:231], a[48:51], v[20:23], 0
    ds_read_b64_tr_b16 a[14:15], v3 offset:28672
    v_mfma_f32_16x16x32_bf16 v[236:239], a[52:55], v[20:23], 0
    ds_read_b64_tr_b16 a[16:17], v4 offset:16384
    v_mfma_f32_16x16x32_bf16 v[232:235], a[52:55], v[16:19], 0
    ds_read_b64_tr_b16 a[18:19], v4 offset:20480
    s_waitcnt lgkmcnt(10)
    v_mfma_f32_16x16x32_bf16 v[240:243], a[56:59], v[16:19], 0
    ds_read_b64_tr_b16 a[20:21], v4 offset:24576
    v_mfma_f32_16x16x32_bf16 v[244:247], a[56:59], v[20:23], 0
    ds_read_b64_tr_b16 a[22:23], v4 offset:28672
    v_mfma_f32_16x16x32_bf16 v[252:255], a[60:63], v[20:23], 0
    ds_read_b64_tr_b16 a[24:25], v5 offset:16384
    v_mfma_f32_16x16x32_bf16 v[248:251], a[60:63], v[16:19], 0
    ds_read_b64_tr_b16 a[26:27], v5 offset:20480
    s_waitcnt lgkmcnt(10)
    s_waitcnt vmcnt(24)
    v_mfma_f32_16x16x32_bf16 v[128:131], a[0:3], v[24:27], v[128:131]
    ds_read_b64_tr_b16 a[28:29], v5 offset:24576
    v_mfma_f32_16x16x32_bf16 v[132:135], a[0:3], v[28:31], v[132:135]
    ds_read_b64_tr_b16 a[30:31], v5 offset:28672
    v_mfma_f32_16x16x32_bf16 v[140:143], a[4:7], v[28:31], v[140:143]
    ds_read_b64_tr_b16 a[32:33], v6 offset:16384
    v_mfma_f32_16x16x32_bf16 v[136:139], a[4:7], v[24:27], v[136:139]
    ds_read_b64_tr_b16 a[34:35], v6 offset:20480
    s_waitcnt lgkmcnt(10)
    v_mfma_f32_16x16x32_bf16 v[144:147], a[8:11], v[24:27], v[144:147]
    ds_read_b64_tr_b16 a[36:37], v6 offset:24576
    v_mfma_f32_16x16x32_bf16 v[148:151], a[8:11], v[28:31], v[148:151]
    ds_read_b64_tr_b16 a[38:39], v6 offset:28672
    v_mfma_f32_16x16x32_bf16 v[156:159], a[12:15], v[28:31], v[156:159]
    ds_read_b64_tr_b16 a[40:41], v7 offset:16384
    v_mfma_f32_16x16x32_bf16 v[152:155], a[12:15], v[24:27], v[152:155]
    ds_read_b64_tr_b16 a[42:43], v7 offset:20480
    s_waitcnt lgkmcnt(10)
    v_mfma_f32_16x16x32_bf16 v[160:163], a[16:19], v[24:27], v[160:163]
    ds_read_b64_tr_b16 a[44:45], v7 offset:24576
    v_mfma_f32_16x16x32_bf16 v[164:167], a[16:19], v[28:31], v[164:167]
    ds_read_b64_tr_b16 a[46:47], v7 offset:28672
    v_mfma_f32_16x16x32_bf16 v[172:175], a[20:23], v[28:31], v[172:175]
    ds_read_b64_tr_b16 a[48:49], v8 offset:16384
    v_mfma_f32_16x16x32_bf16 v[168:171], a[20:23], v[24:27], v[168:171]
    ds_read_b64_tr_b16 a[50:51], v8 offset:20480
    s_waitcnt lgkmcnt(10)
    v_mfma_f32_16x16x32_bf16 v[176:179], a[24:27], v[24:27], v[176:179]
    ds_read_b64_tr_b16 a[52:53], v8 offset:24576
    v_mfma_f32_16x16x32_bf16 v[180:183], a[24:27], v[28:31], v[180:183]
    ds_read_b64_tr_b16 a[54:55], v8 offset:28672
    v_mfma_f32_16x16x32_bf16 v[188:191], a[28:31], v[28:31], v[188:191]
    ds_read_b64_tr_b16 a[56:57], v9 offset:16384
    v_mfma_f32_16x16x32_bf16 v[184:187], a[28:31], v[24:27], v[184:187]
    ds_read_b64_tr_b16 a[58:59], v9 offset:20480
    s_waitcnt lgkmcnt(10)
    v_mfma_f32_16x16x32_bf16 v[192:195], a[32:35], v[24:27], v[192:195]
    ds_read_b64_tr_b16 a[60:61], v9 offset:24576
    v_mfma_f32_16x16x32_bf16 v[196:199], a[32:35], v[28:31], v[196:199]
    ds_read_b64_tr_b16 a[62:63], v9 offset:28672
    v_mfma_f32_16x16x32_bf16 v[204:207], a[36:39], v[28:31], v[204:207]
    ds_read_b64_tr_b16 a[0:1], v2 offset:32768
    v_mfma_f32_16x16x32_bf16 v[200:203], a[36:39], v[24:27], v[200:203]
    ds_read_b64_tr_b16 a[2:3], v2 offset:36864
    s_waitcnt lgkmcnt(10)
    v_mfma_f32_16x16x32_bf16 v[208:211], a[40:43], v[24:27], v[208:211]
    ds_read_b64_tr_b16 a[4:5], v2 offset:40960
    v_mfma_f32_16x16x32_bf16 v[212:215], a[40:43], v[28:31], v[212:215]
    ds_read_b64_tr_b16 a[6:7], v2 offset:45056
    v_mfma_f32_16x16x32_bf16 v[220:223], a[44:47], v[28:31], v[220:223]
    ds_read_b64_tr_b16 a[8:9], v3 offset:32768
    v_mfma_f32_16x16x32_bf16 v[216:219], a[44:47], v[24:27], v[216:219]
    ds_read_b64_tr_b16 a[10:11], v3 offset:36864
    s_waitcnt lgkmcnt(10)
    v_mfma_f32_16x16x32_bf16 v[224:227], a[48:51], v[24:27], v[224:227]
    ds_read_b64_tr_b16 a[12:13], v3 offset:40960
    v_mfma_f32_16x16x32_bf16 v[228:231], a[48:51], v[28:31], v[228:231]
    ds_read_b64_tr_b16 a[14:15], v3 offset:45056
    v_mfma_f32_16x16x32_bf16 v[236:239], a[52:55], v[28:31], v[236:239]
    ds_read_b64_tr_b16 a[16:17], v4 offset:32768
    v_mfma_f32_16x16x32_bf16 v[232:235], a[52:55], v[24:27], v[232:235]
    ds_read_b64_tr_b16 a[18:19], v4 offset:36864
    s_waitcnt lgkmcnt(10)
    v_mfma_f32_16x16x32_bf16 v[240:243], a[56:59], v[24:27], v[240:243]
    ds_read_b64_tr_b16 a[20:21], v4 offset:40960
    v_mfma_f32_16x16x32_bf16 v[244:247], a[56:59], v[28:31], v[244:247]
    ds_read_b64_tr_b16 a[22:23], v4 offset:45056
    v_mfma_f32_16x16x32_bf16 v[252:255], a[60:63], v[28:31], v[252:255]
    ds_read_b64_tr_b16 a[24:25], v5 offset:32768
    v_mfma_f32_16x16x32_bf16 v[248:251], a[60:63], v[24:27], v[248:251]
    ds_read_b64_tr_b16 a[26:27], v5 offset:36864
    s_waitcnt lgkmcnt(10)
    s_waitcnt vmcnt(22)
    v_mfma_f32_16x16x32_bf16 v[128:131], a[0:3], v[32:35], v[128:131]
    ds_read_b64_tr_b16 a[28:29], v5 offset:40960
    v_mfma_f32_16x16x32_bf16 v[132:135], a[0:3], v[36:39], v[132:135]
    ds_read_b64_tr_b16 a[30:31], v5 offset:45056
    v_mfma_f32_16x16x32_bf16 v[140:143], a[4:7], v[36:39], v[140:143]
    ds_read_b64_tr_b16 a[32:33], v6 offset:32768
    v_mfma_f32_16x16x32_bf16 v[136:139], a[4:7], v[32:35], v[136:139]
    ds_read_b64_tr_b16 a[34:35], v6 offset:36864
    s_waitcnt lgkmcnt(10)
    v_mfma_f32_16x16x32_bf16 v[144:147], a[8:11], v[32:35], v[144:147]
    ds_read_b64_tr_b16 a[36:37], v6 offset:40960
    v_mfma_f32_16x16x32_bf16 v[148:151], a[8:11], v[36:39], v[148:151]
    ds_read_b64_tr_b16 a[38:39], v6 offset:45056
    v_mfma_f32_16x16x32_bf16 v[156:159], a[12:15], v[36:39], v[156:159]
    ds_read_b64_tr_b16 a[40:41], v7 offset:32768
    v_mfma_f32_16x16x32_bf16 v[152:155], a[12:15], v[32:35], v[152:155]
    ds_read_b64_tr_b16 a[42:43], v7 offset:36864
    s_waitcnt lgkmcnt(10)
    v_mfma_f32_16x16x32_bf16 v[160:163], a[16:19], v[32:35], v[160:163]
    ds_read_b64_tr_b16 a[44:45], v7 offset:40960
    v_mfma_f32_16x16x32_bf16 v[164:167], a[16:19], v[36:39], v[164:167]
    ds_read_b64_tr_b16 a[46:47], v7 offset:45056
    v_mfma_f32_16x16x32_bf16 v[172:175], a[20:23], v[36:39], v[172:175]
    ds_read_b64_tr_b16 a[48:49], v8 offset:32768
    v_mfma_f32_16x16x32_bf16 v[168:171], a[20:23], v[32:35], v[168:171]
    ds_read_b64_tr_b16 a[50:51], v8 offset:36864
    s_waitcnt lgkmcnt(10)
    v_mfma_f32_16x16x32_bf16 v[176:179], a[24:27], v[32:35], v[176:179]
    ds_read_b64_tr_b16 a[52:53], v8 offset:40960
    v_mfma_f32_16x16x32_bf16 v[180:183], a[24:27], v[36:39], v[180:183]
    ds_read_b64_tr_b16 a[54:55], v8 offset:45056
    v_mfma_f32_16x16x32_bf16 v[188:191], a[28:31], v[36:39], v[188:191]
    ds_read_b64_tr_b16 a[56:57], v9 offset:32768
    v_mfma_f32_16x16x32_bf16 v[184:187], a[28:31], v[32:35], v[184:187]
    ds_read_b64_tr_b16 a[58:59], v9 offset:36864
    s_waitcnt lgkmcnt(10)
    v_mfma_f32_16x16x32_bf16 v[192:195], a[32:35], v[32:35], v[192:195]
    ds_read_b64_tr_b16 a[60:61], v9 offset:40960
    v_mfma_f32_16x16x32_bf16 v[196:199], a[32:35], v[36:39], v[196:199]
    ds_read_b64_tr_b16 a[62:63], v9 offset:45056
    v_mfma_f32_16x16x32_bf16 v[204:207], a[36:39], v[36:39], v[204:207]
    ds_read_b64_tr_b16 a[0:1], v2 offset:49152
    v_mfma_f32_16x16x32_bf16 v[200:203], a[36:39], v[32:35], v[200:203]
    ds_read_b64_tr_b16 a[2:3], v2 offset:53248
    s_waitcnt lgkmcnt(10)
    v_mfma_f32_16x16x32_bf16 v[208:211], a[40:43], v[32:35], v[208:211]
    ds_read_b64_tr_b16 a[4:5], v2 offset:57344
    v_mfma_f32_16x16x32_bf16 v[212:215], a[40:43], v[36:39], v[212:215]
    ds_read_b64_tr_b16 a[6:7], v2 offset:61440
    v_add_u32 v2, 0x10000, v2
    v_mfma_f32_16x16x32_bf16 v[220:223], a[44:47], v[36:39], v[220:223]
    ds_read_b64_tr_b16 a[8:9], v3 offset:49152
    v_mfma_f32_16x16x32_bf16 v[216:219], a[44:47], v[32:35], v[216:219]
    ds_read_b64_tr_b16 a[10:11], v3 offset:53248
    s_waitcnt lgkmcnt(10)
    v_mfma_f32_16x16x32_bf16 v[224:227], a[48:51], v[32:35], v[224:227]
    ds_read_b64_tr_b16 a[12:13], v3 offset:57344
    v_mfma_f32_16x16x32_bf16 v[228:231], a[48:51], v[36:39], v[228:231]
    ds_read_b64_tr_b16 a[14:15], v3 offset:61440
    v_add_u32 v3, 0x10000, v3
    v_mfma_f32_16x16x32_bf16 v[236:239], a[52:55], v[36:39], v[236:239]
    ds_read_b64_tr_b16 a[16:17], v4 offset:49152
    v_mfma_f32_16x16x32_bf16 v[232:235], a[52:55], v[32:35], v[232:235]
    ds_read_b64_tr_b16 a[18:19], v4 offset:53248
    s_waitcnt lgkmcnt(10)
    v_mfma_f32_16x16x32_bf16 v[240:243], a[56:59], v[32:35], v[240:243]
    ds_read_b64_tr_b16 a[20:21], v4 offset:57344
    v_mfma_f32_16x16x32_bf16 v[244:247], a[56:59], v[36:39], v[244:247]
    ds_read_b64_tr_b16 a[22:23], v4 offset:61440
    v_add_u32 v4, 0x10000, v4
    v_mfma_f32_16x16x32_bf16 v[252:255], a[60:63], v[36:39], v[252:255]
    ds_read_b64_tr_b16 a[24:25], v5 offset:49152
    v_mfma_f32_16x16x32_bf16 v[248:251], a[60:63], v[32:35], v[248:251]
    ds_read_b64_tr_b16 a[26:27], v5 offset:53248
    s_waitcnt lgkmcnt(10)
    s_waitcnt vmcnt(20)
    v_mfma_f32_16x16x32_bf16 v[128:131], a[0:3], v[40:43], v[128:131]
    ds_read_b64_tr_b16 a[28:29], v5 offset:57344
    v_mfma_f32_16x16x32_bf16 v[132:135], a[0:3], v[44:47], v[132:135]
    ds_read_b64_tr_b16 a[30:31], v5 offset:61440
    v_add_u32 v5, 0x10000, v5
    v_mfma_f32_16x16x32_bf16 v[140:143], a[4:7], v[44:47], v[140:143]
    ds_read_b64_tr_b16 a[32:33], v6 offset:49152
    v_mfma_f32_16x16x32_bf16 v[136:139], a[4:7], v[40:43], v[136:139]
    ds_read_b64_tr_b16 a[34:35], v6 offset:53248
    s_waitcnt lgkmcnt(10)
    v_mfma_f32_16x16x32_bf16 v[144:147], a[8:11], v[40:43], v[144:147]
    ds_read_b64_tr_b16 a[36:37], v6 offset:57344
    v_mfma_f32_16x16x32_bf16 v[148:151], a[8:11], v[44:47], v[148:151]
    ds_read_b64_tr_b16 a[38:39], v6 offset:61440
    v_add_u32 v6, 0x10000, v6
    v_mfma_f32_16x16x32_bf16 v[156:159], a[12:15], v[44:47], v[156:159]
    ds_read_b64_tr_b16 a[40:41], v7 offset:49152
    v_mfma_f32_16x16x32_bf16 v[152:155], a[12:15], v[40:43], v[152:155]
    ds_read_b64_tr_b16 a[42:43], v7 offset:53248
    s_waitcnt lgkmcnt(10)
    v_mfma_f32_16x16x32_bf16 v[160:163], a[16:19], v[40:43], v[160:163]
    ds_read_b64_tr_b16 a[44:45], v7 offset:57344
    v_mfma_f32_16x16x32_bf16 v[164:167], a[16:19], v[44:47], v[164:167]
    ds_read_b64_tr_b16 a[46:47], v7 offset:61440
    v_add_u32 v7, 0x10000, v7
    v_mfma_f32_16x16x32_bf16 v[172:175], a[20:23], v[44:47], v[172:175]
    ds_read_b64_tr_b16 a[48:49], v8 offset:49152
    v_mfma_f32_16x16x32_bf16 v[168:171], a[20:23], v[40:43], v[168:171]
    ds_read_b64_tr_b16 a[50:51], v8 offset:53248
    s_waitcnt lgkmcnt(10)
    v_mfma_f32_16x16x32_bf16 v[176:179], a[24:27], v[40:43], v[176:179]
    ds_read_b64_tr_b16 a[52:53], v8 offset:57344
    v_mfma_f32_16x16x32_bf16 v[180:183], a[24:27], v[44:47], v[180:183]
    ds_read_b64_tr_b16 a[54:55], v8 offset:61440
    v_add_u32 v8, 0x10000, v8
    v_mfma_f32_16x16x32_bf16 v[188:191], a[28:31], v[44:47], v[188:191]
    ds_read_b64_tr_b16 a[56:57], v9 offset:49152
    v_mfma_f32_16x16x32_bf16 v[184:187], a[28:31], v[40:43], v[184:187]
    ds_read_b64_tr_b16 a[58:59], v9 offset:53248
    s_waitcnt lgkmcnt(10)
    v_mfma_f32_16x16x32_bf16 v[192:195], a[32:35], v[40:43], v[192:195]
    ds_read_b64_tr_b16 a[60:61], v9 offset:57344
    v_mfma_f32_16x16x32_bf16 v[196:199], a[32:35], v[44:47], v[196:199]
    ds_read_b64_tr_b16 a[62:63], v9 offset:61440
    v_add_u32 v9, 0x10000, v9
    v_mfma_f32_16x16x32_bf16 v[204:207], a[36:39], v[44:47], v[204:207]
    ds_read_b64_tr_b16 a[0:1], v2 offset:0
    v_mfma_f32_16x16x32_bf16 v[200:203], a[36:39], v[40:43], v[200:203]
    ds_read_b64_tr_b16 a[2:3], v2 offset:4096
    s_waitcnt lgkmcnt(10)
    v_mfma_f32_16x16x32_bf16 v[208:211], a[40:43], v[40:43], v[208:211]
    ds_read_b64_tr_b16 a[4:5], v2 offset:8192
    v_mfma_f32_16x16x32_bf16 v[212:215], a[40:43], v[44:47], v[212:215]
    ds_read_b64_tr_b16 a[6:7], v2 offset:12288
    v_mfma_f32_16x16x32_bf16 v[220:223], a[44:47], v[44:47], v[220:223]
    ds_read_b64_tr_b16 a[8:9], v3 offset:0
    v_mfma_f32_16x16x32_bf16 v[216:219], a[44:47], v[40:43], v[216:219]
    ds_read_b64_tr_b16 a[10:11], v3 offset:4096
    s_waitcnt lgkmcnt(10)
    v_mfma_f32_16x16x32_bf16 v[224:227], a[48:51], v[40:43], v[224:227]
    ds_read_b64_tr_b16 a[12:13], v3 offset:8192
    v_mfma_f32_16x16x32_bf16 v[228:231], a[48:51], v[44:47], v[228:231]
    ds_read_b64_tr_b16 a[14:15], v3 offset:12288
    v_mfma_f32_16x16x32_bf16 v[236:239], a[52:55], v[44:47], v[236:239]
    ds_read_b64_tr_b16 a[16:17], v4 offset:0
    v_mfma_f32_16x16x32_bf16 v[232:235], a[52:55], v[40:43], v[232:235]
    ds_read_b64_tr_b16 a[18:19], v4 offset:4096
    s_waitcnt lgkmcnt(10)
    v_mfma_f32_16x16x32_bf16 v[240:243], a[56:59], v[40:43], v[240:243]
    ds_read_b64_tr_b16 a[20:21], v4 offset:8192
    v_mfma_f32_16x16x32_bf16 v[244:247], a[56:59], v[44:47], v[244:247]
    ds_read_b64_tr_b16 a[22:23], v4 offset:12288
    v_mfma_f32_16x16x32_bf16 v[252:255], a[60:63], v[44:47], v[252:255]
    ds_read_b64_tr_b16 a[24:25], v5 offset:0
    v_mfma_f32_16x16x32_bf16 v[248:251], a[60:63], v[40:43], v[248:251]
    ds_read_b64_tr_b16 a[26:27], v5 offset:4096
    s_waitcnt lgkmcnt(10)
    s_waitcnt vmcnt(0)
    v_mfma_f32_16x16x32_bf16 v[128:131], a[0:3], v[48:51], v[128:131]
    ds_read_b64_tr_b16 a[28:29], v5 offset:8192
    v_mfma_f32_16x16x32_bf16 v[132:135], a[0:3], v[52:55], v[132:135]
    ds_read_b64_tr_b16 a[30:31], v5 offset:12288
    v_mfma_f32_16x16x32_bf16 v[140:143], a[4:7], v[52:55], v[140:143]
    ds_read_b64_tr_b16 a[32:33], v6 offset:0
    v_mfma_f32_16x16x32_bf16 v[136:139], a[4:7], v[48:51], v[136:139]
    ds_read_b64_tr_b16 a[34:35], v6 offset:4096
    s_waitcnt lgkmcnt(10)
    v_mfma_f32_16x16x32_bf16 v[144:147], a[8:11], v[48:51], v[144:147]
    ds_read_b64_tr_b16 a[36:37], v6 offset:8192
    s_barrier
    v_mfma_f32_16x16x32_bf16 v[148:151], a[8:11], v[52:55], v[148:151]
    ds_read_b64_tr_b16 a[38:39], v6 offset:12288
    v_mfma_f32_16x16x32_bf16 v[156:159], a[12:15], v[52:55], v[156:159]
    ds_read_b64_tr_b16 a[40:41], v7 offset:0
    v_mfma_f32_16x16x32_bf16 v[152:155], a[12:15], v[48:51], v[152:155]
    ds_read_b64_tr_b16 a[42:43], v7 offset:4096
    s_waitcnt lgkmcnt(10)
    v_mfma_f32_16x16x32_bf16 v[160:163], a[16:19], v[48:51], v[160:163]
    ds_read_b64_tr_b16 a[44:45], v7 offset:8192
    s_add_u32 m0, s38, 0
    v_mfma_f32_16x16x32_bf16 v[164:167], a[16:19], v[52:55], v[164:167]
    ds_read_b64_tr_b16 a[46:47], v7 offset:12288
    v_mfma_f32_16x16x32_bf16 v[172:175], a[20:23], v[52:55], v[172:175]
    ds_read_b64_tr_b16 a[48:49], v8 offset:0
    v_mfma_f32_16x16x32_bf16 v[168:171], a[20:23], v[48:51], v[168:171]
    ds_read_b64_tr_b16 a[50:51], v8 offset:4096
    buffer_load_dwordx4 v10, s[8:11], s50 offen offset:0 lds
    s_waitcnt lgkmcnt(10)
    v_mfma_f32_16x16x32_bf16 v[176:179], a[24:27], v[48:51], v[176:179]
    ds_read_b64_tr_b16 a[52:53], v8 offset:8192
    buffer_load_dwordx4 v11, s[8:11], s50 offen offset:1024 lds
    v_mfma_f32_16x16x32_bf16 v[180:183], a[24:27], v[52:55], v[180:183]
    ds_read_b64_tr_b16 a[54:55], v8 offset:12288
    v_mfma_f32_16x16x32_bf16 v[188:191], a[28:31], v[52:55], v[188:191]
    ds_read_b64_tr_b16 a[56:57], v9 offset:0
    v_mfma_f32_16x16x32_bf16 v[184:187], a[28:31], v[48:51], v[184:187]
    ds_read_b64_tr_b16 a[58:59], v9 offset:4096
    s_add_u32 m0, s38, 8192
    s_waitcnt lgkmcnt(10)
    v_mfma_f32_16x16x32_bf16 v[192:195], a[32:35], v[48:51], v[192:195]
    ds_read_b64_tr_b16 a[60:61], v9 offset:8192
    buffer_load_dwordx4 v10, s[16:19], s50 offen offset:0 lds
    v_mfma_f32_16x16x32_bf16 v[196:199], a[32:35], v[52:55], v[196:199]
    ds_read_b64_tr_b16 a[62:63], v9 offset:12288
    v_mfma_f32_16x16x32_bf16 v[204:207], a[36:39], v[52:55], v[204:207]
    ds_read_b64_tr_b16 a[0:1], v2 offset:16384
    v_mfma_f32_16x16x32_bf16 v[200:203], a[36:39], v[48:51], v[200:203]
    ds_read_b64_tr_b16 a[2:3], v2 offset:20480
    buffer_load_dwordx4 v11, s[16:19], s50 offen offset:1024 lds
    s_waitcnt lgkmcnt(10)
    v_mfma_f32_16x16x32_bf16 v[208:211], a[40:43], v[48:51], v[208:211]
    ds_read_b64_tr_b16 a[4:5], v2 offset:24576
    s_add_u32 s50, s50, 114688
    v_mfma_f32_16x16x32_bf16 v[212:215], a[40:43], v[52:55], v[212:215]
    ds_read_b64_tr_b16 a[6:7], v2 offset:28672
    v_mfma_f32_16x16x32_bf16 v[220:223], a[44:47], v[52:55], v[220:223]
    ds_read_b64_tr_b16 a[8:9], v3 offset:16384
    v_mfma_f32_16x16x32_bf16 v[216:219], a[44:47], v[48:51], v[216:219]
    ds_read_b64_tr_b16 a[10:11], v3 offset:20480
    s_add_u32 m0, s38, 16384
    s_waitcnt lgkmcnt(10)
    v_mfma_f32_16x16x32_bf16 v[224:227], a[48:51], v[48:51], v[224:227]
    ds_read_b64_tr_b16 a[12:13], v3 offset:24576
    buffer_load_dwordx4 v10, s[8:11], s50 offen offset:0 lds
    v_mfma_f32_16x16x32_bf16 v[228:231], a[48:51], v[52:55], v[228:231]
    ds_read_b64_tr_b16 a[14:15], v3 offset:28672
    v_mfma_f32_16x16x32_bf16 v[236:239], a[52:55], v[52:55], v[236:239]
    ds_read_b64_tr_b16 a[16:17], v4 offset:16384
    v_mfma_f32_16x16x32_bf16 v[232:235], a[52:55], v[48:51], v[232:235]
    ds_read_b64_tr_b16 a[18:19], v4 offset:20480
    buffer_load_dwordx4 v11, s[8:11], s50 offen offset:1024 lds
    s_waitcnt lgkmcnt(10)
    v_mfma_f32_16x16x32_bf16 v[240:243], a[56:59], v[48:51], v[240:243]
    ds_read_b64_tr_b16 a[20:21], v4 offset:24576
    s_add_u32 m0, s38, 24576
    v_mfma_f32_16x16x32_bf16 v[244:247], a[56:59], v[52:55], v[244:247]
    ds_read_b64_tr_b16 a[22:23], v4 offset:28672
    v_mfma_f32_16x16x32_bf16 v[252:255], a[60:63], v[52:55], v[252:255]
    ds_read_b64_tr_b16 a[24:25], v5 offset:16384
    v_mfma_f32_16x16x32_bf16 v[248:251], a[60:63], v[48:51], v[248:251]
    ds_read_b64_tr_b16 a[26:27], v5 offset:20480
    buffer_load_dwordx4 v10, s[16:19], s50 offen offset:0 lds
    s_waitcnt lgkmcnt(10)
    v_mfma_f32_16x16x32_bf16 v[128:131], a[0:3], v[56:59], v[128:131]
    ds_read_b64_tr_b16 a[28:29], v5 offset:24576
    buffer_load_dwordx4 v11, s[16:19], s50 offen offset:1024 lds
    v_mfma_f32_16x16x32_bf16 v[132:135], a[0:3], v[60:63], v[132:135]
    ds_read_b64_tr_b16 a[30:31], v5 offset:28672
    v_mfma_f32_16x16x32_bf16 v[140:143], a[4:7], v[60:63], v[140:143]
    ds_read_b64_tr_b16 a[32:33], v6 offset:16384
    v_mfma_f32_16x16x32_bf16 v[136:139], a[4:7], v[56:59], v[136:139]
    ds_read_b64_tr_b16 a[34:35], v6 offset:20480
    s_add_u32 s50, s50, 114688
    s_waitcnt lgkmcnt(10)
    v_mfma_f32_16x16x32_bf16 v[144:147], a[8:11], v[56:59], v[144:147]
    ds_read_b64_tr_b16 a[36:37], v6 offset:24576
    s_add_u32 m0, s38, 32768
    v_mfma_f32_16x16x32_bf16 v[148:151], a[8:11], v[60:63], v[148:151]
    ds_read_b64_tr_b16 a[38:39], v6 offset:28672
    v_mfma_f32_16x16x32_bf16 v[156:159], a[12:15], v[60:63], v[156:159]
    ds_read_b64_tr_b16 a[40:41], v7 offset:16384
    v_mfma_f32_16x16x32_bf16 v[152:155], a[12:15], v[56:59], v[152:155]
    ds_read_b64_tr_b16 a[42:43], v7 offset:20480
    buffer_load_dwordx4 v10, s[8:11], s50 offen offset:0 lds
    s_waitcnt lgkmcnt(10)
    v_mfma_f32_16x16x32_bf16 v[160:163], a[16:19], v[56:59], v[160:163]
    ds_read_b64_tr_b16 a[44:45], v7 offset:24576
    buffer_load_dwordx4 v11, s[8:11], s50 offen offset:1024 lds
    v_mfma_f32_16x16x32_bf16 v[164:167], a[16:19], v[60:63], v[164:167]
    ds_read_b64_tr_b16 a[46:47], v7 offset:28672
    v_mfma_f32_16x16x32_bf16 v[172:175], a[20:23], v[60:63], v[172:175]
    ds_read_b64_tr_b16 a[48:49], v8 offset:16384
    v_mfma_f32_16x16x32_bf16 v[168:171], a[20:23], v[56:59], v[168:171]
    ds_read_b64_tr_b16 a[50:51], v8 offset:20480
    s_add_u32 m0, s38, 40960
    s_waitcnt lgkmcnt(10)
    v_mfma_f32_16x16x32_bf16 v[176:179], a[24:27], v[56:59], v[176:179]
    ds_read_b64_tr_b16 a[52:53], v8 offset:24576
    buffer_load_dwordx4 v10, s[16:19], s50 offen offset:0 lds
    v_mfma_f32_16x16x32_bf16 v[180:183], a[24:27], v[60:63], v[180:183]
    ds_read_b64_tr_b16 a[54:55], v8 offset:28672
    v_mfma_f32_16x16x32_bf16 v[188:191], a[28:31], v[60:63], v[188:191]
    ds_read_b64_tr_b16 a[56:57], v9 offset:16384
    v_mfma_f32_16x16x32_bf16 v[184:187], a[28:31], v[56:59], v[184:187]
    ds_read_b64_tr_b16 a[58:59], v9 offset:20480
    buffer_load_dwordx4 v11, s[16:19], s50 offen offset:1024 lds
    s_waitcnt lgkmcnt(10)
    v_mfma_f32_16x16x32_bf16 v[192:195], a[32:35], v[56:59], v[192:195]
    ds_read_b64_tr_b16 a[60:61], v9 offset:24576
    s_add_u32 s50, s50, 114688
    v_mfma_f32_16x16x32_bf16 v[196:199], a[32:35], v[60:63], v[196:199]
    ds_read_b64_tr_b16 a[62:63], v9 offset:28672
    v_mfma_f32_16x16x32_bf16 v[204:207], a[36:39], v[60:63], v[204:207]
    ds_read_b64_tr_b16 a[0:1], v2 offset:32768
    v_mfma_f32_16x16x32_bf16 v[200:203], a[36:39], v[56:59], v[200:203]
    ds_read_b64_tr_b16 a[2:3], v2 offset:36864
    s_add_u32 m0, s38, 49152
    s_waitcnt lgkmcnt(10)
    v_mfma_f32_16x16x32_bf16 v[208:211], a[40:43], v[56:59], v[208:211]
    ds_read_b64_tr_b16 a[4:5], v2 offset:40960
    buffer_load_dwordx4 v10, s[8:11], s50 offen offset:0 lds
    v_mfma_f32_16x16x32_bf16 v[212:215], a[40:43], v[60:63], v[212:215]
    ds_read_b64_tr_b16 a[6:7], v2 offset:45056
    v_mfma_f32_16x16x32_bf16 v[220:223], a[44:47], v[60:63], v[220:223]
    ds_read_b64_tr_b16 a[8:9], v3 offset:32768
    v_mfma_f32_16x16x32_bf16 v[216:219], a[44:47], v[56:59], v[216:219]
    ds_read_b64_tr_b16 a[10:11], v3 offset:36864
    buffer_load_dwordx4 v11, s[8:11], s50 offen offset:1024 lds
    s_waitcnt lgkmcnt(10)
    v_mfma_f32_16x16x32_bf16 v[224:227], a[48:51], v[56:59], v[224:227]
    ds_read_b64_tr_b16 a[12:13], v3 offset:40960
    s_add_u32 m0, s38, 57344
    v_mfma_f32_16x16x32_bf16 v[228:231], a[48:51], v[60:63], v[228:231]
    ds_read_b64_tr_b16 a[14:15], v3 offset:45056
    v_mfma_f32_16x16x32_bf16 v[236:239], a[52:55], v[60:63], v[236:239]
    ds_read_b64_tr_b16 a[16:17], v4 offset:32768
    v_mfma_f32_16x16x32_bf16 v[232:235], a[52:55], v[56:59], v[232:235]
    ds_read_b64_tr_b16 a[18:19], v4 offset:36864
    buffer_load_dwordx4 v10, s[16:19], s50 offen offset:0 lds
    s_waitcnt lgkmcnt(10)
    v_mfma_f32_16x16x32_bf16 v[240:243], a[56:59], v[56:59], v[240:243]
    ds_read_b64_tr_b16 a[20:21], v4 offset:40960
    buffer_load_dwordx4 v11, s[16:19], s50 offen offset:1024 lds
    v_mfma_f32_16x16x32_bf16 v[244:247], a[56:59], v[60:63], v[244:247]
    ds_read_b64_tr_b16 a[22:23], v4 offset:45056
    v_mfma_f32_16x16x32_bf16 v[252:255], a[60:63], v[60:63], v[252:255]
    ds_read_b64_tr_b16 a[24:25], v5 offset:32768
    v_mfma_f32_16x16x32_bf16 v[248:251], a[60:63], v[56:59], v[248:251]
    ds_read_b64_tr_b16 a[26:27], v5 offset:36864
    s_add_u32 s50, s50, 114688
    s_waitcnt lgkmcnt(10)
    v_mfma_f32_16x16x32_bf16 v[128:131], a[0:3], v[64:67], v[128:131]
    ds_read_b64_tr_b16 a[28:29], v5 offset:40960
    v_mfma_f32_16x16x32_bf16 v[132:135], a[0:3], v[68:71], v[132:135]
    ds_read_b64_tr_b16 a[30:31], v5 offset:45056
    v_mfma_f32_16x16x32_bf16 v[140:143], a[4:7], v[68:71], v[140:143]
    ds_read_b64_tr_b16 a[32:33], v6 offset:32768
    v_mfma_f32_16x16x32_bf16 v[136:139], a[4:7], v[64:67], v[136:139]
    ds_read_b64_tr_b16 a[34:35], v6 offset:36864
    s_waitcnt lgkmcnt(10)
    v_mfma_f32_16x16x32_bf16 v[144:147], a[8:11], v[64:67], v[144:147]
    ds_read_b64_tr_b16 a[36:37], v6 offset:40960
    v_mfma_f32_16x16x32_bf16 v[148:151], a[8:11], v[68:71], v[148:151]
    ds_read_b64_tr_b16 a[38:39], v6 offset:45056
    v_mfma_f32_16x16x32_bf16 v[156:159], a[12:15], v[68:71], v[156:159]
    ds_read_b64_tr_b16 a[40:41], v7 offset:32768
    v_and_b32 v10, 15, v0
    v_mfma_f32_16x16x32_bf16 v[152:155], a[12:15], v[64:67], v[152:155]
    ds_read_b64_tr_b16 a[42:43], v7 offset:36864
    s_waitcnt lgkmcnt(10)
    v_bfe_u32 v11, v0, 4, 2
    v_mfma_f32_16x16x32_bf16 v[160:163], a[16:19], v[64:67], v[160:163]
    ds_read_b64_tr_b16 a[44:45], v7 offset:40960
    v_lshlrev_b32 v10, 6, v10
    v_mfma_f32_16x16x32_bf16 v[164:167], a[16:19], v[68:71], v[164:167]
    ds_read_b64_tr_b16 a[46:47], v7 offset:45056
    v_lshlrev_b32 v11, 4, v11
    v_mfma_f32_16x16x32_bf16 v[172:175], a[20:23], v[68:71], v[172:175]
    ds_read_b64_tr_b16 a[48:49], v8 offset:32768
    v_add_u32 v10, v10, v11
    v_mfma_f32_16x16x32_bf16 v[168:171], a[20:23], v[64:67], v[168:171]
    ds_read_b64_tr_b16 a[50:51], v8 offset:36864
    s_waitcnt lgkmcnt(10)
    s_lshl_b32 s39, s73, 7
    v_mfma_f32_16x16x32_bf16 v[176:179], a[24:27], v[64:67], v[176:179]
    ds_read_b64_tr_b16 a[52:53], v8 offset:40960
    s_add_u32 s39, s39, 196608
    v_mfma_f32_16x16x32_bf16 v[180:183], a[24:27], v[68:71], v[180:183]
    ds_read_b64_tr_b16 a[54:55], v8 offset:45056
    s_lshl_b32 s46, s73, 10
    v_mfma_f32_16x16x32_bf16 v[188:191], a[28:31], v[68:71], v[188:191]
    ds_read_b64_tr_b16 a[56:57], v9 offset:32768
    s_add_u32 s46, s46, 0x600000
    v_mfma_f32_16x16x32_bf16 v[184:187], a[28:31], v[64:67], v[184:187]
    ds_read_b64_tr_b16 a[58:59], v9 offset:36864
    s_waitcnt lgkmcnt(10)
    s_mov_b32 s22, s52
    v_mfma_f32_16x16x32_bf16 v[192:195], a[32:35], v[64:67], v[192:195]
    ds_read_b64_tr_b16 a[60:61], v9 offset:40960
    v_mfma_f32_16x16x32_bf16 v[196:199], a[32:35], v[68:71], v[196:199]
    ds_read_b64_tr_b16 a[62:63], v9 offset:45056
    v_mfma_f32_16x16x32_bf16 v[204:207], a[36:39], v[68:71], v[204:207]
    ds_read_b64_tr_b16 a[0:1], v2 offset:49152
    buffer_load_dwordx4 v[16:19], v10, s[40:43], 0 offen sc1
    v_mfma_f32_16x16x32_bf16 v[200:203], a[36:39], v[64:67], v[200:203]
    ds_read_b64_tr_b16 a[2:3], v2 offset:53248
    s_waitcnt lgkmcnt(10)
    v_mfma_f32_16x16x32_bf16 v[208:211], a[40:43], v[64:67], v[208:211]
    ds_read_b64_tr_b16 a[4:5], v2 offset:57344
    v_mfma_f32_16x16x32_bf16 v[212:215], a[40:43], v[68:71], v[212:215]
    ds_read_b64_tr_b16 a[6:7], v2 offset:61440
    v_add_u32 v2, 0x10000, v2
    v_mfma_f32_16x16x32_bf16 v[220:223], a[44:47], v[68:71], v[220:223]
    ds_read_b64_tr_b16 a[8:9], v3 offset:49152
    buffer_load_dwordx4 v[20:23], v10, s[40:43], 0 offen offset:1024 sc1
    v_mfma_f32_16x16x32_bf16 v[216:219], a[44:47], v[64:67], v[216:219]
    ds_read_b64_tr_b16 a[10:11], v3 offset:53248
    s_waitcnt lgkmcnt(10)
    v_mfma_f32_16x16x32_bf16 v[224:227], a[48:51], v[64:67], v[224:227]
    ds_read_b64_tr_b16 a[12:13], v3 offset:57344
    v_mfma_f32_16x16x32_bf16 v[228:231], a[48:51], v[68:71], v[228:231]
    ds_read_b64_tr_b16 a[14:15], v3 offset:61440
    v_add_u32 v3, 0x10000, v3
    v_mov_b32 v10, 0
    v_mfma_f32_16x16x32_bf16 v[236:239], a[52:55], v[68:71], v[236:239]
    ds_read_b64_tr_b16 a[16:17], v4 offset:49152
    v_mfma_f32_16x16x32_bf16 v[232:235], a[52:55], v[64:67], v[232:235]
    ds_read_b64_tr_b16 a[18:19], v4 offset:53248
    s_waitcnt lgkmcnt(10)
    buffer_load_dword v24, v10, s[28:31], s39 offen sc1
    v_mfma_f32_16x16x32_bf16 v[240:243], a[56:59], v[64:67], v[240:243]
    ds_read_b64_tr_b16 a[20:21], v4 offset:57344
    v_mfma_f32_16x16x32_bf16 v[244:247], a[56:59], v[68:71], v[244:247]
    ds_read_b64_tr_b16 a[22:23], v4 offset:61440
    v_add_u32 v4, 0x10000, v4
    v_mfma_f32_16x16x32_bf16 v[252:255], a[60:63], v[68:71], v[252:255]
    ds_read_b64_tr_b16 a[24:25], v5 offset:49152
    s_getpc_b64 s[56:57]
    s_add_u32 s56, s56, L5_entry@rel32@lo+4
    s_addc_u32 s57, s57, L5_entry@rel32@hi+12
    s_mul_i32 s3, s74, (((L_hot_end-L5_entry)/28+63)&~63)
    s_add_u32 s56, s56, s3
    s_addc_u32 s57, s57, 0
    s_sub_u32 s58, L_hot_end-L5_entry, s3
    s_cselect_b32 s58, 0, s58
    s_min_u32 s58, s58, (((L_hot_end-L5_entry)/28+63)&~63)
    s_mov_b32 s59, 0x20000
    v_lshlrev_b32 v25, 6, v0
    buffer_load_dword v25, v25, s[56:59], 0 offen
    v_mfma_f32_16x16x32_bf16 v[248:251], a[60:63], v[64:67], v[248:251]
    ds_read_b64_tr_b16 a[26:27], v5 offset:53248
    s_waitcnt lgkmcnt(10)
    v_mfma_f32_16x16x32_bf16 v[128:131], a[0:3], v[72:75], v[128:131]
    ds_read_b64_tr_b16 a[28:29], v5 offset:57344
    v_mfma_f32_16x16x32_bf16 v[132:135], a[0:3], v[76:79], v[132:135]
    ds_read_b64_tr_b16 a[30:31], v5 offset:61440
    v_add_u32 v5, 0x10000, v5
    v_mfma_f32_16x16x32_bf16 v[140:143], a[4:7], v[76:79], v[140:143]
    ds_read_b64_tr_b16 a[32:33], v6 offset:49152
    v_mfma_f32_16x16x32_bf16 v[136:139], a[4:7], v[72:75], v[136:139]
    ds_read_b64_tr_b16 a[34:35], v6 offset:53248
    s_waitcnt lgkmcnt(10)
    v_mfma_f32_16x16x32_bf16 v[144:147], a[8:11], v[72:75], v[144:147]
    ds_read_b64_tr_b16 a[36:37], v6 offset:57344
    v_mfma_f32_16x16x32_bf16 v[148:151], a[8:11], v[76:79], v[148:151]
    ds_read_b64_tr_b16 a[38:39], v6 offset:61440
    v_add_u32 v6, 0x10000, v6
    v_mfma_f32_16x16x32_bf16 v[156:159], a[12:15], v[76:79], v[156:159]
    ds_read_b64_tr_b16 a[40:41], v7 offset:49152
    s_mul_i32 s37, s36, 57344
    v_mfma_f32_16x16x32_bf16 v[152:155], a[12:15], v[72:75], v[152:155]
    ds_read_b64_tr_b16 a[42:43], v7 offset:53248
    s_waitcnt lgkmcnt(10)
    v_mfma_f32_16x16x32_bf16 v[160:163], a[16:19], v[72:75], v[160:163]
    ds_read_b64_tr_b16 a[44:45], v7 offset:57344
    s_lshl_b32 s3, s73, 12
    v_mfma_f32_16x16x32_bf16 v[164:167], a[16:19], v[76:79], v[164:167]
    ds_read_b64_tr_b16 a[46:47], v7 offset:61440
    v_add_u32 v7, 0x10000, v7
    v_mfma_f32_16x16x32_bf16 v[172:175], a[20:23], v[76:79], v[172:175]
    ds_read_b64_tr_b16 a[48:49], v8 offset:49152
    s_add_u32 s37, s37, s3
    v_mfma_f32_16x16x32_bf16 v[168:171], a[20:23], v[72:75], v[168:171]
    ds_read_b64_tr_b16 a[50:51], v8 offset:53248
    s_waitcnt lgkmcnt(10)
    v_mfma_f32_16x16x32_bf16 v[176:179], a[24:27], v[72:75], v[176:179]
    ds_read_b64_tr_b16 a[52:53], v8 offset:57344
    s_mul_i32 s36, s44, 401408
    v_mfma_f32_16x16x32_bf16 v[180:183], a[24:27], v[76:79], v[180:183]
    ds_read_b64_tr_b16 a[54:55], v8 offset:61440
    v_add_u32 v8, 0x10000, v8
    v_mfma_f32_16x16x32_bf16 v[188:191], a[28:31], v[76:79], v[188:191]
    ds_read_b64_tr_b16 a[56:57], v9 offset:49152
    s_lshl_b32 s3, s71, 7
    v_mfma_f32_16x16x32_bf16 v[184:187], a[28:31], v[72:75], v[184:187]
    ds_read_b64_tr_b16 a[58:59], v9 offset:53248
    s_waitcnt lgkmcnt(10)
    v_mfma_f32_16x16x32_bf16 v[192:195], a[32:35], v[72:75], v[192:195]
    ds_read_b64_tr_b16 a[60:61], v9 offset:57344
    s_add_u32 s36, s36, s3
    v_mfma_f32_16x16x32_bf16 v[196:199], a[32:35], v[76:79], v[196:199]
    ds_read_b64_tr_b16 a[62:63], v9 offset:61440
    v_add_u32 v9, 0x10000, v9
    v_mfma_f32_16x16x32_bf16 v[204:207], a[36:39], v[76:79], v[204:207]
    ds_read_b64_tr_b16 a[0:1], v2 offset:0
    s_add_u32 s16, s60, s36
    s_addc_u32 s17, s61, 0
    v_mfma_f32_16x16x32_bf16 v[200:203], a[36:39], v[72:75], v[200:203]
    ds_read_b64_tr_b16 a[2:3], v2 offset:4096
    s_waitcnt lgkmcnt(10)
    v_mfma_f32_16x16x32_bf16 v[208:211], a[40:43], v[72:75], v[208:211]
    ds_read_b64_tr_b16 a[4:5], v2 offset:8192
    v_mfma_f32_16x16x32_bf16 v[212:215], a[40:43], v[76:79], v[212:215]
    ds_read_b64_tr_b16 a[6:7], v2 offset:12288
    v_mfma_f32_16x16x32_bf16 v[220:223], a[44:47], v[76:79], v[220:223]
    ds_read_b64_tr_b16 a[8:9], v3 offset:0
    s_sub_u32 s18, 1605632, s36
    v_mfma_f32_16x16x32_bf16 v[216:219], a[44:47], v[72:75], v[216:219]
    ds_read_b64_tr_b16 a[10:11], v3 offset:4096
    s_waitcnt lgkmcnt(10)
    v_mfma_f32_16x16x32_bf16 v[224:227], a[48:51], v[72:75], v[224:227]
    ds_read_b64_tr_b16 a[12:13], v3 offset:8192
    s_mov_b32 s36, 0
    v_mfma_f32_16x16x32_bf16 v[228:231], a[48:51], v[76:79], v[228:231]
    ds_read_b64_tr_b16 a[14:15], v3 offset:12288
    v_mfma_f32_16x16x32_bf16 v[236:239], a[52:55], v[76:79], v[236:239]
    ds_read_b64_tr_b16 a[16:17], v4 offset:0
    s_mul_i32 s53, s44, 24576
    v_mfma_f32_16x16x32_bf16 v[232:235], a[52:55], v[72:75], v[232:235]
    ds_read_b64_tr_b16 a[18:19], v4 offset:4096
    s_waitcnt lgkmcnt(10)
    v_mfma_f32_16x16x32_bf16 v[240:243], a[56:59], v[72:75], v[240:243]
    ds_read_b64_tr_b16 a[20:21], v4 offset:8192
    s_add_u32 s53, s53, 65536
    v_mfma_f32_16x16x32_bf16 v[244:247], a[56:59], v[76:79], v[244:247]
    ds_read_b64_tr_b16 a[22:23], v4 offset:12288
    v_mfma_f32_16x16x32_bf16 v[252:255], a[60:63], v[76:79], v[252:255]
    ds_read_b64_tr_b16 a[24:25], v5 offset:0
    s_lshl_b32 s54, s44, 14
    v_mfma_f32_16x16x32_bf16 v[248:251], a[60:63], v[72:75], v[248:251]
    ds_read_b64_tr_b16 a[26:27], v5 offset:4096
    s_waitcnt lgkmcnt(10)
    v_mfma_f32_16x16x32_bf16 v[128:131], a[0:3], v[80:83], v[128:131]
    ds_read_b64_tr_b16 a[28:29], v5 offset:8192
    v_accvgpr_read_b32 v12, a248
    v_mfma_f32_16x16x32_bf16 v[132:135], a[0:3], v[84:87], v[132:135]
    ds_read_b64_tr_b16 a[30:31], v5 offset:12288
    v_mfma_f32_16x16x32_bf16 v[140:143], a[4:7], v[84:87], v[140:143]
    ds_read_b64_tr_b16 a[32:33], v6 offset:0
    v_accvgpr_read_b32 v13, a249
    v_mfma_f32_16x16x32_bf16 v[136:139], a[4:7], v[80:83], v[136:139]
    ds_read_b64_tr_b16 a[34:35], v6 offset:4096
    s_waitcnt lgkmcnt(10)
    v_mfma_f32_16x16x32_bf16 v[144:147], a[8:11], v[80:83], v[144:147]
    ds_read_b64_tr_b16 a[36:37], v6 offset:8192
    v_accvgpr_read_b32 v14, a250
    v_mfma_f32_16x16x32_bf16 v[148:151], a[8:11], v[84:87], v[148:151]
    ds_read_b64_tr_b16 a[38:39], v6 offset:12288
    v_mfma_f32_16x16x32_bf16 v[156:159], a[12:15], v[84:87], v[156:159]
    ds_read_b64_tr_b16 a[40:41], v7 offset:0
    v_accvgpr_read_b32 v15, a251
    v_mfma_f32_16x16x32_bf16 v[152:155], a[12:15], v[80:83], v[152:155]
    ds_read_b64_tr_b16 a[42:43], v7 offset:4096
    s_waitcnt lgkmcnt(10)
    v_mfma_f32_16x16x32_bf16 v[160:163], a[16:19], v[80:83], v[160:163]
    ds_read_b64_tr_b16 a[44:45], v7 offset:8192
    v_mfma_f32_16x16x32_bf16 v[164:167], a[16:19], v[84:87], v[164:167]
    ds_read_b64_tr_b16 a[46:47], v7 offset:12288
    v_mfma_f32_16x16x32_bf16 v[172:175], a[20:23], v[84:87], v[172:175]
    ds_read_b64_tr_b16 a[48:49], v8 offset:0
    v_mfma_f32_16x16x32_bf16 v[168:171], a[20:23], v[80:83], v[168:171]
    ds_read_b64_tr_b16 a[50:51], v8 offset:4096
    s_waitcnt lgkmcnt(10)
    v_mfma_f32_16x16x32_bf16 v[176:179], a[24:27], v[80:83], v[176:179]
    ds_read_b64_tr_b16 a[52:53], v8 offset:8192
    v_mfma_f32_16x16x32_bf16 v[180:183], a[24:27], v[84:87], v[180:183]
    ds_read_b64_tr_b16 a[54:55], v8 offset:12288
    v_mfma_f32_16x16x32_bf16 v[188:191], a[28:31], v[84:87], v[188:191]
    ds_read_b64_tr_b16 a[56:57], v9 offset:0
    v_mfma_f32_16x16x32_bf16 v[184:187], a[28:31], v[80:83], v[184:187]
    ds_read_b64_tr_b16 a[58:59], v9 offset:4096
    s_waitcnt lgkmcnt(10)
    v_mfma_f32_16x16x32_bf16 v[192:195], a[32:35], v[80:83], v[192:195]
    ds_read_b64_tr_b16 a[60:61], v9 offset:8192
    v_mfma_f32_16x16x32_bf16 v[196:199], a[32:35], v[84:87], v[196:199]
    ds_read_b64_tr_b16 a[62:63], v9 offset:12288
    v_mfma_f32_16x16x32_bf16 v[204:207], a[36:39], v[84:87], v[204:207]
    ds_read_b64_tr_b16 a[0:1], v2 offset:16384
    v_mfma_f32_16x16x32_bf16 v[200:203], a[36:39], v[80:83], v[200:203]
    ds_read_b64_tr_b16 a[2:3], v2 offset:20480
    s_waitcnt lgkmcnt(10)
    v_mfma_f32_16x16x32_bf16 v[208:211], a[40:43], v[80:83], v[208:211]
    ds_read_b64_tr_b16 a[4:5], v2 offset:24576
    v_mfma_f32_16x16x32_bf16 v[212:215], a[40:43], v[84:87], v[212:215]
    ds_read_b64_tr_b16 a[6:7], v2 offset:28672
    v_subrev_u32 v2, 0x20000, v2
    v_mfma_f32_16x16x32_bf16 v[220:223], a[44:47], v[84:87], v[220:223]
    ds_read_b64_tr_b16 a[8:9], v3 offset:16384
    v_mfma_f32_16x16x32_bf16 v[216:219], a[44:47], v[80:83], v[216:219]
    ds_read_b64_tr_b16 a[10:11], v3 offset:20480
    s_waitcnt lgkmcnt(10)
    v_mfma_f32_16x16x32_bf16 v[224:227], a[48:51], v[80:83], v[224:227]
    ds_read_b64_tr_b16 a[12:13], v3 offset:24576
    v_mfma_f32_16x16x32_bf16 v[228:231], a[48:51], v[84:87], v[228:231]
    ds_read_b64_tr_b16 a[14:15], v3 offset:28672
    v_subrev_u32 v3, 0x20000, v3
    v_mfma_f32_16x16x32_bf16 v[236:239], a[52:55], v[84:87], v[236:239]
    ds_read_b64_tr_b16 a[16:17], v4 offset:16384
    v_mfma_f32_16x16x32_bf16 v[232:235], a[52:55], v[80:83], v[232:235]
    ds_read_b64_tr_b16 a[18:19], v4 offset:20480
    s_waitcnt lgkmcnt(10)
    v_mfma_f32_16x16x32_bf16 v[240:243], a[56:59], v[80:83], v[240:243]
    ds_read_b64_tr_b16 a[20:21], v4 offset:24576
    v_mfma_f32_16x16x32_bf16 v[244:247], a[56:59], v[84:87], v[244:247]
    ds_read_b64_tr_b16 a[22:23], v4 offset:28672
    v_subrev_u32 v4, 0x20000, v4
    v_mfma_f32_16x16x32_bf16 v[252:255], a[60:63], v[84:87], v[252:255]
    ds_read_b64_tr_b16 a[24:25], v5 offset:16384
    v_mfma_f32_16x16x32_bf16 v[248:251], a[60:63], v[80:83], v[248:251]
    ds_read_b64_tr_b16 a[26:27], v5 offset:20480
    s_waitcnt lgkmcnt(10)
    v_mfma_f32_16x16x32_bf16 v[128:131], a[0:3], v[88:91], v[128:131]
    ds_read_b64_tr_b16 a[28:29], v5 offset:24576
    v_mfma_f32_16x16x32_bf16 v[132:135], a[0:3], v[92:95], v[132:135]
    ds_read_b64_tr_b16 a[30:31], v5 offset:28672
    v_subrev_u32 v5, 0x20000, v5
    v_mfma_f32_16x16x32_bf16 v[140:143], a[4:7], v[92:95], v[140:143]
    ds_read_b64_tr_b16 a[32:33], v6 offset:16384
    v_mfma_f32_16x16x32_bf16 v[136:139], a[4:7], v[88:91], v[136:139]
    ds_read_b64_tr_b16 a[34:35], v6 offset:20480
    s_waitcnt lgkmcnt(10)
    v_mfma_f32_16x16x32_bf16 v[144:147], a[8:11], v[88:91], v[144:147]
    ds_read_b64_tr_b16 a[36:37], v6 offset:24576
    v_mfma_f32_16x16x32_bf16 v[148:151], a[8:11], v[92:95], v[148:151]
    ds_read_b64_tr_b16 a[38:39], v6 offset:28672
    v_subrev_u32 v6, 0x20000, v6
    v_mfma_f32_16x16x32_bf16 v[156:159], a[12:15], v[92:95], v[156:159]
    ds_read_b64_tr_b16 a[40:41], v7 offset:16384
    v_mfma_f32_16x16x32_bf16 v[152:155], a[12:15], v[88:91], v[152:155]
    ds_read_b64_tr_b16 a[42:43], v7 offset:20480
    s_waitcnt lgkmcnt(10)
    v_mfma_f32_16x16x32_bf16 v[160:163], a[16:19], v[88:91], v[160:163]
    ds_read_b64_tr_b16 a[44:45], v7 offset:24576
    v_mfma_f32_16x16x32_bf16 v[164:167], a[16:19], v[92:95], v[164:167]
    ds_read_b64_tr_b16 a[46:47], v7 offset:28672
    v_subrev_u32 v7, 0x20000, v7
    v_mfma_f32_16x16x32_bf16 v[172:175], a[20:23], v[92:95], v[172:175]
    ds_read_b64_tr_b16 a[48:49], v8 offset:16384
    v_mfma_f32_16x16x32_bf16 v[168:171], a[20:23], v[88:91], v[168:171]
    ds_read_b64_tr_b16 a[50:51], v8 offset:20480
    s_waitcnt lgkmcnt(10)
    v_mfma_f32_16x16x32_bf16 v[176:179], a[24:27], v[88:91], v[176:179]
    ds_read_b64_tr_b16 a[52:53], v8 offset:24576
    v_mfma_f32_16x16x32_bf16 v[180:183], a[24:27], v[92:95], v[180:183]
    ds_read_b64_tr_b16 a[54:55], v8 offset:28672
    v_subrev_u32 v8, 0x20000, v8
    v_mfma_f32_16x16x32_bf16 v[188:191], a[28:31], v[92:95], v[188:191]
    ds_read_b64_tr_b16 a[56:57], v9 offset:16384
    v_mfma_f32_16x16x32_bf16 v[184:187], a[28:31], v[88:91], v[184:187]
    ds_read_b64_tr_b16 a[58:59], v9 offset:20480
    s_waitcnt lgkmcnt(10)
    v_mfma_f32_16x16x32_bf16 v[192:195], a[32:35], v[88:91], v[192:195]
    ds_read_b64_tr_b16 a[60:61], v9 offset:24576
    v_mfma_f32_16x16x32_bf16 v[196:199], a[32:35], v[92:95], v[196:199]
    ds_read_b64_tr_b16 a[62:63], v9 offset:28672
    v_subrev_u32 v9, 0x20000, v9
    s_waitcnt vmcnt(1)
    s_barrier
    v_mfma_f32_16x16x32_bf16 v[204:207], a[36:39], v[92:95], v[204:207]
    ds_read_b64_tr_b16 a[0:1], v2 offset:0
    v_mfma_f32_16x16x32_bf16 v[200:203], a[36:39], v[88:91], v[200:203]
    ds_read_b64_tr_b16 a[2:3], v2 offset:4096
    s_waitcnt lgkmcnt(10)
    v_mfma_f32_16x16x32_bf16 v[208:211], a[40:43], v[88:91], v[208:211]
    ds_read_b64_tr_b16 a[4:5], v2 offset:8192
    v_mfma_f32_16x16x32_bf16 v[212:215], a[40:43], v[92:95], v[212:215]
    ds_read_b64_tr_b16 a[6:7], v2 offset:12288
    v_cmp_ne_u32 vcc, s7, v24
    s_cbranch_vccnz L4_cw
L4_cr:
    v_mfma_f32_16x16x32_bf16 v[220:223], a[44:47], v[92:95], v[220:223]
    ds_read_b64_tr_b16 a[8:9], v3 offset:0
    v_mfma_f32_16x16x32_bf16 v[216:219], a[44:47], v[88:91], v[216:219]
    ds_read_b64_tr_b16 a[10:11], v3 offset:4096
    s_waitcnt lgkmcnt(10)
    buffer_load_dwordx4 v[24:27], v11, s[20:23], s46 offen offset:0 sc1
    v_mfma_f32_16x16x32_bf16 v[224:227], a[48:51], v[88:91], v[224:227]
    ds_read_b64_tr_b16 a[12:13], v3 offset:8192
    buffer_load_dwordx4 v[28:31], v11, s[20:23], s46 offen offset:64 sc1
    v_mfma_f32_16x16x32_bf16 v[228:231], a[48:51], v[92:95], v[228:231]
    ds_read_b64_tr_b16 a[14:15], v3 offset:12288
    buffer_load_dwordx4 v[32:35], v11, s[20:23], s46 offen offset:128 sc1
    v_mfma_f32_16x16x32_bf16 v[236:239], a[52:55], v[92:95], v[236:239]
    ds_read_b64_tr_b16 a[16:17], v4 offset:0
    buffer_load_dwordx4 v[36:39], v11, s[20:23], s46 offen offset:192 sc1
    v_mfma_f32_16x16x32_bf16 v[232:235], a[52:55], v[88:91], v[232:235]
    ds_read_b64_tr_b16 a[18:19], v4 offset:4096
    s_waitcnt lgkmcnt(10)
    buffer_load_dwordx4 v[40:43], v11, s[20:23], s46 offen offset:256 sc1
    v_mfma_f32_16x16x32_bf16 v[240:243], a[56:59], v[88:91], v[240:243]
    ds_read_b64_tr_b16 a[20:21], v4 offset:8192
    buffer_load_dwordx4 v[44:47], v11, s[20:23], s46 offen offset:320 sc1
    v_mfma_f32_16x16x32_bf16 v[244:247], a[56:59], v[92:95], v[244:247]
    ds_read_b64_tr_b16 a[22:23], v4 offset:12288
    buffer_load_dwordx4 v[48:51], v11, s[20:23], s46 offen offset:384 sc1
    v_mfma_f32_16x16x32_bf16 v[252:255], a[60:63], v[92:95], v[252:255]
    ds_read_b64_tr_b16 a[24:25], v5 offset:0
    buffer_load_dwordx4 v[52:55], v11, s[20:23], s46 offen offset:448 sc1
    v_mfma_f32_16x16x32_bf16 v[248:251], a[60:63], v[88:91], v[248:251]
    ds_read_b64_tr_b16 a[26:27], v5 offset:4096
    s_waitcnt lgkmcnt(10)
    buffer_load_dwordx4 v[56:59], v11, s[20:23], s46 offen offset:512 sc1
    v_mfma_f32_16x16x32_bf16 v[128:131], a[0:3], v[96:99], v[128:131]
    ds_read_b64_tr_b16 a[28:29], v5 offset:8192
    buffer_load_dwordx4 v[60:63], v11, s[20:23], s46 offen offset:576 sc1
    v_mfma_f32_16x16x32_bf16 v[132:135], a[0:3], v[100:103], v[132:135]
    ds_read_b64_tr_b16 a[30:31], v5 offset:12288
    buffer_load_dwordx4 v[64:67], v11, s[20:23], s46 offen offset:640 sc1
    v_mfma_f32_16x16x32_bf16 v[140:143], a[4:7], v[100:103], v[140:143]
    ds_read_b64_tr_b16 a[32:33], v6 offset:0
    buffer_load_dwordx4 v[68:71], v11, s[20:23], s46 offen offset:704 sc1
    v_mfma_f32_16x16x32_bf16 v[136:139], a[4:7], v[96:99], v[136:139]
    ds_read_b64_tr_b16 a[34:35], v6 offset:4096
    s_waitcnt lgkmcnt(10)
    buffer_load_dwordx4 v[72:75], v11, s[20:23], s46 offen offset:768 sc1
    v_mfma_f32_16x16x32_bf16 v[144:147], a[8:11], v[96:99], v[144:147]
    ds_read_b64_tr_b16 a[36:37], v6 offset:8192
    buffer_load_dwordx4 v[76:79], v11, s[20:23], s46 offen offset:832 sc1
    v_mfma_f32_16x16x32_bf16 v[148:151], a[8:11], v[100:103], v[148:151]
    ds_read_b64_tr_b16 a[38:39], v6 offset:12288
    buffer_load_dwordx4 v[80:83], v11, s[20:23], s46 offen offset:896 sc1
    v_mfma_f32_16x16x32_bf16 v[156:159], a[12:15], v[100:103], v[156:159]
    ds_read_b64_tr_b16 a[40:41], v7 offset:0
    buffer_load_dwordx4 v[84:87], v11, s[20:23], s46 offen offset:960 sc1
    v_mfma_f32_16x16x32_bf16 v[152:155], a[12:15], v[96:99], v[152:155]
    ds_read_b64_tr_b16 a[42:43], v7 offset:4096
    s_waitcnt lgkmcnt(10)
    v_mfma_f32_16x16x32_bf16 v[160:163], a[16:19], v[96:99], v[160:163]
    ds_read_b64_tr_b16 a[44:45], v7 offset:8192
    s_barrier
    v_mfma_f32_16x16x32_bf16 v[164:167], a[16:19], v[100:103], v[164:167]
    ds_read_b64_tr_b16 a[46:47], v7 offset:12288
    s_add_u32 m0, s53, 0
    v_mfma_f32_16x16x32_bf16 v[172:175], a[20:23], v[100:103], v[172:175]
    ds_read_b64_tr_b16 a[48:49], v8 offset:0
    buffer_load_dwordx4 v12, s[16:19], s36 offen offset:0 lds
    v_mfma_f32_16x16x32_bf16 v[168:171], a[20:23], v[96:99], v[168:171]
    ds_read_b64_tr_b16 a[50:51], v8 offset:4096
    s_waitcnt lgkmcnt(10)
    v_mfma_f32_16x16x32_bf16 v[176:179], a[24:27], v[96:99], v[176:179]
    ds_read_b64_tr_b16 a[52:53], v8 offset:8192
    v_mfma_f32_16x16x32_bf16 v[180:183], a[24:27], v[100:103], v[180:183]
    ds_read_b64_tr_b16 a[54:55], v8 offset:12288
    v_mfma_f32_16x16x32_bf16 v[188:191], a[28:31], v[100:103], v[188:191]
    ds_read_b64_tr_b16 a[56:57], v9 offset:0
    buffer_load_dwordx4 v13, s[16:19], s36 offen offset:1024 lds
    v_mfma_f32_16x16x32_bf16 v[184:187], a[28:31], v[96:99], v[184:187]
    ds_read_b64_tr_b16 a[58:59], v9 offset:4096
    s_waitcnt lgkmcnt(10)
    v_mfma_f32_16x16x32_bf16 v[192:195], a[32:35], v[96:99], v[192:195]
    ds_read_b64_tr_b16 a[60:61], v9 offset:8192
    v_mfma_f32_16x16x32_bf16 v[196:199], a[32:35], v[100:103], v[196:199]
    ds_read_b64_tr_b16 a[62:63], v9 offset:12288
    v_mfma_f32_16x16x32_bf16 v[204:207], a[36:39], v[100:103], v[204:207]
    ds_read_b64_tr_b16 a[0:1], v2 offset:16384
    buffer_load_dwordx4 v14, s[16:19], s36 offen offset:2048 lds
    v_mfma_f32_16x16x32_bf16 v[200:203], a[36:39], v[96:99], v[200:203]
    ds_read_b64_tr_b16 a[2:3], v2 offset:20480
    s_waitcnt lgkmcnt(10)
    v_mfma_f32_16x16x32_bf16 v[208:211], a[40:43], v[96:99], v[208:211]
    ds_read_b64_tr_b16 a[4:5], v2 offset:24576
    v_mfma_f32_16x16x32_bf16 v[212:215], a[40:43], v[100:103], v[212:215]
    ds_read_b64_tr_b16 a[6:7], v2 offset:28672
    v_mfma_f32_16x16x32_bf16 v[220:223], a[44:47], v[100:103], v[220:223]
    ds_read_b64_tr_b16 a[8:9], v3 offset:16384
    buffer_load_dwordx4 v15, s[16:19], s36 offen offset:3072 lds
    v_mfma_f32_16x16x32_bf16 v[216:219], a[44:47], v[96:99], v[216:219]
    ds_read_b64_tr_b16 a[10:11], v3 offset:20480
    s_waitcnt lgkmcnt(10)
    v_mfma_f32_16x16x32_bf16 v[224:227], a[48:51], v[96:99], v[224:227]
    ds_read_b64_tr_b16 a[12:13], v3 offset:24576
    v_mfma_f32_16x16x32_bf16 v[228:231], a[48:51], v[100:103], v[228:231]
    ds_read_b64_tr_b16 a[14:15], v3 offset:28672
    v_mfma_f32_16x16x32_bf16 v[236:239], a[52:55], v[100:103], v[236:239]
    ds_read_b64_tr_b16 a[16:17], v4 offset:16384
    s_add_u32 s36, s36, 28672
    s_add_u32 m0, s53, 4096
    v_mfma_f32_16x16x32_bf16 v[232:235], a[52:55], v[96:99], v[232:235]
    ds_read_b64_tr_b16 a[18:19], v4 offset:20480
    s_waitcnt lgkmcnt(10)
    buffer_load_dwordx4 v12, s[16:19], s36 offen offset:0 lds
    v_mfma_f32_16x16x32_bf16 v[240:243], a[56:59], v[96:99], v[240:243]
    ds_read_b64_tr_b16 a[20:21], v4 offset:24576
    v_mfma_f32_16x16x32_bf16 v[244:247], a[56:59], v[100:103], v[244:247]
    ds_read_b64_tr_b16 a[22:23], v4 offset:28672
    v_mfma_f32_16x16x32_bf16 v[252:255], a[60:63], v[100:103], v[252:255]
    ds_read_b64_tr_b16 a[24:25], v5 offset:16384
    v_mfma_f32_16x16x32_bf16 v[248:251], a[60:63], v[96:99], v[248:251]
    ds_read_b64_tr_b16 a[26:27], v5 offset:20480
    s_waitcnt lgkmcnt(10)
    buffer_load_dwordx4 v13, s[16:19], s36 offen offset:1024 lds
    v_mfma_f32_16x16x32_bf16 v[128:131], a[0:3], v[104:107], v[128:131]
    ds_read_b64_tr_b16 a[28:29], v5 offset:24576
    v_mfma_f32_16x16x32_bf16 v[132:135], a[0:3], v[108:111], v[132:135]
    ds_read_b64_tr_b16 a[30:31], v5 offset:28672
    v_mfma_f32_16x16x32_bf16 v[140:143], a[4:7], v[108:111], v[140:143]
    ds_read_b64_tr_b16 a[32:33], v6 offset:16384
    v_mfma_f32_16x16x32_bf16 v[136:139], a[4:7], v[104:107], v[136:139]
    ds_read_b64_tr_b16 a[34:35], v6 offset:20480
    s_waitcnt lgkmcnt(10)
    buffer_load_dwordx4 v14, s[16:19], s36 offen offset:2048 lds
    v_mfma_f32_16x16x32_bf16 v[144:147], a[8:11], v[104:107], v[144:147]
    ds_read_b64_tr_b16 a[36:37], v6 offset:24576
    v_mfma_f32_16x16x32_bf16 v[148:151], a[8:11], v[108:111], v[148:151]
    ds_read_b64_tr_b16 a[38:39], v6 offset:28672
    v_mfma_f32_16x16x32_bf16 v[156:159], a[12:15], v[108:111], v[156:159]
    ds_read_b64_tr_b16 a[40:41], v7 offset:16384
    v_mfma_f32_16x16x32_bf16 v[152:155], a[12:15], v[104:107], v[152:155]
    ds_read_b64_tr_b16 a[42:43], v7 offset:20480
    s_waitcnt lgkmcnt(10)
    buffer_load_dwordx4 v15, s[16:19], s36 offen offset:3072 lds
    v_mfma_f32_16x16x32_bf16 v[160:163], a[16:19], v[104:107], v[160:163]
    ds_read_b64_tr_b16 a[44:45], v7 offset:24576
    v_mfma_f32_16x16x32_bf16 v[164:167], a[16:19], v[108:111], v[164:167]
    ds_read_b64_tr_b16 a[46:47], v7 offset:28672
    v_mfma_f32_16x16x32_bf16 v[172:175], a[20:23], v[108:111], v[172:175]
    ds_read_b64_tr_b16 a[48:49], v8 offset:16384
    v_mfma_f32_16x16x32_bf16 v[168:171], a[20:23], v[104:107], v[168:171]
    ds_read_b64_tr_b16 a[50:51], v8 offset:20480
    s_waitcnt lgkmcnt(10)
    s_add_u32 s36, s36, 28672
    s_add_u32 m0, s53, 8192
    v_mfma_f32_16x16x32_bf16 v[176:179], a[24:27], v[104:107], v[176:179]
    ds_read_b64_tr_b16 a[52:53], v8 offset:24576
    buffer_load_dwordx4 v12, s[16:19], s36 offen offset:0 lds
    v_mfma_f32_16x16x32_bf16 v[180:183], a[24:27], v[108:111], v[180:183]
    ds_read_b64_tr_b16 a[54:55], v8 offset:28672
    v_mfma_f32_16x16x32_bf16 v[188:191], a[28:31], v[108:111], v[188:191]
    ds_read_b64_tr_b16 a[56:57], v9 offset:16384
    v_mfma_f32_16x16x32_bf16 v[184:187], a[28:31], v[104:107], v[184:187]
    ds_read_b64_tr_b16 a[58:59], v9 offset:20480
    s_waitcnt lgkmcnt(10)
    v_mfma_f32_16x16x32_bf16 v[192:195], a[32:35], v[104:107], v[192:195]
    ds_read_b64_tr_b16 a[60:61], v9 offset:24576
    buffer_load_dwordx4 v13, s[16:19], s36 offen offset:1024 lds
    v_mfma_f32_16x16x32_bf16 v[196:199], a[32:35], v[108:111], v[196:199]
    ds_read_b64_tr_b16 a[62:63], v9 offset:28672
    v_mfma_f32_16x16x32_bf16 v[204:207], a[36:39], v[108:111], v[204:207]
    ds_read_b64_tr_b16 a[0:1], v2 offset:32768
    v_mfma_f32_16x16x32_bf16 v[200:203], a[36:39], v[104:107], v[200:203]
    ds_read_b64_tr_b16 a[2:3], v2 offset:36864
    s_waitcnt lgkmcnt(10)
    v_mfma_f32_16x16x32_bf16 v[208:211], a[40:43], v[104:107], v[208:211]
    ds_read_b64_tr_b16 a[4:5], v2 offset:40960
    buffer_load_dwordx4 v14, s[16:19], s36 offen offset:2048 lds
    v_mfma_f32_16x16x32_bf16 v[212:215], a[40:43], v[108:111], v[212:215]
    ds_read_b64_tr_b16 a[6:7], v2 offset:45056
    v_mfma_f32_16x16x32_bf16 v[220:223], a[44:47], v[108:111], v[220:223]
    ds_read_b64_tr_b16 a[8:9], v3 offset:32768
    v_mfma_f32_16x16x32_bf16 v[216:219], a[44:47], v[104:107], v[216:219]
    ds_read_b64_tr_b16 a[10:11], v3 offset:36864
    s_waitcnt lgkmcnt(10)
    v_mfma_f32_16x16x32_bf16 v[224:227], a[48:51], v[104:107], v[224:227]
    ds_read_b64_tr_b16 a[12:13], v3 offset:40960
    buffer_load_dwordx4 v15, s[16:19], s36 offen offset:3072 lds
    v_mfma_f32_16x16x32_bf16 v[228:231], a[48:51], v[108:111], v[228:231]
    ds_read_b64_tr_b16 a[14:15], v3 offset:45056
    v_mfma_f32_16x16x32_bf16 v[236:239], a[52:55], v[108:111], v[236:239]
    ds_read_b64_tr_b16 a[16:17], v4 offset:32768
    v_mfma_f32_16x16x32_bf16 v[232:235], a[52:55], v[104:107], v[232:235]
    ds_read_b64_tr_b16 a[18:19], v4 offset:36864
    s_waitcnt lgkmcnt(10)
    v_mfma_f32_16x16x32_bf16 v[240:243], a[56:59], v[104:107], v[240:243]
    ds_read_b64_tr_b16 a[20:21], v4 offset:40960
    s_add_u32 s36, s36, 28672
    s_add_u32 m0, s53, 12288
    v_mfma_f32_16x16x32_bf16 v[244:247], a[56:59], v[108:111], v[244:247]
    ds_read_b64_tr_b16 a[22:23], v4 offset:45056
    buffer_load_dwordx4 v12, s[16:19], s36 offen offset:0 lds
    v_mfma_f32_16x16x32_bf16 v[252:255], a[60:63], v[108:111], v[252:255]
    ds_read_b64_tr_b16 a[24:25], v5 offset:32768
    v_mfma_f32_16x16x32_bf16 v[248:251], a[60:63], v[104:107], v[248:251]
    ds_read_b64_tr_b16 a[26:27], v5 offset:36864
    s_waitcnt lgkmcnt(10)
    v_mfma_f32_16x16x32_bf16 v[128:131], a[0:3], v[112:115], v[128:131]
    ds_read_b64_tr_b16 a[28:29], v5 offset:40960
    v_mfma_f32_16x16x32_bf16 v[132:135], a[0:3], v[116:119], v[132:135]
    ds_read_b64_tr_b16 a[30:31], v5 offset:45056
    buffer_load_dwordx4 v13, s[16:19], s36 offen offset:1024 lds
    v_mfma_f32_16x16x32_bf16 v[140:143], a[4:7], v[116:119], v[140:143]
    ds_read_b64_tr_b16 a[32:33], v6 offset:32768
    v_mfma_f32_16x16x32_bf16 v[136:139], a[4:7], v[112:115], v[136:139]
    ds_read_b64_tr_b16 a[34:35], v6 offset:36864
    s_waitcnt lgkmcnt(10)
    v_mfma_f32_16x16x32_bf16 v[144:147], a[8:11], v[112:115], v[144:147]
    ds_read_b64_tr_b16 a[36:37], v6 offset:40960
    v_mfma_f32_16x16x32_bf16 v[148:151], a[8:11], v[116:119], v[148:151]
    ds_read_b64_tr_b16 a[38:39], v6 offset:45056
    buffer_load_dwordx4 v14, s[16:19], s36 offen offset:2048 lds
    v_mfma_f32_16x16x32_bf16 v[156:159], a[12:15], v[116:119], v[156:159]
    ds_read_b64_tr_b16 a[40:41], v7 offset:32768
    v_mfma_f32_16x16x32_bf16 v[152:155], a[12:15], v[112:115], v[152:155]
    ds_read_b64_tr_b16 a[42:43], v7 offset:36864
    s_waitcnt lgkmcnt(10)
    v_mfma_f32_16x16x32_bf16 v[160:163], a[16:19], v[112:115], v[160:163]
    ds_read_b64_tr_b16 a[44:45], v7 offset:40960
    v_mfma_f32_16x16x32_bf16 v[164:167], a[16:19], v[116:119], v[164:167]
    ds_read_b64_tr_b16 a[46:47], v7 offset:45056
    buffer_load_dwordx4 v15, s[16:19], s36 offen offset:3072 lds
    v_mfma_f32_16x16x32_bf16 v[172:175], a[20:23], v[116:119], v[172:175]
    ds_read_b64_tr_b16 a[48:49], v8 offset:32768
    v_mfma_f32_16x16x32_bf16 v[168:171], a[20:23], v[112:115], v[168:171]
    ds_read_b64_tr_b16 a[50:51], v8 offset:36864
    s_waitcnt lgkmcnt(10)
    v_mfma_f32_16x16x32_bf16 v[176:179], a[24:27], v[112:115], v[176:179]
    ds_read_b64_tr_b16 a[52:53], v8 offset:40960
    v_mfma_f32_16x16x32_bf16 v[180:183], a[24:27], v[116:119], v[180:183]
    ds_read_b64_tr_b16 a[54:55], v8 offset:45056
    s_add_u32 s36, s36, 28672
    s_add_u32 m0, s53, 16384
    v_mfma_f32_16x16x32_bf16 v[188:191], a[28:31], v[116:119], v[188:191]
    ds_read_b64_tr_b16 a[56:57], v9 offset:32768
    buffer_load_dwordx4 v12, s[16:19], s36 offen offset:0 lds
    v_mfma_f32_16x16x32_bf16 v[184:187], a[28:31], v[112:115], v[184:187]
    ds_read_b64_tr_b16 a[58:59], v9 offset:36864
    s_waitcnt lgkmcnt(10)
    v_mfma_f32_16x16x32_bf16 v[192:195], a[32:35], v[112:115], v[192:195]
    ds_read_b64_tr_b16 a[60:61], v9 offset:40960
    v_mfma_f32_16x16x32_bf16 v[196:199], a[32:35], v[116:119], v[196:199]
    ds_read_b64_tr_b16 a[62:63], v9 offset:45056
    v_mfma_f32_16x16x32_bf16 v[204:207], a[36:39], v[116:119], v[204:207]
    ds_read_b64_tr_b16 a[0:1], v2 offset:49152
    buffer_load_dwordx4 v13, s[16:19], s36 offen offset:1024 lds
    v_mfma_f32_16x16x32_bf16 v[200:203], a[36:39], v[112:115], v[200:203]
    ds_read_b64_tr_b16 a[2:3], v2 offset:53248
    s_waitcnt lgkmcnt(10)
    v_mfma_f32_16x16x32_bf16 v[208:211], a[40:43], v[112:115], v[208:211]
    ds_read_b64_tr_b16 a[4:5], v2 offset:57344
    v_mfma_f32_16x16x32_bf16 v[212:215], a[40:43], v[116:119], v[212:215]
    ds_read_b64_tr_b16 a[6:7], v2 offset:61440
    v_mfma_f32_16x16x32_bf16 v[220:223], a[44:47], v[116:119], v[220:223]
    ds_read_b64_tr_b16 a[8:9], v3 offset:49152
    buffer_load_dwordx4 v14, s[16:19], s36 offen offset:2048 lds
    v_mfma_f32_16x16x32_bf16 v[216:219], a[44:47], v[112:115], v[216:219]
    ds_read_b64_tr_b16 a[10:11], v3 offset:53248
    s_waitcnt lgkmcnt(10)
    v_mfma_f32_16x16x32_bf16 v[224:227], a[48:51], v[112:115], v[224:227]
    ds_read_b64_tr_b16 a[12:13], v3 offset:57344
    v_mfma_f32_16x16x32_bf16 v[228:231], a[48:51], v[116:119], v[228:231]
    ds_read_b64_tr_b16 a[14:15], v3 offset:61440
    v_mfma_f32_16x16x32_bf16 v[236:239], a[52:55], v[116:119], v[236:239]
    ds_read_b64_tr_b16 a[16:17], v4 offset:49152
    buffer_load_dwordx4 v15, s[16:19], s36 offen offset:3072 lds
    v_mfma_f32_16x16x32_bf16 v[232:235], a[52:55], v[112:115], v[232:235]
    ds_read_b64_tr_b16 a[18:19], v4 offset:53248
    s_waitcnt lgkmcnt(10)
    v_mfma_f32_16x16x32_bf16 v[240:243], a[56:59], v[112:115], v[240:243]
    ds_read_b64_tr_b16 a[20:21], v4 offset:57344
    v_mfma_f32_16x16x32_bf16 v[244:247], a[56:59], v[116:119], v[244:247]
    ds_read_b64_tr_b16 a[22:23], v4 offset:61440
    v_mfma_f32_16x16x32_bf16 v[252:255], a[60:63], v[116:119], v[252:255]
    ds_read_b64_tr_b16 a[24:25], v5 offset:49152
    s_add_u32 s36, s36, 28672
    s_add_u32 m0, s53, 20480
    v_mfma_f32_16x16x32_bf16 v[248:251], a[60:63], v[112:115], v[248:251]
    ds_read_b64_tr_b16 a[26:27], v5 offset:53248
    s_waitcnt lgkmcnt(10)
    buffer_load_dwordx4 v12, s[16:19], s36 offen offset:0 lds
    v_mfma_f32_16x16x32_bf16 v[128:131], a[0:3], v[120:123], v[128:131]
    ds_read_b64_tr_b16 a[28:29], v5 offset:57344
    v_mfma_f32_16x16x32_bf16 v[132:135], a[0:3], v[124:127], v[132:135]
    ds_read_b64_tr_b16 a[30:31], v5 offset:61440
    v_mfma_f32_16x16x32_bf16 v[140:143], a[4:7], v[124:127], v[140:143]
    ds_read_b64_tr_b16 a[32:33], v6 offset:49152
    v_mfma_f32_16x16x32_bf16 v[136:139], a[4:7], v[120:123], v[136:139]
    ds_read_b64_tr_b16 a[34:35], v6 offset:53248
    s_waitcnt lgkmcnt(10)
    buffer_load_dwordx4 v13, s[16:19], s36 offen offset:1024 lds
    v_mfma_f32_16x16x32_bf16 v[144:147], a[8:11], v[120:123], v[144:147]
    ds_read_b64_tr_b16 a[36:37], v6 offset:57344
    v_mfma_f32_16x16x32_bf16 v[148:151], a[8:11], v[124:127], v[148:151]
    ds_read_b64_tr_b16 a[38:39], v6 offset:61440
    v_mfma_f32_16x16x32_bf16 v[156:159], a[12:15], v[124:127], v[156:159]
    ds_read_b64_tr_b16 a[40:41], v7 offset:49152
    v_mfma_f32_16x16x32_bf16 v[152:155], a[12:15], v[120:123], v[152:155]
    ds_read_b64_tr_b16 a[42:43], v7 offset:53248
    s_waitcnt lgkmcnt(10)
    buffer_load_dwordx4 v14, s[16:19], s36 offen offset:2048 lds
    v_mfma_f32_16x16x32_bf16 v[160:163], a[16:19], v[120:123], v[160:163]
    ds_read_b64_tr_b16 a[44:45], v7 offset:57344
    v_mfma_f32_16x16x32_bf16 v[164:167], a[16:19], v[124:127], v[164:167]
    ds_read_b64_tr_b16 a[46:47], v7 offset:61440
    v_mfma_f32_16x16x32_bf16 v[172:175], a[20:23], v[124:127], v[172:175]
    ds_read_b64_tr_b16 a[48:49], v8 offset:49152
    v_mfma_f32_16x16x32_bf16 v[168:171], a[20:23], v[120:123], v[168:171]
    ds_read_b64_tr_b16 a[50:51], v8 offset:53248
    s_waitcnt lgkmcnt(10)
    buffer_load_dwordx4 v15, s[16:19], s36 offen offset:3072 lds
    v_mfma_f32_16x16x32_bf16 v[176:179], a[24:27], v[120:123], v[176:179]
    ds_read_b64_tr_b16 a[52:53], v8 offset:57344
    v_mfma_f32_16x16x32_bf16 v[180:183], a[24:27], v[124:127], v[180:183]
    ds_read_b64_tr_b16 a[54:55], v8 offset:61440
    v_mfma_f32_16x16x32_bf16 v[188:191], a[28:31], v[124:127], v[188:191]
    ds_read_b64_tr_b16 a[56:57], v9 offset:49152
    v_mfma_f32_16x16x32_bf16 v[184:187], a[28:31], v[120:123], v[184:187]
    ds_read_b64_tr_b16 a[58:59], v9 offset:53248
    s_waitcnt lgkmcnt(10)
    s_add_u32 s36, s36, 28672
    v_mfma_f32_16x16x32_bf16 v[192:195], a[32:35], v[120:123], v[192:195]
    ds_read_b64_tr_b16 a[60:61], v9 offset:57344
    v_mfma_f32_16x16x32_bf16 v[196:199], a[32:35], v[124:127], v[196:199]
    ds_read_b64_tr_b16 a[62:63], v9 offset:61440
    v_mfma_f32_16x16x32_bf16 v[204:207], a[36:39], v[124:127], v[204:207]
    v_mfma_f32_16x16x32_bf16 v[200:203], a[36:39], v[120:123], v[200:203]
    s_waitcnt lgkmcnt(8)
    v_mfma_f32_16x16x32_bf16 v[208:211], a[40:43], v[120:123], v[208:211]
    v_mfma_f32_16x16x32_bf16 v[212:215], a[40:43], v[124:127], v[212:215]
    v_mfma_f32_16x16x32_bf16 v[220:223], a[44:47], v[124:127], v[220:223]
    v_mfma_f32_16x16x32_bf16 v[216:219], a[44:47], v[120:123], v[216:219]
    s_waitcnt lgkmcnt(4)
    v_mfma_f32_16x16x32_bf16 v[224:227], a[48:51], v[120:123], v[224:227]
    v_mfma_f32_16x16x32_bf16 v[228:231], a[48:51], v[124:127], v[228:231]
    v_mfma_f32_16x16x32_bf16 v[236:239], a[52:55], v[124:127], v[236:239]
    v_mfma_f32_16x16x32_bf16 v[232:235], a[52:55], v[120:123], v[232:235]
    s_waitcnt lgkmcnt(0)
    v_mfma_f32_16x16x32_bf16 v[240:243], a[56:59], v[120:123], v[240:243]
    v_mfma_f32_16x16x32_bf16 v[244:247], a[56:59], v[124:127], v[244:247]
    v_mfma_f32_16x16x32_bf16 v[252:255], a[60:63], v[124:127], v[252:255]
    v_mfma_f32_16x16x32_bf16 v[248:251], a[60:63], v[120:123], v[248:251]
    s_cmp_eq_u32 s77, 1
    s_cbranch_scc1 L4_cs
    v_mov_b32 v4, v12
    v_mov_b32 v5, v13
    v_mov_b32 v6, v14
    v_mov_b32 v7, v15
    s_waitcnt vmcnt(24)
    s_mov_b32 s3, 0x3b124925
    s_mov_b32 s47, 0x3727c5ac
    v_cndmask_b32 v18, v18, 0, s[48:49]
    v_cndmask_b32 v19, v19, 0, s[48:49]
    v_add_f32 v120, v16, v18
    v_add_f32 v122, v17, v19
    v_cndmask_b32 v22, v22, 0, s[48:49]
    v_cndmask_b32 v23, v23, 0, s[48:49]
    v_add_f32 v121, v20, v22
    v_add_f32 v123, v21, v23
    v_mov_b32 v124, v120
    v_mov_b32 v125, v121
    v_mov_b32 v126, v122
    v_mov_b32 v127, v123
    v_permlane32_swap_b32 v120, v124
    v_permlane32_swap_b32 v121, v125
    v_permlane32_swap_b32 v122, v126
    v_permlane32_swap_b32 v123, v127
    v_add_f32 v120, v120, v124
    v_add_f32 v121, v121, v125
    v_add_f32 v122, v122, v126
    v_add_f32 v123, v123, v127
    v_mov_b32 v124, v120
    v_mov_b32 v125, v121
    v_mov_b32 v126, v122
    v_mov_b32 v127, v123
    v_permlane16_swap_b32 v120, v124
    v_permlane16_swap_b32 v121, v125
    v_permlane16_swap_b32 v122, v126
    v_permlane16_swap_b32 v123, v127
    v_add_f32 v120, v120, v124
    v_add_f32 v121, v121, v125
    v_add_f32 v122, v122, v126
    v_add_f32 v123, v123, v127
    v_mul_f32 v120, -s3, v120
    v_mul_f32 v122, s3, v122
    v_fma_f32 v122, -v120, v120, v122
    v_max_f32 v122, 0, v122
    v_add_f32 v122, s47, v122
    v_rcp_f32 v122, v122
    v_mul_f32 v121, -s3, v121
    v_mul_f32 v123, s3, v123
    v_fma_f32 v123, -v121, v121, v123
    v_max_f32 v123, 0, v123
    v_add_f32 v123, s47, v123
    v_rcp_f32 v123, v123
    s_nop 0
    v_pk_fma_f32 v[128:129], v[24:25], v[120:121], v[128:129] op_sel_hi:[1,0,1]
    v_pk_fma_f32 v[136:137], v[28:29], v[120:121], v[136:137] op_sel_hi:[1,0,1]
    v_pk_fma_f32 v[130:131], v[26:27], v[120:121], v[130:131] op_sel_hi:[1,0,1]
    v_pk_fma_f32 v[138:139], v[30:31], v[120:121], v[138:139] op_sel_hi:[1,0,1]
    v_pk_mul_f32 v[128:129], v[128:129], v[122:123] op_sel_hi:[1,0]
    v_pk_mul_f32 v[130:131], v[130:131], v[122:123] op_sel_hi:[1,0]
    v_pk_mul_f32 v[128:129], v[128:129], v[136:137]
    v_pk_mul_f32 v[130:131], v[130:131], v[138:139]
    v_cvt_pk_bf16_f32 v88, v128, v129
    v_cvt_pk_bf16_f32 v89, v130, v131
    v_pk_fma_f32 v[144:145], v[32:33], v[120:121], v[144:145] op_sel_hi:[1,0,1]
    v_pk_fma_f32 v[152:153], v[36:37], v[120:121], v[152:153] op_sel_hi:[1,0,1]
    v_pk_fma_f32 v[146:147], v[34:35], v[120:121], v[146:147] op_sel_hi:[1,0,1]
    v_pk_fma_f32 v[154:155], v[38:39], v[120:121], v[154:155] op_sel_hi:[1,0,1]
    v_pk_mul_f32 v[144:145], v[144:145], v[122:123] op_sel_hi:[1,0]
    v_pk_mul_f32 v[146:147], v[146:147], v[122:123] op_sel_hi:[1,0]
    v_pk_mul_f32 v[144:145], v[144:145], v[152:153]
    v_pk_mul_f32 v[146:147], v[146:147], v[154:155]
    v_cvt_pk_bf16_f32 v90, v144, v145
    v_cvt_pk_bf16_f32 v91, v146, v147
    buffer_store_dwordx4 v[88:91], v1, s[24:27], s37 offen offset:0 sc1
    v_pk_fma_f32 v[160:161], v[40:41], v[120:121], v[160:161] op_sel_hi:[1,0,1]
    v_pk_fma_f32 v[168:169], v[44:45], v[120:121], v[168:169] op_sel_hi:[1,0,1]
    v_pk_fma_f32 v[162:163], v[42:43], v[120:121], v[162:163] op_sel_hi:[1,0,1]
    v_pk_fma_f32 v[170:171], v[46:47], v[120:121], v[170:171] op_sel_hi:[1,0,1]
    v_pk_mul_f32 v[160:161], v[160:161], v[122:123] op_sel_hi:[1,0]
    v_pk_mul_f32 v[162:163], v[162:163], v[122:123] op_sel_hi:[1,0]
    v_pk_mul_f32 v[160:161], v[160:161], v[168:169]
    v_pk_mul_f32 v[162:163], v[162:163], v[170:171]
    v_cvt_pk_bf16_f32 v92, v160, v161
    v_cvt_pk_bf16_f32 v93, v162, v163
    v_pk_fma_f32 v[176:177], v[48:49], v[120:121], v[176:177] op_sel_hi:[1,0,1]
    v_pk_fma_f32 v[184:185], v[52:53], v[120:121], v[184:185] op_sel_hi:[1,0,1]
    v_pk_fma_f32 v[178:179], v[50:51], v[120:121], v[178:179] op_sel_hi:[1,0,1]
    v_pk_fma_f32 v[186:187], v[54:55], v[120:121], v[186:187] op_sel_hi:[1,0,1]
    v_pk_mul_f32 v[176:177], v[176:177], v[122:123] op_sel_hi:[1,0]
    v_pk_mul_f32 v[178:179], v[178:179], v[122:123] op_sel_hi:[1,0]
    v_pk_mul_f32 v[176:177], v[176:177], v[184:185]
    v_pk_mul_f32 v[178:179], v[178:179], v[186:187]
    v_cvt_pk_bf16_f32 v94, v176, v177
    v_cvt_pk_bf16_f32 v95, v178, v179
    buffer_store_dwordx4 v[92:95], v1, s[24:27], s37 offen offset:1024 sc1
    v_pk_fma_f32 v[192:193], v[56:57], v[120:121], v[192:193] op_sel_hi:[1,0,1]
    v_pk_fma_f32 v[200:201], v[60:61], v[120:121], v[200:201] op_sel_hi:[1,0,1]
    v_pk_fma_f32 v[194:195], v[58:59], v[120:121], v[194:195] op_sel_hi:[1,0,1]
    v_pk_fma_f32 v[202:203], v[62:63], v[120:121], v[202:203] op_sel_hi:[1,0,1]
    v_pk_mul_f32 v[192:193], v[192:193], v[122:123] op_sel_hi:[1,0]
    v_pk_mul_f32 v[194:195], v[194:195], v[122:123] op_sel_hi:[1,0]
    v_pk_mul_f32 v[192:193], v[192:193], v[200:201]
    v_pk_mul_f32 v[194:195], v[194:195], v[202:203]
    v_cvt_pk_bf16_f32 v96, v192, v193
    v_cvt_pk_bf16_f32 v97, v194, v195
    v_pk_fma_f32 v[208:209], v[64:65], v[120:121], v[208:209] op_sel_hi:[1,0,1]
    v_pk_fma_f32 v[216:217], v[68:69], v[120:121], v[216:217] op_sel_hi:[1,0,1]
    v_pk_fma_f32 v[210:211], v[66:67], v[120:121], v[210:211] op_sel_hi:[1,0,1]
    v_pk_fma_f32 v[218:219], v[70:71], v[120:121], v[218:219] op_sel_hi:[1,0,1]
    v_pk_mul_f32 v[208:209], v[208:209], v[122:123] op_sel_hi:[1,0]
    v_pk_mul_f32 v[210:211], v[210:211], v[122:123] op_sel_hi:[1,0]
    v_pk_mul_f32 v[208:209], v[208:209], v[216:217]
    v_pk_mul_f32 v[210:211], v[210:211], v[218:219]
    v_cvt_pk_bf16_f32 v98, v208, v209
    v_cvt_pk_bf16_f32 v99, v210, v211
    buffer_store_dwordx4 v[96:99], v1, s[24:27], s37 offen offset:2048 sc1
    v_pk_fma_f32 v[224:225], v[72:73], v[120:121], v[224:225] op_sel_hi:[1,0,1]
    v_pk_fma_f32 v[232:233], v[76:77], v[120:121], v[232:233] op_sel_hi:[1,0,1]
    v_pk_fma_f32 v[226:227], v[74:75], v[120:121], v[226:227] op_sel_hi:[1,0,1]
    v_pk_fma_f32 v[234:235], v[78:79], v[120:121], v[234:235] op_sel_hi:[1,0,1]
    v_pk_mul_f32 v[224:225], v[224:225], v[122:123] op_sel_hi:[1,0]
    v_pk_mul_f32 v[226:227], v[226:227], v[122:123] op_sel_hi:[1,0]
    v_pk_mul_f32 v[224:225], v[224:225], v[232:233]
    v_pk_mul_f32 v[226:227], v[226:227], v[234:235]
    v_cvt_pk_bf16_f32 v100, v224, v225
    v_cvt_pk_bf16_f32 v101, v226, v227
    v_pk_fma_f32 v[240:241], v[80:81], v[120:121], v[240:241] op_sel_hi:[1,0,1]
    v_pk_fma_f32 v[248:249], v[84:85], v[120:121], v[248:249] op_sel_hi:[1,0,1]
    v_pk_fma_f32 v[242:243], v[82:83], v[120:121], v[242:243] op_sel_hi:[1,0,1]
    v_pk_fma_f32 v[250:251], v[86:87], v[120:121], v[250:251] op_sel_hi:[1,0,1]
    v_pk_mul_f32 v[240:241], v[240:241], v[122:123] op_sel_hi:[1,0]
    v_pk_mul_f32 v[242:243], v[242:243], v[122:123] op_sel_hi:[1,0]
    v_pk_mul_f32 v[240:241], v[240:241], v[248:249]
    v_pk_mul_f32 v[242:243], v[242:243], v[250:251]
    v_cvt_pk_bf16_f32 v102, v240, v241
    v_cvt_pk_bf16_f32 v103, v242, v243
    buffer_store_dwordx4 v[100:103], v1, s[24:27], s37 offen offset:3072 sc1
    s_add_u32 s37, s37, 57344
    v_pk_fma_f32 v[132:133], v[24:25], v[120:121], v[132:133] op_sel:[0,1,0] op_sel_hi:[1,1,1]
    v_pk_fma_f32 v[140:141], v[28:29], v[120:121], v[140:141] op_sel:[0,1,0] op_sel_hi:[1,1,1]
    v_pk_fma_f32 v[134:135], v[26:27], v[120:121], v[134:135] op_sel:[0,1,0] op_sel_hi:[1,1,1]
    v_pk_fma_f32 v[142:143], v[30:31], v[120:121], v[142:143] op_sel:[0,1,0] op_sel_hi:[1,1,1]
    v_pk_mul_f32 v[132:133], v[132:133], v[122:123] op_sel:[0,1] op_sel_hi:[1,1]
    v_pk_mul_f32 v[134:135], v[134:135], v[122:123] op_sel:[0,1] op_sel_hi:[1,1]
    v_pk_mul_f32 v[132:133], v[132:133], v[140:141]
    v_pk_mul_f32 v[134:135], v[134:135], v[142:143]
    v_cvt_pk_bf16_f32 v104, v132, v133
    v_cvt_pk_bf16_f32 v105, v134, v135
    v_pk_fma_f32 v[148:149], v[32:33], v[120:121], v[148:149] op_sel:[0,1,0] op_sel_hi:[1,1,1]
    v_pk_fma_f32 v[156:157], v[36:37], v[120:121], v[156:157] op_sel:[0,1,0] op_sel_hi:[1,1,1]
    v_pk_fma_f32 v[150:151], v[34:35], v[120:121], v[150:151] op_sel:[0,1,0] op_sel_hi:[1,1,1]
    v_pk_fma_f32 v[158:159], v[38:39], v[120:121], v[158:159] op_sel:[0,1,0] op_sel_hi:[1,1,1]
    v_pk_mul_f32 v[148:149], v[148:149], v[122:123] op_sel:[0,1] op_sel_hi:[1,1]
    v_pk_mul_f32 v[150:151], v[150:151], v[122:123] op_sel:[0,1] op_sel_hi:[1,1]
    v_pk_mul_f32 v[148:149], v[148:149], v[156:157]
    v_pk_mul_f32 v[150:151], v[150:151], v[158:159]
    v_cvt_pk_bf16_f32 v106, v148, v149
    v_cvt_pk_bf16_f32 v107, v150, v151
    buffer_store_dwordx4 v[104:107], v1, s[24:27], s37 offen offset:0 sc1
    v_pk_fma_f32 v[164:165], v[40:41], v[120:121], v[164:165] op_sel:[0,1,0] op_sel_hi:[1,1,1]
    v_pk_fma_f32 v[172:173], v[44:45], v[120:121], v[172:173] op_sel:[0,1,0] op_sel_hi:[1,1,1]
    v_pk_fma_f32 v[166:167], v[42:43], v[120:121], v[166:167] op_sel:[0,1,0] op_sel_hi:[1,1,1]
    v_pk_fma_f32 v[174:175], v[46:47], v[120:121], v[174:175] op_sel:[0,1,0] op_sel_hi:[1,1,1]
    v_pk_mul_f32 v[164:165], v[164:165], v[122:123] op_sel:[0,1] op_sel_hi:[1,1]
    v_pk_mul_f32 v[166:167], v[166:167], v[122:123] op_sel:[0,1] op_sel_hi:[1,1]
    v_pk_mul_f32 v[164:165], v[164:165], v[172:173]
    v_pk_mul_f32 v[166:167], v[166:167], v[174:175]
    v_cvt_pk_bf16_f32 v108, v164, v165
    v_cvt_pk_bf16_f32 v109, v166, v167
    v_pk_fma_f32 v[180:181], v[48:49], v[120:121], v[180:181] op_sel:[0,1,0] op_sel_hi:[1,1,1]
    v_pk_fma_f32 v[188:189], v[52:53], v[120:121], v[188:189] op_sel:[0,1,0] op_sel_hi:[1,1,1]
    v_pk_fma_f32 v[182:183], v[50:51], v[120:121], v[182:183] op_sel:[0,1,0] op_sel_hi:[1,1,1]
    v_pk_fma_f32 v[190:191], v[54:55], v[120:121], v[190:191] op_sel:[0,1,0] op_sel_hi:[1,1,1]
    v_pk_mul_f32 v[180:181], v[180:181], v[122:123] op_sel:[0,1] op_sel_hi:[1,1]
    v_pk_mul_f32 v[182:183], v[182:183], v[122:123] op_sel:[0,1] op_sel_hi:[1,1]
    v_pk_mul_f32 v[180:181], v[180:181], v[188:189]
    v_pk_mul_f32 v[182:183], v[182:183], v[190:191]
    v_cvt_pk_bf16_f32 v110, v180, v181
    v_cvt_pk_bf16_f32 v111, v182, v183
    buffer_store_dwordx4 v[108:111], v1, s[24:27], s37 offen offset:1024 sc1
    v_pk_fma_f32 v[196:197], v[56:57], v[120:121], v[196:197] op_sel:[0,1,0] op_sel_hi:[1,1,1]
    v_pk_fma_f32 v[204:205], v[60:61], v[120:121], v[204:205] op_sel:[0,1,0] op_sel_hi:[1,1,1]
    v_pk_fma_f32 v[198:199], v[58:59], v[120:121], v[198:199] op_sel:[0,1,0] op_sel_hi:[1,1,1]
    v_pk_fma_f32 v[206:207], v[62:63], v[120:121], v[206:207] op_sel:[0,1,0] op_sel_hi:[1,1,1]
    v_pk_mul_f32 v[196:197], v[196:197], v[122:123] op_sel:[0,1] op_sel_hi:[1,1]
    v_pk_mul_f32 v[198:199], v[198:199], v[122:123] op_sel:[0,1] op_sel_hi:[1,1]
    v_pk_mul_f32 v[196:197], v[196:197], v[204:205]
    v_pk_mul_f32 v[198:199], v[198:199], v[206:207]
    v_cvt_pk_bf16_f32 v112, v196, v197
    v_cvt_pk_bf16_f32 v113, v198, v199
    v_pk_fma_f32 v[212:213], v[64:65], v[120:121], v[212:213] op_sel:[0,1,0] op_sel_hi:[1,1,1]
    v_pk_fma_f32 v[220:221], v[68:69], v[120:121], v[220:221] op_sel:[0,1,0] op_sel_hi:[1,1,1]
    v_pk_fma_f32 v[214:215], v[66:67], v[120:121], v[214:215] op_sel:[0,1,0] op_sel_hi:[1,1,1]
    v_pk_fma_f32 v[222:223], v[70:71], v[120:121], v[222:223] op_sel:[0,1,0] op_sel_hi:[1,1,1]
    v_pk_mul_f32 v[212:213], v[212:213], v[122:123] op_sel:[0,1] op_sel_hi:[1,1]
    v_pk_mul_f32 v[214:215], v[214:215], v[122:123] op_sel:[0,1] op_sel_hi:[1,1]
    v_pk_mul_f32 v[212:213], v[212:213], v[220:221]
    v_pk_mul_f32 v[214:215], v[214:215], v[222:223]
    v_cvt_pk_bf16_f32 v114, v212, v213
    v_cvt_pk_bf16_f32 v115, v214, v215
    buffer_store_dwordx4 v[112:115], v1, s[24:27], s37 offen offset:2048 sc1
    v_pk_fma_f32 v[228:229], v[72:73], v[120:121], v[228:229] op_sel:[0,1,0] op_sel_hi:[1,1,1]
    v_pk_fma_f32 v[236:237], v[76:77], v[120:121], v[236:237] op_sel:[0,1,0] op_sel_hi:[1,1,1]
    v_pk_fma_f32 v[230:231], v[74:75], v[120:121], v[230:231] op_sel:[0,1,0] op_sel_hi:[1,1,1]
    v_pk_fma_f32 v[238:239], v[78:79], v[120:121], v[238:239] op_sel:[0,1,0] op_sel_hi:[1,1,1]
    v_pk_mul_f32 v[228:229], v[228:229], v[122:123] op_sel:[0,1] op_sel_hi:[1,1]
    v_pk_mul_f32 v[230:231], v[230:231], v[122:123] op_sel:[0,1] op_sel_hi:[1,1]
    v_pk_mul_f32 v[228:229], v[228:229], v[236:237]
    v_pk_mul_f32 v[230:231], v[230:231], v[238:239]
    v_cvt_pk_bf16_f32 v116, v228, v229
    v_cvt_pk_bf16_f32 v117, v230, v231
    v_pk_fma_f32 v[244:245], v[80:81], v[120:121], v[244:245] op_sel:[0,1,0] op_sel_hi:[1,1,1]
    v_pk_fma_f32 v[252:253], v[84:85], v[120:121], v[252:253] op_sel:[0,1,0] op_sel_hi:[1,1,1]
    v_pk_fma_f32 v[246:247], v[82:83], v[120:121], v[246:247] op_sel:[0,1,0] op_sel_hi:[1,1,1]
    v_pk_fma_f32 v[254:255], v[86:87], v[120:121], v[254:255] op_sel:[0,1,0] op_sel_hi:[1,1,1]
    v_pk_mul_f32 v[244:245], v[244:245], v[122:123] op_sel:[0,1] op_sel_hi:[1,1]
    v_pk_mul_f32 v[246:247], v[246:247], v[122:123] op_sel:[0,1] op_sel_hi:[1,1]
    v_pk_mul_f32 v[244:245], v[244:245], v[252:253]
    v_pk_mul_f32 v[246:247], v[246:247], v[254:255]
    v_cvt_pk_bf16_f32 v118, v244, v245
    v_cvt_pk_bf16_f32 v119, v246, v247
    buffer_store_dwordx4 v[116:119], v1, s[24:27], s37 offen offset:3072 sc1
    s_lshl_b32 s69, s76, 4
    s_add_u32 s69, s69, s73
    s_lshl_b32 s69, s69, 7
    s_add_u32 s69, s69, 131072
L5_entry:
    s_load_dwordx2 s[12:13], s[0:1], 80
    v_and_b32 v12, 63, v0
    v_and_b32 v13, 15, v12
    v_lshrrev_b32 v14, 4, v12
    v_lshrrev_b32 v15, 2, v13
    v_lshl_add_u32 v14, v14, 2, v15
    v_and_b32 v13, 3, v13
    v_lshlrev_b32 v13, 3, v13
    v_lshl_add_u32 v13, v14, 7, v13
    s_mov_b32 s37, s53
    v_add_u32 v13, s37, v13
    v_bfe_u32 v14, v14, 1, 2
    v_xor_b32 v15, 0, v14
    v_lshl_add_u32 v8, v15, 5, v13
    v_xor_b32 v15, 1, v14
    v_lshl_add_u32 v9, v15, 5, v13
    v_xor_b32 v15, 2, v14
    v_lshl_add_u32 v10, v15, 5, v13
    v_xor_b32 v15, 3, v14
    v_lshl_add_u32 v11, v15, 5, v13
    s_sub_u32 s3, s53, s54
    v_subrev_u32 v120, s3, v8
    v_subrev_u32 v121, s3, v9
    v_subrev_u32 v122, s3, v10
    v_subrev_u32 v123, s3, v11
    s_mul_i32 s38, s70, 229376
    s_mul_i32 s3, s44, 14336
    s_add_u32 s38, s38, s3
    s_add_u32 s38, s38, 0x6800000
    s_add_u32 s8, s14, s38
    s_addc_u32 s9, s15, 0
    s_mov_b32 s10, 0x2d800
    s_mov_b32 s11, 0x20000
    s_add_u32 s3, s44, 0
    s_and_b32 s3, s3, 3
    s_mul_i32 s3, s3, 57344
    v_add_u32 v112, s3, v1
    s_add_u32 s3, s44, 1
    s_and_b32 s3, s3, 3
    s_mul_i32 s3, s3, 57344
    v_add_u32 v113, s3, v1
    s_add_u32 s3, s44, 2
    s_and_b32 s3, s3, 3
    s_mul_i32 s3, s3, 57344
    v_add_u32 v114, s3, v1
    s_add_u32 s3, s44, 3
    s_and_b32 s3, s3, 3
    s_mul_i32 s3, s3, 57344
    v_add_u32 v115, s3, v1
    s_sub_u32 s3, s44, 1
    s_and_b32 s3, s3, 3
    s_mul_i32 s3, s3, 24576
    s_add_u32 s3, s3, 65536
    v_add_u32 v116, s3, v1
    s_sub_u32 s3, s44, 2
    s_and_b32 s3, s3, 3
    s_mul_i32 s3, s3, 24576
    s_add_u32 s3, s3, 69632
    v_add_u32 v117, s3, v1
    s_sub_u32 s3, s44, 3
    s_and_b32 s3, s3, 3
    s_mul_i32 s3, s3, 24576
    s_add_u32 s3, s3, 73728
    v_add_u32 v118, s3, v1
    v_add_u32 v119, s37, v1
    s_lshl_b32 s33, s71, 11
    s_mov_b32 s33, 0
    s_mov_b32 s32, s33
    s_lshl_b32 s39, s72, 11
    s_add_u32 s39, s39, 131072
    s_mul_i32 s3, s44, 14
    s_lshr_b32 s3, s3, 2
    s_lshl_b32 s3, s3, 7
    s_add_u32 s39, s39, s3
    v_bfe_u32 v3, v0, 2, 2
    v_and_b32 v13, 3, v0
    v_lshlrev_b32 v13, 2, v13
    v_lshl_add_u32 v3, v3, 7, v13
    s_waitcnt vmcnt(8) lgkmcnt(0)
    s_barrier
    s_add_u32 m0, s54, 0
    s_nop 0
    buffer_load_dwordx4 v4, s[16:19], s36 offen offset:0 lds
    buffer_load_dwordx4 v5, s[16:19], s36 offen offset:1024 lds
    buffer_load_dwordx4 v6, s[16:19], s36 offen offset:2048 lds
    buffer_load_dwordx4 v7, s[16:19], s36 offen offset:3072 lds
    s_add_u32 s36, s36, 28672
    s_waitcnt vmcnt(4)
    s_lshl_b32 s3, s44, 2
    v_mov_b32 v13, s3
    v_mov_b32 v14, s7
    buffer_store_dword v14, v13, s[28:31], s69 offen sc1
    s_add_u32 m0, s54, 4096
    s_nop 0
    buffer_load_dwordx4 v4, s[16:19], s36 offen offset:0 lds
    buffer_load_dwordx4 v5, s[16:19], s36 offen offset:1024 lds
    buffer_load_dwordx4 v6, s[16:19], s36 offen offset:2048 lds
    buffer_load_dwordx4 v7, s[16:19], s36 offen offset:3072 lds
    s_add_u32 s36, s36, 28672
    s_add_u32 m0, s54, 8192
    s_nop 0
    buffer_load_dwordx4 v4, s[16:19], s36 offen offset:0 lds
    buffer_load_dwordx4 v5, s[16:19], s36 offen offset:1024 lds
    buffer_load_dwordx4 v6, s[16:19], s36 offen offset:2048 lds
    buffer_load_dwordx4 v7, s[16:19], s36 offen offset:3072 lds
    s_add_u32 s36, s36, 28672
    s_add_u32 m0, s54, 12288
    s_nop 0
    buffer_load_dwordx4 v4, s[16:19], s36 offen offset:0 lds
    buffer_load_dwordx4 v5, s[16:19], s36 offen offset:1024 lds
    buffer_load_dwordx4 v6, s[16:19], s36 offen offset:2048 lds
    buffer_load_dwordx4 v7, s[16:19], s36 offen offset:3072 lds
    s_add_u32 s36, s36, 28672
    s_waitcnt vmcnt(38)
    ds_read_b64_tr_b16 a[0:1], v8 offset:0
    ds_read_b64_tr_b16 a[2:3], v8 offset:2048
    ds_read_b64_tr_b16 a[4:5], v9 offset:0
    ds_read_b64_tr_b16 a[6:7], v9 offset:2048
    ds_read_b64_tr_b16 a[8:9], v10 offset:0
    ds_read_b64_tr_b16 a[10:11], v10 offset:2048
    ds_read_b64_tr_b16 a[12:13], v11 offset:0
    ds_read_b64_tr_b16 a[14:15], v11 offset:2048
    buffer_load_dword v15, v3, s[28:31], s39 offen sc1
    s_waitcnt vmcnt(35)
    ds_read_b64_tr_b16 a[16:17], v8 offset:4096
    ds_read_b64_tr_b16 a[18:19], v8 offset:6144
    ds_read_b64_tr_b16 a[20:21], v9 offset:4096
    ds_read_b64_tr_b16 a[22:23], v9 offset:6144
    ds_read_b64_tr_b16 a[24:25], v10 offset:4096
    ds_read_b64_tr_b16 a[26:27], v10 offset:6144
    ds_read_b64_tr_b16 a[28:29], v11 offset:4096
    ds_read_b64_tr_b16 a[30:31], v11 offset:6144
    s_waitcnt lgkmcnt(8)
    s_add_u32 m0, s53, 0
    s_nop 0
    buffer_load_dwordx4 v4, s[16:19], s36 offen offset:0 lds
    buffer_load_dwordx4 v5, s[16:19], s36 offen offset:1024 lds
    buffer_load_dwordx4 v6, s[16:19], s36 offen offset:2048 lds
    buffer_load_dwordx4 v7, s[16:19], s36 offen offset:3072 lds
    s_add_u32 s36, s36, 28672
    s_waitcnt vmcnt(35)
    ds_read_b64_tr_b16 a[32:33], v8 offset:8192
    ds_read_b64_tr_b16 a[34:35], v8 offset:10240
    ds_read_b64_tr_b16 a[36:37], v9 offset:8192
    ds_read_b64_tr_b16 a[38:39], v9 offset:10240
    ds_read_b64_tr_b16 a[40:41], v10 offset:8192
    ds_read_b64_tr_b16 a[42:43], v10 offset:10240
    ds_read_b64_tr_b16 a[44:45], v11 offset:8192
    ds_read_b64_tr_b16 a[46:47], v11 offset:10240
    s_waitcnt lgkmcnt(8)
    s_add_u32 m0, s53, 4096
    s_nop 0
    buffer_load_dwordx4 v4, s[16:19], s36 offen offset:0 lds
    buffer_load_dwordx4 v5, s[16:19], s36 offen offset:1024 lds
    buffer_load_dwordx4 v6, s[16:19], s36 offen offset:2048 lds
    buffer_load_dwordx4 v7, s[16:19], s36 offen offset:3072 lds
    s_add_u32 s36, s36, 28672
    s_waitcnt vmcnt(35)
    ds_read_b64_tr_b16 a[48:49], v8 offset:12288
    ds_read_b64_tr_b16 a[50:51], v8 offset:14336
    ds_read_b64_tr_b16 a[52:53], v9 offset:12288
    ds_read_b64_tr_b16 a[54:55], v9 offset:14336
    ds_read_b64_tr_b16 a[56:57], v10 offset:12288
    ds_read_b64_tr_b16 a[58:59], v10 offset:14336
    ds_read_b64_tr_b16 a[60:61], v11 offset:12288
    ds_read_b64_tr_b16 a[62:63], v11 offset:14336
    s_waitcnt lgkmcnt(8)
    s_add_u32 m0, s53, 8192
    s_nop 0
    buffer_load_dwordx4 v4, s[16:19], s36 offen offset:0 lds
    buffer_load_dwordx4 v5, s[16:19], s36 offen offset:1024 lds
    buffer_load_dwordx4 v6, s[16:19], s36 offen offset:2048 lds
    buffer_load_dwordx4 v7, s[16:19], s36 offen offset:3072 lds
    s_add_u32 s36, s36, 28672
    s_waitcnt lgkmcnt(0)
    s_add_u32 m0, s53, 12288
    s_nop 0
    buffer_load_dwordx4 v4, s[16:19], s36 offen offset:0 lds
    buffer_load_dwordx4 v5, s[16:19], s36 offen offset:1024 lds
    buffer_load_dwordx4 v6, s[16:19], s36 offen offset:2048 lds
    buffer_load_dwordx4 v7, s[16:19], s36 offen offset:3072 lds
    s_add_u32 s36, s36, 28672
    s_waitcnt vmcnt(16)
    v_cmp_ne_u32 vcc, s7, v15
    s_and_b32 s3, vcc_lo, 0xffff
    s_cbranch_scc1 L5_cP0
L5_cP0_r:
    buffer_load_dwordx4 v[176:179], v112, s[8:11], s32 offen sc1
    buffer_load_dwordx4 v[180:183], v113, s[8:11], s32 offen sc1
    buffer_load_dwordx4 v[184:187], v114, s[8:11], s32 offen sc1
    buffer_load_dwordx4 v[188:191], v115, s[8:11], s32 offen sc1
    s_add_u32 s32, s32, 1024
    s_cmp_eq_u32 s32, 14336
    s_cselect_b32 s32, 0, s32
    buffer_load_dwordx4 v[192:195], v112, s[8:11], s32 offen sc1
    buffer_load_dwordx4 v[196:199], v113, s[8:11], s32 offen sc1
    buffer_load_dwordx4 v[200:203], v114, s[8:11], s32 offen sc1
    buffer_load_dwordx4 v[204:207], v115, s[8:11], s32 offen sc1
    s_add_u32 s32, s32, 1024
    s_cmp_eq_u32 s32, 14336
    s_cselect_b32 s32, 0, s32
    buffer_load_dwordx4 v[208:211], v112, s[8:11], s32 offen sc1
    buffer_load_dwordx4 v[212:215], v113, s[8:11], s32 offen sc1
    buffer_load_dwordx4 v[216:219], v114, s[8:11], s32 offen sc1
    buffer_load_dwordx4 v[220:223], v115, s[8:11], s32 offen sc1
    s_add_u32 s32, s32, 1024
    s_cmp_eq_u32 s32, 14336
    s_cselect_b32 s32, 0, s32
    buffer_load_dwordx4 v[224:227], v112, s[8:11], s32 offen sc1
    buffer_load_dwordx4 v[228:231], v113, s[8:11], s32 offen sc1
    buffer_load_dwordx4 v[232:235], v114, s[8:11], s32 offen sc1
    buffer_load_dwordx4 v[236:239], v115, s[8:11], s32 offen sc1
    s_add_u32 s32, s32, 1024
    s_cmp_eq_u32 s32, 14336
    s_cselect_b32 s32, 0, s32
    s_waitcnt vmcnt(12) lgkmcnt(0)
    v_mfma_f32_16x16x32_bf16 v[48:51], a[0:3], v[176:179], 0
    v_mfma_f32_16x16x32_bf16 v[52:55], a[0:3], v[180:183], 0
    v_mfma_f32_16x16x32_bf16 v[56:59], a[0:3], v[184:187], 0
    v_mfma_f32_16x16x32_bf16 v[60:63], a[0:3], v[188:191], 0
    v_mfma_f32_16x16x32_bf16 v[76:79], a[4:7], v[188:191], 0
    buffer_load_dwordx4 v[240:243], v112, s[8:11], s32 offen sc1
    buffer_load_dwordx4 v[244:247], v113, s[8:11], s32 offen sc1
    v_mfma_f32_16x16x32_bf16 v[72:75], a[4:7], v[184:187], 0
    buffer_load_dwordx4 v[248:251], v114, s[8:11], s32 offen sc1
    buffer_load_dwordx4 v[252:255], v115, s[8:11], s32 offen sc1
    v_mfma_f32_16x16x32_bf16 v[68:71], a[4:7], v[180:183], 0
    s_add_u32 s32, s32, 1024
    v_mfma_f32_16x16x32_bf16 v[64:67], a[4:7], v[176:179], 0
    s_cmp_eq_u32 s32, 14336
    s_cselect_b32 s32, 0, s32
    v_mfma_f32_16x16x32_bf16 v[80:83], a[8:11], v[176:179], 0
    v_mfma_f32_16x16x32_bf16 v[84:87], a[8:11], v[180:183], 0
    v_mfma_f32_16x16x32_bf16 v[88:91], a[8:11], v[184:187], 0
    v_mfma_f32_16x16x32_bf16 v[92:95], a[8:11], v[188:191], 0
    v_mfma_f32_16x16x32_bf16 v[108:111], a[12:15], v[188:191], 0
    v_mfma_f32_16x16x32_bf16 v[104:107], a[12:15], v[184:187], 0
    v_mfma_f32_16x16x32_bf16 v[100:103], a[12:15], v[180:183], 0
    v_mfma_f32_16x16x32_bf16 v[96:99], a[12:15], v[176:179], 0
    s_waitcnt vmcnt(12) lgkmcnt(0)
    v_mfma_f32_16x16x32_bf16 v[48:51], a[16:19], v[192:195], v[48:51]
    v_mfma_f32_16x16x32_bf16 v[52:55], a[16:19], v[196:199], v[52:55]
    v_mfma_f32_16x16x32_bf16 v[56:59], a[16:19], v[200:203], v[56:59]
    v_mfma_f32_16x16x32_bf16 v[60:63], a[16:19], v[204:207], v[60:63]
    v_mfma_f32_16x16x32_bf16 v[76:79], a[20:23], v[204:207], v[76:79]
    buffer_load_dwordx4 v[176:179], v112, s[8:11], s32 offen sc1
    buffer_load_dwordx4 v[180:183], v113, s[8:11], s32 offen sc1
    v_mfma_f32_16x16x32_bf16 v[72:75], a[20:23], v[200:203], v[72:75]
    buffer_load_dwordx4 v[184:187], v114, s[8:11], s32 offen sc1
    buffer_load_dwordx4 v[188:191], v115, s[8:11], s32 offen sc1
    v_mfma_f32_16x16x32_bf16 v[68:71], a[20:23], v[196:199], v[68:71]
    s_add_u32 s32, s32, 1024
    v_mfma_f32_16x16x32_bf16 v[64:67], a[20:23], v[192:195], v[64:67]
    s_cmp_eq_u32 s32, 14336
    s_cselect_b32 s32, 0, s32
    v_mfma_f32_16x16x32_bf16 v[80:83], a[24:27], v[192:195], v[80:83]
    v_mfma_f32_16x16x32_bf16 v[84:87], a[24:27], v[196:199], v[84:87]
    v_mfma_f32_16x16x32_bf16 v[88:91], a[24:27], v[200:203], v[88:91]
    v_mfma_f32_16x16x32_bf16 v[92:95], a[24:27], v[204:207], v[92:95]
    v_mfma_f32_16x16x32_bf16 v[108:111], a[28:31], v[204:207], v[108:111]
    v_mfma_f32_16x16x32_bf16 v[104:107], a[28:31], v[200:203], v[104:107]
    v_mfma_f32_16x16x32_bf16 v[100:103], a[28:31], v[196:199], v[100:103]
    v_mfma_f32_16x16x32_bf16 v[96:99], a[28:31], v[192:195], v[96:99]
    s_waitcnt vmcnt(12) lgkmcnt(0)
    v_mfma_f32_16x16x32_bf16 v[48:51], a[32:35], v[208:211], v[48:51]
    v_mfma_f32_16x16x32_bf16 v[52:55], a[32:35], v[212:215], v[52:55]
    v_mfma_f32_16x16x32_bf16 v[56:59], a[32:35], v[216:219], v[56:59]
    v_mfma_f32_16x16x32_bf16 v[60:63], a[32:35], v[220:223], v[60:63]
    v_mfma_f32_16x16x32_bf16 v[76:79], a[36:39], v[220:223], v[76:79]
    buffer_load_dwordx4 v[192:195], v112, s[8:11], s32 offen sc1
    buffer_load_dwordx4 v[196:199], v113, s[8:11], s32 offen sc1
    v_mfma_f32_16x16x32_bf16 v[72:75], a[36:39], v[216:219], v[72:75]
    buffer_load_dwordx4 v[200:203], v114, s[8:11], s32 offen sc1
    buffer_load_dwordx4 v[204:207], v115, s[8:11], s32 offen sc1
    v_mfma_f32_16x16x32_bf16 v[68:71], a[36:39], v[212:215], v[68:71]
    s_add_u32 s32, s32, 1024
    v_mfma_f32_16x16x32_bf16 v[64:67], a[36:39], v[208:211], v[64:67]
    s_cmp_eq_u32 s32, 14336
    s_cselect_b32 s32, 0, s32
    v_mfma_f32_16x16x32_bf16 v[80:83], a[40:43], v[208:211], v[80:83]
    v_mfma_f32_16x16x32_bf16 v[84:87], a[40:43], v[212:215], v[84:87]
    v_mfma_f32_16x16x32_bf16 v[88:91], a[40:43], v[216:219], v[88:91]
    v_mfma_f32_16x16x32_bf16 v[92:95], a[40:43], v[220:223], v[92:95]
    v_mfma_f32_16x16x32_bf16 v[108:111], a[44:47], v[220:223], v[108:111]
    v_mfma_f32_16x16x32_bf16 v[104:107], a[44:47], v[216:219], v[104:107]
    v_mfma_f32_16x16x32_bf16 v[100:103], a[44:47], v[212:215], v[100:103]
    v_mfma_f32_16x16x32_bf16 v[96:99], a[44:47], v[208:211], v[96:99]
    s_waitcnt vmcnt(12) lgkmcnt(0)
    v_mfma_f32_16x16x32_bf16 v[48:51], a[48:51], v[224:227], v[48:51]
    s_waitcnt vmcnt(63)
    ds_read_b64_tr_b16 v[16:17], v8 offset:16384
    ds_read_b64_tr_b16 v[18:19], v8 offset:18432
    v_mfma_f32_16x16x32_bf16 v[52:55], a[48:51], v[228:231], v[52:55]
    ds_read_b64_tr_b16 v[20:21], v9 offset:16384
    ds_read_b64_tr_b16 v[22:23], v9 offset:18432
    v_mfma_f32_16x16x32_bf16 v[56:59], a[48:51], v[232:235], v[56:59]
    ds_read_b64_tr_b16 v[24:25], v10 offset:16384
    ds_read_b64_tr_b16 v[26:27], v10 offset:18432
    v_mfma_f32_16x16x32_bf16 v[60:63], a[48:51], v[236:239], v[60:63]
    ds_read_b64_tr_b16 v[28:29], v11 offset:16384
    ds_read_b64_tr_b16 v[30:31], v11 offset:18432
    v_mfma_f32_16x16x32_bf16 v[76:79], a[52:55], v[236:239], v[76:79]
    buffer_load_dwordx4 v[208:211], v112, s[8:11], s32 offen sc1
    buffer_load_dwordx4 v[212:215], v113, s[8:11], s32 offen sc1
    v_mfma_f32_16x16x32_bf16 v[72:75], a[52:55], v[232:235], v[72:75]
    buffer_load_dwordx4 v[216:219], v114, s[8:11], s32 offen sc1
    buffer_load_dwordx4 v[220:223], v115, s[8:11], s32 offen sc1
    v_mfma_f32_16x16x32_bf16 v[68:71], a[52:55], v[228:231], v[68:71]
    s_add_u32 s32, s32, 1024
    v_mfma_f32_16x16x32_bf16 v[64:67], a[52:55], v[224:227], v[64:67]
    s_cmp_eq_u32 s32, 14336
    s_cselect_b32 s32, 0, s32
    v_mfma_f32_16x16x32_bf16 v[80:83], a[56:59], v[224:227], v[80:83]
    v_mfma_f32_16x16x32_bf16 v[84:87], a[56:59], v[228:231], v[84:87]
    v_mfma_f32_16x16x32_bf16 v[88:91], a[56:59], v[232:235], v[88:91]
    v_mfma_f32_16x16x32_bf16 v[92:95], a[56:59], v[236:239], v[92:95]
    v_mfma_f32_16x16x32_bf16 v[108:111], a[60:63], v[236:239], v[108:111]
    v_mfma_f32_16x16x32_bf16 v[104:107], a[60:63], v[232:235], v[104:107]
    v_mfma_f32_16x16x32_bf16 v[100:103], a[60:63], v[228:231], v[100:103]
    v_mfma_f32_16x16x32_bf16 v[96:99], a[60:63], v[224:227], v[96:99]
    s_waitcnt vmcnt(12) lgkmcnt(0)
    v_mfma_f32_16x16x32_bf16 v[48:51], v[16:19], v[240:243], v[48:51]
    s_waitcnt vmcnt(63)
    ds_read_b64_tr_b16 v[32:33], v8 offset:20480
    ds_read_b64_tr_b16 v[34:35], v8 offset:22528
    v_mfma_f32_16x16x32_bf16 v[52:55], v[16:19], v[244:247], v[52:55]
    ds_read_b64_tr_b16 v[36:37], v9 offset:20480
    ds_read_b64_tr_b16 v[38:39], v9 offset:22528
    v_mfma_f32_16x16x32_bf16 v[56:59], v[16:19], v[248:251], v[56:59]
    ds_read_b64_tr_b16 v[40:41], v10 offset:20480
    ds_read_b64_tr_b16 v[42:43], v10 offset:22528
    v_mfma_f32_16x16x32_bf16 v[60:63], v[16:19], v[252:255], v[60:63]
    ds_read_b64_tr_b16 v[44:45], v11 offset:20480
    ds_read_b64_tr_b16 v[46:47], v11 offset:22528
    v_mfma_f32_16x16x32_bf16 v[76:79], v[20:23], v[252:255], v[76:79]
    buffer_load_dwordx4 v[224:227], v112, s[8:11], s32 offen sc1
    buffer_load_dwordx4 v[228:231], v113, s[8:11], s32 offen sc1
    v_mfma_f32_16x16x32_bf16 v[72:75], v[20:23], v[248:251], v[72:75]
    buffer_load_dwordx4 v[232:235], v114, s[8:11], s32 offen sc1
    buffer_load_dwordx4 v[236:239], v115, s[8:11], s32 offen sc1
    v_mfma_f32_16x16x32_bf16 v[68:71], v[20:23], v[244:247], v[68:71]
    s_add_u32 s32, s32, 1024
    v_mfma_f32_16x16x32_bf16 v[64:67], v[20:23], v[240:243], v[64:67]
    s_cmp_eq_u32 s32, 14336
    s_cselect_b32 s32, 0, s32
    v_mfma_f32_16x16x32_bf16 v[80:83], v[24:27], v[240:243], v[80:83]
    v_mfma_f32_16x16x32_bf16 v[84:87], v[24:27], v[244:247], v[84:87]
    v_mfma_f32_16x16x32_bf16 v[88:91], v[24:27], v[248:251], v[88:91]
    v_mfma_f32_16x16x32_bf16 v[92:95], v[24:27], v[252:255], v[92:95]
    v_mfma_f32_16x16x32_bf16 v[108:111], v[28:31], v[252:255], v[108:111]
    v_mfma_f32_16x16x32_bf16 v[104:107], v[28:31], v[248:251], v[104:107]
    v_mfma_f32_16x16x32_bf16 v[100:103], v[28:31], v[244:247], v[100:103]
    v_mfma_f32_16x16x32_bf16 v[96:99], v[28:31], v[240:243], v[96:99]
    s_waitcnt vmcnt(12) lgkmcnt(0)
    v_mfma_f32_16x16x32_bf16 v[48:51], v[32:35], v[176:179], v[48:51]
    s_waitcnt vmcnt(63)
    ds_read_b64_tr_b16 v[16:17], v120 offset:0
    ds_read_b64_tr_b16 v[18:19], v120 offset:2048
    v_mfma_f32_16x16x32_bf16 v[52:55], v[32:35], v[180:183], v[52:55]
    ds_read_b64_tr_b16 v[20:21], v121 offset:0
    ds_read_b64_tr_b16 v[22:23], v121 offset:2048
    v_mfma_f32_16x16x32_bf16 v[56:59], v[32:35], v[184:187], v[56:59]
    ds_read_b64_tr_b16 v[24:25], v122 offset:0
    ds_read_b64_tr_b16 v[26:27], v122 offset:2048
    v_mfma_f32_16x16x32_bf16 v[60:63], v[32:35], v[188:191], v[60:63]
    ds_read_b64_tr_b16 v[28:29], v123 offset:0
    ds_read_b64_tr_b16 v[30:31], v123 offset:2048
    v_mfma_f32_16x16x32_bf16 v[76:79], v[36:39], v[188:191], v[76:79]
    buffer_load_dwordx4 v[240:243], v112, s[8:11], s32 offen sc1
    buffer_load_dwordx4 v[244:247], v113, s[8:11], s32 offen sc1
    v_mfma_f32_16x16x32_bf16 v[72:75], v[36:39], v[184:187], v[72:75]
    buffer_load_dwordx4 v[248:251], v114, s[8:11], s32 offen sc1
    buffer_load_dwordx4 v[252:255], v115, s[8:11], s32 offen sc1
    v_mfma_f32_16x16x32_bf16 v[68:71], v[36:39], v[180:183], v[68:71]
    s_add_u32 s32, s32, 1024
    v_mfma_f32_16x16x32_bf16 v[64:67], v[36:39], v[176:179], v[64:67]
    s_cmp_eq_u32 s32, 14336
    s_cselect_b32 s32, 0, s32
    v_mfma_f32_16x16x32_bf16 v[80:83], v[40:43], v[176:179], v[80:83]
    v_mfma_f32_16x16x32_bf16 v[84:87], v[40:43], v[180:183], v[84:87]
    v_mfma_f32_16x16x32_bf16 v[88:91], v[40:43], v[184:187], v[88:91]
    v_mfma_f32_16x16x32_bf16 v[92:95], v[40:43], v[188:191], v[92:95]
    v_mfma_f32_16x16x32_bf16 v[108:111], v[44:47], v[188:191], v[108:111]
    v_mfma_f32_16x16x32_bf16 v[104:107], v[44:47], v[184:187], v[104:107]
    v_mfma_f32_16x16x32_bf16 v[100:103], v[44:47], v[180:183], v[100:103]
    v_mfma_f32_16x16x32_bf16 v[96:99], v[44:47], v[176:179], v[96:99]
    s_waitcnt vmcnt(12) lgkmcnt(0)
    v_mfma_f32_16x16x32_bf16 v[48:51], v[16:19], v[192:195], v[48:51]
    s_waitcnt vmcnt(63)
    ds_read_b64_tr_b16 v[32:33], v120 offset:4096
    ds_read_b64_tr_b16 v[34:35], v120 offset:6144
    v_mfma_f32_16x16x32_bf16 v[52:55], v[16:19], v[196:199], v[52:55]
    ds_read_b64_tr_b16 v[36:37], v121 offset:4096
    ds_read_b64_tr_b16 v[38:39], v121 offset:6144
    v_mfma_f32_16x16x32_bf16 v[56:59], v[16:19], v[200:203], v[56:59]
    ds_read_b64_tr_b16 v[40:41], v122 offset:4096
    ds_read_b64_tr_b16 v[42:43], v122 offset:6144
    v_mfma_f32_16x16x32_bf16 v[60:63], v[16:19], v[204:207], v[60:63]
    ds_read_b64_tr_b16 v[44:45], v123 offset:4096
    ds_read_b64_tr_b16 v[46:47], v123 offset:6144
    v_mfma_f32_16x16x32_bf16 v[76:79], v[20:23], v[204:207], v[76:79]
    buffer_load_dwordx4 v[176:179], v112, s[8:11], s32 offen sc1
    buffer_load_dwordx4 v[180:183], v113, s[8:11], s32 offen sc1
    v_mfma_f32_16x16x32_bf16 v[72:75], v[20:23], v[200:203], v[72:75]
    buffer_load_dwordx4 v[184:187], v114, s[8:11], s32 offen sc1
    buffer_load_dwordx4 v[188:191], v115, s[8:11], s32 offen sc1
    v_mfma_f32_16x16x32_bf16 v[68:71], v[20:23], v[196:199], v[68:71]
    s_add_u32 s32, s32, 1024
    v_mfma_f32_16x16x32_bf16 v[64:67], v[20:23], v[192:195], v[64:67]
    s_cmp_eq_u32 s32, 14336
    s_cselect_b32 s32, 0, s32
    v_mfma_f32_16x16x32_bf16 v[80:83], v[24:27], v[192:195], v[80:83]
    v_mfma_f32_16x16x32_bf16 v[84:87], v[24:27], v[196:199], v[84:87]
    v_mfma_f32_16x16x32_bf16 v[88:91], v[24:27], v[200:203], v[88:91]
    v_mfma_f32_16x16x32_bf16 v[92:95], v[24:27], v[204:207], v[92:95]
    v_mfma_f32_16x16x32_bf16 v[108:111], v[28:31], v[204:207], v[108:111]
    v_mfma_f32_16x16x32_bf16 v[104:107], v[28:31], v[200:203], v[104:107]
    v_mfma_f32_16x16x32_bf16 v[100:103], v[28:31], v[196:199], v[100:103]
    v_mfma_f32_16x16x32_bf16 v[96:99], v[28:31], v[192:195], v[96:99]
    s_waitcnt vmcnt(12) lgkmcnt(0)
    v_mfma_f32_16x16x32_bf16 v[48:51], v[32:35], v[208:211], v[48:51]
    s_waitcnt vmcnt(63)
    ds_read_b64_tr_b16 v[16:17], v120 offset:8192
    ds_read_b64_tr_b16 v[18:19], v120 offset:10240
    v_mfma_f32_16x16x32_bf16 v[52:55], v[32:35], v[212:215], v[52:55]
    ds_read_b64_tr_b16 v[20:21], v121 offset:8192
    ds_read_b64_tr_b16 v[22:23], v121 offset:10240
    v_mfma_f32_16x16x32_bf16 v[56:59], v[32:35], v[216:219], v[56:59]
    ds_read_b64_tr_b16 v[24:25], v122 offset:8192
    ds_read_b64_tr_b16 v[26:27], v122 offset:10240
    v_mfma_f32_16x16x32_bf16 v[60:63], v[32:35], v[220:223], v[60:63]
    ds_read_b64_tr_b16 v[28:29], v123 offset:8192
    ds_read_b64_tr_b16 v[30:31], v123 offset:10240
    v_mfma_f32_16x16x32_bf16 v[76:79], v[36:39], v[220:223], v[76:79]
    buffer_load_dwordx4 v[192:195], v112, s[8:11], s32 offen sc1
    buffer_load_dwordx4 v[196:199], v113, s[8:11], s32 offen sc1
    v_mfma_f32_16x16x32_bf16 v[72:75], v[36:39], v[216:219], v[72:75]
    buffer_load_dwordx4 v[200:203], v114, s[8:11], s32 offen sc1
    buffer_load_dwordx4 v[204:207], v115, s[8:11], s32 offen sc1
    v_mfma_f32_16x16x32_bf16 v[68:71], v[36:39], v[212:215], v[68:71]
    s_add_u32 s32, s32, 1024
    v_mfma_f32_16x16x32_bf16 v[64:67], v[36:39], v[208:211], v[64:67]
    s_cmp_eq_u32 s32, 14336
    s_cselect_b32 s32, 0, s32
    v_mfma_f32_16x16x32_bf16 v[80:83], v[40:43], v[208:211], v[80:83]
    v_mfma_f32_16x16x32_bf16 v[84:87], v[40:43], v[212:215], v[84:87]
    v_mfma_f32_16x16x32_bf16 v[88:91], v[40:43], v[216:219], v[88:91]
    v_mfma_f32_16x16x32_bf16 v[92:95], v[40:43], v[220:223], v[92:95]
    v_mfma_f32_16x16x32_bf16 v[108:111], v[44:47], v[220:223], v[108:111]
    v_mfma_f32_16x16x32_bf16 v[104:107], v[44:47], v[216:219], v[104:107]
    v_mfma_f32_16x16x32_bf16 v[100:103], v[44:47], v[212:215], v[100:103]
    v_mfma_f32_16x16x32_bf16 v[96:99], v[44:47], v[208:211], v[96:99]
    s_waitcnt vmcnt(12) lgkmcnt(0)
    v_mfma_f32_16x16x32_bf16 v[48:51], v[16:19], v[224:227], v[48:51]
    s_waitcnt vmcnt(63)
    ds_read_b64_tr_b16 v[32:33], v120 offset:12288
    ds_read_b64_tr_b16 v[34:35], v120 offset:14336
    v_mfma_f32_16x16x32_bf16 v[52:55], v[16:19], v[228:231], v[52:55]
    ds_read_b64_tr_b16 v[36:37], v121 offset:12288
    ds_read_b64_tr_b16 v[38:39], v121 offset:14336
    v_mfma_f32_16x16x32_bf16 v[56:59], v[16:19], v[232:235], v[56:59]
    ds_read_b64_tr_b16 v[40:41], v122 offset:12288
    ds_read_b64_tr_b16 v[42:43], v122 offset:14336
    v_mfma_f32_16x16x32_bf16 v[60:63], v[16:19], v[236:239], v[60:63]
    ds_read_b64_tr_b16 v[44:45], v123 offset:12288
    ds_read_b64_tr_b16 v[46:47], v123 offset:14336
    v_mfma_f32_16x16x32_bf16 v[76:79], v[20:23], v[236:239], v[76:79]
    buffer_load_dwordx4 v[208:211], v112, s[8:11], s32 offen sc1
    buffer_load_dwordx4 v[212:215], v113, s[8:11], s32 offen sc1
    v_mfma_f32_16x16x32_bf16 v[72:75], v[20:23], v[232:235], v[72:75]
    buffer_load_dwordx4 v[216:219], v114, s[8:11], s32 offen sc1
    buffer_load_dwordx4 v[220:223], v115, s[8:11], s32 offen sc1
    v_mfma_f32_16x16x32_bf16 v[68:71], v[20:23], v[228:231], v[68:71]
    s_add_u32 s32, s32, 1024
    v_mfma_f32_16x16x32_bf16 v[64:67], v[20:23], v[224:227], v[64:67]
    s_cmp_eq_u32 s32, 14336
    s_cselect_b32 s32, 0, s32
    v_mfma_f32_16x16x32_bf16 v[80:83], v[24:27], v[224:227], v[80:83]
    v_mfma_f32_16x16x32_bf16 v[84:87], v[24:27], v[228:231], v[84:87]
    v_mfma_f32_16x16x32_bf16 v[88:91], v[24:27], v[232:235], v[88:91]
    v_mfma_f32_16x16x32_bf16 v[92:95], v[24:27], v[236:239], v[92:95]
    v_mfma_f32_16x16x32_bf16 v[108:111], v[28:31], v[236:239], v[108:111]
    v_mfma_f32_16x16x32_bf16 v[104:107], v[28:31], v[232:235], v[104:107]
    v_mfma_f32_16x16x32_bf16 v[100:103], v[28:31], v[228:231], v[100:103]
    v_mfma_f32_16x16x32_bf16 v[96:99], v[28:31], v[224:227], v[96:99]
    s_waitcnt vmcnt(12) lgkmcnt(0)
    v_mfma_f32_16x16x32_bf16 v[48:51], v[32:35], v[240:243], v[48:51]
    s_waitcnt vmcnt(63)
    ds_read_b64_tr_b16 v[16:17], v8 offset:0
    ds_read_b64_tr_b16 v[18:19], v8 offset:2048
    v_mfma_f32_16x16x32_bf16 v[52:55], v[32:35], v[244:247], v[52:55]
    ds_read_b64_tr_b16 v[20:21], v9 offset:0
    ds_read_b64_tr_b16 v[22:23], v9 offset:2048
    v_mfma_f32_16x16x32_bf16 v[56:59], v[32:35], v[248:251], v[56:59]
    ds_read_b64_tr_b16 v[24:25], v10 offset:0
    ds_read_b64_tr_b16 v[26:27], v10 offset:2048
    v_mfma_f32_16x16x32_bf16 v[60:63], v[32:35], v[252:255], v[60:63]
    ds_read_b64_tr_b16 v[28:29], v11 offset:0
    ds_read_b64_tr_b16 v[30:31], v11 offset:2048
    v_mfma_f32_16x16x32_bf16 v[76:79], v[36:39], v[252:255], v[76:79]
    buffer_load_dwordx4 v[224:227], v112, s[8:11], s32 offen sc1
    buffer_load_dwordx4 v[228:231], v113, s[8:11], s32 offen sc1
    v_mfma_f32_16x16x32_bf16 v[72:75], v[36:39], v[248:251], v[72:75]
    buffer_load_dwordx4 v[232:235], v114, s[8:11], s32 offen sc1
    buffer_load_dwordx4 v[236:239], v115, s[8:11], s32 offen sc1
    v_mfma_f32_16x16x32_bf16 v[68:71], v[36:39], v[244:247], v[68:71]
    s_add_u32 s32, s32, 1024
    v_mfma_f32_16x16x32_bf16 v[64:67], v[36:39], v[240:243], v[64:67]
    s_cmp_eq_u32 s32, 14336
    s_cselect_b32 s32, 0, s32
    v_mfma_f32_16x16x32_bf16 v[80:83], v[40:43], v[240:243], v[80:83]
    v_mfma_f32_16x16x32_bf16 v[84:87], v[40:43], v[244:247], v[84:87]
    v_mfma_f32_16x16x32_bf16 v[88:91], v[40:43], v[248:251], v[88:91]
    v_mfma_f32_16x16x32_bf16 v[92:95], v[40:43], v[252:255], v[92:95]
    v_mfma_f32_16x16x32_bf16 v[108:111], v[44:47], v[252:255], v[108:111]
    v_mfma_f32_16x16x32_bf16 v[104:107], v[44:47], v[248:251], v[104:107]
    v_mfma_f32_16x16x32_bf16 v[100:103], v[44:47], v[244:247], v[100:103]
    v_mfma_f32_16x16x32_bf16 v[96:99], v[44:47], v[240:243], v[96:99]
    s_waitcnt vmcnt(12) lgkmcnt(0)
    v_mfma_f32_16x16x32_bf16 v[48:51], v[16:19], v[176:179], v[48:51]
    s_waitcnt vmcnt(63)
    ds_read_b64_tr_b16 v[32:33], v8 offset:4096
    ds_read_b64_tr_b16 v[34:35], v8 offset:6144
    v_mfma_f32_16x16x32_bf16 v[52:55], v[16:19], v[180:183], v[52:55]
    ds_read_b64_tr_b16 v[36:37], v9 offset:4096
    ds_read_b64_tr_b16 v[38:39], v9 offset:6144
    v_mfma_f32_16x16x32_bf16 v[56:59], v[16:19], v[184:187], v[56:59]
    ds_read_b64_tr_b16 v[40:41], v10 offset:4096
    ds_read_b64_tr_b16 v[42:43], v10 offset:6144
    v_mfma_f32_16x16x32_bf16 v[60:63], v[16:19], v[188:191], v[60:63]
    ds_read_b64_tr_b16 v[44:45], v11 offset:4096
    ds_read_b64_tr_b16 v[46:47], v11 offset:6144
    v_mfma_f32_16x16x32_bf16 v[76:79], v[20:23], v[188:191], v[76:79]
    v_mfma_f32_16x16x32_bf16 v[72:75], v[20:23], v[184:187], v[72:75]
    v_mfma_f32_16x16x32_bf16 v[68:71], v[20:23], v[180:183], v[68:71]
    v_mfma_f32_16x16x32_bf16 v[64:67], v[20:23], v[176:179], v[64:67]
    v_mfma_f32_16x16x32_bf16 v[80:83], v[24:27], v[176:179], v[80:83]
    v_mfma_f32_16x16x32_bf16 v[84:87], v[24:27], v[180:183], v[84:87]
    v_mfma_f32_16x16x32_bf16 v[88:91], v[24:27], v[184:187], v[88:91]
    v_mfma_f32_16x16x32_bf16 v[92:95], v[24:27], v[188:191], v[92:95]
    v_mfma_f32_16x16x32_bf16 v[108:111], v[28:31], v[188:191], v[108:111]
    v_mfma_f32_16x16x32_bf16 v[104:107], v[28:31], v[184:187], v[104:107]
    v_mfma_f32_16x16x32_bf16 v[100:103], v[28:31], v[180:183], v[100:103]
    v_mfma_f32_16x16x32_bf16 v[96:99], v[28:31], v[176:179], v[96:99]
    s_waitcnt vmcnt(8) lgkmcnt(0)
    v_mfma_f32_16x16x32_bf16 v[48:51], v[32:35], v[192:195], v[48:51]
    s_waitcnt vmcnt(60)
    ds_read_b64_tr_b16 v[16:17], v8 offset:8192
    ds_read_b64_tr_b16 v[18:19], v8 offset:10240
    v_mfma_f32_16x16x32_bf16 v[52:55], v[32:35], v[196:199], v[52:55]
    ds_read_b64_tr_b16 v[20:21], v9 offset:8192
    ds_read_b64_tr_b16 v[22:23], v9 offset:10240
    v_mfma_f32_16x16x32_bf16 v[56:59], v[32:35], v[200:203], v[56:59]
    ds_read_b64_tr_b16 v[24:25], v10 offset:8192
    ds_read_b64_tr_b16 v[26:27], v10 offset:10240
    v_mfma_f32_16x16x32_bf16 v[60:63], v[32:35], v[204:207], v[60:63]
    ds_read_b64_tr_b16 v[28:29], v11 offset:8192
    ds_read_b64_tr_b16 v[30:31], v11 offset:10240
    v_mfma_f32_16x16x32_bf16 v[76:79], v[36:39], v[204:207], v[76:79]
    v_mfma_f32_16x16x32_bf16 v[72:75], v[36:39], v[200:203], v[72:75]
    v_mfma_f32_16x16x32_bf16 v[68:71], v[36:39], v[196:199], v[68:71]
    v_mfma_f32_16x16x32_bf16 v[64:67], v[36:39], v[192:195], v[64:67]
    v_mfma_f32_16x16x32_bf16 v[80:83], v[40:43], v[192:195], v[80:83]
    v_mfma_f32_16x16x32_bf16 v[84:87], v[40:43], v[196:199], v[84:87]
    v_mfma_f32_16x16x32_bf16 v[88:91], v[40:43], v[200:203], v[88:91]
    v_mfma_f32_16x16x32_bf16 v[92:95], v[40:43], v[204:207], v[92:95]
    v_mfma_f32_16x16x32_bf16 v[108:111], v[44:47], v[204:207], v[108:111]
    v_mfma_f32_16x16x32_bf16 v[104:107], v[44:47], v[200:203], v[104:107]
    v_mfma_f32_16x16x32_bf16 v[100:103], v[44:47], v[196:199], v[100:103]
    v_mfma_f32_16x16x32_bf16 v[96:99], v[44:47], v[192:195], v[96:99]
    s_waitcnt vmcnt(4) lgkmcnt(0)
    v_mfma_f32_16x16x32_bf16 v[48:51], v[16:19], v[208:211], v[48:51]
    s_waitcnt vmcnt(56)
    ds_read_b64_tr_b16 v[32:33], v8 offset:12288
    ds_read_b64_tr_b16 v[34:35], v8 offset:14336
    v_mfma_f32_16x16x32_bf16 v[52:55], v[16:19], v[212:215], v[52:55]
    ds_read_b64_tr_b16 v[36:37], v9 offset:12288
    ds_read_b64_tr_b16 v[38:39], v9 offset:14336
    v_mfma_f32_16x16x32_bf16 v[56:59], v[16:19], v[216:219], v[56:59]
    ds_read_b64_tr_b16 v[40:41], v10 offset:12288
    ds_read_b64_tr_b16 v[42:43], v10 offset:14336
    v_mfma_f32_16x16x32_bf16 v[60:63], v[16:19], v[220:223], v[60:63]
    ds_read_b64_tr_b16 v[44:45], v11 offset:12288
    ds_read_b64_tr_b16 v[46:47], v11 offset:14336
    v_mfma_f32_16x16x32_bf16 v[76:79], v[20:23], v[220:223], v[76:79]
    v_mfma_f32_16x16x32_bf16 v[72:75], v[20:23], v[216:219], v[72:75]
    v_mfma_f32_16x16x32_bf16 v[68:71], v[20:23], v[212:215], v[68:71]
    v_mfma_f32_16x16x32_bf16 v[64:67], v[20:23], v[208:211], v[64:67]
    v_mfma_f32_16x16x32_bf16 v[80:83], v[24:27], v[208:211], v[80:83]
    v_mfma_f32_16x16x32_bf16 v[84:87], v[24:27], v[212:215], v[84:87]
    v_mfma_f32_16x16x32_bf16 v[88:91], v[24:27], v[216:219], v[88:91]
    v_mfma_f32_16x16x32_bf16 v[92:95], v[24:27], v[220:223], v[92:95]
    v_mfma_f32_16x16x32_bf16 v[108:111], v[28:31], v[220:223], v[108:111]
    v_mfma_f32_16x16x32_bf16 v[104:107], v[28:31], v[216:219], v[104:107]
    v_mfma_f32_16x16x32_bf16 v[100:103], v[28:31], v[212:215], v[100:103]
    v_mfma_f32_16x16x32_bf16 v[96:99], v[28:31], v[208:211], v[96:99]
    s_waitcnt vmcnt(0) lgkmcnt(0)
    v_mfma_f32_16x16x32_bf16 v[48:51], v[32:35], v[224:227], v[48:51]
    v_mfma_f32_16x16x32_bf16 v[52:55], v[32:35], v[228:231], v[52:55]
    v_mfma_f32_16x16x32_bf16 v[56:59], v[32:35], v[232:235], v[56:59]
    v_mfma_f32_16x16x32_bf16 v[60:63], v[32:35], v[236:239], v[60:63]
    v_mfma_f32_16x16x32_bf16 v[76:79], v[36:39], v[236:239], v[76:79]
    v_mfma_f32_16x16x32_bf16 v[72:75], v[36:39], v[232:235], v[72:75]
    v_mfma_f32_16x16x32_bf16 v[68:71], v[36:39], v[228:231], v[68:71]
    v_mfma_f32_16x16x32_bf16 v[64:67], v[36:39], v[224:227], v[64:67]
    v_mfma_f32_16x16x32_bf16 v[80:83], v[40:43], v[224:227], v[80:83]
    v_mfma_f32_16x16x32_bf16 v[84:87], v[40:43], v[228:231], v[84:87]
    v_mfma_f32_16x16x32_bf16 v[88:91], v[40:43], v[232:235], v[88:91]
    v_mfma_f32_16x16x32_bf16 v[92:95], v[40:43], v[236:239], v[92:95]
    v_mfma_f32_16x16x32_bf16 v[108:111], v[44:47], v[236:239], v[108:111]
    v_mfma_f32_16x16x32_bf16 v[104:107], v[44:47], v[232:235], v[104:107]
    v_mfma_f32_16x16x32_bf16 v[100:103], v[44:47], v[228:231], v[100:103]
    v_mfma_f32_16x16x32_bf16 v[96:99], v[44:47], v[224:227], v[96:99]
    s_mov_b32 s24, s12
    s_mov_b32 s25, s13
    s_mov_b32 s26, 0x1c0000
    s_mov_b32 s27, 0x20000
    s_mov_b32 s34, 0xffff0000
    ds_write_b128 v119, v[52:55] offset:0
    ds_write_b128 v119, v[68:71] offset:1024
    ds_write_b128 v119, v[84:87] offset:2048
    ds_write_b128 v119, v[100:103] offset:3072
    ds_write_b128 v119, v[56:59] offset:4096
    ds_write_b128 v119, v[72:75] offset:5120
    ds_write_b128 v119, v[88:91] offset:6144
    ds_write_b128 v119, v[104:107] offset:7168
    ds_write_b128 v119, v[60:63] offset:8192
    ds_write_b128 v119, v[76:79] offset:9216
    ds_write_b128 v119, v[92:95] offset:10240
    ds_write_b128 v119, v[108:111] offset:11264
    v_accvgpr_read_b32 v176, a240
    v_accvgpr_read_b32 v177, a241
    v_accvgpr_read_b32 v178, a242
    v_accvgpr_read_b32 v179, a243
    v_accvgpr_read_b32 v180, a244
    v_accvgpr_read_b32 v181, a245
    v_accvgpr_read_b32 v182, a246
    v_accvgpr_read_b32 v183, a247
    v_lshlrev_b32 v16, 16, v176
    v_and_b32 v17, s34, v176
    v_pk_add_f32 v[48:49], v[48:49], v[16:17]
    v_lshlrev_b32 v16, 16, v177
    v_and_b32 v17, s34, v177
    v_pk_add_f32 v[50:51], v[50:51], v[16:17]
    v_lshlrev_b32 v16, 16, v178
    v_and_b32 v17, s34, v178
    v_pk_add_f32 v[64:65], v[64:65], v[16:17]
    v_lshlrev_b32 v16, 16, v179
    v_and_b32 v17, s34, v179
    v_pk_add_f32 v[66:67], v[66:67], v[16:17]
    v_lshlrev_b32 v16, 16, v180
    v_and_b32 v17, s34, v180
    v_pk_add_f32 v[80:81], v[80:81], v[16:17]
    v_lshlrev_b32 v16, 16, v181
    v_and_b32 v17, s34, v181
    v_pk_add_f32 v[82:83], v[82:83], v[16:17]
    v_lshlrev_b32 v16, 16, v182
    v_and_b32 v17, s34, v182
    v_pk_add_f32 v[96:97], v[96:97], v[16:17]
    v_lshlrev_b32 v16, 16, v183
    v_and_b32 v17, s34, v183
    v_pk_add_f32 v[98:99], v[98:99], v[16:17]
    s_waitcnt lgkmcnt(0)
    s_barrier
    ds_read_b128 v[52:55], v116 offset:0
    ds_read_b128 v[56:59], v117 offset:0
    ds_read_b128 v[60:63], v118 offset:0
    ds_read_b128 v[68:71], v116 offset:1024
    ds_read_b128 v[72:75], v117 offset:1024
    ds_read_b128 v[76:79], v118 offset:1024
    ds_read_b128 v[84:87], v116 offset:2048
    ds_read_b128 v[88:91], v117 offset:2048
    ds_read_b128 v[92:95], v118 offset:2048
    ds_read_b128 v[100:103], v116 offset:3072
    ds_read_b128 v[104:107], v117 offset:3072
    ds_read_b128 v[108:111], v118 offset:3072
    s_waitcnt lgkmcnt(9)
    v_pk_add_f32 v[52:53], v[52:53], v[56:57]
    v_pk_add_f32 v[48:49], v[48:49], v[60:61]
    v_pk_add_f32 v[54:55], v[54:55], v[58:59]
    v_pk_add_f32 v[50:51], v[50:51], v[62:63]
    v_pk_add_f32 v[48:49], v[48:49], v[52:53]
    v_pk_add_f32 v[50:51], v[50:51], v[54:55]
    v_cvt_pk_bf16_f32 v24, v48, v49
    v_cvt_pk_bf16_f32 v25, v50, v51
    s_waitcnt lgkmcnt(6)
    v_pk_add_f32 v[68:69], v[68:69], v[72:73]
    v_pk_add_f32 v[64:65], v[64:65], v[76:77]
    v_pk_add_f32 v[70:71], v[70:71], v[74:75]
    v_pk_add_f32 v[66:67], v[66:67], v[78:79]
    v_pk_add_f32 v[64:65], v[64:65], v[68:69]
    v_pk_add_f32 v[66:67], v[66:67], v[70:71]
    v_cvt_pk_bf16_f32 v26, v64, v65
    v_cvt_pk_bf16_f32 v27, v66, v67
    s_waitcnt lgkmcnt(3)
    v_pk_add_f32 v[84:85], v[84:85], v[88:89]
    v_pk_add_f32 v[80:81], v[80:81], v[92:93]
    v_pk_add_f32 v[86:87], v[86:87], v[90:91]
    v_pk_add_f32 v[82:83], v[82:83], v[94:95]
    v_pk_add_f32 v[80:81], v[80:81], v[84:85]
    v_pk_add_f32 v[82:83], v[82:83], v[86:87]
    v_cvt_pk_bf16_f32 v28, v80, v81
    v_cvt_pk_bf16_f32 v29, v82, v83
    s_waitcnt lgkmcnt(0)
    v_pk_add_f32 v[100:101], v[100:101], v[104:105]
    v_pk_add_f32 v[96:97], v[96:97], v[108:109]
    v_pk_add_f32 v[102:103], v[102:103], v[106:107]
    v_pk_add_f32 v[98:99], v[98:99], v[110:111]
    v_pk_add_f32 v[96:97], v[96:97], v[100:101]
    v_pk_add_f32 v[98:99], v[98:99], v[102:103]
    v_cvt_pk_bf16_f32 v30, v96, v97
    v_cvt_pk_bf16_f32 v31, v98, v99
    v_and_b32 v13, 15, v0
    v_bfe_u32 v14, v0, 4, 2
    s_lshl_b32 s3, s70, 6
    s_lshl_b32 s38, s44, 4
    s_add_u32 s3, s3, s38
    v_add_u32 v13, s3, v13
    v_mul_u32_u24 v13, 896, v13
    v_lshl_add_u32 v13, v14, 3, v13
    s_lshl_b32 s38, s71, 7
    buffer_store_dwordx2 v[24:25], v13, s[24:27], s38 offen offset:0
    buffer_store_dwordx2 v[26:27], v13, s[24:27], s38 offen offset:32
    buffer_store_dwordx2 v[28:29], v13, s[24:27], s38 offen offset:64
    buffer_store_dwordx2 v[30:31], v13, s[24:27], s38 offen offset:96
    s_cmp_eq_u32 s2, 0
    s_cbranch_scc0 L_fin
    v_mov_b32 v2, 0x40000
    v_mov_b32 v3, s7
    buffer_store_dword v3, v2, s[28:31], 0 offen
L_fin:
L_done:
    s_endpgm
L1_loopK_hk:
    s_cmp_eq_u32 s50, 6
    s_cbranch_scc0 L1_loopK_h2
    buffer_store_dword v31, v30, s[28:31], 0 offen sc1
    s_branch L1_loopK_hr
L1_loopK_h2:
    buffer_load_dword v28, v29, s[28:31], 0 offen sc1
    s_lshr_b32 s62, s2, 3
    s_getpc_b64 s[64:65]
    s_add_u32 s64, s64, L1_loopK@rel32@lo+4
    s_addc_u32 s65, s65, L1_loopK@rel32@hi+12
    s_mul_i32 s3, s62, (((L1_epi-L1_loopK)/32+63)&~63)
    s_add_u32 s64, s64, s3
    s_addc_u32 s65, s65, 0
    s_sub_u32 s66, L1_epi-L1_loopK, s3
    s_cselect_b32 s66, 0, s66
    s_min_u32 s66, s66, (((L1_epi-L1_loopK)/32+63)&~63)
    s_mov_b32 s67, 0x20000
    v_lshlrev_b32 v30, 6, v0
    buffer_load_dword v225, v30, s[64:67], 0 offen
    s_branch L1_loopK_hr
L1_loopK_xw:
    s_mov_b32 s3, 0x10000
L1_loopK_xp:
    buffer_load_dword v28, v29, s[28:31], 0 offen sc1
    s_waitcnt vmcnt(0)
    v_cmp_ne_u32 vcc, s7, v28
    s_cbranch_vccz L1_loopK_xr
    s_sleep 2
    s_sub_u32 s3, s3, 1
    s_cbranch_scc0 L1_loopK_xp
    s_branch L1_loopK_xr
L1_loopV_hk:
    s_cmp_eq_u32 s50, 6
    s_cbranch_scc0 L1_loopV_h2
    buffer_store_dword v31, v30, s[28:31], 0 offen sc1
    s_branch L1_loopV_hr
L1_loopV_h2:
    buffer_load_dword v28, v29, s[28:31], 0 offen sc1
    s_lshr_b32 s62, s2, 3
    s_getpc_b64 s[64:65]
    s_add_u32 s64, s64, L1_loopK@rel32@lo+4
    s_addc_u32 s65, s65, L1_loopK@rel32@hi+12
    s_mul_i32 s3, s62, (((L1_epi-L1_loopK)/32+63)&~63)
    s_add_u32 s64, s64, s3
    s_addc_u32 s65, s65, 0
    s_sub_u32 s66, L1_epi-L1_loopK, s3
    s_cselect_b32 s66, 0, s66
    s_min_u32 s66, s66, (((L1_epi-L1_loopK)/32+63)&~63)
    s_mov_b32 s67, 0x20000
    v_lshlrev_b32 v30, 6, v0
    buffer_load_dword v225, v30, s[64:67], 0 offen
    s_branch L1_loopV_hr
L1_loopV_xw:
    s_mov_b32 s3, 0x10000
L1_loopV_xp:
    buffer_load_dword v28, v29, s[28:31], 0 offen sc1
    s_waitcnt vmcnt(0)
    v_cmp_ne_u32 vcc, s7, v28
    s_cbranch_vccz L1_loopV_xr
    s_sleep 2
    s_sub_u32 s3, s3, 1
    s_cbranch_scc0 L1_loopV_xp
    s_branch L1_loopV_xr
L2_mk2:
    s_mov_b32 s39, 0
    s_cmp_lt_u32 s40, s70
    s_cbranch_scc1 L2_mk2_sw
    v_mov_b32 v15, 0xf149f2ca
    v_subrev_u32 v13, s40, v5
    v_cmp_le_i32 s[52:53], 0, v13
    v_cmp_le_i32 s[54:55], 1, v13
    v_cmp_le_i32 s[56:57], 2, v13
    v_cmp_le_i32 s[58:59], 3, v13
    v_cndmask_b32 v16, v15, v7, s[52:53]
    v_cndmask_b32 v17, v15, v7, s[54:55]
    v_cndmask_b32 v18, v15, v7, s[56:57]
    v_cndmask_b32 v19, v15, v7, s[58:59]
    v_cmp_le_i32 s[52:53], 16, v13
    v_cmp_le_i32 s[54:55], 17, v13
    v_cmp_le_i32 s[56:57], 18, v13
    v_cmp_le_i32 s[58:59], 19, v13
    v_cndmask_b32 v24, v15, v7, s[52:53]
    v_cndmask_b32 v25, v15, v7, s[54:55]
    v_cndmask_b32 v26, v15, v7, s[56:57]
    v_cndmask_b32 v27, v15, v7, s[58:59]
    v_subrev_u32 v13, s40, v6
    v_cmp_le_i32 s[52:53], 0, v13
    v_cmp_le_i32 s[54:55], 1, v13
    v_cmp_le_i32 s[56:57], 2, v13
    v_cmp_le_i32 s[58:59], 3, v13
    v_cndmask_b32 v20, v15, v8, s[52:53]
    v_cndmask_b32 v21, v15, v8, s[54:55]
    v_cndmask_b32 v22, v15, v8, s[56:57]
    v_cndmask_b32 v23, v15, v8, s[58:59]
    v_cmp_le_i32 s[52:53], 16, v13
    v_cmp_le_i32 s[54:55], 17, v13
    v_cmp_le_i32 s[56:57], 18, v13
    v_cmp_le_i32 s[58:59], 19, v13
    v_cndmask_b32 v28, v15, v8, s[52:53]
    v_cndmask_b32 v29, v15, v8, s[54:55]
    v_cndmask_b32 v30, v15, v8, s[56:57]
    v_cndmask_b32 v31, v15, v8, s[58:59]
L2_mk2_sw:
    s_cmp_eq_u32 s40, s41
    s_cbranch_scc0 L2_mk2_ns
    s_mov_b32 s41, -1
    s_mov_b32 s32, 0
    s_lshl_b32 s10, s43, 14
    s_add_u32 s18, s10, 32768
L2_mk2_ns:
    s_add_u32 s40, s40, 32
    s_branch L2_mk2_ret
L2_mk3:
    s_mov_b32 s39, 0
    s_cmp_lt_u32 s40, s70
    s_cbranch_scc1 L2_mk3_sw
    v_mov_b32 v15, 0xf149f2ca
    v_subrev_u32 v13, s40, v5
    v_cmp_le_i32 s[52:53], 0, v13
    v_cmp_le_i32 s[54:55], 1, v13
    v_cmp_le_i32 s[56:57], 2, v13
    v_cmp_le_i32 s[58:59], 3, v13
    v_cndmask_b32 v16, v15, v7, s[52:53]
    v_cndmask_b32 v17, v15, v7, s[54:55]
    v_cndmask_b32 v18, v15, v7, s[56:57]
    v_cndmask_b32 v19, v15, v7, s[58:59]
    v_cmp_le_i32 s[52:53], 16, v13
    v_cmp_le_i32 s[54:55], 17, v13
    v_cmp_le_i32 s[56:57], 18, v13
    v_cmp_le_i32 s[58:59], 19, v13
    v_cndmask_b32 v24, v15, v7, s[52:53]
    v_cndmask_b32 v25, v15, v7, s[54:55]
    v_cndmask_b32 v26, v15, v7, s[56:57]
    v_cndmask_b32 v27, v15, v7, s[58:59]
    v_subrev_u32 v13, s40, v6
    v_cmp_le_i32 s[52:53], 0, v13
    v_cmp_le_i32 s[54:55], 1, v13
    v_cmp_le_i32 s[56:57], 2, v13
    v_cmp_le_i32 s[58:59], 3, v13
    v_cndmask_b32 v20, v15, v8, s[52:53]
    v_cndmask_b32 v21, v15, v8, s[54:55]
    v_cndmask_b32 v22, v15, v8, s[56:57]
    v_cndmask_b32 v23, v15, v8, s[58:59]
    v_cmp_le_i32 s[52:53], 16, v13
    v_cmp_le_i32 s[54:55], 17, v13
    v_cmp_le_i32 s[56:57], 18, v13
    v_cmp_le_i32 s[58:59], 19, v13
    v_cndmask_b32 v28, v15, v8, s[52:53]
    v_cndmask_b32 v29, v15, v8, s[54:55]
    v_cndmask_b32 v30, v15, v8, s[56:57]
    v_cndmask_b32 v31, v15, v8, s[58:59]
L2_mk3_sw:
    s_cmp_eq_u32 s40, s41
    s_cbranch_scc0 L2_mk3_ns
    s_mov_b32 s41, -1
    s_mov_b32 s32, 0
    s_lshl_b32 s10, s43, 14
    s_add_u32 s18, s10, 32768
L2_mk3_ns:
    s_add_u32 s40, s40, 32
    s_branch L2_mk3_ret
L2_mk6:
    s_mov_b32 s39, 0
    s_cmp_lt_u32 s40, s70
    s_cbranch_scc1 L2_mk6_sw
    v_mov_b32 v15, 0xf149f2ca
    v_subrev_u32 v13, s40, v5
    v_cmp_le_i32 s[52:53], 0, v13
    v_cmp_le_i32 s[54:55], 1, v13
    v_cmp_le_i32 s[56:57], 2, v13
    v_cmp_le_i32 s[58:59], 3, v13
    v_cndmask_b32 v16, v15, v7, s[52:53]
    v_cndmask_b32 v17, v15, v7, s[54:55]
    v_cndmask_b32 v18, v15, v7, s[56:57]
    v_cndmask_b32 v19, v15, v7, s[58:59]
    v_cmp_le_i32 s[52:53], 16, v13
    v_cmp_le_i32 s[54:55], 17, v13
    v_cmp_le_i32 s[56:57], 18, v13
    v_cmp_le_i32 s[58:59], 19, v13
    v_cndmask_b32 v24, v15, v7, s[52:53]
    v_cndmask_b32 v25, v15, v7, s[54:55]
    v_cndmask_b32 v26, v15, v7, s[56:57]
    v_cndmask_b32 v27, v15, v7, s[58:59]
    v_subrev_u32 v13, s40, v6
    v_cmp_le_i32 s[52:53], 0, v13
    v_cmp_le_i32 s[54:55], 1, v13
    v_cmp_le_i32 s[56:57], 2, v13
    v_cmp_le_i32 s[58:59], 3, v13
    v_cndmask_b32 v20, v15, v8, s[52:53]
    v_cndmask_b32 v21, v15, v8, s[54:55]
    v_cndmask_b32 v22, v15, v8, s[56:57]
    v_cndmask_b32 v23, v15, v8, s[58:59]
    v_cmp_le_i32 s[52:53], 16, v13
    v_cmp_le_i32 s[54:55], 17, v13
    v_cmp_le_i32 s[56:57], 18, v13
    v_cmp_le_i32 s[58:59], 19, v13
    v_cndmask_b32 v28, v15, v8, s[52:53]
    v_cndmask_b32 v29, v15, v8, s[54:55]
    v_cndmask_b32 v30, v15, v8, s[56:57]
    v_cndmask_b32 v31, v15, v8, s[58:59]
L2_mk6_sw:
    s_cmp_eq_u32 s40, s41
    s_cbranch_scc0 L2_mk6_ns
    s_mov_b32 s41, -1
    s_mov_b32 s32, 0
    s_lshl_b32 s10, s43, 14
    s_add_u32 s18, s10, 32768
L2_mk6_ns:
    s_add_u32 s40, s40, 32
    s_branch L2_mk6_ret
L2_mk7:
    s_mov_b32 s39, 0
    s_cmp_lt_u32 s40, s70
    s_cbranch_scc1 L2_mk7_sw
    v_mov_b32 v15, 0xf149f2ca
    v_subrev_u32 v13, s40, v5
    v_cmp_le_i32 s[52:53], 0, v13
    v_cmp_le_i32 s[54:55], 1, v13
    v_cmp_le_i32 s[56:57], 2, v13
    v_cmp_le_i32 s[58:59], 3, v13
    v_cndmask_b32 v16, v15, v7, s[52:53]
    v_cndmask_b32 v17, v15, v7, s[54:55]
    v_cndmask_b32 v18, v15, v7, s[56:57]
    v_cndmask_b32 v19, v15, v7, s[58:59]
    v_cmp_le_i32 s[52:53], 16, v13
    v_cmp_le_i32 s[54:55], 17, v13
    v_cmp_le_i32 s[56:57], 18, v13
    v_cmp_le_i32 s[58:59], 19, v13
    v_cndmask_b32 v24, v15, v7, s[52:53]
    v_cndmask_b32 v25, v15, v7, s[54:55]
    v_cndmask_b32 v26, v15, v7, s[56:57]
    v_cndmask_b32 v27, v15, v7, s[58:59]
    v_subrev_u32 v13, s40, v6
    v_cmp_le_i32 s[52:53], 0, v13
    v_cmp_le_i32 s[54:55], 1, v13
    v_cmp_le_i32 s[56:57], 2, v13
    v_cmp_le_i32 s[58:59], 3, v13
    v_cndmask_b32 v20, v15, v8, s[52:53]
    v_cndmask_b32 v21, v15, v8, s[54:55]
    v_cndmask_b32 v22, v15, v8, s[56:57]
    v_cndmask_b32 v23, v15, v8, s[58:59]
    v_cmp_le_i32 s[52:53], 16, v13
    v_cmp_le_i32 s[54:55], 17, v13
    v_cmp_le_i32 s[56:57], 18, v13
    v_cmp_le_i32 s[58:59], 19, v13
    v_cndmask_b32 v28, v15, v8, s[52:53]
    v_cndmask_b32 v29, v15, v8, s[54:55]
    v_cndmask_b32 v30, v15, v8, s[56:57]
    v_cndmask_b32 v31, v15, v8, s[58:59]
L2_mk7_sw:
    s_cmp_eq_u32 s40, s41
    s_cbranch_scc0 L2_mk7_ns
    s_mov_b32 s41, -1
    s_mov_b32 s32, 0
    s_lshl_b32 s10, s43, 14
    s_add_u32 s18, s10, 32768
L2_mk7_ns:
    s_add_u32 s40, s40, 32
    s_branch L2_mk7_ret
L2_pub1:
    s_waitcnt vmcnt(16)
    s_lshl_b32 s3, s44, 2
    v_mov_b32 v13, s3
    v_mov_b32 v14, s7
    buffer_store_dword v14, v13, s[28:31], s68 offen sc1
    s_mov_b32 s68, 0
    s_branch L2_pub1_ret
L2_pub2:
    s_waitcnt vmcnt(16)
    s_lshl_b32 s3, s44, 2
    v_mov_b32 v13, s3
    v_mov_b32 v14, s7
    buffer_store_dword v14, v13, s[28:31], s68 offen sc1
    s_mov_b32 s68, 0
    s_branch L2_pub2_ret
L3_cP0:
    s_mov_b32 s55, 0x10000
L3_cP0_p:
    buffer_load_dword v15, v3, s[28:31], s39 offen sc1
    s_waitcnt vmcnt(0)
    v_cmp_ne_u32 vcc, s7, v15
    s_and_b32 s3, vcc_lo, 0xf
    s_cbranch_scc0 L3_cP0_r
    s_sleep 2
    s_sub_u32 s55, s55, 1
    s_cbranch_scc0 L3_cP0_p
    s_branch L3_cP0_r
L3_cP4:
    s_mov_b32 s55, 0x10000
L3_cP4_p:
    buffer_load_dword v15, v3, s[28:31], s39 offen sc1
    s_waitcnt vmcnt(0)
    v_cmp_ne_u32 vcc, s7, v15
    s_and_b32 s3, vcc_lo, 0xf0
    s_cbranch_scc0 L3_cP4_r
    s_sleep 2
    s_sub_u32 s55, s55, 1
    s_cbranch_scc0 L3_cP4_p
    s_branch L3_cP4_r
L3_cP12:
    s_mov_b32 s55, 0x10000
L3_cP12_p:
    buffer_load_dword v15, v3, s[28:31], s39 offen sc1
    s_waitcnt vmcnt(0)
    v_cmp_ne_u32 vcc, s7, v15
    s_and_b32 s3, vcc_lo, 0xf00
    s_cbranch_scc0 L3_cP12_r
    s_sleep 2
    s_sub_u32 s55, s55, 1
    s_cbranch_scc0 L3_cP12_p
    s_branch L3_cP12_r
L3_cP20:
    s_mov_b32 s55, 0x10000
L3_cP20_p:
    buffer_load_dword v15, v3, s[28:31], s39 offen sc1
    s_waitcnt vmcnt(0)
    v_cmp_ne_u32 vcc, s7, v15
    s_and_b32 s3, vcc_lo, 0xf000
    s_cbranch_scc0 L3_cP20_r
    s_sleep 2
    s_sub_u32 s55, s55, 1
    s_cbranch_scc0 L3_cP20_p
    s_branch L3_cP20_r
L4_ones:
    v_mov_b32 v16, 0x3f803f80
    v_mov_b32 v17, 0x3f803f80
    v_mov_b32 v18, 0x3f803f80
    v_mov_b32 v19, 0x3f803f80
    v_mov_b32 v20, 0x3f803f80
    v_mov_b32 v21, 0x3f803f80
    v_mov_b32 v22, 0x3f803f80
    v_mov_b32 v23, 0x3f803f80
    v_mov_b32 v24, 0x3f803f80
    v_mov_b32 v25, 0x3f803f80
    v_mov_b32 v26, 0x3f803f80
    v_mov_b32 v27, 0x3f803f80
    v_mov_b32 v28, 0x3f803f80
    v_mov_b32 v29, 0x3f803f80
    v_mov_b32 v30, 0x3f803f80
    v_mov_b32 v31, 0x3f803f80
    v_mov_b32 v32, 0x3f803f80
    v_mov_b32 v33, 0x3f803f80
    v_mov_b32 v34, 0x3f803f80
    v_mov_b32 v35, 0x3f803f80
    v_mov_b32 v36, 0x3f803f80
    v_mov_b32 v37, 0x3f803f80
    v_mov_b32 v38, 0x3f803f80
    v_mov_b32 v39, 0x3f803f80
    v_mov_b32 v40, 0x3f803f80
    v_mov_b32 v41, 0x3f803f80
    v_mov_b32 v42, 0x3f803f80
    v_mov_b32 v43, 0x3f803f80
    v_mov_b32 v44, 0x3f803f80
    v_mov_b32 v45, 0x3f803f80
    v_mov_b32 v46, 0x3f803f80
    v_mov_b32 v47, 0x3f803f80
    v_mov_b32 v48, 0x3f803f80
    v_mov_b32 v49, 0x3f803f80
    v_mov_b32 v50, 0x3f803f80
    v_mov_b32 v51, 0x3f803f80
    v_mov_b32 v52, 0x3f803f80
    v_mov_b32 v53, 0x3f803f80
    v_mov_b32 v54, 0x3f803f80
    v_mov_b32 v55, 0x3f803f80
    v_mov_b32 v56, 0x3f803f80
    v_mov_b32 v57, 0x3f803f80
    v_mov_b32 v58, 0x3f803f80
    v_mov_b32 v59, 0x3f803f80
    v_mov_b32 v60, 0x3f803f80
    v_mov_b32 v61, 0x3f803f80
    v_mov_b32 v62, 0x3f803f80
    v_mov_b32 v63, 0x3f803f80
    v_mov_b32 v64, 0x3f803f80
    v_mov_b32 v65, 0x3f803f80
    v_mov_b32 v66, 0x3f803f80
    v_mov_b32 v67, 0x3f803f80
    v_mov_b32 v68, 0x3f803f80
    v_mov_b32 v69, 0x3f803f80
    v_mov_b32 v70, 0x3f803f80
    v_mov_b32 v71, 0x3f803f80
    v_mov_b32 v72, 0x3f803f80
    v_mov_b32 v73, 0x3f803f80
    v_mov_b32 v74, 0x3f803f80
    v_mov_b32 v75, 0x3f803f80
    v_mov_b32 v76, 0x3f803f80
    v_mov_b32 v77, 0x3f803f80
    v_mov_b32 v78, 0x3f803f80
    v_mov_b32 v79, 0x3f803f80
    v_mov_b32 v80, 0x3f803f80
    v_mov_b32 v81, 0x3f803f80
    v_mov_b32 v82, 0x3f803f80
    v_mov_b32 v83, 0x3f803f80
    v_mov_b32 v84, 0x3f803f80
    v_mov_b32 v85, 0x3f803f80
    v_mov_b32 v86, 0x3f803f80
    v_mov_b32 v87, 0x3f803f80
    v_mov_b32 v88, 0x3f803f80
    v_mov_b32 v89, 0x3f803f80
    v_mov_b32 v90, 0x3f803f80
    v_mov_b32 v91, 0x3f803f80
    v_mov_b32 v92, 0x3f803f80
    v_mov_b32 v93, 0x3f803f80
    v_mov_b32 v94, 0x3f803f80
    v_mov_b32 v95, 0x3f803f80
    v_mov_b32 v96, 0x3f803f80
    v_mov_b32 v97, 0x3f803f80
    v_mov_b32 v98, 0x3f803f80
    v_mov_b32 v99, 0x3f803f80
    v_mov_b32 v100, 0x3f803f80
    v_mov_b32 v101, 0x3f803f80
    v_mov_b32 v102, 0x3f803f80
    v_mov_b32 v103, 0x3f803f80
    v_mov_b32 v104, 0x3f803f80
    v_mov_b32 v105, 0x3f803f80
    v_mov_b32 v106, 0x3f803f80
    v_mov_b32 v107, 0x3f803f80
    v_mov_b32 v108, 0x3f803f80
    v_mov_b32 v109, 0x3f803f80
    v_mov_b32 v110, 0x3f803f80
    v_mov_b32 v111, 0x3f803f80
    v_mov_b32 v112, 0x3f803f80
    v_mov_b32 v113, 0x3f803f80
    v_mov_b32 v114, 0x3f803f80
    v_mov_b32 v115, 0x3f803f80
    v_mov_b32 v116, 0x3f803f80
    v_mov_b32 v117, 0x3f803f80
    v_mov_b32 v118, 0x3f803f80
    v_mov_b32 v119, 0x3f803f80
    v_mov_b32 v120, 0x3f803f80
    v_mov_b32 v121, 0x3f803f80
    v_mov_b32 v122, 0x3f803f80
    v_mov_b32 v123, 0x3f803f80
    v_mov_b32 v124, 0x3f803f80
    v_mov_b32 v125, 0x3f803f80
    v_mov_b32 v126, 0x3f803f80
    v_mov_b32 v127, 0x3f803f80
    s_waitcnt vmcnt(0)
    s_branch L4_go
L4_cw:
    s_cmp_eq_u32 s77, 1
    s_cbranch_scc1 L4_cr
    s_mov_b32 s55, 0x10000
L4_cp:
    buffer_load_dword v24, v10, s[28:31], s39 offen sc1
    s_waitcnt vmcnt(0)
    v_cmp_ne_u32 vcc, s7, v24
    s_cbranch_vccz L4_cr
    s_sleep 2
    s_sub_u32 s55, s55, 1
    s_cbranch_scc0 L4_cp
    s_branch L4_cr
L4_cs:
    v_and_b32 v10, 15, v0
    v_lshlrev_b32 v10, 20, v10
    v_add_u32 v10, v10, v11
    s_add_u32 s22, s46, 1024
    s_nop 4
    buffer_store_dwordx4 v[128:131], v10, s[20:23], s46 offen offset:0 sc1
    buffer_store_dwordx4 v[136:139], v10, s[20:23], s46 offen offset:64 sc1
    buffer_store_dwordx4 v[144:147], v10, s[20:23], s46 offen offset:128 sc1
    buffer_store_dwordx4 v[152:155], v10, s[20:23], s46 offen offset:192 sc1
    buffer_store_dwordx4 v[160:163], v10, s[20:23], s46 offen offset:256 sc1
    buffer_store_dwordx4 v[168:171], v10, s[20:23], s46 offen offset:320 sc1
    buffer_store_dwordx4 v[176:179], v10, s[20:23], s46 offen offset:384 sc1
    buffer_store_dwordx4 v[184:187], v10, s[20:23], s46 offen offset:448 sc1
    buffer_store_dwordx4 v[192:195], v10, s[20:23], s46 offen offset:512 sc1
    buffer_store_dwordx4 v[200:203], v10, s[20:23], s46 offen offset:576 sc1
    buffer_store_dwordx4 v[208:211], v10, s[20:23], s46 offen offset:640 sc1
    buffer_store_dwordx4 v[216:219], v10, s[20:23], s46 offen offset:704 sc1
    buffer_store_dwordx4 v[224:227], v10, s[20:23], s46 offen offset:768 sc1
    buffer_store_dwordx4 v[232:235], v10, s[20:23], s46 offen offset:832 sc1
    buffer_store_dwordx4 v[240:243], v10, s[20:23], s46 offen offset:896 sc1
    buffer_store_dwordx4 v[248:251], v10, s[20:23], s46 offen offset:960 sc1
    s_waitcnt vmcnt(0)
    v_mov_b32 v10, 0
    v_mov_b32 v11, s7
    s_cmp_eq_u32 s44, 0
    s_cbranch_scc0 L_fin
    buffer_store_dword v11, v10, s[28:31], s39 offen sc1
    s_branch L_fin
L5_cP0:
    s_mov_b32 s55, 0x10000
L5_cP0_p:
    buffer_load_dword v15, v3, s[28:31], s39 offen sc1
    s_waitcnt vmcnt(0)
    v_cmp_ne_u32 vcc, s7, v15
    s_and_b32 s3, vcc_lo, 0xffff
    s_cbranch_scc0 L5_cP0_r
    s_sleep 2
    s_sub_u32 s55, s55, 1
    s_cbranch_scc0 L5_cP0_p
    s_branch L5_cP0_r
L_hot_end:
L2_rare3:
    s_nop 7
    s_nop 3
    v_max3_f32 v13, v32, v33, v34
    v_max3_f32 v13, v13, v35, v40
    v_max3_f32 v13, v13, v41, v42
    v_max_f32 v13, v13, v43
    v_max3_f32 v14, v36, v37, v38
    v_max3_f32 v14, v14, v39, v44
    v_max3_f32 v14, v14, v45, v46
    v_max_f32 v14, v14, v47
    v_log_f32 v96, v11
    s_nop 0
    v_max3_f32 v13, v13, v96, 0
    v_log_f32 v97, v12
    s_nop 0
    v_max3_f32 v14, v14, v97, 0
    v_mov_b32 v96, v13
    v_mov_b32 v97, v14
    s_nop 1
    v_permlane32_swap_b32 v13, v96
    v_permlane32_swap_b32 v14, v97
    v_max_f32 v13, v13, v96
    v_max_f32 v14, v14, v97
    v_mov_b32 v96, v13
    v_mov_b32 v97, v14
    s_nop 1
    v_permlane16_swap_b32 v13, v96
    v_permlane16_swap_b32 v14, v97
    v_max_f32 v13, v13, v96
    v_max_f32 v14, v14, v97
    v_sub_f32 v32, v32, v13
    v_sub_f32 v33, v33, v13
    v_sub_f32 v34, v34, v13
    v_sub_f32 v35, v35, v13
    v_sub_f32 v40, v40, v13
    v_sub_f32 v41, v41, v13
    v_sub_f32 v42, v42, v13
    v_sub_f32 v43, v43, v13
    v_sub_f32 v36, v36, v14
    v_sub_f32 v37, v37, v14
    v_sub_f32 v38, v38, v14
    v_sub_f32 v39, v39, v14
    v_sub_f32 v44, v44, v14
    v_sub_f32 v45, v45, v14
    v_sub_f32 v46, v46, v14
    v_sub_f32 v47, v47, v14
    v_sub_f32 v48, v48, v13
    v_sub_f32 v49, v49, v13
    v_sub_f32 v50, v50, v13
    v_sub_f32 v51, v51, v13
    v_sub_f32 v56, v56, v13
    v_sub_f32 v57, v57, v13
    v_sub_f32 v58, v58, v13
    v_sub_f32 v59, v59, v13
    v_sub_f32 v52, v52, v14
    v_sub_f32 v53, v53, v14
    v_sub_f32 v54, v54, v14
    v_sub_f32 v55, v55, v14
    v_sub_f32 v60, v60, v14
    v_sub_f32 v61, v61, v14
    v_sub_f32 v62, v62, v14
    v_sub_f32 v63, v63, v14
    v_sub_f32 v16, v16, v13
    v_sub_f32 v17, v17, v13
    v_sub_f32 v18, v18, v13
    v_sub_f32 v19, v19, v13
    v_sub_f32 v24, v24, v13
    v_sub_f32 v25, v25, v13
    v_sub_f32 v26, v26, v13
    v_sub_f32 v27, v27, v13
    v_sub_f32 v20, v20, v14
    v_sub_f32 v21, v21, v14
    v_sub_f32 v22, v22, v14
    v_sub_f32 v23, v23, v14
    v_sub_f32 v28, v28, v14
    v_sub_f32 v29, v29, v14
    v_sub_f32 v30, v30, v14
    v_sub_f32 v31, v31, v14
    v_sub_f32 v7, v7, v13
    v_sub_f32 v8, v8, v14
    v_exp_f32 v13, -v13
    v_exp_f32 v14, -v14
    s_nop 0
    v_mul_f32 v11, v11, v13
    v_mul_f32 v128, v128, v13
    v_mul_f32 v129, v129, v13
    v_mul_f32 v130, v130, v13
    v_mul_f32 v131, v131, v13
    v_mul_f32 v136, v136, v13
    v_mul_f32 v137, v137, v13
    v_mul_f32 v138, v138, v13
    v_mul_f32 v139, v139, v13
    v_mul_f32 v144, v144, v13
    v_mul_f32 v145, v145, v13
    v_mul_f32 v146, v146, v13
    v_mul_f32 v147, v147, v13
    v_mul_f32 v152, v152, v13
    v_mul_f32 v153, v153, v13
    v_mul_f32 v154, v154, v13
    v_mul_f32 v155, v155, v13
    v_mul_f32 v160, v160, v13
    v_mul_f32 v161, v161, v13
    v_mul_f32 v162, v162, v13
    v_mul_f32 v163, v163, v13
    v_mul_f32 v168, v168, v13
    v_mul_f32 v169, v169, v13
    v_mul_f32 v170, v170, v13
    v_mul_f32 v171, v171, v13
    v_mul_f32 v176, v176, v13
    v_mul_f32 v177, v177, v13
    v_mul_f32 v178, v178, v13
    v_mul_f32 v179, v179, v13
    v_mul_f32 v184, v184, v13
    v_mul_f32 v185, v185, v13
    v_mul_f32 v186, v186, v13
    v_mul_f32 v187, v187, v13
    v_mul_f32 v192, v192, v13
    v_mul_f32 v193, v193, v13
    v_mul_f32 v194, v194, v13
    v_mul_f32 v195, v195, v13
    v_mul_f32 v200, v200, v13
    v_mul_f32 v201, v201, v13
    v_mul_f32 v202, v202, v13
    v_mul_f32 v203, v203, v13
    v_mul_f32 v208, v208, v13
    v_mul_f32 v209, v209, v13
    v_mul_f32 v210, v210, v13
    v_mul_f32 v211, v211, v13
    v_mul_f32 v216, v216, v13
    v_mul_f32 v217, v217, v13
    v_mul_f32 v218, v218, v13
    v_mul_f32 v219, v219, v13
    v_mul_f32 v224, v224, v13
    v_mul_f32 v225, v225, v13
    v_mul_f32 v226, v226, v13
    v_mul_f32 v227, v227, v13
    v_mul_f32 v232, v232, v13
    v_mul_f32 v233, v233, v13
    v_mul_f32 v234, v234, v13
    v_mul_f32 v235, v235, v13
    v_mul_f32 v240, v240, v13
    v_mul_f32 v241, v241, v13
    v_mul_f32 v242, v242, v13
    v_mul_f32 v243, v243, v13
    v_mul_f32 v248, v248, v13
    v_mul_f32 v249, v249, v13
    v_mul_f32 v250, v250, v13
    v_mul_f32 v251, v251, v13
    v_mul_f32 v12, v12, v14
    v_mul_f32 v132, v132, v14
    v_mul_f32 v133, v133, v14
    v_mul_f32 v134, v134, v14
    v_mul_f32 v135, v135, v14
    v_mul_f32 v140, v140, v14
    v_mul_f32 v141, v141, v14
    v_mul_f32 v142, v142, v14
    v_mul_f32 v143, v143, v14
    v_mul_f32 v148, v148, v14
    v_mul_f32 v149, v149, v14
    v_mul_f32 v150, v150, v14
    v_mul_f32 v151, v151, v14
    v_mul_f32 v156, v156, v14
    v_mul_f32 v157, v157, v14
    v_mul_f32 v158, v158, v14
    v_mul_f32 v159, v159, v14
    v_mul_f32 v164, v164, v14
    v_mul_f32 v165, v165, v14
    v_mul_f32 v166, v166, v14
    v_mul_f32 v167, v167, v14
    v_mul_f32 v172, v172, v14
    v_mul_f32 v173, v173, v14
    v_mul_f32 v174, v174, v14
    v_mul_f32 v175, v175, v14
    v_mul_f32 v180, v180, v14
    v_mul_f32 v181, v181, v14
    v_mul_f32 v182, v182, v14
    v_mul_f32 v183, v183, v14
    v_mul_f32 v188, v188, v14
    v_mul_f32 v189, v189, v14
    v_mul_f32 v190, v190, v14
    v_mul_f32 v191, v191, v14
    v_mul_f32 v196, v196, v14
    v_mul_f32 v197, v197, v14
    v_mul_f32 v198, v198, v14
    v_mul_f32 v199, v199, v14
    v_mul_f32 v204, v204, v14
    v_mul_f32 v205, v205, v14
    v_mul_f32 v206, v206, v14
    v_mul_f32 v207, v207, v14
    v_mul_f32 v212, v212, v14
    v_mul_f32 v213, v213, v14
    v_mul_f32 v214, v214, v14
    v_mul_f32 v215, v215, v14
    v_mul_f32 v220, v220, v14
    v_mul_f32 v221, v221, v14
    v_mul_f32 v222, v222, v14
    v_mul_f32 v223, v223, v14
    v_mul_f32 v228, v228, v14
    v_mul_f32 v229, v229, v14
    v_mul_f32 v230, v230, v14
    v_mul_f32 v231, v231, v14
    v_mul_f32 v236, v236, v14
    v_mul_f32 v237, v237, v14
    v_mul_f32 v238, v238, v14
    v_mul_f32 v239, v239, v14
    v_mul_f32 v244, v244, v14
    v_mul_f32 v245, v245, v14
    v_mul_f32 v246, v246, v14
    v_mul_f32 v247, v247, v14
    v_mul_f32 v252, v252, v14
    v_mul_f32 v253, v253, v14
    v_mul_f32 v254, v254, v14
    v_mul_f32 v255, v255, v14
    v_exp_f32 v64, v32
    v_exp_f32 v65, v33
    v_add_f32 v9, v11, v64
    v_exp_f32 v66, v34
    v_add_f32 v9, v9, v65
    v_cvt_pk_bf16_f32 v80, v64, v65
    v_exp_f32 v67, v35
    v_add_f32 v9, v9, v66
    v_exp_f32 v72, v40
    v_add_f32 v9, v9, v67
    v_cvt_pk_bf16_f32 v81, v66, v67
    v_exp_f32 v73, v41
    v_add_f32 v9, v9, v72
    v_exp_f32 v74, v42
    v_add_f32 v9, v9, v73
    v_cvt_pk_bf16_f32 v82, v72, v73
    v_exp_f32 v75, v43
    v_add_f32 v9, v9, v74
    v_exp_f32 v68, v36
    v_add_f32 v9, v9, v75
    v_cvt_pk_bf16_f32 v83, v74, v75
    v_exp_f32 v69, v37
    v_add_f32 v10, v12, v68
    v_exp_f32 v70, v38
    v_add_f32 v10, v10, v69
    v_cvt_pk_bf16_f32 v84, v68, v69
    v_exp_f32 v71, v39
    v_add_f32 v10, v10, v70
    v_exp_f32 v76, v44
    v_add_f32 v10, v10, v71
    v_cvt_pk_bf16_f32 v85, v70, v71
    v_exp_f32 v77, v45
    v_add_f32 v10, v10, v76
    v_exp_f32 v78, v46
    v_add_f32 v10, v10, v77
    v_cvt_pk_bf16_f32 v86, v76, v77
    v_exp_f32 v79, v47
    v_add_f32 v10, v10, v78
    v_add_f32 v13, v9, v10
    v_add_f32 v10, v10, v79
    v_cvt_pk_bf16_f32 v87, v78, v79
    s_nop 1
    s_branch L2_rare3_ret
L2_rare4:
    s_nop 7
    s_nop 3
    v_max3_f32 v13, v48, v49, v50
    v_max3_f32 v13, v13, v51, v56
    v_max3_f32 v13, v13, v57, v58
    v_max_f32 v13, v13, v59
    v_max3_f32 v14, v52, v53, v54
    v_max3_f32 v14, v14, v55, v60
    v_max3_f32 v14, v14, v61, v62
    v_max_f32 v14, v14, v63
    v_log_f32 v96, v9
    s_nop 0
    v_max3_f32 v13, v13, v96, 0
    v_log_f32 v97, v10
    s_nop 0
    v_max3_f32 v14, v14, v97, 0
    v_mov_b32 v96, v13
    v_mov_b32 v97, v14
    s_nop 1
    v_permlane32_swap_b32 v13, v96
    v_permlane32_swap_b32 v14, v97
    v_max_f32 v13, v13, v96
    v_max_f32 v14, v14, v97
    v_mov_b32 v96, v13
    v_mov_b32 v97, v14
    s_nop 1
    v_permlane16_swap_b32 v13, v96
    v_permlane16_swap_b32 v14, v97
    v_max_f32 v13, v13, v96
    v_max_f32 v14, v14, v97
    v_sub_f32 v48, v48, v13
    v_sub_f32 v49, v49, v13
    v_sub_f32 v50, v50, v13
    v_sub_f32 v51, v51, v13
    v_sub_f32 v56, v56, v13
    v_sub_f32 v57, v57, v13
    v_sub_f32 v58, v58, v13
    v_sub_f32 v59, v59, v13
    v_sub_f32 v52, v52, v14
    v_sub_f32 v53, v53, v14
    v_sub_f32 v54, v54, v14
    v_sub_f32 v55, v55, v14
    v_sub_f32 v60, v60, v14
    v_sub_f32 v61, v61, v14
    v_sub_f32 v62, v62, v14
    v_sub_f32 v63, v63, v14
    v_sub_f32 v32, v32, v13
    v_sub_f32 v33, v33, v13
    v_sub_f32 v34, v34, v13
    v_sub_f32 v35, v35, v13
    v_sub_f32 v40, v40, v13
    v_sub_f32 v41, v41, v13
    v_sub_f32 v42, v42, v13
    v_sub_f32 v43, v43, v13
    v_sub_f32 v36, v36, v14
    v_sub_f32 v37, v37, v14
    v_sub_f32 v38, v38, v14
    v_sub_f32 v39, v39, v14
    v_sub_f32 v44, v44, v14
    v_sub_f32 v45, v45, v14
    v_sub_f32 v46, v46, v14
    v_sub_f32 v47, v47, v14
    v_sub_f32 v16, v16, v13
    v_sub_f32 v17, v17, v13
    v_sub_f32 v18, v18, v13
    v_sub_f32 v19, v19, v13
    v_sub_f32 v24, v24, v13
    v_sub_f32 v25, v25, v13
    v_sub_f32 v26, v26, v13
    v_sub_f32 v27, v27, v13
    v_sub_f32 v20, v20, v14
    v_sub_f32 v21, v21, v14
    v_sub_f32 v22, v22, v14
    v_sub_f32 v23, v23, v14
    v_sub_f32 v28, v28, v14
    v_sub_f32 v29, v29, v14
    v_sub_f32 v30, v30, v14
    v_sub_f32 v31, v31, v14
    v_sub_f32 v7, v7, v13
    v_sub_f32 v8, v8, v14
    v_exp_f32 v13, -v13
    v_exp_f32 v14, -v14
    s_nop 0
    v_mul_f32 v9, v9, v13
    v_mul_f32 v128, v128, v13
    v_mul_f32 v129, v129, v13
    v_mul_f32 v130, v130, v13
    v_mul_f32 v131, v131, v13
    v_mul_f32 v136, v136, v13
    v_mul_f32 v137, v137, v13
    v_mul_f32 v138, v138, v13
    v_mul_f32 v139, v139, v13
    v_mul_f32 v144, v144, v13
    v_mul_f32 v145, v145, v13
    v_mul_f32 v146, v146, v13
    v_mul_f32 v147, v147, v13
    v_mul_f32 v152, v152, v13
    v_mul_f32 v153, v153, v13
    v_mul_f32 v154, v154, v13
    v_mul_f32 v155, v155, v13
    v_mul_f32 v160, v160, v13
    v_mul_f32 v161, v161, v13
    v_mul_f32 v162, v162, v13
    v_mul_f32 v163, v163, v13
    v_mul_f32 v168, v168, v13
    v_mul_f32 v169, v169, v13
    v_mul_f32 v170, v170, v13
    v_mul_f32 v171, v171, v13
    v_mul_f32 v176, v176, v13
    v_mul_f32 v177, v177, v13
    v_mul_f32 v178, v178, v13
    v_mul_f32 v179, v179, v13
    v_mul_f32 v184, v184, v13
    v_mul_f32 v185, v185, v13
    v_mul_f32 v186, v186, v13
    v_mul_f32 v187, v187, v13
    v_mul_f32 v192, v192, v13
    v_mul_f32 v193, v193, v13
    v_mul_f32 v194, v194, v13
    v_mul_f32 v195, v195, v13
    v_mul_f32 v200, v200, v13
    v_mul_f32 v201, v201, v13
    v_mul_f32 v202, v202, v13
    v_mul_f32 v203, v203, v13
    v_mul_f32 v208, v208, v13
    v_mul_f32 v209, v209, v13
    v_mul_f32 v210, v210, v13
    v_mul_f32 v211, v211, v13
    v_mul_f32 v216, v216, v13
    v_mul_f32 v217, v217, v13
    v_mul_f32 v218, v218, v13
    v_mul_f32 v219, v219, v13
    v_mul_f32 v224, v224, v13
    v_mul_f32 v225, v225, v13
    v_mul_f32 v226, v226, v13
    v_mul_f32 v227, v227, v13
    v_mul_f32 v232, v232, v13
    v_mul_f32 v233, v233, v13
    v_mul_f32 v234, v234, v13
    v_mul_f32 v235, v235, v13
    v_mul_f32 v240, v240, v13
    v_mul_f32 v241, v241, v13
    v_mul_f32 v242, v242, v13
    v_mul_f32 v243, v243, v13
    v_mul_f32 v248, v248, v13
    v_mul_f32 v249, v249, v13
    v_mul_f32 v250, v250, v13
    v_mul_f32 v251, v251, v13
    v_mul_f32 v10, v10, v14
    v_mul_f32 v132, v132, v14
    v_mul_f32 v133, v133, v14
    v_mul_f32 v134, v134, v14
    v_mul_f32 v135, v135, v14
    v_mul_f32 v140, v140, v14
    v_mul_f32 v141, v141, v14
    v_mul_f32 v142, v142, v14
    v_mul_f32 v143, v143, v14
    v_mul_f32 v148, v148, v14
    v_mul_f32 v149, v149, v14
    v_mul_f32 v150, v150, v14
    v_mul_f32 v151, v151, v14
    v_mul_f32 v156, v156, v14
    v_mul_f32 v157, v157, v14
    v_mul_f32 v158, v158, v14
    v_mul_f32 v159, v159, v14
    v_mul_f32 v164, v164, v14
    v_mul_f32 v165, v165, v14
    v_mul_f32 v166, v166, v14
    v_mul_f32 v167, v167, v14
    v_mul_f32 v172, v172, v14
    v_mul_f32 v173, v173, v14
    v_mul_f32 v174, v174, v14
    v_mul_f32 v175, v175, v14
    v_mul_f32 v180, v180, v14
    v_mul_f32 v181, v181, v14
    v_mul_f32 v182, v182, v14
    v_mul_f32 v183, v183, v14
    v_mul_f32 v188, v188, v14
    v_mul_f32 v189, v189, v14
    v_mul_f32 v190, v190, v14
    v_mul_f32 v191, v191, v14
    v_mul_f32 v196, v196, v14
    v_mul_f32 v197, v197, v14
    v_mul_f32 v198, v198, v14
    v_mul_f32 v199, v199, v14
    v_mul_f32 v204, v204, v14
    v_mul_f32 v205, v205, v14
    v_mul_f32 v206, v206, v14
    v_mul_f32 v207, v207, v14
    v_mul_f32 v212, v212, v14
    v_mul_f32 v213, v213, v14
    v_mul_f32 v214, v214, v14
    v_mul_f32 v215, v215, v14
    v_mul_f32 v220, v220, v14
    v_mul_f32 v221, v221, v14
    v_mul_f32 v222, v222, v14
    v_mul_f32 v223, v223, v14
    v_mul_f32 v228, v228, v14
    v_mul_f32 v229, v229, v14
    v_mul_f32 v230, v230, v14
    v_mul_f32 v231, v231, v14
    v_mul_f32 v236, v236, v14
    v_mul_f32 v237, v237, v14
    v_mul_f32 v238, v238, v14
    v_mul_f32 v239, v239, v14
    v_mul_f32 v244, v244, v14
    v_mul_f32 v245, v245, v14
    v_mul_f32 v246, v246, v14
    v_mul_f32 v247, v247, v14
    v_mul_f32 v252, v252, v14
    v_mul_f32 v253, v253, v14
    v_mul_f32 v254, v254, v14
    v_mul_f32 v255, v255, v14
    v_exp_f32 v64, v48
    v_exp_f32 v65, v49
    v_add_f32 v11, v9, v64
    v_exp_f32 v66, v50
    v_add_f32 v11, v11, v65
    v_cvt_pk_bf16_f32 v88, v64, v65
    v_exp_f32 v67, v51
    v_add_f32 v11, v11, v66
    v_exp_f32 v72, v56
    v_add_f32 v11, v11, v67
    v_cvt_pk_bf16_f32 v89, v66, v67
    v_exp_f32 v73, v57
    v_add_f32 v11, v11, v72
    v_exp_f32 v74, v58
    v_add_f32 v11, v11, v73
    v_cvt_pk_bf16_f32 v90, v72, v73
    v_exp_f32 v75, v59
    v_add_f32 v11, v11, v74
    v_exp_f32 v68, v52
    v_add_f32 v11, v11, v75
    v_cvt_pk_bf16_f32 v91, v74, v75
    v_exp_f32 v69, v53
    v_add_f32 v12, v10, v68
    v_exp_f32 v70, v54
    v_add_f32 v12, v12, v69
    v_cvt_pk_bf16_f32 v92, v68, v69
    v_exp_f32 v71, v55
    v_add_f32 v12, v12, v70
    v_exp_f32 v76, v60
    v_add_f32 v12, v12, v71
    v_cvt_pk_bf16_f32 v93, v70, v71
    v_exp_f32 v77, v61
    v_add_f32 v12, v12, v76
    v_exp_f32 v78, v62
    v_add_f32 v12, v12, v77
    v_cvt_pk_bf16_f32 v94, v76, v77
    v_exp_f32 v79, v63
    v_add_f32 v12, v12, v78
    v_add_f32 v13, v11, v12
    v_add_f32 v12, v12, v79
    v_cvt_pk_bf16_f32 v95, v78, v79
    s_nop 1
    s_branch L2_rare4_ret
L2_rare5:
    s_nop 7
    s_nop 3
    v_max3_f32 v13, v32, v33, v34
    v_max3_f32 v13, v13, v35, v40
    v_max3_f32 v13, v13, v41, v42
    v_max_f32 v13, v13, v43
    v_max3_f32 v14, v36, v37, v38
    v_max3_f32 v14, v14, v39, v44
    v_max3_f32 v14, v14, v45, v46
    v_max_f32 v14, v14, v47
    v_log_f32 v96, v11
    s_nop 0
    v_max3_f32 v13, v13, v96, 0
    v_log_f32 v97, v12
    s_nop 0
    v_max3_f32 v14, v14, v97, 0
    v_mov_b32 v96, v13
    v_mov_b32 v97, v14
    s_nop 1
    v_permlane32_swap_b32 v13, v96
    v_permlane32_swap_b32 v14, v97
    v_max_f32 v13, v13, v96
    v_max_f32 v14, v14, v97
    v_mov_b32 v96, v13
    v_mov_b32 v97, v14
    s_nop 1
    v_permlane16_swap_b32 v13, v96
    v_permlane16_swap_b32 v14, v97
    v_max_f32 v13, v13, v96
    v_max_f32 v14, v14, v97
    v_sub_f32 v32, v32, v13
    v_sub_f32 v33, v33, v13
    v_sub_f32 v34, v34, v13
    v_sub_f32 v35, v35, v13
    v_sub_f32 v40, v40, v13
    v_sub_f32 v41, v41, v13
    v_sub_f32 v42, v42, v13
    v_sub_f32 v43, v43, v13
    v_sub_f32 v36, v36, v14
    v_sub_f32 v37, v37, v14
    v_sub_f32 v38, v38, v14
    v_sub_f32 v39, v39, v14
    v_sub_f32 v44, v44, v14
    v_sub_f32 v45, v45, v14
    v_sub_f32 v46, v46, v14
    v_sub_f32 v47, v47, v14
    v_sub_f32 v48, v48, v13
    v_sub_f32 v49, v49, v13
    v_sub_f32 v50, v50, v13
    v_sub_f32 v51, v51, v13
    v_sub_f32 v56, v56, v13
    v_sub_f32 v57, v57, v13
    v_sub_f32 v58, v58, v13
    v_sub_f32 v59, v59, v13
    v_sub_f32 v52, v52, v14
    v_sub_f32 v53, v53, v14
    v_sub_f32 v54, v54, v14
    v_sub_f32 v55, v55, v14
    v_sub_f32 v60, v60, v14
    v_sub_f32 v61, v61, v14
    v_sub_f32 v62, v62, v14
    v_sub_f32 v63, v63, v14
    v_sub_f32 v16, v16, v13
    v_sub_f32 v17, v17, v13
    v_sub_f32 v18, v18, v13
    v_sub_f32 v19, v19, v13
    v_sub_f32 v24, v24, v13
    v_sub_f32 v25, v25, v13
    v_sub_f32 v26, v26, v13
    v_sub_f32 v27, v27, v13
    v_sub_f32 v20, v20, v14
    v_sub_f32 v21, v21, v14
    v_sub_f32 v22, v22, v14
    v_sub_f32 v23, v23, v14
    v_sub_f32 v28, v28, v14
    v_sub_f32 v29, v29, v14
    v_sub_f32 v30, v30, v14
    v_sub_f32 v31, v31, v14
    v_sub_f32 v7, v7, v13
    v_sub_f32 v8, v8, v14
    v_exp_f32 v13, -v13
    v_exp_f32 v14, -v14
    s_nop 0
    v_mul_f32 v11, v11, v13
    v_mul_f32 v128, v128, v13
    v_mul_f32 v129, v129, v13
    v_mul_f32 v130, v130, v13
    v_mul_f32 v131, v131, v13
    v_mul_f32 v136, v136, v13
    v_mul_f32 v137, v137, v13
    v_mul_f32 v138, v138, v13
    v_mul_f32 v139, v139, v13
    v_mul_f32 v144, v144, v13
    v_mul_f32 v145, v145, v13
    v_mul_f32 v146, v146, v13
    v_mul_f32 v147, v147, v13
    v_mul_f32 v152, v152, v13
    v_mul_f32 v153, v153, v13
    v_mul_f32 v154, v154, v13
    v_mul_f32 v155, v155, v13
    v_mul_f32 v160, v160, v13
    v_mul_f32 v161, v161, v13
    v_mul_f32 v162, v162, v13
    v_mul_f32 v163, v163, v13
    v_mul_f32 v168, v168, v13
    v_mul_f32 v169, v169, v13
    v_mul_f32 v170, v170, v13
    v_mul_f32 v171, v171, v13
    v_mul_f32 v176, v176, v13
    v_mul_f32 v177, v177, v13
    v_mul_f32 v178, v178, v13
    v_mul_f32 v179, v179, v13
    v_mul_f32 v184, v184, v13
    v_mul_f32 v185, v185, v13
    v_mul_f32 v186, v186, v13
    v_mul_f32 v187, v187, v13
    v_mul_f32 v192, v192, v13
    v_mul_f32 v193, v193, v13
    v_mul_f32 v194, v194, v13
    v_mul_f32 v195, v195, v13
    v_mul_f32 v200, v200, v13
    v_mul_f32 v201, v201, v13
    v_mul_f32 v202, v202, v13
    v_mul_f32 v203, v203, v13
    v_mul_f32 v208, v208, v13
    v_mul_f32 v209, v209, v13
    v_mul_f32 v210, v210, v13
    v_mul_f32 v211, v211, v13
    v_mul_f32 v216, v216, v13
    v_mul_f32 v217, v217, v13
    v_mul_f32 v218, v218, v13
    v_mul_f32 v219, v219, v13
    v_mul_f32 v224, v224, v13
    v_mul_f32 v225, v225, v13
    v_mul_f32 v226, v226, v13
    v_mul_f32 v227, v227, v13
    v_mul_f32 v232, v232, v13
    v_mul_f32 v233, v233, v13
    v_mul_f32 v234, v234, v13
    v_mul_f32 v235, v235, v13
    v_mul_f32 v240, v240, v13
    v_mul_f32 v241, v241, v13
    v_mul_f32 v242, v242, v13
    v_mul_f32 v243, v243, v13
    v_mul_f32 v248, v248, v13
    v_mul_f32 v249, v249, v13
    v_mul_f32 v250, v250, v13
    v_mul_f32 v251, v251, v13
    v_mul_f32 v12, v12, v14
    v_mul_f32 v132, v132, v14
    v_mul_f32 v133, v133, v14
    v_mul_f32 v134, v134, v14
    v_mul_f32 v135, v135, v14
    v_mul_f32 v140, v140, v14
    v_mul_f32 v141, v141, v14
    v_mul_f32 v142, v142, v14
    v_mul_f32 v143, v143, v14
    v_mul_f32 v148, v148, v14
    v_mul_f32 v149, v149, v14
    v_mul_f32 v150, v150, v14
    v_mul_f32 v151, v151, v14
    v_mul_f32 v156, v156, v14
    v_mul_f32 v157, v157, v14
    v_mul_f32 v158, v158, v14
    v_mul_f32 v159, v159, v14
    v_mul_f32 v164, v164, v14
    v_mul_f32 v165, v165, v14
    v_mul_f32 v166, v166, v14
    v_mul_f32 v167, v167, v14
    v_mul_f32 v172, v172, v14
    v_mul_f32 v173, v173, v14
    v_mul_f32 v174, v174, v14
    v_mul_f32 v175, v175, v14
    v_mul_f32 v180, v180, v14
    v_mul_f32 v181, v181, v14
    v_mul_f32 v182, v182, v14
    v_mul_f32 v183, v183, v14
    v_mul_f32 v188, v188, v14
    v_mul_f32 v189, v189, v14
    v_mul_f32 v190, v190, v14
    v_mul_f32 v191, v191, v14
    v_mul_f32 v196, v196, v14
    v_mul_f32 v197, v197, v14
    v_mul_f32 v198, v198, v14
    v_mul_f32 v199, v199, v14
    v_mul_f32 v204, v204, v14
    v_mul_f32 v205, v205, v14
    v_mul_f32 v206, v206, v14
    v_mul_f32 v207, v207, v14
    v_mul_f32 v212, v212, v14
    v_mul_f32 v213, v213, v14
    v_mul_f32 v214, v214, v14
    v_mul_f32 v215, v215, v14
    v_mul_f32 v220, v220, v14
    v_mul_f32 v221, v221, v14
    v_mul_f32 v222, v222, v14
    v_mul_f32 v223, v223, v14
    v_mul_f32 v228, v228, v14
    v_mul_f32 v229, v229, v14
    v_mul_f32 v230, v230, v14
    v_mul_f32 v231, v231, v14
    v_mul_f32 v236, v236, v14
    v_mul_f32 v237, v237, v14
    v_mul_f32 v238, v238, v14
    v_mul_f32 v239, v239, v14
    v_mul_f32 v244, v244, v14
    v_mul_f32 v245, v245, v14
    v_mul_f32 v246, v246, v14
    v_mul_f32 v247, v247, v14
    v_mul_f32 v252, v252, v14
    v_mul_f32 v253, v253, v14
    v_mul_f32 v254, v254, v14
    v_mul_f32 v255, v255, v14
    v_exp_f32 v64, v32
    v_exp_f32 v65, v33
    v_add_f32 v9, v11, v64
    v_exp_f32 v66, v34
    v_add_f32 v9, v9, v65
    v_cvt_pk_bf16_f32 v80, v64, v65
    v_exp_f32 v67, v35
    v_add_f32 v9, v9, v66
    v_exp_f32 v72, v40
    v_add_f32 v9, v9, v67
    v_cvt_pk_bf16_f32 v81, v66, v67
    v_exp_f32 v73, v41
    v_add_f32 v9, v9, v72
    v_exp_f32 v74, v42
    v_add_f32 v9, v9, v73
    v_cvt_pk_bf16_f32 v82, v72, v73
    v_exp_f32 v75, v43
    v_add_f32 v9, v9, v74
    v_exp_f32 v68, v36
    v_add_f32 v9, v9, v75
    v_cvt_pk_bf16_f32 v83, v74, v75
    v_exp_f32 v69, v37
    v_add_f32 v10, v12, v68
    v_exp_f32 v70, v38
    v_add_f32 v10, v10, v69
    v_cvt_pk_bf16_f32 v84, v68, v69
    v_exp_f32 v71, v39
    v_add_f32 v10, v10, v70
    v_exp_f32 v76, v44
    v_add_f32 v10, v10, v71
    v_cvt_pk_bf16_f32 v85, v70, v71
    v_exp_f32 v77, v45
    v_add_f32 v10, v10, v76
    v_exp_f32 v78, v46
    v_add_f32 v10, v10, v77
    v_cvt_pk_bf16_f32 v86, v76, v77
    v_exp_f32 v79, v47
    v_add_f32 v10, v10, v78
    v_add_f32 v13, v9, v10
    v_add_f32 v10, v10, v79
    v_cvt_pk_bf16_f32 v87, v78, v79
    s_nop 1
    s_branch L2_rare5_ret
L2_rare6:
    s_nop 7
    s_nop 3
    v_max3_f32 v13, v48, v49, v50
    v_max3_f32 v13, v13, v51, v56
    v_max3_f32 v13, v13, v57, v58
    v_max_f32 v13, v13, v59
    v_max3_f32 v14, v52, v53, v54
    v_max3_f32 v14, v14, v55, v60
    v_max3_f32 v14, v14, v61, v62
    v_max_f32 v14, v14, v63
    v_log_f32 v96, v9
    s_nop 0
    v_max3_f32 v13, v13, v96, 0
    v_log_f32 v97, v10
    s_nop 0
    v_max3_f32 v14, v14, v97, 0
    v_mov_b32 v96, v13
    v_mov_b32 v97, v14
    s_nop 1
    v_permlane32_swap_b32 v13, v96
    v_permlane32_swap_b32 v14, v97
    v_max_f32 v13, v13, v96
    v_max_f32 v14, v14, v97
    v_mov_b32 v96, v13
    v_mov_b32 v97, v14
    s_nop 1
    v_permlane16_swap_b32 v13, v96
    v_permlane16_swap_b32 v14, v97
    v_max_f32 v13, v13, v96
    v_max_f32 v14, v14, v97
    v_sub_f32 v48, v48, v13
    v_sub_f32 v49, v49, v13
    v_sub_f32 v50, v50, v13
    v_sub_f32 v51, v51, v13
    v_sub_f32 v56, v56, v13
    v_sub_f32 v57, v57, v13
    v_sub_f32 v58, v58, v13
    v_sub_f32 v59, v59, v13
    v_sub_f32 v52, v52, v14
    v_sub_f32 v53, v53, v14
    v_sub_f32 v54, v54, v14
    v_sub_f32 v55, v55, v14
    v_sub_f32 v60, v60, v14
    v_sub_f32 v61, v61, v14
    v_sub_f32 v62, v62, v14
    v_sub_f32 v63, v63, v14
    v_sub_f32 v32, v32, v13
    v_sub_f32 v33, v33, v13
    v_sub_f32 v34, v34, v13
    v_sub_f32 v35, v35, v13
    v_sub_f32 v40, v40, v13
    v_sub_f32 v41, v41, v13
    v_sub_f32 v42, v42, v13
    v_sub_f32 v43, v43, v13
    v_sub_f32 v36, v36, v14
    v_sub_f32 v37, v37, v14
    v_sub_f32 v38, v38, v14
    v_sub_f32 v39, v39, v14
    v_sub_f32 v44, v44, v14
    v_sub_f32 v45, v45, v14
    v_sub_f32 v46, v46, v14
    v_sub_f32 v47, v47, v14
    v_sub_f32 v16, v16, v13
    v_sub_f32 v17, v17, v13
    v_sub_f32 v18, v18, v13
    v_sub_f32 v19, v19, v13
    v_sub_f32 v24, v24, v13
    v_sub_f32 v25, v25, v13
    v_sub_f32 v26, v26, v13
    v_sub_f32 v27, v27, v13
    v_sub_f32 v20, v20, v14
    v_sub_f32 v21, v21, v14
    v_sub_f32 v22, v22, v14
    v_sub_f32 v23, v23, v14
    v_sub_f32 v28, v28, v14
    v_sub_f32 v29, v29, v14
    v_sub_f32 v30, v30, v14
    v_sub_f32 v31, v31, v14
    v_sub_f32 v7, v7, v13
    v_sub_f32 v8, v8, v14
    v_exp_f32 v13, -v13
    v_exp_f32 v14, -v14
    s_nop 0
    v_mul_f32 v9, v9, v13
    v_mul_f32 v128, v128, v13
    v_mul_f32 v129, v129, v13
    v_mul_f32 v130, v130, v13
    v_mul_f32 v131, v131, v13
    v_mul_f32 v136, v136, v13
    v_mul_f32 v137, v137, v13
    v_mul_f32 v138, v138, v13
    v_mul_f32 v139, v139, v13
    v_mul_f32 v144, v144, v13
    v_mul_f32 v145, v145, v13
    v_mul_f32 v146, v146, v13
    v_mul_f32 v147, v147, v13
    v_mul_f32 v152, v152, v13
    v_mul_f32 v153, v153, v13
    v_mul_f32 v154, v154, v13
    v_mul_f32 v155, v155, v13
    v_mul_f32 v160, v160, v13
    v_mul_f32 v161, v161, v13
    v_mul_f32 v162, v162, v13
    v_mul_f32 v163, v163, v13
    v_mul_f32 v168, v168, v13
    v_mul_f32 v169, v169, v13
    v_mul_f32 v170, v170, v13
    v_mul_f32 v171, v171, v13
    v_mul_f32 v176, v176, v13
    v_mul_f32 v177, v177, v13
    v_mul_f32 v178, v178, v13
    v_mul_f32 v179, v179, v13
    v_mul_f32 v184, v184, v13
    v_mul_f32 v185, v185, v13
    v_mul_f32 v186, v186, v13
    v_mul_f32 v187, v187, v13
    v_mul_f32 v192, v192, v13
    v_mul_f32 v193, v193, v13
    v_mul_f32 v194, v194, v13
    v_mul_f32 v195, v195, v13
    v_mul_f32 v200, v200, v13
    v_mul_f32 v201, v201, v13
    v_mul_f32 v202, v202, v13
    v_mul_f32 v203, v203, v13
    v_mul_f32 v208, v208, v13
    v_mul_f32 v209, v209, v13
    v_mul_f32 v210, v210, v13
    v_mul_f32 v211, v211, v13
    v_mul_f32 v216, v216, v13
    v_mul_f32 v217, v217, v13
    v_mul_f32 v218, v218, v13
    v_mul_f32 v219, v219, v13
    v_mul_f32 v224, v224, v13
    v_mul_f32 v225, v225, v13
    v_mul_f32 v226, v226, v13
    v_mul_f32 v227, v227, v13
    v_mul_f32 v232, v232, v13
    v_mul_f32 v233, v233, v13
    v_mul_f32 v234, v234, v13
    v_mul_f32 v235, v235, v13
    v_mul_f32 v240, v240, v13
    v_mul_f32 v241, v241, v13
    v_mul_f32 v242, v242, v13
    v_mul_f32 v243, v243, v13
    v_mul_f32 v248, v248, v13
    v_mul_f32 v249, v249, v13
    v_mul_f32 v250, v250, v13
    v_mul_f32 v251, v251, v13
    v_mul_f32 v10, v10, v14
    v_mul_f32 v132, v132, v14
    v_mul_f32 v133, v133, v14
    v_mul_f32 v134, v134, v14
    v_mul_f32 v135, v135, v14
    v_mul_f32 v140, v140, v14
    v_mul_f32 v141, v141, v14
    v_mul_f32 v142, v142, v14
    v_mul_f32 v143, v143, v14
    v_mul_f32 v148, v148, v14
    v_mul_f32 v149, v149, v14
    v_mul_f32 v150, v150, v14
    v_mul_f32 v151, v151, v14
    v_mul_f32 v156, v156, v14
    v_mul_f32 v157, v157, v14
    v_mul_f32 v158, v158, v14
    v_mul_f32 v159, v159, v14
    v_mul_f32 v164, v164, v14
    v_mul_f32 v165, v165, v14
    v_mul_f32 v166, v166, v14
    v_mul_f32 v167, v167, v14
    v_mul_f32 v172, v172, v14
    v_mul_f32 v173, v173, v14
    v_mul_f32 v174, v174, v14
    v_mul_f32 v175, v175, v14
    v_mul_f32 v180, v180, v14
    v_mul_f32 v181, v181, v14
    v_mul_f32 v182, v182, v14
    v_mul_f32 v183, v183, v14
    v_mul_f32 v188, v188, v14
    v_mul_f32 v189, v189, v14
    v_mul_f32 v190, v190, v14
    v_mul_f32 v191, v191, v14
    v_mul_f32 v196, v196, v14
    v_mul_f32 v197, v197, v14
    v_mul_f32 v198, v198, v14
    v_mul_f32 v199, v199, v14
    v_mul_f32 v204, v204, v14
    v_mul_f32 v205, v205, v14
    v_mul_f32 v206, v206, v14
    v_mul_f32 v207, v207, v14
    v_mul_f32 v212, v212, v14
    v_mul_f32 v213, v213, v14
    v_mul_f32 v214, v214, v14
    v_mul_f32 v215, v215, v14
    v_mul_f32 v220, v220, v14
    v_mul_f32 v221, v221, v14
    v_mul_f32 v222, v222, v14
    v_mul_f32 v223, v223, v14
    v_mul_f32 v228, v228, v14
    v_mul_f32 v229, v229, v14
    v_mul_f32 v230, v230, v14
    v_mul_f32 v231, v231, v14
    v_mul_f32 v236, v236, v14
    v_mul_f32 v237, v237, v14
    v_mul_f32 v238, v238, v14
    v_mul_f32 v239, v239, v14
    v_mul_f32 v244, v244, v14
    v_mul_f32 v245, v245, v14
    v_mul_f32 v246, v246, v14
    v_mul_f32 v247, v247, v14
    v_mul_f32 v252, v252, v14
    v_mul_f32 v253, v253, v14
    v_mul_f32 v254, v254, v14
    v_mul_f32 v255, v255, v14
    v_exp_f32 v64, v48
    v_exp_f32 v65, v49
    v_add_f32 v11, v9, v64
    v_exp_f32 v66, v50
    v_add_f32 v11, v11, v65
    v_cvt_pk_bf16_f32 v88, v64, v65
    v_exp_f32 v67, v51
    v_add_f32 v11, v11, v66
    v_exp_f32 v72, v56
    v_add_f32 v11, v11, v67
    v_cvt_pk_bf16_f32 v89, v66, v67
    v_exp_f32 v73, v57
    v_add_f32 v11, v11, v72
    v_exp_f32 v74, v58
    v_add_f32 v11, v11, v73
    v_cvt_pk_bf16_f32 v90, v72, v73
    v_exp_f32 v75, v59
    v_add_f32 v11, v11, v74
    v_exp_f32 v68, v52
    v_add_f32 v11, v11, v75
    v_cvt_pk_bf16_f32 v91, v74, v75
    v_exp_f32 v69, v53
    v_add_f32 v12, v10, v68
    v_exp_f32 v70, v54
    v_add_f32 v12, v12, v69
    v_cvt_pk_bf16_f32 v92, v68, v69
    v_exp_f32 v71, v55
    v_add_f32 v12, v12, v70
    v_exp_f32 v76, v60
    v_add_f32 v12, v12, v71
    v_cvt_pk_bf16_f32 v93, v70, v71
    v_exp_f32 v77, v61
    v_add_f32 v12, v12, v76
    v_exp_f32 v78, v62
    v_add_f32 v12, v12, v77
    v_cvt_pk_bf16_f32 v94, v76, v77
    v_exp_f32 v79, v63
    v_add_f32 v12, v12, v78
    v_add_f32 v13, v11, v12
    v_add_f32 v12, v12, v79
    v_cvt_pk_bf16_f32 v95, v78, v79
    s_nop 1
    s_branch L2_rare6_ret
L2_rare7:
    s_nop 7
    s_nop 3
    v_max3_f32 v13, v32, v33, v34
    v_max3_f32 v13, v13, v35, v40
    v_max3_f32 v13, v13, v41, v42
    v_max_f32 v13, v13, v43
    v_max3_f32 v14, v36, v37, v38
    v_max3_f32 v14, v14, v39, v44
    v_max3_f32 v14, v14, v45, v46
    v_max_f32 v14, v14, v47
    v_log_f32 v96, v11
    s_nop 0
    v_max3_f32 v13, v13, v96, 0
    v_log_f32 v97, v12
    s_nop 0
    v_max3_f32 v14, v14, v97, 0
    v_mov_b32 v96, v13
    v_mov_b32 v97, v14
    s_nop 1
    v_permlane32_swap_b32 v13, v96
    v_permlane32_swap_b32 v14, v97
    v_max_f32 v13, v13, v96
    v_max_f32 v14, v14, v97
    v_mov_b32 v96, v13
    v_mov_b32 v97, v14
    s_nop 1
    v_permlane16_swap_b32 v13, v96
    v_permlane16_swap_b32 v14, v97
    v_max_f32 v13, v13, v96
    v_max_f32 v14, v14, v97
    v_sub_f32 v32, v32, v13
    v_sub_f32 v33, v33, v13
    v_sub_f32 v34, v34, v13
    v_sub_f32 v35, v35, v13
    v_sub_f32 v40, v40, v13
    v_sub_f32 v41, v41, v13
    v_sub_f32 v42, v42, v13
    v_sub_f32 v43, v43, v13
    v_sub_f32 v36, v36, v14
    v_sub_f32 v37, v37, v14
    v_sub_f32 v38, v38, v14
    v_sub_f32 v39, v39, v14
    v_sub_f32 v44, v44, v14
    v_sub_f32 v45, v45, v14
    v_sub_f32 v46, v46, v14
    v_sub_f32 v47, v47, v14
    v_sub_f32 v48, v48, v13
    v_sub_f32 v49, v49, v13
    v_sub_f32 v50, v50, v13
    v_sub_f32 v51, v51, v13
    v_sub_f32 v56, v56, v13
    v_sub_f32 v57, v57, v13
    v_sub_f32 v58, v58, v13
    v_sub_f32 v59, v59, v13
    v_sub_f32 v52, v52, v14
    v_sub_f32 v53, v53, v14
    v_sub_f32 v54, v54, v14
    v_sub_f32 v55, v55, v14
    v_sub_f32 v60, v60, v14
    v_sub_f32 v61, v61, v14
    v_sub_f32 v62, v62, v14
    v_sub_f32 v63, v63, v14
    v_sub_f32 v16, v16, v13
    v_sub_f32 v17, v17, v13
    v_sub_f32 v18, v18, v13
    v_sub_f32 v19, v19, v13
    v_sub_f32 v24, v24, v13
    v_sub_f32 v25, v25, v13
    v_sub_f32 v26, v26, v13
    v_sub_f32 v27, v27, v13
    v_sub_f32 v20, v20, v14
    v_sub_f32 v21, v21, v14
    v_sub_f32 v22, v22, v14
    v_sub_f32 v23, v23, v14
    v_sub_f32 v28, v28, v14
    v_sub_f32 v29, v29, v14
    v_sub_f32 v30, v30, v14
    v_sub_f32 v31, v31, v14
    v_sub_f32 v7, v7, v13
    v_sub_f32 v8, v8, v14
    v_exp_f32 v13, -v13
    v_exp_f32 v14, -v14
    s_nop 0
    v_mul_f32 v11, v11, v13
    v_mul_f32 v128, v128, v13
    v_mul_f32 v129, v129, v13
    v_mul_f32 v130, v130, v13
    v_mul_f32 v131, v131, v13
    v_mul_f32 v136, v136, v13
    v_mul_f32 v137, v137, v13
    v_mul_f32 v138, v138, v13
    v_mul_f32 v139, v139, v13
    v_mul_f32 v144, v144, v13
    v_mul_f32 v145, v145, v13
    v_mul_f32 v146, v146, v13
    v_mul_f32 v147, v147, v13
    v_mul_f32 v152, v152, v13
    v_mul_f32 v153, v153, v13
    v_mul_f32 v154, v154, v13
    v_mul_f32 v155, v155, v13
    v_mul_f32 v160, v160, v13
    v_mul_f32 v161, v161, v13
    v_mul_f32 v162, v162, v13
    v_mul_f32 v163, v163, v13
    v_mul_f32 v168, v168, v13
    v_mul_f32 v169, v169, v13
    v_mul_f32 v170, v170, v13
    v_mul_f32 v171, v171, v13
    v_mul_f32 v176, v176, v13
    v_mul_f32 v177, v177, v13
    v_mul_f32 v178, v178, v13
    v_mul_f32 v179, v179, v13
    v_mul_f32 v184, v184, v13
    v_mul_f32 v185, v185, v13
    v_mul_f32 v186, v186, v13
    v_mul_f32 v187, v187, v13
    v_mul_f32 v192, v192, v13
    v_mul_f32 v193, v193, v13
    v_mul_f32 v194, v194, v13
    v_mul_f32 v195, v195, v13
    v_mul_f32 v200, v200, v13
    v_mul_f32 v201, v201, v13
    v_mul_f32 v202, v202, v13
    v_mul_f32 v203, v203, v13
    v_mul_f32 v208, v208, v13
    v_mul_f32 v209, v209, v13
    v_mul_f32 v210, v210, v13
    v_mul_f32 v211, v211, v13
    v_mul_f32 v216, v216, v13
    v_mul_f32 v217, v217, v13
    v_mul_f32 v218, v218, v13
    v_mul_f32 v219, v219, v13
    v_mul_f32 v224, v224, v13
    v_mul_f32 v225, v225, v13
    v_mul_f32 v226, v226, v13
    v_mul_f32 v227, v227, v13
    v_mul_f32 v232, v232, v13
    v_mul_f32 v233, v233, v13
    v_mul_f32 v234, v234, v13
    v_mul_f32 v235, v235, v13
    v_mul_f32 v240, v240, v13
    v_mul_f32 v241, v241, v13
    v_mul_f32 v242, v242, v13
    v_mul_f32 v243, v243, v13
    v_mul_f32 v248, v248, v13
    v_mul_f32 v249, v249, v13
    v_mul_f32 v250, v250, v13
    v_mul_f32 v251, v251, v13
    v_mul_f32 v12, v12, v14
    v_mul_f32 v132, v132, v14
    v_mul_f32 v133, v133, v14
    v_mul_f32 v134, v134, v14
    v_mul_f32 v135, v135, v14
    v_mul_f32 v140, v140, v14
    v_mul_f32 v141, v141, v14
    v_mul_f32 v142, v142, v14
    v_mul_f32 v143, v143, v14
    v_mul_f32 v148, v148, v14
    v_mul_f32 v149, v149, v14
    v_mul_f32 v150, v150, v14
    v_mul_f32 v151, v151, v14
    v_mul_f32 v156, v156, v14
    v_mul_f32 v157, v157, v14
    v_mul_f32 v158, v158, v14
    v_mul_f32 v159, v159, v14
    v_mul_f32 v164, v164, v14
    v_mul_f32 v165, v165, v14
    v_mul_f32 v166, v166, v14
    v_mul_f32 v167, v167, v14
    v_mul_f32 v172, v172, v14
    v_mul_f32 v173, v173, v14
    v_mul_f32 v174, v174, v14
    v_mul_f32 v175, v175, v14
    v_mul_f32 v180, v180, v14
    v_mul_f32 v181, v181, v14
    v_mul_f32 v182, v182, v14
    v_mul_f32 v183, v183, v14
    v_mul_f32 v188, v188, v14
    v_mul_f32 v189, v189, v14
    v_mul_f32 v190, v190, v14
    v_mul_f32 v191, v191, v14
    v_mul_f32 v196, v196, v14
    v_mul_f32 v197, v197, v14
    v_mul_f32 v198, v198, v14
    v_mul_f32 v199, v199, v14
    v_mul_f32 v204, v204, v14
    v_mul_f32 v205, v205, v14
    v_mul_f32 v206, v206, v14
    v_mul_f32 v207, v207, v14
    v_mul_f32 v212, v212, v14
    v_mul_f32 v213, v213, v14
    v_mul_f32 v214, v214, v14
    v_mul_f32 v215, v215, v14
    v_mul_f32 v220, v220, v14
    v_mul_f32 v221, v221, v14
    v_mul_f32 v222, v222, v14
    v_mul_f32 v223, v223, v14
    v_mul_f32 v228, v228, v14
    v_mul_f32 v229, v229, v14
    v_mul_f32 v230, v230, v14
    v_mul_f32 v231, v231, v14
    v_mul_f32 v236, v236, v14
    v_mul_f32 v237, v237, v14
    v_mul_f32 v238, v238, v14
    v_mul_f32 v239, v239, v14
    v_mul_f32 v244, v244, v14
    v_mul_f32 v245, v245, v14
    v_mul_f32 v246, v246, v14
    v_mul_f32 v247, v247, v14
    v_mul_f32 v252, v252, v14
    v_mul_f32 v253, v253, v14
    v_mul_f32 v254, v254, v14
    v_mul_f32 v255, v255, v14
    v_exp_f32 v64, v32
    v_exp_f32 v65, v33
    v_add_f32 v9, v11, v64
    v_exp_f32 v66, v34
    v_add_f32 v9, v9, v65
    v_cvt_pk_bf16_f32 v80, v64, v65
    v_exp_f32 v67, v35
    v_add_f32 v9, v9, v66
    v_exp_f32 v72, v40
    v_add_f32 v9, v9, v67
    v_cvt_pk_bf16_f32 v81, v66, v67
    v_exp_f32 v73, v41
    v_add_f32 v9, v9, v72
    v_exp_f32 v74, v42
    v_add_f32 v9, v9, v73
    v_cvt_pk_bf16_f32 v82, v72, v73
    v_exp_f32 v75, v43
    v_add_f32 v9, v9, v74
    v_exp_f32 v68, v36
    v_add_f32 v9, v9, v75
    v_cvt_pk_bf16_f32 v83, v74, v75
    v_exp_f32 v69, v37
    v_add_f32 v10, v12, v68
    v_exp_f32 v70, v38
    v_add_f32 v10, v10, v69
    v_cvt_pk_bf16_f32 v84, v68, v69
    v_exp_f32 v71, v39
    v_add_f32 v10, v10, v70
    v_exp_f32 v76, v44
    v_add_f32 v10, v10, v71
    v_cvt_pk_bf16_f32 v85, v70, v71
    v_exp_f32 v77, v45
    v_add_f32 v10, v10, v76
    v_exp_f32 v78, v46
    v_add_f32 v10, v10, v77
    v_cvt_pk_bf16_f32 v86, v76, v77
    v_exp_f32 v79, v47
    v_add_f32 v10, v10, v78
    v_add_f32 v13, v9, v10
    v_add_f32 v10, v10, v79
    v_cvt_pk_bf16_f32 v87, v78, v79
    s_nop 1
    s_branch L2_rare7_ret
L2_rare9:
    s_nop 7
    s_nop 3
    v_max3_f32 v13, v48, v49, v50
    v_max3_f32 v13, v13, v51, v56
    v_max3_f32 v13, v13, v57, v58
    v_max_f32 v13, v13, v59
    v_max3_f32 v14, v52, v53, v54
    v_max3_f32 v14, v14, v55, v60
    v_max3_f32 v14, v14, v61, v62
    v_max_f32 v14, v14, v63
    v_log_f32 v96, v9
    s_nop 0
    v_max3_f32 v13, v13, v96, 0
    v_log_f32 v97, v10
    s_nop 0
    v_max3_f32 v14, v14, v97, 0
    v_mov_b32 v96, v13
    v_mov_b32 v97, v14
    s_nop 1
    v_permlane32_swap_b32 v13, v96
    v_permlane32_swap_b32 v14, v97
    v_max_f32 v13, v13, v96
    v_max_f32 v14, v14, v97
    v_mov_b32 v96, v13
    v_mov_b32 v97, v14
    s_nop 1
    v_permlane16_swap_b32 v13, v96
    v_permlane16_swap_b32 v14, v97
    v_max_f32 v13, v13, v96
    v_max_f32 v14, v14, v97
    v_sub_f32 v48, v48, v13
    v_sub_f32 v49, v49, v13
    v_sub_f32 v50, v50, v13
    v_sub_f32 v51, v51, v13
    v_sub_f32 v56, v56, v13
    v_sub_f32 v57, v57, v13
    v_sub_f32 v58, v58, v13
    v_sub_f32 v59, v59, v13
    v_sub_f32 v52, v52, v14
    v_sub_f32 v53, v53, v14
    v_sub_f32 v54, v54, v14
    v_sub_f32 v55, v55, v14
    v_sub_f32 v60, v60, v14
    v_sub_f32 v61, v61, v14
    v_sub_f32 v62, v62, v14
    v_sub_f32 v63, v63, v14
    v_sub_f32 v16, v16, v13
    v_sub_f32 v17, v17, v13
    v_sub_f32 v18, v18, v13
    v_sub_f32 v19, v19, v13
    v_sub_f32 v24, v24, v13
    v_sub_f32 v25, v25, v13
    v_sub_f32 v26, v26, v13
    v_sub_f32 v27, v27, v13
    v_sub_f32 v20, v20, v14
    v_sub_f32 v21, v21, v14
    v_sub_f32 v22, v22, v14
    v_sub_f32 v23, v23, v14
    v_sub_f32 v28, v28, v14
    v_sub_f32 v29, v29, v14
    v_sub_f32 v30, v30, v14
    v_sub_f32 v31, v31, v14
    v_sub_f32 v7, v7, v13
    v_sub_f32 v8, v8, v14
    v_exp_f32 v13, -v13
    v_exp_f32 v14, -v14
    s_nop 0
    v_mul_f32 v9, v9, v13
    v_mul_f32 v128, v128, v13
    v_mul_f32 v129, v129, v13
    v_mul_f32 v130, v130, v13
    v_mul_f32 v131, v131, v13
    v_mul_f32 v136, v136, v13
    v_mul_f32 v137, v137, v13
    v_mul_f32 v138, v138, v13
    v_mul_f32 v139, v139, v13
    v_mul_f32 v144, v144, v13
    v_mul_f32 v145, v145, v13
    v_mul_f32 v146, v146, v13
    v_mul_f32 v147, v147, v13
    v_mul_f32 v152, v152, v13
    v_mul_f32 v153, v153, v13
    v_mul_f32 v154, v154, v13
    v_mul_f32 v155, v155, v13
    v_mul_f32 v160, v160, v13
    v_mul_f32 v161, v161, v13
    v_mul_f32 v162, v162, v13
    v_mul_f32 v163, v163, v13
    v_mul_f32 v168, v168, v13
    v_mul_f32 v169, v169, v13
    v_mul_f32 v170, v170, v13
    v_mul_f32 v171, v171, v13
    v_mul_f32 v176, v176, v13
    v_mul_f32 v177, v177, v13
    v_mul_f32 v178, v178, v13
    v_mul_f32 v179, v179, v13
    v_mul_f32 v184, v184, v13
    v_mul_f32 v185, v185, v13
    v_mul_f32 v186, v186, v13
    v_mul_f32 v187, v187, v13
    v_mul_f32 v192, v192, v13
    v_mul_f32 v193, v193, v13
    v_mul_f32 v194, v194, v13
    v_mul_f32 v195, v195, v13
    v_mul_f32 v200, v200, v13
    v_mul_f32 v201, v201, v13
    v_mul_f32 v202, v202, v13
    v_mul_f32 v203, v203, v13
    v_mul_f32 v208, v208, v13
    v_mul_f32 v209, v209, v13
    v_mul_f32 v210, v210, v13
    v_mul_f32 v211, v211, v13
    v_mul_f32 v216, v216, v13
    v_mul_f32 v217, v217, v13
    v_mul_f32 v218, v218, v13
    v_mul_f32 v219, v219, v13
    v_mul_f32 v224, v224, v13
    v_mul_f32 v225, v225, v13
    v_mul_f32 v226, v226, v13
    v_mul_f32 v227, v227, v13
    v_mul_f32 v232, v232, v13
    v_mul_f32 v233, v233, v13
    v_mul_f32 v234, v234, v13
    v_mul_f32 v235, v235, v13
    v_mul_f32 v240, v240, v13
    v_mul_f32 v241, v241, v13
    v_mul_f32 v242, v242, v13
    v_mul_f32 v243, v243, v13
    v_mul_f32 v248, v248, v13
    v_mul_f32 v249, v249, v13
    v_mul_f32 v250, v250, v13
    v_mul_f32 v251, v251, v13
    v_mul_f32 v10, v10, v14
    v_mul_f32 v132, v132, v14
    v_mul_f32 v133, v133, v14
    v_mul_f32 v134, v134, v14
    v_mul_f32 v135, v135, v14
    v_mul_f32 v140, v140, v14
    v_mul_f32 v141, v141, v14
    v_mul_f32 v142, v142, v14
    v_mul_f32 v143, v143, v14
    v_mul_f32 v148, v148, v14
    v_mul_f32 v149, v149, v14
    v_mul_f32 v150, v150, v14
    v_mul_f32 v151, v151, v14
    v_mul_f32 v156, v156, v14
    v_mul_f32 v157, v157, v14
    v_mul_f32 v158, v158, v14
    v_mul_f32 v159, v159, v14
    v_mul_f32 v164, v164, v14
    v_mul_f32 v165, v165, v14
    v_mul_f32 v166, v166, v14
    v_mul_f32 v167, v167, v14
    v_mul_f32 v172, v172, v14
    v_mul_f32 v173, v173, v14
    v_mul_f32 v174, v174, v14
    v_mul_f32 v175, v175, v14
    v_mul_f32 v180, v180, v14
    v_mul_f32 v181, v181, v14
    v_mul_f32 v182, v182, v14
    v_mul_f32 v183, v183, v14
    v_mul_f32 v188, v188, v14
    v_mul_f32 v189, v189, v14
    v_mul_f32 v190, v190, v14
    v_mul_f32 v191, v191, v14
    v_mul_f32 v196, v196, v14
    v_mul_f32 v197, v197, v14
    v_mul_f32 v198, v198, v14
    v_mul_f32 v199, v199, v14
    v_mul_f32 v204, v204, v14
    v_mul_f32 v205, v205, v14
    v_mul_f32 v206, v206, v14
    v_mul_f32 v207, v207, v14
    v_mul_f32 v212, v212, v14
    v_mul_f32 v213, v213, v14
    v_mul_f32 v214, v214, v14
    v_mul_f32 v215, v215, v14
    v_mul_f32 v220, v220, v14
    v_mul_f32 v221, v221, v14
    v_mul_f32 v222, v222, v14
    v_mul_f32 v223, v223, v14
    v_mul_f32 v228, v228, v14
    v_mul_f32 v229, v229, v14
    v_mul_f32 v230, v230, v14
    v_mul_f32 v231, v231, v14
    v_mul_f32 v236, v236, v14
    v_mul_f32 v237, v237, v14
    v_mul_f32 v238, v238, v14
    v_mul_f32 v239, v239, v14
    v_mul_f32 v244, v244, v14
    v_mul_f32 v245, v245, v14
    v_mul_f32 v246, v246, v14
    v_mul_f32 v247, v247, v14
    v_mul_f32 v252, v252, v14
    v_mul_f32 v253, v253, v14
    v_mul_f32 v254, v254, v14
    v_mul_f32 v255, v255, v14
    v_exp_f32 v64, v48
    v_exp_f32 v65, v49
    v_add_f32 v11, v9, v64
    v_exp_f32 v66, v50
    v_add_f32 v11, v11, v65
    v_cvt_pk_bf16_f32 v88, v64, v65
    v_exp_f32 v67, v51
    v_add_f32 v11, v11, v66
    v_exp_f32 v72, v56
    v_add_f32 v11, v11, v67
    v_cvt_pk_bf16_f32 v89, v66, v67
    v_exp_f32 v73, v57
    v_add_f32 v11, v11, v72
    v_exp_f32 v74, v58
    v_add_f32 v11, v11, v73
    v_cvt_pk_bf16_f32 v90, v72, v73
    v_exp_f32 v75, v59
    v_add_f32 v11, v11, v74
    v_exp_f32 v68, v52
    v_add_f32 v11, v11, v75
    v_cvt_pk_bf16_f32 v91, v74, v75
    v_exp_f32 v69, v53
    v_add_f32 v12, v10, v68
    v_exp_f32 v70, v54
    v_add_f32 v12, v12, v69
    v_cvt_pk_bf16_f32 v92, v68, v69
    v_exp_f32 v71, v55
    v_add_f32 v12, v12, v70
    v_exp_f32 v76, v60
    v_add_f32 v12, v12, v71
    v_cvt_pk_bf16_f32 v93, v70, v71
    v_exp_f32 v77, v61
    v_add_f32 v12, v12, v76
    v_exp_f32 v78, v62
    v_add_f32 v12, v12, v77
    v_cvt_pk_bf16_f32 v94, v76, v77
    v_exp_f32 v79, v63
    v_add_f32 v12, v12, v78
    v_add_f32 v13, v11, v12
    v_add_f32 v12, v12, v79
    v_cvt_pk_bf16_f32 v95, v78, v79
    s_nop 1
    s_branch L2_rare9_ret
L2_rare10:
    s_nop 7
    s_nop 3
    v_max3_f32 v13, v48, v49, v50
    v_max3_f32 v13, v13, v51, v56
    v_max3_f32 v13, v13, v57, v58
    v_max_f32 v13, v13, v59
    v_max3_f32 v14, v52, v53, v54
    v_max3_f32 v14, v14, v55, v60
    v_max3_f32 v14, v14, v61, v62
    v_max_f32 v14, v14, v63
    v_log_f32 v96, v9
    s_nop 0
    v_max3_f32 v13, v13, v96, 0
    v_log_f32 v97, v10
    s_nop 0
    v_max3_f32 v14, v14, v97, 0
    v_mov_b32 v96, v13
    v_mov_b32 v97, v14
    s_nop 1
    v_permlane32_swap_b32 v13, v96
    v_permlane32_swap_b32 v14, v97
    v_max_f32 v13, v13, v96
    v_max_f32 v14, v14, v97
    v_mov_b32 v96, v13
    v_mov_b32 v97, v14
    s_nop 1
    v_permlane16_swap_b32 v13, v96
    v_permlane16_swap_b32 v14, v97
    v_max_f32 v13, v13, v96
    v_max_f32 v14, v14, v97
    v_sub_f32 v48, v48, v13
    v_sub_f32 v49, v49, v13
    v_sub_f32 v50, v50, v13
    v_sub_f32 v51, v51, v13
    v_sub_f32 v56, v56, v13
    v_sub_f32 v57, v57, v13
    v_sub_f32 v58, v58, v13
    v_sub_f32 v59, v59, v13
    v_sub_f32 v52, v52, v14
    v_sub_f32 v53, v53, v14
    v_sub_f32 v54, v54, v14
    v_sub_f32 v55, v55, v14
    v_sub_f32 v60, v60, v14
    v_sub_f32 v61, v61, v14
    v_sub_f32 v62, v62, v14
    v_sub_f32 v63, v63, v14
    v_sub_f32 v16, v16, v13
    v_sub_f32 v17, v17, v13
    v_sub_f32 v18, v18, v13
    v_sub_f32 v19, v19, v13
    v_sub_f32 v24, v24, v13
    v_sub_f32 v25, v25, v13
    v_sub_f32 v26, v26, v13
    v_sub_f32 v27, v27, v13
    v_sub_f32 v20, v20, v14
    v_sub_f32 v21, v21, v14
    v_sub_f32 v22, v22, v14
    v_sub_f32 v23, v23, v14
    v_sub_f32 v28, v28, v14
    v_sub_f32 v29, v29, v14
    v_sub_f32 v30, v30, v14
    v_sub_f32 v31, v31, v14
    v_sub_f32 v7, v7, v13
    v_sub_f32 v8, v8, v14
    v_exp_f32 v13, -v13
    v_exp_f32 v14, -v14
    s_nop 0
    v_mul_f32 v9, v9, v13
    v_mul_f32 v128, v128, v13
    v_mul_f32 v129, v129, v13
    v_mul_f32 v130, v130, v13
    v_mul_f32 v131, v131, v13
    v_mul_f32 v136, v136, v13
    v_mul_f32 v137, v137, v13
    v_mul_f32 v138, v138, v13
    v_mul_f32 v139, v139, v13
    v_mul_f32 v144, v144, v13
    v_mul_f32 v145, v145, v13
    v_mul_f32 v146, v146, v13
    v_mul_f32 v147, v147, v13
    v_mul_f32 v152, v152, v13
    v_mul_f32 v153, v153, v13
    v_mul_f32 v154, v154, v13
    v_mul_f32 v155, v155, v13
    v_mul_f32 v160, v160, v13
    v_mul_f32 v161, v161, v13
    v_mul_f32 v162, v162, v13
    v_mul_f32 v163, v163, v13
    v_mul_f32 v168, v168, v13
    v_mul_f32 v169, v169, v13
    v_mul_f32 v170, v170, v13
    v_mul_f32 v171, v171, v13
    v_mul_f32 v176, v176, v13
    v_mul_f32 v177, v177, v13
    v_mul_f32 v178, v178, v13
    v_mul_f32 v179, v179, v13
    v_mul_f32 v184, v184, v13
    v_mul_f32 v185, v185, v13
    v_mul_f32 v186, v186, v13
    v_mul_f32 v187, v187, v13
    v_mul_f32 v192, v192, v13
    v_mul_f32 v193, v193, v13
    v_mul_f32 v194, v194, v13
    v_mul_f32 v195, v195, v13
    v_mul_f32 v200, v200, v13
    v_mul_f32 v201, v201, v13
    v_mul_f32 v202, v202, v13
    v_mul_f32 v203, v203, v13
    v_mul_f32 v208, v208, v13
    v_mul_f32 v209, v209, v13
    v_mul_f32 v210, v210, v13
    v_mul_f32 v211, v211, v13
    v_mul_f32 v216, v216, v13
    v_mul_f32 v217, v217, v13
    v_mul_f32 v218, v218, v13
    v_mul_f32 v219, v219, v13
    v_mul_f32 v224, v224, v13
    v_mul_f32 v225, v225, v13
    v_mul_f32 v226, v226, v13
    v_mul_f32 v227, v227, v13
    v_mul_f32 v232, v232, v13
    v_mul_f32 v233, v233, v13
    v_mul_f32 v234, v234, v13
    v_mul_f32 v235, v235, v13
    v_mul_f32 v240, v240, v13
    v_mul_f32 v241, v241, v13
    v_mul_f32 v242, v242, v13
    v_mul_f32 v243, v243, v13
    v_mul_f32 v248, v248, v13
    v_mul_f32 v249, v249, v13
    v_mul_f32 v250, v250, v13
    v_mul_f32 v251, v251, v13
    v_mul_f32 v10, v10, v14
    v_mul_f32 v132, v132, v14
    v_mul_f32 v133, v133, v14
    v_mul_f32 v134, v134, v14
    v_mul_f32 v135, v135, v14
    v_mul_f32 v140, v140, v14
    v_mul_f32 v141, v141, v14
    v_mul_f32 v142, v142, v14
    v_mul_f32 v143, v143, v14
    v_mul_f32 v148, v148, v14
    v_mul_f32 v149, v149, v14
    v_mul_f32 v150, v150, v14
    v_mul_f32 v151, v151, v14
    v_mul_f32 v156, v156, v14
    v_mul_f32 v157, v157, v14
    v_mul_f32 v158, v158, v14
    v_mul_f32 v159, v159, v14
    v_mul_f32 v164, v164, v14
    v_mul_f32 v165, v165, v14
    v_mul_f32 v166, v166, v14
    v_mul_f32 v167, v167, v14
    v_mul_f32 v172, v172, v14
    v_mul_f32 v173, v173, v14
    v_mul_f32 v174, v174, v14
    v_mul_f32 v175, v175, v14
    v_mul_f32 v180, v180, v14
    v_mul_f32 v181, v181, v14
    v_mul_f32 v182, v182, v14
    v_mul_f32 v183, v183, v14
    v_mul_f32 v188, v188, v14
    v_mul_f32 v189, v189, v14
    v_mul_f32 v190, v190, v14
    v_mul_f32 v191, v191, v14
    v_mul_f32 v196, v196, v14
    v_mul_f32 v197, v197, v14
    v_mul_f32 v198, v198, v14
    v_mul_f32 v199, v199, v14
    v_mul_f32 v204, v204, v14
    v_mul_f32 v205, v205, v14
    v_mul_f32 v206, v206, v14
    v_mul_f32 v207, v207, v14
    v_mul_f32 v212, v212, v14
    v_mul_f32 v213, v213, v14
    v_mul_f32 v214, v214, v14
    v_mul_f32 v215, v215, v14
    v_mul_f32 v220, v220, v14
    v_mul_f32 v221, v221, v14
    v_mul_f32 v222, v222, v14
    v_mul_f32 v223, v223, v14
    v_mul_f32 v228, v228, v14
    v_mul_f32 v229, v229, v14
    v_mul_f32 v230, v230, v14
    v_mul_f32 v231, v231, v14
    v_mul_f32 v236, v236, v14
    v_mul_f32 v237, v237, v14
    v_mul_f32 v238, v238, v14
    v_mul_f32 v239, v239, v14
    v_mul_f32 v244, v244, v14
    v_mul_f32 v245, v245, v14
    v_mul_f32 v246, v246, v14
    v_mul_f32 v247, v247, v14
    v_mul_f32 v252, v252, v14
    v_mul_f32 v253, v253, v14
    v_mul_f32 v254, v254, v14
    v_mul_f32 v255, v255, v14
    v_exp_f32 v64, v48
    v_exp_f32 v65, v49
    v_add_f32 v11, v9, v64
    v_exp_f32 v66, v50
    v_add_f32 v11, v11, v65
    v_cvt_pk_bf16_f32 v88, v64, v65
    v_exp_f32 v67, v51
    v_add_f32 v11, v11, v66
    v_exp_f32 v72, v56
    v_add_f32 v11, v11, v67
    v_cvt_pk_bf16_f32 v89, v66, v67
    v_exp_f32 v73, v57
    v_add_f32 v11, v11, v72
    v_exp_f32 v74, v58
    v_add_f32 v11, v11, v73
    v_cvt_pk_bf16_f32 v90, v72, v73
    v_exp_f32 v75, v59
    v_add_f32 v11, v11, v74
    v_exp_f32 v68, v52
    v_add_f32 v11, v11, v75
    v_cvt_pk_bf16_f32 v91, v74, v75
    v_exp_f32 v69, v53
    v_add_f32 v12, v10, v68
    v_exp_f32 v70, v54
    v_add_f32 v12, v12, v69
    v_cvt_pk_bf16_f32 v92, v68, v69
    v_exp_f32 v71, v55
    v_add_f32 v12, v12, v70
    v_exp_f32 v76, v60
    v_add_f32 v12, v12, v71
    v_cvt_pk_bf16_f32 v93, v70, v71
    v_exp_f32 v77, v61
    v_add_f32 v12, v12, v76
    v_exp_f32 v78, v62
    v_add_f32 v12, v12, v77
    v_cvt_pk_bf16_f32 v94, v76, v77
    v_exp_f32 v79, v63
    v_add_f32 v12, v12, v78
    v_add_f32 v13, v11, v12
    v_add_f32 v12, v12, v79
    v_cvt_pk_bf16_f32 v95, v78, v79
    s_nop 1
    s_branch L2_rare10_ret
sequential_preLN__compressed_kv_cla__glu_gated_bilinear__prompt_kernel_end:

.section .rodata,"a"
.p2align 6
.amdhsa_kernel sequential_preLN__compressed_kv_cla__glu_gated_bilinear__prompt_kernel
  .amdhsa_next_free_vgpr 512
  .amdhsa_next_free_sgpr 102
  .amdhsa_accum_offset 256
  .amdhsa_group_segment_fixed_size 0
  .amdhsa_kernarg_size 104
  .amdhsa_float_denorm_mode_32 3
  .amdhsa_user_sgpr_count 2
  .amdhsa_user_sgpr_kernarg_segment_ptr 1
  .amdhsa_system_sgpr_workgroup_id_x 1
.end_amdhsa_kernel
```
